```python
import torch

def _softmax(x, axis=-1):
    return torch.softmax(x, dim=axis)

def _gelu(x):
    return torch.nn.functional.gelu(x, approximate='tanh')

def _silu(x):
    return torch.nn.functional.silu(x)

def _sigmoid(x):
    return torch.sigmoid(x)

def _layernorm(x, axis=-1, eps=1e-05):
    m = x.mean(dim=axis, keepdim=True)
    v = x.var(dim=axis, keepdim=True, unbiased=False)
    return (x - m) / torch.sqrt(v + eps)

def _scatter_add(tgt, idx, src, axis=0):
    return tgt.clone().index_add_(axis, idx, src)

def _segment_sum(src, seg, n):
    out = torch.zeros((n,) + src.shape[1:], dtype=src.dtype)
    return out.index_add_(0, seg, src)

def _pad(x, pw):
    flat = tuple((v for pair in reversed(pw) for v in pair))
    return torch.nn.functional.pad(x, flat)
kernel_name = 'adaLN_cond__gqa_block_cached__moe_arch_mod__prompt'

def setup_inputs():

    _w = lambda a: (lambda t: t.to(torch.bfloat16) if t.is_floating_point() else t)(torch.as_tensor(a))

    def _A_setup():
        B, Sq, D = (1, 2048, 448)
        Hq, Hkv, Sk, Dh = (16, 8, 2048, 256)
        assert Hq % Hkv == 0, (Hq, Hkv)
        return {'x': _w((lambda *s: torch.randn(*s, dtype=torch.bfloat16) * 0.1)(B, Sq, D)), 'k_cache': _w((lambda *s: torch.randn(*s, dtype=torch.bfloat16) * 0.8)(B, Hkv, Sk, Dh)), 'v_cache': _w((lambda *s: torch.randn(*s, dtype=torch.bfloat16) * 1.6)(B, Hkv, Sk, Dh)), 'wq': _w((lambda *s: torch.randn(*s, dtype=torch.bfloat16) * 0.8)(D, Hq * Dh) * D ** (-0.5)), 'wo': _w((lambda *s: torch.randn(*s, dtype=torch.bfloat16) * 1.6)(Hq * Dh, D) * (Hq * Dh) ** (-0.5))}
    _A_in = _A_setup()

    def _B_setup():
        B, S, D, F, C = (1, 2048, 448, 1792, 8)
        return {'x': _w((lambda *s: torch.randn(*s, dtype=torch.bfloat16) * 0.1)(B, S, D)), 'w_r': _w((lambda *s: torch.randn(*s, dtype=torch.bfloat16) * 0.2)(D)), 'w_gate': _w((lambda *s: torch.randn(*s, dtype=torch.bfloat16) * 0.2)(D, F)), 'w_up': _w((lambda *s: torch.randn(*s, dtype=torch.bfloat16) * 0.2)(D, F)), 'w_down': _w((lambda *s: torch.randn(*s, dtype=torch.bfloat16) * 0.2)(F, D))}
    _B_in = _B_setup()
    return {'A_x': _A_in['x'], 'A_k_cache': _A_in['k_cache'], 'A_v_cache': _A_in['v_cache'], 'A_wq': _A_in['wq'], 'A_wo': _A_in['wo'], 'B_x': _B_in['x'], 'B_w_r': _B_in['w_r'], 'B_w_gate': _B_in['w_gate'], 'B_w_up': _B_in['w_up'], 'B_w_down': _B_in['w_down'], 'c': _w((lambda *s: torch.randn(*s, dtype=torch.bfloat16) * 0.2)(1, 448) * 8.0), 'w_mod': _w((lambda *s: torch.randn(*s, dtype=torch.bfloat16) * 0.2)(448, 6 * 448) * 448 ** (-0.5) * 8.0)}

def reference(A_x, A_k_cache, A_v_cache, A_wq, A_wo, B_x, B_w_r, B_w_gate, B_w_up, B_w_down, c, w_mod):

    def _A_ref(x, k_cache, v_cache, wq, wo):
        B, Sq, D = x.shape
        Hq, Dh = (16, 256)
        Hkv = k_cache.shape[1]
        rep = Hq // Hkv
        q = (lambda x, *d: x.permute(*d))((x @ wq).reshape(B, Sq, Hq, Dh), 0, 2, 1, 3)
        k = (lambda x, n, axis: torch.repeat_interleave(x, n, dim=axis))(k_cache, rep, axis=1)
        v = (lambda x, n, axis: torch.repeat_interleave(x, n, dim=axis))(v_cache, rep, axis=1)
        scores = torch.einsum('bhqd,bhkd->bhqk', q, k) * Dh ** (-0.5)
        p = _softmax(scores, axis=-1)
        o = torch.einsum('bhqk,bhkd->bhqd', p, v)
        return (lambda x, *d: x.permute(*d))(o, 0, 2, 1, 3).reshape(B, Sq, Hq * Dh) @ wo

    def _B_ref(x, w_r, w_gate, w_up, w_down):
        B, S, D = x.shape
        C = 8
        r = x @ w_r
        idx = torch.argsort(-r, axis=-1)[:, :C]
        idx_e = (lambda x, n, axis: torch.repeat_interleave(x, n, dim=axis))(idx.reshape(B, C, 1), D, axis=2)
        x_sel = (lambda x, i, axis: torch.take_along_dim(x, i, dim=axis))(x, idx_e, axis=1)
        g = _silu(x_sel @ w_gate)
        u = x_sel @ w_up
        y = g * u @ w_down
        r_sel = _sigmoid((lambda x, i, axis: torch.take_along_dim(x, i, dim=axis))(r, idx, axis=1))
        y = y * r_sel.reshape(B, C, 1)
        b_off = (torch.arange(B) * S).reshape(B, 1)
        flat_idx = (idx + b_off).reshape(B * C)
        zero = (x * 0.0).reshape(B * S, D)
        upd = _scatter_add(zero, flat_idx, y.reshape(B * C, D), axis=0)
        return x + upd.reshape(B, S, D)
    x = A_x
    mod = (_silu(c) @ w_mod).reshape(c.shape[0], 6, 1, -1)
    sa, ca, ga, sb, cb, gb = (mod[:, 0].clone(), mod[:, 1].clone(), mod[:, 2].clone(), mod[:, 3].clone(), mod[:, 4].clone(), mod[:, 5].clone())
    h = _layernorm(x, axis=-1) * (1 + ca) + sa
    x = x + ga * _A_ref(h, A_k_cache, A_v_cache, A_wq, A_wo)
    h = _layernorm(x, axis=-1) * (1 + cb) + sb
    x = x + gb * _B_ref(h, B_w_r, B_w_gate, B_w_up, B_w_down)
    return x
```

```asm
; @launch kernel=mod_kernel grid=(175,1,1) block=(256,1,1) lds=8192
; @launch kernel=attn_kernel grid=(256,1,1) block=(256,1,1) lds=163840
.amdgcn_target "amdgcn-amd-amdhsa--gfx950"
.text
.globl mod_kernel
.p2align 8
.type mod_kernel,@function
mod_kernel:
  s_cmp_ge_u32 s2, 175
  s_cbranch_scc1 K0_DONE
  s_cmp_ge_u32 s2, 16
  s_cbranch_scc1 K0_NOC
  s_getpc_b64 s[32:33]
K0_PC0:
  s_mov_b32 s34, K0_CODE_END - K0_PC0
  s_mov_b32 s35, 0x20000
  v_lshlrev_b32 v62, 7, v0
  buffer_load_dword v63, v62, s[32:35], 0 offen
K0_NOC:
  s_cmp_ge_u32 s2, 148
  s_cbranch_scc1 K0_WARM
  s_cmp_ge_u32 s2, 84
  s_cbranch_scc1 K0_STAT
  s_load_dwordx4 s[4:7], s[0:1], 80
  s_load_dwordx2 s[8:9], s[0:1], 112
  v_and_b32 v1, 3, v0
  v_lshrrev_b32 v2, 2, v0
  v_mul_u32_u24 v3, 14, v2
  v_mul_u32_u24 v4, 37632, v2
  v_lshl_add_u32 v4, v1, 4, v4
  s_lshl_b32 s3, s2, 6
  v_add_u32 v4, s3, v4
  s_waitcnt lgkmcnt(0)
  s_mov_b32 s12, s4
  s_mov_b32 s13, s5
  s_mov_b32 s14, 896
  s_mov_b32 s15, 0x20000
  s_mov_b32 s16, s6
  s_mov_b32 s17, s7
  s_mov_b32 s18, 2408448
  s_mov_b32 s19, 0x20000
  s_mov_b32 s20, s8
  s_mov_b32 s21, s9
  s_mov_b32 s22, 268435456
  s_mov_b32 s23, 0x20000
  buffer_load_ushort v8, v3, s[12:15], 0 offen offset:0
  buffer_load_ushort v9, v3, s[12:15], 0 offen offset:2
  buffer_load_ushort v10, v3, s[12:15], 0 offen offset:4
  buffer_load_ushort v11, v3, s[12:15], 0 offen offset:6
  buffer_load_ushort v12, v3, s[12:15], 0 offen offset:8
  buffer_load_ushort v13, v3, s[12:15], 0 offen offset:10
  buffer_load_ushort v14, v3, s[12:15], 0 offen offset:12
  s_mov_b32 s24, 0
  buffer_load_dwordx4 v[16:19], v4, s[16:19], s24 offen
  s_mov_b32 s24, 5376
  buffer_load_dwordx4 v[20:23], v4, s[16:19], s24 offen
  s_mov_b32 s24, 10752
  buffer_load_dwordx4 v[24:27], v4, s[16:19], s24 offen
  s_mov_b32 s24, 16128
  buffer_load_dwordx4 v[28:31], v4, s[16:19], s24 offen
  s_mov_b32 s24, 21504
  buffer_load_dwordx4 v[32:35], v4, s[16:19], s24 offen
  s_mov_b32 s24, 26880
  buffer_load_dwordx4 v[36:39], v4, s[16:19], s24 offen
  s_mov_b32 s24, 32256
  buffer_load_dwordx4 v[40:43], v4, s[16:19], s24 offen
  s_waitcnt vmcnt(7)
  v_lshlrev_b32 v8, 16, v8
  v_lshlrev_b32 v9, 16, v9
  v_lshlrev_b32 v10, 16, v10
  v_lshlrev_b32 v11, 16, v11
  v_lshlrev_b32 v12, 16, v12
  v_lshlrev_b32 v13, 16, v13
  v_lshlrev_b32 v14, 16, v14
  v_mul_f32 v56, 0xbfb8aa3b, v8
  v_mul_f32 v57, 0xbfb8aa3b, v9
  v_mul_f32 v58, 0xbfb8aa3b, v10
  v_mul_f32 v59, 0xbfb8aa3b, v11
  v_mul_f32 v60, 0xbfb8aa3b, v12
  v_mul_f32 v61, 0xbfb8aa3b, v13
  v_mul_f32 v62, 0xbfb8aa3b, v14
  v_exp_f32 v56, v56
  v_exp_f32 v57, v57
  v_exp_f32 v58, v58
  v_exp_f32 v59, v59
  v_exp_f32 v60, v60
  v_exp_f32 v61, v61
  v_exp_f32 v62, v62
  v_add_f32 v56, 1.0, v56
  v_add_f32 v57, 1.0, v57
  v_add_f32 v58, 1.0, v58
  v_add_f32 v59, 1.0, v59
  v_add_f32 v60, 1.0, v60
  v_add_f32 v61, 1.0, v61
  v_add_f32 v62, 1.0, v62
  v_rcp_f32 v56, v56
  v_rcp_f32 v57, v57
  v_rcp_f32 v58, v58
  v_rcp_f32 v59, v59
  v_rcp_f32 v60, v60
  v_rcp_f32 v61, v61
  v_rcp_f32 v62, v62
  v_mul_f32 v8, v8, v56
  v_mul_f32 v9, v9, v57
  v_mul_f32 v10, v10, v58
  v_mul_f32 v11, v11, v59
  v_mul_f32 v12, v12, v60
  v_mul_f32 v13, v13, v61
  v_mul_f32 v14, v14, v62
  v_cvt_pk_bf16_f32 v8, v8, v8
  v_cvt_pk_bf16_f32 v9, v9, v9
  v_cvt_pk_bf16_f32 v10, v10, v10
  v_cvt_pk_bf16_f32 v11, v11, v11
  v_cvt_pk_bf16_f32 v12, v12, v12
  v_cvt_pk_bf16_f32 v13, v13, v13
  v_cvt_pk_bf16_f32 v14, v14, v14
  v_lshlrev_b32 v8, 16, v8
  v_lshlrev_b32 v9, 16, v9
  v_lshlrev_b32 v10, 16, v10
  v_lshlrev_b32 v11, 16, v11
  v_lshlrev_b32 v12, 16, v12
  v_lshlrev_b32 v13, 16, v13
  v_lshlrev_b32 v14, 16, v14
  v_mov_b32 v48, 0
  v_mov_b32 v49, 0
  v_mov_b32 v50, 0
  v_mov_b32 v51, 0
  v_mov_b32 v52, 0
  v_mov_b32 v53, 0
  v_mov_b32 v54, 0
  v_mov_b32 v55, 0
  s_waitcnt vmcnt(6)
  v_lshlrev_b32 v5, 16, v16
  v_and_b32 v6, 0xffff0000, v16
  v_fmac_f32 v48, v8, v5
  v_fmac_f32 v49, v8, v6
  v_lshlrev_b32 v5, 16, v17
  v_and_b32 v6, 0xffff0000, v17
  v_fmac_f32 v50, v8, v5
  v_fmac_f32 v51, v8, v6
  v_lshlrev_b32 v5, 16, v18
  v_and_b32 v6, 0xffff0000, v18
  v_fmac_f32 v52, v8, v5
  v_fmac_f32 v53, v8, v6
  v_lshlrev_b32 v5, 16, v19
  v_and_b32 v6, 0xffff0000, v19
  v_fmac_f32 v54, v8, v5
  v_fmac_f32 v55, v8, v6
  s_waitcnt vmcnt(5)
  v_lshlrev_b32 v5, 16, v20
  v_and_b32 v6, 0xffff0000, v20
  v_fmac_f32 v48, v9, v5
  v_fmac_f32 v49, v9, v6
  v_lshlrev_b32 v5, 16, v21
  v_and_b32 v6, 0xffff0000, v21
  v_fmac_f32 v50, v9, v5
  v_fmac_f32 v51, v9, v6
  v_lshlrev_b32 v5, 16, v22
  v_and_b32 v6, 0xffff0000, v22
  v_fmac_f32 v52, v9, v5
  v_fmac_f32 v53, v9, v6
  v_lshlrev_b32 v5, 16, v23
  v_and_b32 v6, 0xffff0000, v23
  v_fmac_f32 v54, v9, v5
  v_fmac_f32 v55, v9, v6
  s_waitcnt vmcnt(4)
  v_lshlrev_b32 v5, 16, v24
  v_and_b32 v6, 0xffff0000, v24
  v_fmac_f32 v48, v10, v5
  v_fmac_f32 v49, v10, v6
  v_lshlrev_b32 v5, 16, v25
  v_and_b32 v6, 0xffff0000, v25
  v_fmac_f32 v50, v10, v5
  v_fmac_f32 v51, v10, v6
  v_lshlrev_b32 v5, 16, v26
  v_and_b32 v6, 0xffff0000, v26
  v_fmac_f32 v52, v10, v5
  v_fmac_f32 v53, v10, v6
  v_lshlrev_b32 v5, 16, v27
  v_and_b32 v6, 0xffff0000, v27
  v_fmac_f32 v54, v10, v5
  v_fmac_f32 v55, v10, v6
  s_waitcnt vmcnt(3)
  v_lshlrev_b32 v5, 16, v28
  v_and_b32 v6, 0xffff0000, v28
  v_fmac_f32 v48, v11, v5
  v_fmac_f32 v49, v11, v6
  v_lshlrev_b32 v5, 16, v29
  v_and_b32 v6, 0xffff0000, v29
  v_fmac_f32 v50, v11, v5
  v_fmac_f32 v51, v11, v6
  v_lshlrev_b32 v5, 16, v30
  v_and_b32 v6, 0xffff0000, v30
  v_fmac_f32 v52, v11, v5
  v_fmac_f32 v53, v11, v6
  v_lshlrev_b32 v5, 16, v31
  v_and_b32 v6, 0xffff0000, v31
  v_fmac_f32 v54, v11, v5
  v_fmac_f32 v55, v11, v6
  s_waitcnt vmcnt(2)
  v_lshlrev_b32 v5, 16, v32
  v_and_b32 v6, 0xffff0000, v32
  v_fmac_f32 v48, v12, v5
  v_fmac_f32 v49, v12, v6
  v_lshlrev_b32 v5, 16, v33
  v_and_b32 v6, 0xffff0000, v33
  v_fmac_f32 v50, v12, v5
  v_fmac_f32 v51, v12, v6
  v_lshlrev_b32 v5, 16, v34
  v_and_b32 v6, 0xffff0000, v34
  v_fmac_f32 v52, v12, v5
  v_fmac_f32 v53, v12, v6
  v_lshlrev_b32 v5, 16, v35
  v_and_b32 v6, 0xffff0000, v35
  v_fmac_f32 v54, v12, v5
  v_fmac_f32 v55, v12, v6
  s_waitcnt vmcnt(1)
  v_lshlrev_b32 v5, 16, v36
  v_and_b32 v6, 0xffff0000, v36
  v_fmac_f32 v48, v13, v5
  v_fmac_f32 v49, v13, v6
  v_lshlrev_b32 v5, 16, v37
  v_and_b32 v6, 0xffff0000, v37
  v_fmac_f32 v50, v13, v5
  v_fmac_f32 v51, v13, v6
  v_lshlrev_b32 v5, 16, v38
  v_and_b32 v6, 0xffff0000, v38
  v_fmac_f32 v52, v13, v5
  v_fmac_f32 v53, v13, v6
  v_lshlrev_b32 v5, 16, v39
  v_and_b32 v6, 0xffff0000, v39
  v_fmac_f32 v54, v13, v5
  v_fmac_f32 v55, v13, v6
  s_waitcnt vmcnt(0)
  v_lshlrev_b32 v5, 16, v40
  v_and_b32 v6, 0xffff0000, v40
  v_fmac_f32 v48, v14, v5
  v_fmac_f32 v49, v14, v6
  v_lshlrev_b32 v5, 16, v41
  v_and_b32 v6, 0xffff0000, v41
  v_fmac_f32 v50, v14, v5
  v_fmac_f32 v51, v14, v6
  v_lshlrev_b32 v5, 16, v42
  v_and_b32 v6, 0xffff0000, v42
  v_fmac_f32 v52, v14, v5
  v_fmac_f32 v53, v14, v6
  v_lshlrev_b32 v5, 16, v43
  v_and_b32 v6, 0xffff0000, v43
  v_fmac_f32 v54, v14, v5
  v_fmac_f32 v55, v14, v6
  s_nop 1
  v_add_f32_dpp v48, v48, v48 row_ror:4 row_mask:0xf bank_mask:0xf
  v_add_f32_dpp v49, v49, v49 row_ror:4 row_mask:0xf bank_mask:0xf
  v_add_f32_dpp v50, v50, v50 row_ror:4 row_mask:0xf bank_mask:0xf
  v_add_f32_dpp v51, v51, v51 row_ror:4 row_mask:0xf bank_mask:0xf
  v_add_f32_dpp v52, v52, v52 row_ror:4 row_mask:0xf bank_mask:0xf
  v_add_f32_dpp v53, v53, v53 row_ror:4 row_mask:0xf bank_mask:0xf
  v_add_f32_dpp v54, v54, v54 row_ror:4 row_mask:0xf bank_mask:0xf
  v_add_f32_dpp v55, v55, v55 row_ror:4 row_mask:0xf bank_mask:0xf
  s_nop 1
  v_add_f32_dpp v48, v48, v48 row_ror:8 row_mask:0xf bank_mask:0xf
  v_add_f32_dpp v49, v49, v49 row_ror:8 row_mask:0xf bank_mask:0xf
  v_add_f32_dpp v50, v50, v50 row_ror:8 row_mask:0xf bank_mask:0xf
  v_add_f32_dpp v51, v51, v51 row_ror:8 row_mask:0xf bank_mask:0xf
  v_add_f32_dpp v52, v52, v52 row_ror:8 row_mask:0xf bank_mask:0xf
  v_add_f32_dpp v53, v53, v53 row_ror:8 row_mask:0xf bank_mask:0xf
  v_add_f32_dpp v54, v54, v54 row_ror:8 row_mask:0xf bank_mask:0xf
  v_add_f32_dpp v55, v55, v55 row_ror:8 row_mask:0xf bank_mask:0xf
  v_lshrrev_b32 v7, 4, v0
  v_lshlrev_b32 v7, 7, v7
  v_lshl_add_u32 v7, v1, 5, v7
  v_and_b32 v5, 12, v0
  v_cmp_eq_u32 vcc, 0, v5
  s_and_saveexec_b64 s[26:27], vcc
  ds_write_b128 v7, v[48:51]
  ds_write_b128 v7, v[52:55] offset:16
  s_mov_b64 exec, s[26:27]
  s_waitcnt lgkmcnt(0)
  s_barrier
  v_cmp_gt_u32 vcc, 32, v0
  s_and_saveexec_b64 s[26:27], vcc
  s_cbranch_execz K0_DONE
  v_lshlrev_b32 v7, 2, v0
  ds_read_b32 v16, v7 offset:0
  ds_read_b32 v17, v7 offset:128
  ds_read_b32 v18, v7 offset:256
  ds_read_b32 v19, v7 offset:384
  ds_read_b32 v20, v7 offset:512
  ds_read_b32 v21, v7 offset:640
  ds_read_b32 v22, v7 offset:768
  ds_read_b32 v23, v7 offset:896
  ds_read_b32 v24, v7 offset:1024
  ds_read_b32 v25, v7 offset:1152
  ds_read_b32 v26, v7 offset:1280
  ds_read_b32 v27, v7 offset:1408
  ds_read_b32 v28, v7 offset:1536
  ds_read_b32 v29, v7 offset:1664
  ds_read_b32 v30, v7 offset:1792
  s_waitcnt lgkmcnt(7)
  ds_read_b32 v31, v7 offset:1920
  v_add_f32 v16, v16, v17
  v_add_f32 v18, v18, v19
  v_add_f32 v20, v20, v21
  v_add_f32 v22, v22, v23
  v_add_f32 v16, v16, v18
  v_add_f32 v20, v20, v22
  s_waitcnt lgkmcnt(0)
  v_add_f32 v24, v24, v25
  v_add_f32 v26, v26, v27
  v_add_f32 v28, v28, v29
  v_add_f32 v30, v30, v31
  v_add_f32 v16, v16, v20
  v_add_f32 v24, v24, v26
  v_add_f32 v28, v28, v30
  v_add_f32 v24, v24, v28
  v_add_f32 v8, v16, v24
  v_cvt_pk_bf16_f32 v8, v8, v8
  v_lshlrev_b32 v8, 16, v8
  s_mul_i32 s24, s2, 4682
  s_lshr_b32 s24, s24, 16
  s_mul_i32 s25, s24, 14
  s_sub_u32 s25, s2, s25
  s_lshl_b32 s25, s25, 5
  v_add_u32 v9, s25, v0
  v_add_f32 v10, 1.0, v8
  v_cvt_pk_bf16_f32 v10, v10, v10
  v_lshlrev_b32 v10, 16, v10
  s_mov_b32 s28, 0x3db8aa3b
  s_cmp_eq_u32 s24, 0
  s_cbranch_scc1 K0_S0
  s_cmp_eq_u32 s24, 1
  s_cbranch_scc1 K0_S1
  s_cmp_eq_u32 s24, 4
  s_cbranch_scc0 K0_NB
  v_mov_b32 v8, v10
K0_NB:
  v_lshrrev_b32 v8, 16, v8
  s_mov_b32 s29, 4096
  s_cmp_eq_u32 s24, 3
  s_cselect_b32 s29, 6144, s29
  s_cmp_eq_u32 s24, 4
  s_cselect_b32 s29, 5120, s29
  s_cmp_eq_u32 s24, 5
  s_cselect_b32 s29, 7168, s29
  v_lshlrev_b32 v9, 1, v9
  buffer_store_short v8, v9, s[20:23], s29 offen
  s_branch K0_END
K0_S0:
  v_mul_f32 v8, s28, v8
  v_lshlrev_b32 v9, 2, v9
  buffer_store_dword v8, v9, s[20:23], 0 offen offset:1792
  s_branch K0_END
K0_S1:
  v_mul_f32 v8, s28, v10
  v_lshlrev_b32 v9, 2, v9
  buffer_store_dword v8, v9, s[20:23], 0 offen offset:0
K0_END:
  s_waitcnt vmcnt(0)
K0_DONE:
  s_endpgm
K0_WARM:
  s_load_dwordx2 s[4:5], s[0:1], 24
  s_sub_u32 s3, s2, 148
  s_lshl_b32 s3, s3, 15
  v_lshlrev_b32 v1, 7, v0
  s_waitcnt lgkmcnt(0)
  s_mov_b32 s8, s4
  s_mov_b32 s9, s5
  s_mov_b32 s10, 3670016
  s_mov_b32 s11, 0x20000
  s_cmp_lt_u32 s2, 151
  s_cbranch_scc1 K0_NKV
  s_cmp_ge_u32 s2, 175
  s_cbranch_scc1 K0_NKV
  s_load_dwordx4 s[16:19], s[0:1], 8
  s_sub_u32 s20, s2, 151
  s_mul_i32 s21, s20, 43
  s_lshr_b32 s21, s21, 7
  s_mul_i32 s22, s21, 3
  s_sub_u32 s22, s20, s22
  s_lshl_b32 s21, s21, 20
  s_waitcnt lgkmcnt(0)
  s_cmp_eq_u32 s22, 2
  s_cselect_b32 s24, s18, s16
  s_cselect_b32 s25, s19, s17
  s_mov_b32 s26, 0x800000
  s_mov_b32 s27, 0x20000
  s_cmp_eq_u32 s22, 1
  s_cselect_b32 s23, 0x80000, 0
  s_add_u32 s21, s21, s23
  v_lshlrev_b32 v4, 7, v0
  s_cmp_eq_u32 s22, 2
  s_cbranch_scc0 K0_KV1
  v_lshrrev_b32 v5, 7, v0
  v_and_b32 v4, 127, v0
  v_lshlrev_b32 v4, 7, v4
  v_lshl_add_u32 v4, v5, 19, v4
K0_KV1:
  buffer_load_dword v5, v4, s[24:27], s21 offen
K0_NKV:
  s_cmp_ge_u32 s2, 151
  s_cbranch_scc1 K0_WE
  s_getpc_b64 s[12:13]
K0_PC:
  s_mov_b32 s14, ALL_END - K0_PC
  s_mov_b32 s15, 0x20000
  buffer_load_dword v3, v1, s[12:15], s3 offen
K0_WE:
  s_endpgm
K0_STAT:
  s_load_dwordx2 s[4:5], s[0:1], 0
  s_load_dwordx2 s[6:7], s[0:1], 112
  v_lshrrev_b32 v1, 3, v0
  s_sub_u32 s3, s2, 84
  s_lshl_b32 s3, s3, 5
  v_add_u32 v1, s3, v1
  v_and_b32 v2, 7, v0
  v_mul_u32_u24 v3, 896, v1
  v_lshl_add_u32 v3, v2, 4, v3
  s_waitcnt lgkmcnt(0)
  s_mov_b32 s8, s4
  s_mov_b32 s9, s5
  s_mov_b32 s10, 1835008
  s_mov_b32 s11, 0x20000
  s_mov_b32 s12, s6
  s_mov_b32 s13, s7
  s_mov_b32 s14, 33554432
  s_mov_b32 s15, 0x20000
  buffer_load_dwordx4 v[8:11], v3, s[8:11], 0 offen offset:0
  buffer_load_dwordx4 v[12:15], v3, s[8:11], 0 offen offset:128
  buffer_load_dwordx4 v[16:19], v3, s[8:11], 0 offen offset:256
  buffer_load_dwordx4 v[20:23], v3, s[8:11], 0 offen offset:384
  buffer_load_dwordx4 v[24:27], v3, s[8:11], 0 offen offset:512
  buffer_load_dwordx4 v[28:31], v3, s[8:11], 0 offen offset:640
  buffer_load_dwordx4 v[32:35], v3, s[8:11], 0 offen offset:768
  s_cmp_lg_u32 s2, 84
  s_cbranch_scc1 K0_NZ
  v_lshrrev_b32 v4, 3, v0
  v_lshlrev_b32 v4, 7, v4
  v_and_b32 v5, 7, v0
  v_lshl_add_u32 v4, v5, 2, v4
  v_mov_b32 v5, 0
  s_mov_b32 s16, 98304
  buffer_store_dword v5, v4, s[12:15], s16 offen
K0_NZ:
  s_cmp_lg_u32 s2, 85
  s_cbranch_scc1 K0_NF
  v_lshlrev_b32 v4, 4, v0
  v_mov_b32 v92, -1
  v_mov_b32 v93, -1
  v_mov_b32 v94, -1
  v_mov_b32 v95, -1
  s_mov_b32 s16, 20480
  buffer_store_dwordx4 v[92:95], v4, s[12:15], s16 offen
  s_mov_b32 s16, 24576
  buffer_store_dwordx4 v[92:95], v4, s[12:15], s16 offen
  s_mov_b32 s16, 28672
  buffer_store_dwordx4 v[92:95], v4, s[12:15], s16 offen
  s_mov_b32 s16, 32768
  buffer_store_dwordx4 v[92:95], v4, s[12:15], s16 offen
  s_mov_b32 s16, 36864
  buffer_store_dwordx4 v[92:95], v4, s[12:15], s16 offen
  s_mov_b32 s16, 40960
  buffer_store_dwordx4 v[92:95], v4, s[12:15], s16 offen
  s_mov_b32 s16, 45056
  buffer_store_dwordx4 v[92:95], v4, s[12:15], s16 offen
K0_NF:
  s_cmp_lt_u32 s2, 86
  s_cbranch_scc1 K0_NR
  s_cmp_ge_u32 s2, 102
  s_cbranch_scc1 K0_NR
  v_lshlrev_b32 v4, 4, v0
  v_mov_b32 v92, -1
  v_mov_b32 v93, -1
  v_mov_b32 v94, -1
  v_mov_b32 v95, -1
  s_sub_u32 s16, s2, 86
  s_lshl_b32 s16, s16, 12
  s_add_u32 s16, s16, 131072
  buffer_store_dwordx4 v[92:95], v4, s[12:15], s16 offen
K0_NR:
  s_waitcnt vmcnt(0)
  v_lshlrev_b32 v40, 16, v8
  v_and_b32 v41, 0xffff0000, v8
  v_lshlrev_b32 v42, 16, v9
  v_and_b32 v43, 0xffff0000, v9
  v_lshlrev_b32 v44, 16, v10
  v_and_b32 v45, 0xffff0000, v10
  v_lshlrev_b32 v46, 16, v11
  v_and_b32 v47, 0xffff0000, v11
  v_lshlrev_b32 v48, 16, v12
  v_and_b32 v49, 0xffff0000, v12
  v_lshlrev_b32 v50, 16, v13
  v_and_b32 v51, 0xffff0000, v13
  v_lshlrev_b32 v52, 16, v14
  v_and_b32 v53, 0xffff0000, v14
  v_lshlrev_b32 v54, 16, v15
  v_and_b32 v55, 0xffff0000, v15
  v_lshlrev_b32 v56, 16, v16
  v_and_b32 v57, 0xffff0000, v16
  v_lshlrev_b32 v58, 16, v17
  v_and_b32 v59, 0xffff0000, v17
  v_lshlrev_b32 v60, 16, v18
  v_and_b32 v61, 0xffff0000, v18
  v_lshlrev_b32 v62, 16, v19
  v_and_b32 v63, 0xffff0000, v19
  v_lshlrev_b32 v64, 16, v20
  v_and_b32 v65, 0xffff0000, v20
  v_lshlrev_b32 v66, 16, v21
  v_and_b32 v67, 0xffff0000, v21
  v_lshlrev_b32 v68, 16, v22
  v_and_b32 v69, 0xffff0000, v22
  v_lshlrev_b32 v70, 16, v23
  v_and_b32 v71, 0xffff0000, v23
  v_lshlrev_b32 v72, 16, v24
  v_and_b32 v73, 0xffff0000, v24
  v_lshlrev_b32 v74, 16, v25
  v_and_b32 v75, 0xffff0000, v25
  v_lshlrev_b32 v76, 16, v26
  v_and_b32 v77, 0xffff0000, v26
  v_lshlrev_b32 v78, 16, v27
  v_and_b32 v79, 0xffff0000, v27
  v_lshlrev_b32 v80, 16, v28
  v_and_b32 v81, 0xffff0000, v28
  v_lshlrev_b32 v82, 16, v29
  v_and_b32 v83, 0xffff0000, v29
  v_lshlrev_b32 v84, 16, v30
  v_and_b32 v85, 0xffff0000, v30
  v_lshlrev_b32 v86, 16, v31
  v_and_b32 v87, 0xffff0000, v31
  v_lshlrev_b32 v88, 16, v32
  v_and_b32 v89, 0xffff0000, v32
  v_lshlrev_b32 v90, 16, v33
  v_and_b32 v91, 0xffff0000, v33
  v_lshlrev_b32 v92, 16, v34
  v_and_b32 v93, 0xffff0000, v34
  v_lshlrev_b32 v94, 16, v35
  v_and_b32 v95, 0xffff0000, v35
  v_pk_add_f32 v[4:5], v[40:41], v[42:43]
  v_pk_add_f32 v[4:5], v[4:5], v[44:45]
  v_pk_add_f32 v[4:5], v[4:5], v[46:47]
  v_pk_add_f32 v[4:5], v[4:5], v[48:49]
  v_pk_add_f32 v[4:5], v[4:5], v[50:51]
  v_pk_add_f32 v[4:5], v[4:5], v[52:53]
  v_pk_add_f32 v[4:5], v[4:5], v[54:55]
  v_pk_add_f32 v[4:5], v[4:5], v[56:57]
  v_pk_add_f32 v[4:5], v[4:5], v[58:59]
  v_pk_add_f32 v[4:5], v[4:5], v[60:61]
  v_pk_add_f32 v[4:5], v[4:5], v[62:63]
  v_pk_add_f32 v[4:5], v[4:5], v[64:65]
  v_pk_add_f32 v[4:5], v[4:5], v[66:67]
  v_pk_add_f32 v[4:5], v[4:5], v[68:69]
  v_pk_add_f32 v[4:5], v[4:5], v[70:71]
  v_pk_add_f32 v[4:5], v[4:5], v[72:73]
  v_pk_add_f32 v[4:5], v[4:5], v[74:75]
  v_pk_add_f32 v[4:5], v[4:5], v[76:77]
  v_pk_add_f32 v[4:5], v[4:5], v[78:79]
  v_pk_add_f32 v[4:5], v[4:5], v[80:81]
  v_pk_add_f32 v[4:5], v[4:5], v[82:83]
  v_pk_add_f32 v[4:5], v[4:5], v[84:85]
  v_pk_add_f32 v[4:5], v[4:5], v[86:87]
  v_pk_add_f32 v[4:5], v[4:5], v[88:89]
  v_pk_add_f32 v[4:5], v[4:5], v[90:91]
  v_pk_add_f32 v[4:5], v[4:5], v[92:93]
  v_pk_add_f32 v[4:5], v[4:5], v[94:95]
  v_add_f32 v4, v4, v5
  s_nop 1
  v_add_f32_dpp v4, v4, v4 quad_perm:[1,0,3,2] row_mask:0xf bank_mask:0xf
  s_nop 1
  v_add_f32_dpp v4, v4, v4 quad_perm:[2,3,0,1] row_mask:0xf bank_mask:0xf
  s_nop 1
  v_add_f32_dpp v4, v4, v4 row_half_mirror row_mask:0xf bank_mask:0xf
  v_mul_f32 v4, 0xbb124925, v4
  v_pk_add_f32 v[40:41], v[40:41], v[4:5] op_sel_hi:[1,0]
  v_pk_add_f32 v[42:43], v[42:43], v[4:5] op_sel_hi:[1,0]
  v_pk_add_f32 v[44:45], v[44:45], v[4:5] op_sel_hi:[1,0]
  v_pk_add_f32 v[46:47], v[46:47], v[4:5] op_sel_hi:[1,0]
  v_pk_add_f32 v[48:49], v[48:49], v[4:5] op_sel_hi:[1,0]
  v_pk_add_f32 v[50:51], v[50:51], v[4:5] op_sel_hi:[1,0]
  v_pk_add_f32 v[52:53], v[52:53], v[4:5] op_sel_hi:[1,0]
  v_pk_add_f32 v[54:55], v[54:55], v[4:5] op_sel_hi:[1,0]
  v_pk_add_f32 v[56:57], v[56:57], v[4:5] op_sel_hi:[1,0]
  v_pk_add_f32 v[58:59], v[58:59], v[4:5] op_sel_hi:[1,0]
  v_pk_add_f32 v[60:61], v[60:61], v[4:5] op_sel_hi:[1,0]
  v_pk_add_f32 v[62:63], v[62:63], v[4:5] op_sel_hi:[1,0]
  v_pk_add_f32 v[64:65], v[64:65], v[4:5] op_sel_hi:[1,0]
  v_pk_add_f32 v[66:67], v[66:67], v[4:5] op_sel_hi:[1,0]
  v_pk_add_f32 v[68:69], v[68:69], v[4:5] op_sel_hi:[1,0]
  v_pk_add_f32 v[70:71], v[70:71], v[4:5] op_sel_hi:[1,0]
  v_pk_add_f32 v[72:73], v[72:73], v[4:5] op_sel_hi:[1,0]
  v_pk_add_f32 v[74:75], v[74:75], v[4:5] op_sel_hi:[1,0]
  v_pk_add_f32 v[76:77], v[76:77], v[4:5] op_sel_hi:[1,0]
  v_pk_add_f32 v[78:79], v[78:79], v[4:5] op_sel_hi:[1,0]
  v_pk_add_f32 v[80:81], v[80:81], v[4:5] op_sel_hi:[1,0]
  v_pk_add_f32 v[82:83], v[82:83], v[4:5] op_sel_hi:[1,0]
  v_pk_add_f32 v[84:85], v[84:85], v[4:5] op_sel_hi:[1,0]
  v_pk_add_f32 v[86:87], v[86:87], v[4:5] op_sel_hi:[1,0]
  v_pk_add_f32 v[88:89], v[88:89], v[4:5] op_sel_hi:[1,0]
  v_pk_add_f32 v[90:91], v[90:91], v[4:5] op_sel_hi:[1,0]
  v_pk_add_f32 v[92:93], v[92:93], v[4:5] op_sel_hi:[1,0]
  v_pk_add_f32 v[94:95], v[94:95], v[4:5] op_sel_hi:[1,0]
  v_pk_mul_f32 v[6:7], v[40:41], v[40:41]
  v_pk_fma_f32 v[6:7], v[42:43], v[42:43], v[6:7]
  v_pk_fma_f32 v[6:7], v[44:45], v[44:45], v[6:7]
  v_pk_fma_f32 v[6:7], v[46:47], v[46:47], v[6:7]
  v_pk_fma_f32 v[6:7], v[48:49], v[48:49], v[6:7]
  v_pk_fma_f32 v[6:7], v[50:51], v[50:51], v[6:7]
  v_pk_fma_f32 v[6:7], v[52:53], v[52:53], v[6:7]
  v_pk_fma_f32 v[6:7], v[54:55], v[54:55], v[6:7]
  v_pk_fma_f32 v[6:7], v[56:57], v[56:57], v[6:7]
  v_pk_fma_f32 v[6:7], v[58:59], v[58:59], v[6:7]
  v_pk_fma_f32 v[6:7], v[60:61], v[60:61], v[6:7]
  v_pk_fma_f32 v[6:7], v[62:63], v[62:63], v[6:7]
  v_pk_fma_f32 v[6:7], v[64:65], v[64:65], v[6:7]
  v_pk_fma_f32 v[6:7], v[66:67], v[66:67], v[6:7]
  v_pk_fma_f32 v[6:7], v[68:69], v[68:69], v[6:7]
  v_pk_fma_f32 v[6:7], v[70:71], v[70:71], v[6:7]
  v_pk_fma_f32 v[6:7], v[72:73], v[72:73], v[6:7]
  v_pk_fma_f32 v[6:7], v[74:75], v[74:75], v[6:7]
  v_pk_fma_f32 v[6:7], v[76:77], v[76:77], v[6:7]
  v_pk_fma_f32 v[6:7], v[78:79], v[78:79], v[6:7]
  v_pk_fma_f32 v[6:7], v[80:81], v[80:81], v[6:7]
  v_pk_fma_f32 v[6:7], v[82:83], v[82:83], v[6:7]
  v_pk_fma_f32 v[6:7], v[84:85], v[84:85], v[6:7]
  v_pk_fma_f32 v[6:7], v[86:87], v[86:87], v[6:7]
  v_pk_fma_f32 v[6:7], v[88:89], v[88:89], v[6:7]
  v_pk_fma_f32 v[6:7], v[90:91], v[90:91], v[6:7]
  v_pk_fma_f32 v[6:7], v[92:93], v[92:93], v[6:7]
  v_pk_fma_f32 v[6:7], v[94:95], v[94:95], v[6:7]
  v_add_f32 v6, v6, v7
  s_nop 1
  v_add_f32_dpp v6, v6, v6 quad_perm:[1,0,3,2] row_mask:0xf bank_mask:0xf
  s_nop 1
  v_add_f32_dpp v6, v6, v6 quad_perm:[2,3,0,1] row_mask:0xf bank_mask:0xf
  s_nop 1
  v_add_f32_dpp v6, v6, v6 row_half_mirror row_mask:0xf bank_mask:0xf
  v_mul_f32 v6, 0x3b124925, v6
  v_add_f32 v6, 0x3727c5ac, v6
  v_rsq_f32 v6, v6
  s_nop 0
  v_mul_f32 v7, v4, v6
  v_lshlrev_b32 v1, 3, v1
  s_mov_b32 s16, 65536
  v_cmp_eq_u32 vcc, 0, v2
  s_and_saveexec_b64 s[18:19], vcc
  buffer_store_dwordx2 v[6:7], v1, s[12:15], s16 offen
  s_endpgm
K0_CODE_END:
.globl attn_kernel
.p2align 8
.type attn_kernel,@function
attn_kernel:
  s_cmp_ge_u32 s2, 256
  s_cbranch_scc1 K1_DONE
  s_lshr_b32 s37, s2, 3
  s_cmp_gt_u32 s37, 9
  s_cbranch_scc1 K1_NCW
  s_getpc_b64 s[92:93]
K1_PC:
  s_mov_b32 s94, K1_END - K1_PC
  s_mov_b32 s95, 0x20000
  s_lshl_b32 s36, s37, 13
  v_subrev_u32 v9, 192, v0
  v_lshlrev_b32 v9, 7, v9
  buffer_load_dword v253, v9, s[92:95], s36 offen
K1_NCW:
  s_load_dwordx2 s[44:45], s[0:1], 0
  s_load_dwordx4 s[48:51], s[0:1], 8
  s_load_dwordx4 s[52:55], s[0:1], 24
  s_load_dwordx2 s[56:57], s[0:1], 112
  s_load_dwordx4 s[60:63], s[0:1], 56
  s_load_dwordx2 s[64:65], s[0:1], 72
  s_load_dwordx2 s[66:67], s[0:1], 96
  s_load_dwordx2 s[58:59], s[0:1], 48
  v_lshrrev_b32 v1, 6, v0
  s_nop 0
  v_readfirstlane_b32 s22, v1
  v_and_b32 v0, 63, v0
  s_and_b32 s32, s22, 1
  s_lshr_b32 s33, s22, 1
  s_and_b32 s34, s2, 7
  s_lshr_b32 s35, s2, 3
  s_waitcnt lgkmcnt(0)
  s_mov_b32 s12, s44
  s_mov_b32 s13, s45
  s_mov_b32 s14, 1835008
  s_mov_b32 s15, 0x20000
  s_mov_b32 s16, s56
  s_mov_b32 s17, s57
  s_mov_b32 s18, 33554432
  s_mov_b32 s19, 0x20000
  s_lshl_b32 s36, s34, 10
  s_add_u32 s68, s52, s36
  s_addc_u32 s69, s53, 0
  s_sub_u32 s70, 3670016, s36
  s_mov_b32 s71, 0x20000
  v_and_b32 v1, 15, v0
  v_lshrrev_b32 v2, 4, v0
  s_lshl_b32 s36, s35, 6
  s_lshl_b32 s37, s22, 4
  s_add_u32 s36, s36, s37
  v_add_u32 v3, s36, v1
  v_lshlrev_b32 v9, 3, v3
  s_mov_b32 s37, 65536
  buffer_load_dwordx2 v[14:15], v9, s[16:19], s37 offen
  v_lshlrev_b32 v8, 4, v0
  s_lshl_b32 s36, s22, 10
  s_add_u32 m0, s36, 160256
  s_cmp_eq_u32 s22, 3
  s_cselect_b32 exec_hi, 0, -1
  buffer_load_dwordx4 v8, s[16:19], s36 offen lds
  s_mov_b32 exec_hi, -1
  v_mul_u32_u24 v3, 896, v3
  v_lshl_add_u32 v3, v2, 4, v3
  buffer_load_dwordx4 v[128:131], v3, s[12:15], 0 offen offset:0
  buffer_load_dwordx4 v[132:135], v3, s[12:15], 0 offen offset:64
  buffer_load_dwordx4 v[136:139], v3, s[12:15], 0 offen offset:128
  buffer_load_dwordx4 v[140:143], v3, s[12:15], 0 offen offset:192
  buffer_load_dwordx4 v[144:147], v3, s[12:15], 0 offen offset:256
  buffer_load_dwordx4 v[148:151], v3, s[12:15], 0 offen offset:320
  buffer_load_dwordx4 v[152:155], v3, s[12:15], 0 offen offset:384
  buffer_load_dwordx4 v[156:159], v3, s[12:15], 0 offen offset:448
  buffer_load_dwordx4 v[160:163], v3, s[12:15], 0 offen offset:512
  buffer_load_dwordx4 v[164:167], v3, s[12:15], 0 offen offset:576
  buffer_load_dwordx4 v[168:171], v3, s[12:15], 0 offen offset:640
  buffer_load_dwordx4 v[172:175], v3, s[12:15], 0 offen offset:704
  buffer_load_dwordx4 v[176:179], v3, s[12:15], 0 offen offset:768
  buffer_load_dwordx4 v[180:183], v3, s[12:15], 0 offen offset:832
  s_lshl_b32 s36, s22, 5
  v_and_b32 v9, 31, v0
  v_add_u32 v9, s36, v9
  v_lshrrev_b32 v10, 3, v9
  s_mul_i32 s36, s35, 14
  v_add_u32 v10, s36, v10
  v_lshlrev_b32 v10, 13, v10
  v_and_b32 v9, 7, v9
  v_lshl_add_u32 v9, v9, 7, v10
  buffer_load_dword v250, v9, s[68:71], 0 offen
  s_lshl_b32 s36, s32, 3
  v_xor_b32 v1, s36, v0
  v_lshlrev_b32 v1, 4, v1
  s_lshl_b32 s36, s22, 16
  v_add_u32 v1, s36, v1
  v_add_u32 v4, 0, v1
  v_add_u32 v5, 7136, v1
  v_add_u32 v6, 14272, v1
  v_add_u32 v7, 21408, v1
  s_mul_i32 s42, s22, 8448
  s_mov_b32 s40, 0
  s_mov_b32 s41, 32768
  s_lshl_b32 s36, s34, 20
  s_add_u32 s4, s48, s36
  s_addc_u32 s5, s49, 0
  s_sub_u32 s4, s4, 128
  s_subb_u32 s5, s5, 0
  s_mov_b32 s6, 1048704
  s_mov_b32 s7, 0x20000
  s_add_u32 s8, s50, s36
  s_addc_u32 s9, s51, 0
  s_sub_u32 s8, s8, 256
  s_subb_u32 s9, s9, 0
  s_mov_b32 s10, 1048832
  s_mov_b32 s11, 0x20000
  s_waitcnt vmcnt(15)
  s_barrier
  v_lshrrev_b32 v2, 4, v0
  v_lshlrev_b32 v2, 5, v2
  v_add_u32 v2, 160256, v2
  v_lshlrev_b32 v1, 4, v0
  s_lshl_b32 s36, s22, 10
  s_add_u32 s36, s36, 102912
  v_add_u32 v1, s36, v1
  ds_read_b128 v[184:187], v2 offset:0
  ds_read_b128 v[192:195], v2 offset:1792
  ds_read_b128 v[188:191], v2 offset:16
  ds_read_b128 v[196:199], v2 offset:1808
  ds_read_b128 v[200:203], v2 offset:128
  ds_read_b128 v[208:211], v2 offset:1920
  ds_read_b128 v[204:207], v2 offset:144
  ds_read_b128 v[212:215], v2 offset:1936
  v_mov_b32 v12, v15
  ds_read_b128 v[216:219], v2 offset:256
  ds_read_b128 v[224:227], v2 offset:2048
  ds_read_b128 v[220:223], v2 offset:272
  ds_read_b128 v[228:231], v2 offset:2064
  s_waitcnt vmcnt(14)
  v_lshlrev_b32 v16, 16, v128
  v_and_b32 v17, 0xffff0000, v128
  v_lshlrev_b32 v18, 16, v129
  v_and_b32 v19, 0xffff0000, v129
  v_lshlrev_b32 v20, 16, v130
  v_and_b32 v21, 0xffff0000, v130
  v_lshlrev_b32 v22, 16, v131
  v_and_b32 v23, 0xffff0000, v131
  v_pk_fma_f32 v[16:17], v[16:17], v[14:15], v[12:13] op_sel_hi:[1,0,0]
  v_pk_fma_f32 v[18:19], v[18:19], v[14:15], v[12:13] op_sel_hi:[1,0,0]
  v_pk_fma_f32 v[20:21], v[20:21], v[14:15], v[12:13] op_sel_hi:[1,0,0]
  v_pk_fma_f32 v[22:23], v[22:23], v[14:15], v[12:13] op_sel_hi:[1,0,0]
  s_waitcnt lgkmcnt(8)
  v_pk_fma_f32 v[16:17], v[16:17], v[184:185], v[192:193]
  v_pk_fma_f32 v[18:19], v[18:19], v[186:187], v[194:195]
  v_pk_fma_f32 v[20:21], v[20:21], v[188:189], v[196:197]
  v_pk_fma_f32 v[22:23], v[22:23], v[190:191], v[198:199]
  v_cvt_pk_bf16_f32 v128, v16, v17
  v_cvt_pk_bf16_f32 v129, v18, v19
  v_cvt_pk_bf16_f32 v130, v20, v21
  v_cvt_pk_bf16_f32 v131, v22, v23
  ds_write_b128 v1, v[128:131] offset:0
  ds_read_b128 v[184:187], v2 offset:384
  ds_read_b128 v[192:195], v2 offset:2176
  ds_read_b128 v[188:191], v2 offset:400
  ds_read_b128 v[196:199], v2 offset:2192
  s_waitcnt vmcnt(13)
  v_lshlrev_b32 v24, 16, v132
  v_and_b32 v25, 0xffff0000, v132
  v_lshlrev_b32 v26, 16, v133
  v_and_b32 v27, 0xffff0000, v133
  v_lshlrev_b32 v28, 16, v134
  v_and_b32 v29, 0xffff0000, v134
  v_lshlrev_b32 v30, 16, v135
  v_and_b32 v31, 0xffff0000, v135
  v_pk_fma_f32 v[24:25], v[24:25], v[14:15], v[12:13] op_sel_hi:[1,0,0]
  v_pk_fma_f32 v[26:27], v[26:27], v[14:15], v[12:13] op_sel_hi:[1,0,0]
  v_pk_fma_f32 v[28:29], v[28:29], v[14:15], v[12:13] op_sel_hi:[1,0,0]
  v_pk_fma_f32 v[30:31], v[30:31], v[14:15], v[12:13] op_sel_hi:[1,0,0]
  s_waitcnt lgkmcnt(9)
  v_pk_fma_f32 v[24:25], v[24:25], v[200:201], v[208:209]
  v_pk_fma_f32 v[26:27], v[26:27], v[202:203], v[210:211]
  v_pk_fma_f32 v[28:29], v[28:29], v[204:205], v[212:213]
  v_pk_fma_f32 v[30:31], v[30:31], v[206:207], v[214:215]
  v_cvt_pk_bf16_f32 v132, v24, v25
  v_cvt_pk_bf16_f32 v133, v26, v27
  v_cvt_pk_bf16_f32 v134, v28, v29
  v_cvt_pk_bf16_f32 v135, v30, v31
  ds_write_b128 v1, v[132:135] offset:4096
  ds_read_b128 v[200:203], v2 offset:512
  ds_read_b128 v[208:211], v2 offset:2304
  ds_read_b128 v[204:207], v2 offset:528
  ds_read_b128 v[212:215], v2 offset:2320
  s_waitcnt vmcnt(12)
  v_lshlrev_b32 v16, 16, v136
  v_and_b32 v17, 0xffff0000, v136
  v_lshlrev_b32 v18, 16, v137
  v_and_b32 v19, 0xffff0000, v137
  v_lshlrev_b32 v20, 16, v138
  v_and_b32 v21, 0xffff0000, v138
  v_lshlrev_b32 v22, 16, v139
  v_and_b32 v23, 0xffff0000, v139
  v_pk_fma_f32 v[16:17], v[16:17], v[14:15], v[12:13] op_sel_hi:[1,0,0]
  v_pk_fma_f32 v[18:19], v[18:19], v[14:15], v[12:13] op_sel_hi:[1,0,0]
  v_pk_fma_f32 v[20:21], v[20:21], v[14:15], v[12:13] op_sel_hi:[1,0,0]
  v_pk_fma_f32 v[22:23], v[22:23], v[14:15], v[12:13] op_sel_hi:[1,0,0]
  s_waitcnt lgkmcnt(10)
  v_pk_fma_f32 v[16:17], v[16:17], v[216:217], v[224:225]
  v_pk_fma_f32 v[18:19], v[18:19], v[218:219], v[226:227]
  v_pk_fma_f32 v[20:21], v[20:21], v[220:221], v[228:229]
  v_pk_fma_f32 v[22:23], v[22:23], v[222:223], v[230:231]
  v_cvt_pk_bf16_f32 v136, v16, v17
  v_cvt_pk_bf16_f32 v137, v18, v19
  v_cvt_pk_bf16_f32 v138, v20, v21
  v_cvt_pk_bf16_f32 v139, v22, v23
  ds_write_b128 v1, v[136:139] offset:8192
  s_add_u32 m0, s42, 67584
  s_nop 0
  buffer_load_dwordx4 v4, s[68:71], s40 offen offset:0 lds
  buffer_load_dwordx4 v5, s[68:71], s40 offen offset:1056 lds
  ds_read_b128 v[216:219], v2 offset:640
  ds_read_b128 v[224:227], v2 offset:2432
  ds_read_b128 v[220:223], v2 offset:656
  ds_read_b128 v[228:231], v2 offset:2448
  s_waitcnt vmcnt(13)
  v_lshlrev_b32 v24, 16, v140
  v_and_b32 v25, 0xffff0000, v140
  v_lshlrev_b32 v26, 16, v141
  v_and_b32 v27, 0xffff0000, v141
  v_lshlrev_b32 v28, 16, v142
  v_and_b32 v29, 0xffff0000, v142
  v_lshlrev_b32 v30, 16, v143
  v_and_b32 v31, 0xffff0000, v143
  v_pk_fma_f32 v[24:25], v[24:25], v[14:15], v[12:13] op_sel_hi:[1,0,0]
  v_pk_fma_f32 v[26:27], v[26:27], v[14:15], v[12:13] op_sel_hi:[1,0,0]
  v_pk_fma_f32 v[28:29], v[28:29], v[14:15], v[12:13] op_sel_hi:[1,0,0]
  v_pk_fma_f32 v[30:31], v[30:31], v[14:15], v[12:13] op_sel_hi:[1,0,0]
  s_waitcnt lgkmcnt(10)
  v_pk_fma_f32 v[24:25], v[24:25], v[184:185], v[192:193]
  v_pk_fma_f32 v[26:27], v[26:27], v[186:187], v[194:195]
  v_pk_fma_f32 v[28:29], v[28:29], v[188:189], v[196:197]
  v_pk_fma_f32 v[30:31], v[30:31], v[190:191], v[198:199]
  v_cvt_pk_bf16_f32 v140, v24, v25
  v_cvt_pk_bf16_f32 v141, v26, v27
  v_cvt_pk_bf16_f32 v142, v28, v29
  v_cvt_pk_bf16_f32 v143, v30, v31
  ds_write_b128 v1, v[140:143] offset:12288
  buffer_load_dwordx4 v6, s[68:71], s40 offen offset:2112 lds
  buffer_load_dwordx4 v7, s[68:71], s40 offen offset:3168 lds
  s_add_u32 s40, s40, 262144
  ds_read_b128 v[184:187], v2 offset:768
  ds_read_b128 v[192:195], v2 offset:2560
  ds_read_b128 v[188:191], v2 offset:784
  ds_read_b128 v[196:199], v2 offset:2576
  s_waitcnt vmcnt(14)
  v_lshlrev_b32 v16, 16, v144
  v_and_b32 v17, 0xffff0000, v144
  v_lshlrev_b32 v18, 16, v145
  v_and_b32 v19, 0xffff0000, v145
  v_lshlrev_b32 v20, 16, v146
  v_and_b32 v21, 0xffff0000, v146
  v_lshlrev_b32 v22, 16, v147
  v_and_b32 v23, 0xffff0000, v147
  v_pk_fma_f32 v[16:17], v[16:17], v[14:15], v[12:13] op_sel_hi:[1,0,0]
  v_pk_fma_f32 v[18:19], v[18:19], v[14:15], v[12:13] op_sel_hi:[1,0,0]
  v_pk_fma_f32 v[20:21], v[20:21], v[14:15], v[12:13] op_sel_hi:[1,0,0]
  v_pk_fma_f32 v[22:23], v[22:23], v[14:15], v[12:13] op_sel_hi:[1,0,0]
  s_waitcnt lgkmcnt(10)
  v_pk_fma_f32 v[16:17], v[16:17], v[200:201], v[208:209]
  v_pk_fma_f32 v[18:19], v[18:19], v[202:203], v[210:211]
  v_pk_fma_f32 v[20:21], v[20:21], v[204:205], v[212:213]
  v_pk_fma_f32 v[22:23], v[22:23], v[206:207], v[214:215]
  v_cvt_pk_bf16_f32 v144, v16, v17
  v_cvt_pk_bf16_f32 v145, v18, v19
  v_cvt_pk_bf16_f32 v146, v20, v21
  v_cvt_pk_bf16_f32 v147, v22, v23
  ds_write_b128 v1, v[144:147] offset:16384
  s_add_u32 m0, s42, 71808
  s_nop 0
  buffer_load_dwordx4 v4, s[68:71], s41 offen offset:0 lds
  buffer_load_dwordx4 v5, s[68:71], s41 offen offset:1056 lds
  ds_read_b128 v[200:203], v2 offset:896
  ds_read_b128 v[208:211], v2 offset:2688
  ds_read_b128 v[204:207], v2 offset:912
  ds_read_b128 v[212:215], v2 offset:2704
  s_waitcnt vmcnt(15)
  v_lshlrev_b32 v24, 16, v148
  v_and_b32 v25, 0xffff0000, v148
  v_lshlrev_b32 v26, 16, v149
  v_and_b32 v27, 0xffff0000, v149
  v_lshlrev_b32 v28, 16, v150
  v_and_b32 v29, 0xffff0000, v150
  v_lshlrev_b32 v30, 16, v151
  v_and_b32 v31, 0xffff0000, v151
  v_pk_fma_f32 v[24:25], v[24:25], v[14:15], v[12:13] op_sel_hi:[1,0,0]
  v_pk_fma_f32 v[26:27], v[26:27], v[14:15], v[12:13] op_sel_hi:[1,0,0]
  v_pk_fma_f32 v[28:29], v[28:29], v[14:15], v[12:13] op_sel_hi:[1,0,0]
  v_pk_fma_f32 v[30:31], v[30:31], v[14:15], v[12:13] op_sel_hi:[1,0,0]
  s_waitcnt lgkmcnt(10)
  v_pk_fma_f32 v[24:25], v[24:25], v[216:217], v[224:225]
  v_pk_fma_f32 v[26:27], v[26:27], v[218:219], v[226:227]
  v_pk_fma_f32 v[28:29], v[28:29], v[220:221], v[228:229]
  v_pk_fma_f32 v[30:31], v[30:31], v[222:223], v[230:231]
  v_cvt_pk_bf16_f32 v148, v24, v25
  v_cvt_pk_bf16_f32 v149, v26, v27
  v_cvt_pk_bf16_f32 v150, v28, v29
  v_cvt_pk_bf16_f32 v151, v30, v31
  ds_write_b128 v1, v[148:151] offset:20480
  buffer_load_dwordx4 v6, s[68:71], s41 offen offset:2112 lds
  buffer_load_dwordx4 v7, s[68:71], s41 offen offset:3168 lds
  s_add_u32 s41, s41, 262144
  ds_read_b128 v[216:219], v2 offset:1024
  ds_read_b128 v[224:227], v2 offset:2816
  ds_read_b128 v[220:223], v2 offset:1040
  ds_read_b128 v[228:231], v2 offset:2832
  s_waitcnt vmcnt(16)
  v_lshlrev_b32 v16, 16, v152
  v_and_b32 v17, 0xffff0000, v152
  v_lshlrev_b32 v18, 16, v153
  v_and_b32 v19, 0xffff0000, v153
  v_lshlrev_b32 v20, 16, v154
  v_and_b32 v21, 0xffff0000, v154
  v_lshlrev_b32 v22, 16, v155
  v_and_b32 v23, 0xffff0000, v155
  v_pk_fma_f32 v[16:17], v[16:17], v[14:15], v[12:13] op_sel_hi:[1,0,0]
  v_pk_fma_f32 v[18:19], v[18:19], v[14:15], v[12:13] op_sel_hi:[1,0,0]
  v_pk_fma_f32 v[20:21], v[20:21], v[14:15], v[12:13] op_sel_hi:[1,0,0]
  v_pk_fma_f32 v[22:23], v[22:23], v[14:15], v[12:13] op_sel_hi:[1,0,0]
  s_waitcnt lgkmcnt(10)
  v_pk_fma_f32 v[16:17], v[16:17], v[184:185], v[192:193]
  v_pk_fma_f32 v[18:19], v[18:19], v[186:187], v[194:195]
  v_pk_fma_f32 v[20:21], v[20:21], v[188:189], v[196:197]
  v_pk_fma_f32 v[22:23], v[22:23], v[190:191], v[198:199]
  v_cvt_pk_bf16_f32 v152, v16, v17
  v_cvt_pk_bf16_f32 v153, v18, v19
  v_cvt_pk_bf16_f32 v154, v20, v21
  v_cvt_pk_bf16_f32 v155, v22, v23
  ds_write_b128 v1, v[152:155] offset:24576
  s_add_u32 m0, s42, 33792
  s_nop 0
  buffer_load_dwordx4 v4, s[68:71], s40 offen offset:0 lds
  buffer_load_dwordx4 v5, s[68:71], s40 offen offset:1056 lds
  ds_read_b128 v[184:187], v2 offset:1152
  ds_read_b128 v[192:195], v2 offset:2944
  ds_read_b128 v[188:191], v2 offset:1168
  ds_read_b128 v[196:199], v2 offset:2960
  s_waitcnt vmcnt(17)
  v_lshlrev_b32 v24, 16, v156
  v_and_b32 v25, 0xffff0000, v156
  v_lshlrev_b32 v26, 16, v157
  v_and_b32 v27, 0xffff0000, v157
  v_lshlrev_b32 v28, 16, v158
  v_and_b32 v29, 0xffff0000, v158
  v_lshlrev_b32 v30, 16, v159
  v_and_b32 v31, 0xffff0000, v159
  v_pk_fma_f32 v[24:25], v[24:25], v[14:15], v[12:13] op_sel_hi:[1,0,0]
  v_pk_fma_f32 v[26:27], v[26:27], v[14:15], v[12:13] op_sel_hi:[1,0,0]
  v_pk_fma_f32 v[28:29], v[28:29], v[14:15], v[12:13] op_sel_hi:[1,0,0]
  v_pk_fma_f32 v[30:31], v[30:31], v[14:15], v[12:13] op_sel_hi:[1,0,0]
  s_waitcnt lgkmcnt(10)
  v_pk_fma_f32 v[24:25], v[24:25], v[200:201], v[208:209]
  v_pk_fma_f32 v[26:27], v[26:27], v[202:203], v[210:211]
  v_pk_fma_f32 v[28:29], v[28:29], v[204:205], v[212:213]
  v_pk_fma_f32 v[30:31], v[30:31], v[206:207], v[214:215]
  v_cvt_pk_bf16_f32 v156, v24, v25
  v_cvt_pk_bf16_f32 v157, v26, v27
  v_cvt_pk_bf16_f32 v158, v28, v29
  v_cvt_pk_bf16_f32 v159, v30, v31
  ds_write_b128 v1, v[156:159] offset:28672
  buffer_load_dwordx4 v6, s[68:71], s40 offen offset:2112 lds
  buffer_load_dwordx4 v7, s[68:71], s40 offen offset:3168 lds
  s_add_u32 s40, s40, 262144
  ds_read_b128 v[200:203], v2 offset:1280
  ds_read_b128 v[208:211], v2 offset:3072
  ds_read_b128 v[204:207], v2 offset:1296
  ds_read_b128 v[212:215], v2 offset:3088
  s_waitcnt vmcnt(18)
  v_lshlrev_b32 v16, 16, v160
  v_and_b32 v17, 0xffff0000, v160
  v_lshlrev_b32 v18, 16, v161
  v_and_b32 v19, 0xffff0000, v161
  v_lshlrev_b32 v20, 16, v162
  v_and_b32 v21, 0xffff0000, v162
  v_lshlrev_b32 v22, 16, v163
  v_and_b32 v23, 0xffff0000, v163
  v_pk_fma_f32 v[16:17], v[16:17], v[14:15], v[12:13] op_sel_hi:[1,0,0]
  v_pk_fma_f32 v[18:19], v[18:19], v[14:15], v[12:13] op_sel_hi:[1,0,0]
  v_pk_fma_f32 v[20:21], v[20:21], v[14:15], v[12:13] op_sel_hi:[1,0,0]
  v_pk_fma_f32 v[22:23], v[22:23], v[14:15], v[12:13] op_sel_hi:[1,0,0]
  s_waitcnt lgkmcnt(10)
  v_pk_fma_f32 v[16:17], v[16:17], v[216:217], v[224:225]
  v_pk_fma_f32 v[18:19], v[18:19], v[218:219], v[226:227]
  v_pk_fma_f32 v[20:21], v[20:21], v[220:221], v[228:229]
  v_pk_fma_f32 v[22:23], v[22:23], v[222:223], v[230:231]
  v_cvt_pk_bf16_f32 v160, v16, v17
  v_cvt_pk_bf16_f32 v161, v18, v19
  v_cvt_pk_bf16_f32 v162, v20, v21
  v_cvt_pk_bf16_f32 v163, v22, v23
  ds_write_b128 v1, v[160:163] offset:32768
  s_add_u32 m0, s42, 38016
  s_nop 0
  buffer_load_dwordx4 v4, s[68:71], s41 offen offset:0 lds
  buffer_load_dwordx4 v5, s[68:71], s41 offen offset:1056 lds
  ds_read_b128 v[216:219], v2 offset:1408
  ds_read_b128 v[224:227], v2 offset:3200
  ds_read_b128 v[220:223], v2 offset:1424
  ds_read_b128 v[228:231], v2 offset:3216
  s_waitcnt vmcnt(19)
  v_lshlrev_b32 v24, 16, v164
  v_and_b32 v25, 0xffff0000, v164
  v_lshlrev_b32 v26, 16, v165
  v_and_b32 v27, 0xffff0000, v165
  v_lshlrev_b32 v28, 16, v166
  v_and_b32 v29, 0xffff0000, v166
  v_lshlrev_b32 v30, 16, v167
  v_and_b32 v31, 0xffff0000, v167
  v_pk_fma_f32 v[24:25], v[24:25], v[14:15], v[12:13] op_sel_hi:[1,0,0]
  v_pk_fma_f32 v[26:27], v[26:27], v[14:15], v[12:13] op_sel_hi:[1,0,0]
  v_pk_fma_f32 v[28:29], v[28:29], v[14:15], v[12:13] op_sel_hi:[1,0,0]
  v_pk_fma_f32 v[30:31], v[30:31], v[14:15], v[12:13] op_sel_hi:[1,0,0]
  s_waitcnt lgkmcnt(10)
  v_pk_fma_f32 v[24:25], v[24:25], v[184:185], v[192:193]
  v_pk_fma_f32 v[26:27], v[26:27], v[186:187], v[194:195]
  v_pk_fma_f32 v[28:29], v[28:29], v[188:189], v[196:197]
  v_pk_fma_f32 v[30:31], v[30:31], v[190:191], v[198:199]
  v_cvt_pk_bf16_f32 v164, v24, v25
  v_cvt_pk_bf16_f32 v165, v26, v27
  v_cvt_pk_bf16_f32 v166, v28, v29
  v_cvt_pk_bf16_f32 v167, v30, v31
  ds_write_b128 v1, v[164:167] offset:36864
  buffer_load_dwordx4 v6, s[68:71], s41 offen offset:2112 lds
  buffer_load_dwordx4 v7, s[68:71], s41 offen offset:3168 lds
  s_add_u32 s41, s41, 262144
  ds_read_b128 v[184:187], v2 offset:1536
  ds_read_b128 v[192:195], v2 offset:3328
  ds_read_b128 v[188:191], v2 offset:1552
  ds_read_b128 v[196:199], v2 offset:3344
  s_waitcnt vmcnt(20)
  v_lshlrev_b32 v16, 16, v168
  v_and_b32 v17, 0xffff0000, v168
  v_lshlrev_b32 v18, 16, v169
  v_and_b32 v19, 0xffff0000, v169
  v_lshlrev_b32 v20, 16, v170
  v_and_b32 v21, 0xffff0000, v170
  v_lshlrev_b32 v22, 16, v171
  v_and_b32 v23, 0xffff0000, v171
  v_pk_fma_f32 v[16:17], v[16:17], v[14:15], v[12:13] op_sel_hi:[1,0,0]
  v_pk_fma_f32 v[18:19], v[18:19], v[14:15], v[12:13] op_sel_hi:[1,0,0]
  v_pk_fma_f32 v[20:21], v[20:21], v[14:15], v[12:13] op_sel_hi:[1,0,0]
  v_pk_fma_f32 v[22:23], v[22:23], v[14:15], v[12:13] op_sel_hi:[1,0,0]
  s_waitcnt lgkmcnt(10)
  v_pk_fma_f32 v[16:17], v[16:17], v[200:201], v[208:209]
  v_pk_fma_f32 v[18:19], v[18:19], v[202:203], v[210:211]
  v_pk_fma_f32 v[20:21], v[20:21], v[204:205], v[212:213]
  v_pk_fma_f32 v[22:23], v[22:23], v[206:207], v[214:215]
  v_cvt_pk_bf16_f32 v168, v16, v17
  v_cvt_pk_bf16_f32 v169, v18, v19
  v_cvt_pk_bf16_f32 v170, v20, v21
  v_cvt_pk_bf16_f32 v171, v22, v23
  ds_write_b128 v1, v[168:171] offset:40960
  s_add_u32 m0, s42, 0
  s_nop 0
  buffer_load_dwordx4 v4, s[68:71], s40 offen offset:0 lds
  buffer_load_dwordx4 v5, s[68:71], s40 offen offset:1056 lds
  ds_read_b128 v[200:203], v2 offset:1664
  ds_read_b128 v[208:211], v2 offset:3456
  ds_read_b128 v[204:207], v2 offset:1680
  ds_read_b128 v[212:215], v2 offset:3472
  s_waitcnt vmcnt(21)
  v_lshlrev_b32 v24, 16, v172
  v_and_b32 v25, 0xffff0000, v172
  v_lshlrev_b32 v26, 16, v173
  v_and_b32 v27, 0xffff0000, v173
  v_lshlrev_b32 v28, 16, v174
  v_and_b32 v29, 0xffff0000, v174
  v_lshlrev_b32 v30, 16, v175
  v_and_b32 v31, 0xffff0000, v175
  v_pk_fma_f32 v[24:25], v[24:25], v[14:15], v[12:13] op_sel_hi:[1,0,0]
  v_pk_fma_f32 v[26:27], v[26:27], v[14:15], v[12:13] op_sel_hi:[1,0,0]
  v_pk_fma_f32 v[28:29], v[28:29], v[14:15], v[12:13] op_sel_hi:[1,0,0]
  v_pk_fma_f32 v[30:31], v[30:31], v[14:15], v[12:13] op_sel_hi:[1,0,0]
  s_waitcnt lgkmcnt(10)
  v_pk_fma_f32 v[24:25], v[24:25], v[216:217], v[224:225]
  v_pk_fma_f32 v[26:27], v[26:27], v[218:219], v[226:227]
  v_pk_fma_f32 v[28:29], v[28:29], v[220:221], v[228:229]
  v_pk_fma_f32 v[30:31], v[30:31], v[222:223], v[230:231]
  v_cvt_pk_bf16_f32 v172, v24, v25
  v_cvt_pk_bf16_f32 v173, v26, v27
  v_cvt_pk_bf16_f32 v174, v28, v29
  v_cvt_pk_bf16_f32 v175, v30, v31
  ds_write_b128 v1, v[172:175] offset:45056
  buffer_load_dwordx4 v6, s[68:71], s40 offen offset:2112 lds
  buffer_load_dwordx4 v7, s[68:71], s40 offen offset:3168 lds
  s_add_u32 s40, s40, 262144
  s_waitcnt vmcnt(22)
  v_lshlrev_b32 v16, 16, v176
  v_and_b32 v17, 0xffff0000, v176
  v_lshlrev_b32 v18, 16, v177
  v_and_b32 v19, 0xffff0000, v177
  v_lshlrev_b32 v20, 16, v178
  v_and_b32 v21, 0xffff0000, v178
  v_lshlrev_b32 v22, 16, v179
  v_and_b32 v23, 0xffff0000, v179
  v_pk_fma_f32 v[16:17], v[16:17], v[14:15], v[12:13] op_sel_hi:[1,0,0]
  v_pk_fma_f32 v[18:19], v[18:19], v[14:15], v[12:13] op_sel_hi:[1,0,0]
  v_pk_fma_f32 v[20:21], v[20:21], v[14:15], v[12:13] op_sel_hi:[1,0,0]
  v_pk_fma_f32 v[22:23], v[22:23], v[14:15], v[12:13] op_sel_hi:[1,0,0]
  s_waitcnt lgkmcnt(6)
  v_pk_fma_f32 v[16:17], v[16:17], v[184:185], v[192:193]
  v_pk_fma_f32 v[18:19], v[18:19], v[186:187], v[194:195]
  v_pk_fma_f32 v[20:21], v[20:21], v[188:189], v[196:197]
  v_pk_fma_f32 v[22:23], v[22:23], v[190:191], v[198:199]
  v_cvt_pk_bf16_f32 v176, v16, v17
  v_cvt_pk_bf16_f32 v177, v18, v19
  v_cvt_pk_bf16_f32 v178, v20, v21
  v_cvt_pk_bf16_f32 v179, v22, v23
  ds_write_b128 v1, v[176:179] offset:49152
  s_add_u32 m0, s42, 4224
  s_nop 0
  buffer_load_dwordx4 v4, s[68:71], s41 offen offset:0 lds
  buffer_load_dwordx4 v5, s[68:71], s41 offen offset:1056 lds
  s_waitcnt vmcnt(23)
  v_lshlrev_b32 v24, 16, v180
  v_and_b32 v25, 0xffff0000, v180
  v_lshlrev_b32 v26, 16, v181
  v_and_b32 v27, 0xffff0000, v181
  v_lshlrev_b32 v28, 16, v182
  v_and_b32 v29, 0xffff0000, v182
  v_lshlrev_b32 v30, 16, v183
  v_and_b32 v31, 0xffff0000, v183
  v_pk_fma_f32 v[24:25], v[24:25], v[14:15], v[12:13] op_sel_hi:[1,0,0]
  v_pk_fma_f32 v[26:27], v[26:27], v[14:15], v[12:13] op_sel_hi:[1,0,0]
  v_pk_fma_f32 v[28:29], v[28:29], v[14:15], v[12:13] op_sel_hi:[1,0,0]
  v_pk_fma_f32 v[30:31], v[30:31], v[14:15], v[12:13] op_sel_hi:[1,0,0]
  s_waitcnt lgkmcnt(2)
  v_pk_fma_f32 v[24:25], v[24:25], v[200:201], v[208:209]
  v_pk_fma_f32 v[26:27], v[26:27], v[202:203], v[210:211]
  v_pk_fma_f32 v[28:29], v[28:29], v[204:205], v[212:213]
  v_pk_fma_f32 v[30:31], v[30:31], v[206:207], v[214:215]
  v_cvt_pk_bf16_f32 v180, v24, v25
  v_cvt_pk_bf16_f32 v181, v26, v27
  v_cvt_pk_bf16_f32 v182, v28, v29
  v_cvt_pk_bf16_f32 v183, v30, v31
  ds_write_b128 v1, v[180:183] offset:53248
  buffer_load_dwordx4 v6, s[68:71], s41 offen offset:2112 lds
  buffer_load_dwordx4 v7, s[68:71], s41 offen offset:3168 lds
  s_add_u32 s41, s41, 262144
  s_waitcnt lgkmcnt(0)
  s_barrier
  v_lshlrev_b32 v14, 4, v0
  v_add_u32 v14, 102912, v14
  ds_read_b128 a[0:3], v14 offset:0
  ds_read_b128 a[4:7], v14 offset:1024
  ds_read_b128 a[8:11], v14 offset:2048
  ds_read_b128 a[12:15], v14 offset:3072
  ds_read_b128 a[16:19], v14 offset:4096
  ds_read_b128 a[20:23], v14 offset:5120
  ds_read_b128 a[24:27], v14 offset:6144
  ds_read_b128 a[28:31], v14 offset:7168
  ds_read_b128 a[32:35], v14 offset:8192
  ds_read_b128 a[36:39], v14 offset:9216
  ds_read_b128 a[40:43], v14 offset:10240
  ds_read_b128 a[44:47], v14 offset:11264
  s_waitcnt lgkmcnt(0)
  ds_read_b128 a[48:51], v14 offset:12288
  ds_read_b128 a[52:55], v14 offset:13312
  ds_read_b128 a[56:59], v14 offset:14336
  ds_read_b128 a[60:63], v14 offset:15360
  ds_read_b128 a[64:67], v14 offset:16384
  ds_read_b128 a[68:71], v14 offset:17408
  ds_read_b128 a[72:75], v14 offset:18432
  ds_read_b128 a[76:79], v14 offset:19456
  ds_read_b128 a[80:83], v14 offset:20480
  ds_read_b128 a[84:87], v14 offset:21504
  ds_read_b128 a[88:91], v14 offset:22528
  ds_read_b128 a[92:95], v14 offset:23552
  s_waitcnt lgkmcnt(0)
  ds_read_b128 a[96:99], v14 offset:24576
  ds_read_b128 a[100:103], v14 offset:25600
  ds_read_b128 a[104:107], v14 offset:26624
  ds_read_b128 a[108:111], v14 offset:27648
  ds_read_b128 a[112:115], v14 offset:28672
  ds_read_b128 a[116:119], v14 offset:29696
  ds_read_b128 a[120:123], v14 offset:30720
  ds_read_b128 a[124:127], v14 offset:31744
  s_waitcnt lgkmcnt(0)
  s_mul_i32 s23, s32, 16896
  s_mul_i32 s36, s33, 8448
  s_add_u32 s23, s23, s36
  s_mul_i32 s28, s32, 17408
  s_mul_i32 s36, s33, 8704
  s_add_u32 s28, s28, s36
  s_lshl_b32 s20, s32, 19
  s_add_u32 s26, s20, 4096
  s_mov_b32 s21, s20
  s_mov_b32 s27, s26
  s_mov_b32 s25, 0x46800000
  v_lshrrev_b32 v2, 5, v0
  v_and_b32 v1, 31, v0
  v_xor_b32 v3, v1, v2
  v_lshlrev_b32 v3, 4, v3
  v_lshl_add_u32 v3, v2, 9, v3
  s_lshl_b32 s36, s33, 13
  v_add_u32 v3, s36, v3
  v_add_u32 v124, 128, v3
  v_add_u32 v125, 96, v3
  v_add_u32 v126, 64, v3
  v_add_u32 v127, 32, v3
  v_lshrrev_b32 v1, 4, v0
  v_bfe_u32 v2, v0, 2, 2
  v_lshl_add_u32 v2, v1, 3, v2
  v_mul_u32_u24 v2, 1056, v2
  v_and_b32 v3, 3, v0
  v_lshl_add_u32 v2, v3, 3, v2
  s_lshl_b32 s36, s22, 8
  v_add_u32 v2, s36, v2
  v_and_b32 v3, 1, v1
  v_lshlrev_b32 v3, 7, v3
  v_add_u32 v8, v2, v3
  v_sub_u32 v9, v2, v3
  v_add_u32 v12, 67584, v8
  v_add_u32 v13, 67584, v9
  s_waitcnt vmcnt(16)
  s_barrier
  ds_read_b64_tr_b16 v[96:97], v12 offset:0
  ds_read_b64_tr_b16 v[98:99], v12 offset:4224
  ds_read_b64_tr_b16 v[100:101], v12 offset:32
  ds_read_b64_tr_b16 v[102:103], v12 offset:4256
  ds_read_b64_tr_b16 v[104:105], v12 offset:64
  ds_read_b64_tr_b16 v[106:107], v12 offset:4288
  s_waitcnt lgkmcnt(4)
  v_mfma_f32_16x16x32_bf16 v[128:131], v[96:99], a[0:3], 0
  ds_read_b64_tr_b16 v[108:109], v12 offset:96
  ds_read_b64_tr_b16 v[110:111], v12 offset:4320
  v_mfma_f32_16x16x32_bf16 v[132:135], v[96:99], a[4:7], 0
  s_waitcnt vmcnt(8)
  s_barrier
  v_mfma_f32_16x16x32_bf16 v[136:139], v[96:99], a[8:11], 0
  s_add_u32 m0, s42, 101376
  ds_read_b128 a[128:131], v14 offset:32768
  v_mfma_f32_16x16x32_bf16 v[140:143], v[96:99], a[12:15], 0
  buffer_load_dwordx4 v4, s[68:71], s40 offen offset:0 lds
  s_waitcnt lgkmcnt(5)
  v_mfma_f32_16x16x32_bf16 v[144:147], v[100:103], a[0:3], 0
  ds_read_b64_tr_b16 v[96:97], v13 offset:128
  ds_read_b64_tr_b16 v[98:99], v13 offset:4352
  v_mfma_f32_16x16x32_bf16 v[148:151], v[100:103], a[4:7], 0
  v_mfma_f32_16x16x32_bf16 v[152:155], v[100:103], a[8:11], 0
  buffer_load_dwordx4 v5, s[68:71], s40 offen offset:1056 lds
  v_mfma_f32_16x16x32_bf16 v[156:159], v[100:103], a[12:15], 0
  s_waitcnt lgkmcnt(5)
  v_mfma_f32_16x16x32_bf16 v[160:163], v[104:107], a[0:3], 0
  ds_read_b64_tr_b16 v[100:101], v13 offset:160
  ds_read_b64_tr_b16 v[102:103], v13 offset:4384
  v_mfma_f32_16x16x32_bf16 v[164:167], v[104:107], a[4:7], 0
  v_mfma_f32_16x16x32_bf16 v[168:171], v[104:107], a[8:11], 0
  buffer_load_dwordx4 v6, s[68:71], s40 offen offset:2112 lds
  ds_read_b128 a[132:135], v14 offset:33792
  v_mfma_f32_16x16x32_bf16 v[172:175], v[104:107], a[12:15], 0
  s_waitcnt lgkmcnt(6)
  v_mfma_f32_16x16x32_bf16 v[176:179], v[108:111], a[0:3], 0
  ds_read_b64_tr_b16 v[104:105], v13 offset:192
  ds_read_b64_tr_b16 v[106:107], v13 offset:4416
  v_mfma_f32_16x16x32_bf16 v[180:183], v[108:111], a[4:7], 0
  v_mfma_f32_16x16x32_bf16 v[184:187], v[108:111], a[8:11], 0
  buffer_load_dwordx4 v7, s[68:71], s40 offen offset:3168 lds
  s_add_u32 s40, s40, 262144
  v_mfma_f32_16x16x32_bf16 v[188:191], v[108:111], a[12:15], 0
  s_waitcnt lgkmcnt(5)
  v_mfma_f32_16x16x32_bf16 v[192:195], v[96:99], a[0:3], 0
  ds_read_b64_tr_b16 v[108:109], v13 offset:224
  ds_read_b64_tr_b16 v[110:111], v13 offset:4448
  v_mfma_f32_16x16x32_bf16 v[196:199], v[96:99], a[4:7], 0
  s_add_u32 m0, s42, 105600
  v_mfma_f32_16x16x32_bf16 v[200:203], v[96:99], a[8:11], 0
  buffer_load_dwordx4 v4, s[68:71], s41 offen offset:0 lds
  ds_read_b128 a[136:139], v14 offset:34816
  v_mfma_f32_16x16x32_bf16 v[204:207], v[96:99], a[12:15], 0
  s_waitcnt lgkmcnt(6)
  v_mfma_f32_16x16x32_bf16 v[208:211], v[100:103], a[0:3], 0
  ds_read_b64_tr_b16 v[96:97], v8 offset:33792
  ds_read_b64_tr_b16 v[98:99], v8 offset:38016
  v_mfma_f32_16x16x32_bf16 v[212:215], v[100:103], a[4:7], 0
  v_mfma_f32_16x16x32_bf16 v[216:219], v[100:103], a[8:11], 0
  buffer_load_dwordx4 v5, s[68:71], s41 offen offset:1056 lds
  v_mfma_f32_16x16x32_bf16 v[220:223], v[100:103], a[12:15], 0
  s_waitcnt lgkmcnt(5)
  v_mfma_f32_16x16x32_bf16 v[224:227], v[104:107], a[0:3], 0
  ds_read_b64_tr_b16 v[100:101], v8 offset:33824
  ds_read_b64_tr_b16 v[102:103], v8 offset:38048
  v_mfma_f32_16x16x32_bf16 v[228:231], v[104:107], a[4:7], 0
  v_mfma_f32_16x16x32_bf16 v[232:235], v[104:107], a[8:11], 0
  buffer_load_dwordx4 v6, s[68:71], s41 offen offset:2112 lds
  ds_read_b128 a[140:143], v14 offset:35840
  v_mfma_f32_16x16x32_bf16 v[236:239], v[104:107], a[12:15], 0
  s_waitcnt lgkmcnt(6)
  v_mfma_f32_16x16x32_bf16 v[240:243], v[108:111], a[0:3], 0
  ds_read_b64_tr_b16 v[104:105], v8 offset:33856
  ds_read_b64_tr_b16 v[106:107], v8 offset:38080
  v_mfma_f32_16x16x32_bf16 v[244:247], v[108:111], a[4:7], 0
  v_mfma_f32_16x16x32_bf16 v[248:251], v[108:111], a[8:11], 0
  buffer_load_dwordx4 v7, s[68:71], s41 offen offset:3168 lds
  s_add_u32 s41, s41, 262144
  v_mfma_f32_16x16x32_bf16 v[252:255], v[108:111], a[12:15], 0
  s_waitcnt lgkmcnt(5)
  v_mfma_f32_16x16x32_bf16 v[128:131], v[96:99], a[16:19], v[128:131]
  ds_read_b64_tr_b16 v[108:109], v8 offset:33888
  ds_read_b64_tr_b16 v[110:111], v8 offset:38112
  v_mfma_f32_16x16x32_bf16 v[132:135], v[96:99], a[20:23], v[132:135]
  s_waitcnt vmcnt(8)
  s_barrier
  v_mfma_f32_16x16x32_bf16 v[136:139], v[96:99], a[24:27], v[136:139]
  s_add_u32 m0, s42, 67584
  ds_read_b128 a[144:147], v14 offset:36864
  v_mfma_f32_16x16x32_bf16 v[140:143], v[96:99], a[28:31], v[140:143]
  buffer_load_dwordx4 v4, s[68:71], s40 offen offset:0 lds
  s_waitcnt lgkmcnt(6)
  v_mfma_f32_16x16x32_bf16 v[144:147], v[100:103], a[16:19], v[144:147]
  ds_read_b64_tr_b16 v[96:97], v9 offset:33920
  ds_read_b64_tr_b16 v[98:99], v9 offset:38144
  v_mfma_f32_16x16x32_bf16 v[148:151], v[100:103], a[20:23], v[148:151]
  v_mfma_f32_16x16x32_bf16 v[152:155], v[100:103], a[24:27], v[152:155]
  buffer_load_dwordx4 v5, s[68:71], s40 offen offset:1056 lds
  v_mfma_f32_16x16x32_bf16 v[156:159], v[100:103], a[28:31], v[156:159]
  s_waitcnt lgkmcnt(5)
  v_mfma_f32_16x16x32_bf16 v[160:163], v[104:107], a[16:19], v[160:163]
  ds_read_b64_tr_b16 v[100:101], v9 offset:33952
  ds_read_b64_tr_b16 v[102:103], v9 offset:38176
  v_mfma_f32_16x16x32_bf16 v[164:167], v[104:107], a[20:23], v[164:167]
  v_mfma_f32_16x16x32_bf16 v[168:171], v[104:107], a[24:27], v[168:171]
  buffer_load_dwordx4 v6, s[68:71], s40 offen offset:2112 lds
  ds_read_b128 a[148:151], v14 offset:37888
  v_mfma_f32_16x16x32_bf16 v[172:175], v[104:107], a[28:31], v[172:175]
  s_waitcnt lgkmcnt(6)
  v_mfma_f32_16x16x32_bf16 v[176:179], v[108:111], a[16:19], v[176:179]
  ds_read_b64_tr_b16 v[104:105], v9 offset:33984
  ds_read_b64_tr_b16 v[106:107], v9 offset:38208
  v_mfma_f32_16x16x32_bf16 v[180:183], v[108:111], a[20:23], v[180:183]
  v_mfma_f32_16x16x32_bf16 v[184:187], v[108:111], a[24:27], v[184:187]
  buffer_load_dwordx4 v7, s[68:71], s40 offen offset:3168 lds
  s_add_u32 s40, s40, 262144
  v_mfma_f32_16x16x32_bf16 v[188:191], v[108:111], a[28:31], v[188:191]
  s_waitcnt lgkmcnt(5)
  v_mfma_f32_16x16x32_bf16 v[192:195], v[96:99], a[16:19], v[192:195]
  ds_read_b64_tr_b16 v[108:109], v9 offset:34016
  ds_read_b64_tr_b16 v[110:111], v9 offset:38240
  v_mfma_f32_16x16x32_bf16 v[196:199], v[96:99], a[20:23], v[196:199]
  s_add_u32 m0, s42, 71808
  v_mfma_f32_16x16x32_bf16 v[200:203], v[96:99], a[24:27], v[200:203]
  buffer_load_dwordx4 v4, s[68:71], s41 offen offset:0 lds
  ds_read_b128 a[152:155], v14 offset:38912
  v_mfma_f32_16x16x32_bf16 v[204:207], v[96:99], a[28:31], v[204:207]
  s_waitcnt lgkmcnt(6)
  v_mfma_f32_16x16x32_bf16 v[208:211], v[100:103], a[16:19], v[208:211]
  ds_read_b64_tr_b16 v[96:97], v8 offset:0
  ds_read_b64_tr_b16 v[98:99], v8 offset:4224
  v_mfma_f32_16x16x32_bf16 v[212:215], v[100:103], a[20:23], v[212:215]
  v_mfma_f32_16x16x32_bf16 v[216:219], v[100:103], a[24:27], v[216:219]
  buffer_load_dwordx4 v5, s[68:71], s41 offen offset:1056 lds
  v_mfma_f32_16x16x32_bf16 v[220:223], v[100:103], a[28:31], v[220:223]
  s_waitcnt lgkmcnt(5)
  v_mfma_f32_16x16x32_bf16 v[224:227], v[104:107], a[16:19], v[224:227]
  ds_read_b64_tr_b16 v[100:101], v8 offset:32
  ds_read_b64_tr_b16 v[102:103], v8 offset:4256
  v_mfma_f32_16x16x32_bf16 v[228:231], v[104:107], a[20:23], v[228:231]
  v_mfma_f32_16x16x32_bf16 v[232:235], v[104:107], a[24:27], v[232:235]
  buffer_load_dwordx4 v6, s[68:71], s41 offen offset:2112 lds
  ds_read_b128 a[156:159], v14 offset:39936
  v_mfma_f32_16x16x32_bf16 v[236:239], v[104:107], a[28:31], v[236:239]
  s_waitcnt lgkmcnt(6)
  v_mfma_f32_16x16x32_bf16 v[240:243], v[108:111], a[16:19], v[240:243]
  ds_read_b64_tr_b16 v[104:105], v8 offset:64
  ds_read_b64_tr_b16 v[106:107], v8 offset:4288
  v_mfma_f32_16x16x32_bf16 v[244:247], v[108:111], a[20:23], v[244:247]
  v_mfma_f32_16x16x32_bf16 v[248:251], v[108:111], a[24:27], v[248:251]
  buffer_load_dwordx4 v7, s[68:71], s41 offen offset:3168 lds
  s_add_u32 s41, s41, 262144
  v_mfma_f32_16x16x32_bf16 v[252:255], v[108:111], a[28:31], v[252:255]
  s_waitcnt lgkmcnt(5)
  v_mfma_f32_16x16x32_bf16 v[128:131], v[96:99], a[32:35], v[128:131]
  ds_read_b64_tr_b16 v[108:109], v8 offset:96
  ds_read_b64_tr_b16 v[110:111], v8 offset:4320
  v_mfma_f32_16x16x32_bf16 v[132:135], v[96:99], a[36:39], v[132:135]
  s_waitcnt vmcnt(8)
  s_barrier
  v_mfma_f32_16x16x32_bf16 v[136:139], v[96:99], a[40:43], v[136:139]
  s_add_u32 m0, s42, 33792
  ds_read_b128 a[160:163], v14 offset:40960
  v_mfma_f32_16x16x32_bf16 v[140:143], v[96:99], a[44:47], v[140:143]
  buffer_load_dwordx4 v4, s[68:71], s40 offen offset:0 lds
  s_waitcnt lgkmcnt(6)
  v_mfma_f32_16x16x32_bf16 v[144:147], v[100:103], a[32:35], v[144:147]
  ds_read_b64_tr_b16 v[96:97], v9 offset:128
  ds_read_b64_tr_b16 v[98:99], v9 offset:4352
  v_mfma_f32_16x16x32_bf16 v[148:151], v[100:103], a[36:39], v[148:151]
  v_mfma_f32_16x16x32_bf16 v[152:155], v[100:103], a[40:43], v[152:155]
  buffer_load_dwordx4 v5, s[68:71], s40 offen offset:1056 lds
  v_mfma_f32_16x16x32_bf16 v[156:159], v[100:103], a[44:47], v[156:159]
  s_waitcnt lgkmcnt(5)
  v_mfma_f32_16x16x32_bf16 v[160:163], v[104:107], a[32:35], v[160:163]
  ds_read_b64_tr_b16 v[100:101], v9 offset:160
  ds_read_b64_tr_b16 v[102:103], v9 offset:4384
  v_mfma_f32_16x16x32_bf16 v[164:167], v[104:107], a[36:39], v[164:167]
  v_mfma_f32_16x16x32_bf16 v[168:171], v[104:107], a[40:43], v[168:171]
  buffer_load_dwordx4 v6, s[68:71], s40 offen offset:2112 lds
  ds_read_b128 a[164:167], v14 offset:41984
  v_mfma_f32_16x16x32_bf16 v[172:175], v[104:107], a[44:47], v[172:175]
  s_waitcnt lgkmcnt(6)
  v_mfma_f32_16x16x32_bf16 v[176:179], v[108:111], a[32:35], v[176:179]
  ds_read_b64_tr_b16 v[104:105], v9 offset:192
  ds_read_b64_tr_b16 v[106:107], v9 offset:4416
  v_mfma_f32_16x16x32_bf16 v[180:183], v[108:111], a[36:39], v[180:183]
  v_mfma_f32_16x16x32_bf16 v[184:187], v[108:111], a[40:43], v[184:187]
  buffer_load_dwordx4 v7, s[68:71], s40 offen offset:3168 lds
  s_add_u32 s40, s40, 262144
  v_mfma_f32_16x16x32_bf16 v[188:191], v[108:111], a[44:47], v[188:191]
  s_waitcnt lgkmcnt(5)
  v_mfma_f32_16x16x32_bf16 v[192:195], v[96:99], a[32:35], v[192:195]
  ds_read_b64_tr_b16 v[108:109], v9 offset:224
  ds_read_b64_tr_b16 v[110:111], v9 offset:4448
  v_mfma_f32_16x16x32_bf16 v[196:199], v[96:99], a[36:39], v[196:199]
  s_add_u32 m0, s42, 38016
  v_mfma_f32_16x16x32_bf16 v[200:203], v[96:99], a[40:43], v[200:203]
  buffer_load_dwordx4 v4, s[68:71], s41 offen offset:0 lds
  ds_read_b128 a[168:171], v14 offset:43008
  v_mfma_f32_16x16x32_bf16 v[204:207], v[96:99], a[44:47], v[204:207]
  s_waitcnt lgkmcnt(6)
  v_mfma_f32_16x16x32_bf16 v[208:211], v[100:103], a[32:35], v[208:211]
  ds_read_b64_tr_b16 v[96:97], v12 offset:33792
  ds_read_b64_tr_b16 v[98:99], v12 offset:38016
  v_mfma_f32_16x16x32_bf16 v[212:215], v[100:103], a[36:39], v[212:215]
  v_mfma_f32_16x16x32_bf16 v[216:219], v[100:103], a[40:43], v[216:219]
  buffer_load_dwordx4 v5, s[68:71], s41 offen offset:1056 lds
  v_mfma_f32_16x16x32_bf16 v[220:223], v[100:103], a[44:47], v[220:223]
  s_waitcnt lgkmcnt(5)
  v_mfma_f32_16x16x32_bf16 v[224:227], v[104:107], a[32:35], v[224:227]
  ds_read_b64_tr_b16 v[100:101], v12 offset:33824
  ds_read_b64_tr_b16 v[102:103], v12 offset:38048
  v_mfma_f32_16x16x32_bf16 v[228:231], v[104:107], a[36:39], v[228:231]
  v_mfma_f32_16x16x32_bf16 v[232:235], v[104:107], a[40:43], v[232:235]
  buffer_load_dwordx4 v6, s[68:71], s41 offen offset:2112 lds
  ds_read_b128 a[172:175], v14 offset:44032
  v_mfma_f32_16x16x32_bf16 v[236:239], v[104:107], a[44:47], v[236:239]
  s_waitcnt lgkmcnt(6)
  v_mfma_f32_16x16x32_bf16 v[240:243], v[108:111], a[32:35], v[240:243]
  ds_read_b64_tr_b16 v[104:105], v12 offset:33856
  ds_read_b64_tr_b16 v[106:107], v12 offset:38080
  v_mfma_f32_16x16x32_bf16 v[244:247], v[108:111], a[36:39], v[244:247]
  v_mfma_f32_16x16x32_bf16 v[248:251], v[108:111], a[40:43], v[248:251]
  buffer_load_dwordx4 v7, s[68:71], s41 offen offset:3168 lds
  s_add_u32 s41, s41, 262144
  v_mfma_f32_16x16x32_bf16 v[252:255], v[108:111], a[44:47], v[252:255]
  s_waitcnt lgkmcnt(5)
  v_mfma_f32_16x16x32_bf16 v[128:131], v[96:99], a[48:51], v[128:131]
  ds_read_b64_tr_b16 v[108:109], v12 offset:33888
  ds_read_b64_tr_b16 v[110:111], v12 offset:38112
  v_mfma_f32_16x16x32_bf16 v[132:135], v[96:99], a[52:55], v[132:135]
  s_waitcnt vmcnt(8)
  s_barrier
  v_mfma_f32_16x16x32_bf16 v[136:139], v[96:99], a[56:59], v[136:139]
  s_add_u32 m0, s42, 0
  ds_read_b128 a[176:179], v14 offset:45056
  v_mfma_f32_16x16x32_bf16 v[140:143], v[96:99], a[60:63], v[140:143]
  buffer_load_dwordx4 v4, s[68:71], s40 offen offset:0 lds
  s_waitcnt lgkmcnt(6)
  v_mfma_f32_16x16x32_bf16 v[144:147], v[100:103], a[48:51], v[144:147]
  ds_read_b64_tr_b16 v[96:97], v13 offset:33920
  ds_read_b64_tr_b16 v[98:99], v13 offset:38144
  v_mfma_f32_16x16x32_bf16 v[148:151], v[100:103], a[52:55], v[148:151]
  v_mfma_f32_16x16x32_bf16 v[152:155], v[100:103], a[56:59], v[152:155]
  buffer_load_dwordx4 v5, s[68:71], s40 offen offset:1056 lds
  v_mfma_f32_16x16x32_bf16 v[156:159], v[100:103], a[60:63], v[156:159]
  s_waitcnt lgkmcnt(5)
  v_mfma_f32_16x16x32_bf16 v[160:163], v[104:107], a[48:51], v[160:163]
  ds_read_b64_tr_b16 v[100:101], v13 offset:33952
  ds_read_b64_tr_b16 v[102:103], v13 offset:38176
  v_mfma_f32_16x16x32_bf16 v[164:167], v[104:107], a[52:55], v[164:167]
  v_mfma_f32_16x16x32_bf16 v[168:171], v[104:107], a[56:59], v[168:171]
  buffer_load_dwordx4 v6, s[68:71], s40 offen offset:2112 lds
  ds_read_b128 a[180:183], v14 offset:46080
  v_mfma_f32_16x16x32_bf16 v[172:175], v[104:107], a[60:63], v[172:175]
  s_waitcnt lgkmcnt(6)
  v_mfma_f32_16x16x32_bf16 v[176:179], v[108:111], a[48:51], v[176:179]
  ds_read_b64_tr_b16 v[104:105], v13 offset:33984
  ds_read_b64_tr_b16 v[106:107], v13 offset:38208
  v_mfma_f32_16x16x32_bf16 v[180:183], v[108:111], a[52:55], v[180:183]
  v_mfma_f32_16x16x32_bf16 v[184:187], v[108:111], a[56:59], v[184:187]
  buffer_load_dwordx4 v7, s[68:71], s40 offen offset:3168 lds
  s_add_u32 s40, s40, 262144
  v_mfma_f32_16x16x32_bf16 v[188:191], v[108:111], a[60:63], v[188:191]
  s_waitcnt lgkmcnt(5)
  v_mfma_f32_16x16x32_bf16 v[192:195], v[96:99], a[48:51], v[192:195]
  ds_read_b64_tr_b16 v[108:109], v13 offset:34016
  ds_read_b64_tr_b16 v[110:111], v13 offset:38240
  v_mfma_f32_16x16x32_bf16 v[196:199], v[96:99], a[52:55], v[196:199]
  s_add_u32 m0, s42, 4224
  v_mfma_f32_16x16x32_bf16 v[200:203], v[96:99], a[56:59], v[200:203]
  buffer_load_dwordx4 v4, s[68:71], s41 offen offset:0 lds
  ds_read_b128 a[184:187], v14 offset:47104
  v_mfma_f32_16x16x32_bf16 v[204:207], v[96:99], a[60:63], v[204:207]
  s_waitcnt lgkmcnt(6)
  v_mfma_f32_16x16x32_bf16 v[208:211], v[100:103], a[48:51], v[208:211]
  ds_read_b64_tr_b16 v[96:97], v12 offset:0
  ds_read_b64_tr_b16 v[98:99], v12 offset:4224
  v_mfma_f32_16x16x32_bf16 v[212:215], v[100:103], a[52:55], v[212:215]
  v_mfma_f32_16x16x32_bf16 v[216:219], v[100:103], a[56:59], v[216:219]
  buffer_load_dwordx4 v5, s[68:71], s41 offen offset:1056 lds
  v_mfma_f32_16x16x32_bf16 v[220:223], v[100:103], a[60:63], v[220:223]
  s_waitcnt lgkmcnt(5)
  v_mfma_f32_16x16x32_bf16 v[224:227], v[104:107], a[48:51], v[224:227]
  ds_read_b64_tr_b16 v[100:101], v12 offset:32
  ds_read_b64_tr_b16 v[102:103], v12 offset:4256
  v_mfma_f32_16x16x32_bf16 v[228:231], v[104:107], a[52:55], v[228:231]
  v_mfma_f32_16x16x32_bf16 v[232:235], v[104:107], a[56:59], v[232:235]
  buffer_load_dwordx4 v6, s[68:71], s41 offen offset:2112 lds
  ds_read_b128 a[188:191], v14 offset:48128
  v_mfma_f32_16x16x32_bf16 v[236:239], v[104:107], a[60:63], v[236:239]
  s_waitcnt lgkmcnt(6)
  v_mfma_f32_16x16x32_bf16 v[240:243], v[108:111], a[48:51], v[240:243]
  ds_read_b64_tr_b16 v[104:105], v12 offset:64
  ds_read_b64_tr_b16 v[106:107], v12 offset:4288
  v_mfma_f32_16x16x32_bf16 v[244:247], v[108:111], a[52:55], v[244:247]
  v_mfma_f32_16x16x32_bf16 v[248:251], v[108:111], a[56:59], v[248:251]
  buffer_load_dwordx4 v7, s[68:71], s41 offen offset:3168 lds
  s_add_u32 s41, s41, 262144
  v_mfma_f32_16x16x32_bf16 v[252:255], v[108:111], a[60:63], v[252:255]
  s_waitcnt lgkmcnt(5)
  v_mfma_f32_16x16x32_bf16 v[128:131], v[96:99], a[64:67], v[128:131]
  ds_read_b64_tr_b16 v[108:109], v12 offset:96
  ds_read_b64_tr_b16 v[110:111], v12 offset:4320
  v_mfma_f32_16x16x32_bf16 v[132:135], v[96:99], a[68:71], v[132:135]
  s_waitcnt vmcnt(8)
  s_barrier
  v_mfma_f32_16x16x32_bf16 v[136:139], v[96:99], a[72:75], v[136:139]
  s_add_u32 m0, s42, 101376
  ds_read_b128 a[192:195], v14 offset:49152
  v_mfma_f32_16x16x32_bf16 v[140:143], v[96:99], a[76:79], v[140:143]
  buffer_load_dwordx4 v4, s[68:71], s40 offen offset:0 lds
  s_waitcnt lgkmcnt(6)
  v_mfma_f32_16x16x32_bf16 v[144:147], v[100:103], a[64:67], v[144:147]
  ds_read_b64_tr_b16 v[96:97], v13 offset:128
  ds_read_b64_tr_b16 v[98:99], v13 offset:4352
  v_mfma_f32_16x16x32_bf16 v[148:151], v[100:103], a[68:71], v[148:151]
  v_mfma_f32_16x16x32_bf16 v[152:155], v[100:103], a[72:75], v[152:155]
  buffer_load_dwordx4 v5, s[68:71], s40 offen offset:1056 lds
  v_mfma_f32_16x16x32_bf16 v[156:159], v[100:103], a[76:79], v[156:159]
  s_waitcnt lgkmcnt(5)
  v_mfma_f32_16x16x32_bf16 v[160:163], v[104:107], a[64:67], v[160:163]
  ds_read_b64_tr_b16 v[100:101], v13 offset:160
  ds_read_b64_tr_b16 v[102:103], v13 offset:4384
  v_mfma_f32_16x16x32_bf16 v[164:167], v[104:107], a[68:71], v[164:167]
  v_mfma_f32_16x16x32_bf16 v[168:171], v[104:107], a[72:75], v[168:171]
  buffer_load_dwordx4 v6, s[68:71], s40 offen offset:2112 lds
  ds_read_b128 a[196:199], v14 offset:50176
  v_mfma_f32_16x16x32_bf16 v[172:175], v[104:107], a[76:79], v[172:175]
  s_waitcnt lgkmcnt(6)
  v_mfma_f32_16x16x32_bf16 v[176:179], v[108:111], a[64:67], v[176:179]
  ds_read_b64_tr_b16 v[104:105], v13 offset:192
  ds_read_b64_tr_b16 v[106:107], v13 offset:4416
  v_mfma_f32_16x16x32_bf16 v[180:183], v[108:111], a[68:71], v[180:183]
  v_mfma_f32_16x16x32_bf16 v[184:187], v[108:111], a[72:75], v[184:187]
  buffer_load_dwordx4 v7, s[68:71], s40 offen offset:3168 lds
  s_add_u32 s40, s40, 262144
  v_mfma_f32_16x16x32_bf16 v[188:191], v[108:111], a[76:79], v[188:191]
  s_waitcnt lgkmcnt(5)
  v_mfma_f32_16x16x32_bf16 v[192:195], v[96:99], a[64:67], v[192:195]
  ds_read_b64_tr_b16 v[108:109], v13 offset:224
  ds_read_b64_tr_b16 v[110:111], v13 offset:4448
  v_mfma_f32_16x16x32_bf16 v[196:199], v[96:99], a[68:71], v[196:199]
  s_add_u32 m0, s42, 105600
  v_mfma_f32_16x16x32_bf16 v[200:203], v[96:99], a[72:75], v[200:203]
  buffer_load_dwordx4 v4, s[68:71], s41 offen offset:0 lds
  ds_read_b128 a[200:203], v14 offset:51200
  v_mfma_f32_16x16x32_bf16 v[204:207], v[96:99], a[76:79], v[204:207]
  s_waitcnt lgkmcnt(6)
  v_mfma_f32_16x16x32_bf16 v[208:211], v[100:103], a[64:67], v[208:211]
  ds_read_b64_tr_b16 v[96:97], v8 offset:33792
  ds_read_b64_tr_b16 v[98:99], v8 offset:38016
  v_mfma_f32_16x16x32_bf16 v[212:215], v[100:103], a[68:71], v[212:215]
  v_mfma_f32_16x16x32_bf16 v[216:219], v[100:103], a[72:75], v[216:219]
  buffer_load_dwordx4 v5, s[68:71], s41 offen offset:1056 lds
  v_mfma_f32_16x16x32_bf16 v[220:223], v[100:103], a[76:79], v[220:223]
  s_waitcnt lgkmcnt(5)
  v_mfma_f32_16x16x32_bf16 v[224:227], v[104:107], a[64:67], v[224:227]
  ds_read_b64_tr_b16 v[100:101], v8 offset:33824
  ds_read_b64_tr_b16 v[102:103], v8 offset:38048
  v_mfma_f32_16x16x32_bf16 v[228:231], v[104:107], a[68:71], v[228:231]
  v_mfma_f32_16x16x32_bf16 v[232:235], v[104:107], a[72:75], v[232:235]
  buffer_load_dwordx4 v6, s[68:71], s41 offen offset:2112 lds
  ds_read_b128 a[204:207], v14 offset:52224
  v_mfma_f32_16x16x32_bf16 v[236:239], v[104:107], a[76:79], v[236:239]
  s_waitcnt lgkmcnt(6)
  v_mfma_f32_16x16x32_bf16 v[240:243], v[108:111], a[64:67], v[240:243]
  ds_read_b64_tr_b16 v[104:105], v8 offset:33856
  ds_read_b64_tr_b16 v[106:107], v8 offset:38080
  v_mfma_f32_16x16x32_bf16 v[244:247], v[108:111], a[68:71], v[244:247]
  v_mfma_f32_16x16x32_bf16 v[248:251], v[108:111], a[72:75], v[248:251]
  buffer_load_dwordx4 v7, s[68:71], s41 offen offset:3168 lds
  s_add_u32 s41, s41, 262144
  v_mfma_f32_16x16x32_bf16 v[252:255], v[108:111], a[76:79], v[252:255]
  s_waitcnt lgkmcnt(5)
  v_mfma_f32_16x16x32_bf16 v[128:131], v[96:99], a[80:83], v[128:131]
  ds_read_b64_tr_b16 v[108:109], v8 offset:33888
  ds_read_b64_tr_b16 v[110:111], v8 offset:38112
  v_mfma_f32_16x16x32_bf16 v[132:135], v[96:99], a[84:87], v[132:135]
  s_waitcnt vmcnt(8)
  s_barrier
  v_mfma_f32_16x16x32_bf16 v[136:139], v[96:99], a[88:91], v[136:139]
  s_add_u32 m0, s42, 67584
  ds_read_b128 a[208:211], v14 offset:53248
  v_mfma_f32_16x16x32_bf16 v[140:143], v[96:99], a[92:95], v[140:143]
  buffer_load_dwordx4 v4, s[68:71], s40 offen offset:0 lds
  s_waitcnt lgkmcnt(6)
  v_mfma_f32_16x16x32_bf16 v[144:147], v[100:103], a[80:83], v[144:147]
  ds_read_b64_tr_b16 v[96:97], v9 offset:33920
  ds_read_b64_tr_b16 v[98:99], v9 offset:38144
  v_mfma_f32_16x16x32_bf16 v[148:151], v[100:103], a[84:87], v[148:151]
  v_mfma_f32_16x16x32_bf16 v[152:155], v[100:103], a[88:91], v[152:155]
  buffer_load_dwordx4 v5, s[68:71], s40 offen offset:1056 lds
  v_mfma_f32_16x16x32_bf16 v[156:159], v[100:103], a[92:95], v[156:159]
  s_waitcnt lgkmcnt(5)
  v_mfma_f32_16x16x32_bf16 v[160:163], v[104:107], a[80:83], v[160:163]
  ds_read_b64_tr_b16 v[100:101], v9 offset:33952
  ds_read_b64_tr_b16 v[102:103], v9 offset:38176
  v_mfma_f32_16x16x32_bf16 v[164:167], v[104:107], a[84:87], v[164:167]
  v_mfma_f32_16x16x32_bf16 v[168:171], v[104:107], a[88:91], v[168:171]
  buffer_load_dwordx4 v6, s[68:71], s40 offen offset:2112 lds
  ds_read_b128 a[212:215], v14 offset:54272
  v_mfma_f32_16x16x32_bf16 v[172:175], v[104:107], a[92:95], v[172:175]
  s_waitcnt lgkmcnt(6)
  v_mfma_f32_16x16x32_bf16 v[176:179], v[108:111], a[80:83], v[176:179]
  ds_read_b64_tr_b16 v[104:105], v9 offset:33984
  ds_read_b64_tr_b16 v[106:107], v9 offset:38208
  v_mfma_f32_16x16x32_bf16 v[180:183], v[108:111], a[84:87], v[180:183]
  v_mfma_f32_16x16x32_bf16 v[184:187], v[108:111], a[88:91], v[184:187]
  buffer_load_dwordx4 v7, s[68:71], s40 offen offset:3168 lds
  s_add_u32 s40, s40, 262144
  v_mfma_f32_16x16x32_bf16 v[188:191], v[108:111], a[92:95], v[188:191]
  s_waitcnt lgkmcnt(5)
  v_mfma_f32_16x16x32_bf16 v[192:195], v[96:99], a[80:83], v[192:195]
  ds_read_b64_tr_b16 v[108:109], v9 offset:34016
  ds_read_b64_tr_b16 v[110:111], v9 offset:38240
  v_mfma_f32_16x16x32_bf16 v[196:199], v[96:99], a[84:87], v[196:199]
  s_add_u32 m0, s42, 71808
  v_mfma_f32_16x16x32_bf16 v[200:203], v[96:99], a[88:91], v[200:203]
  buffer_load_dwordx4 v4, s[68:71], s41 offen offset:0 lds
  ds_read_b128 a[216:219], v14 offset:55296
  v_mfma_f32_16x16x32_bf16 v[204:207], v[96:99], a[92:95], v[204:207]
  s_waitcnt lgkmcnt(6)
  v_mfma_f32_16x16x32_bf16 v[208:211], v[100:103], a[80:83], v[208:211]
  ds_read_b64_tr_b16 v[96:97], v8 offset:0
  ds_read_b64_tr_b16 v[98:99], v8 offset:4224
  v_mfma_f32_16x16x32_bf16 v[212:215], v[100:103], a[84:87], v[212:215]
  v_mfma_f32_16x16x32_bf16 v[216:219], v[100:103], a[88:91], v[216:219]
  buffer_load_dwordx4 v5, s[68:71], s41 offen offset:1056 lds
  v_mfma_f32_16x16x32_bf16 v[220:223], v[100:103], a[92:95], v[220:223]
  s_waitcnt lgkmcnt(5)
  v_mfma_f32_16x16x32_bf16 v[224:227], v[104:107], a[80:83], v[224:227]
  ds_read_b64_tr_b16 v[100:101], v8 offset:32
  ds_read_b64_tr_b16 v[102:103], v8 offset:4256
  v_mfma_f32_16x16x32_bf16 v[228:231], v[104:107], a[84:87], v[228:231]
  v_mfma_f32_16x16x32_bf16 v[232:235], v[104:107], a[88:91], v[232:235]
  buffer_load_dwordx4 v6, s[68:71], s41 offen offset:2112 lds
  ds_read_b128 a[220:223], v14 offset:56320
  v_mfma_f32_16x16x32_bf16 v[236:239], v[104:107], a[92:95], v[236:239]
  s_waitcnt lgkmcnt(6)
  v_mfma_f32_16x16x32_bf16 v[240:243], v[108:111], a[80:83], v[240:243]
  ds_read_b64_tr_b16 v[104:105], v8 offset:64
  ds_read_b64_tr_b16 v[106:107], v8 offset:4288
  v_mfma_f32_16x16x32_bf16 v[244:247], v[108:111], a[84:87], v[244:247]
  v_mfma_f32_16x16x32_bf16 v[248:251], v[108:111], a[88:91], v[248:251]
  buffer_load_dwordx4 v7, s[68:71], s41 offen offset:3168 lds
  s_add_u32 s41, s41, 262144
  v_mfma_f32_16x16x32_bf16 v[252:255], v[108:111], a[92:95], v[252:255]
  s_waitcnt lgkmcnt(5)
  v_mfma_f32_16x16x32_bf16 v[128:131], v[96:99], a[96:99], v[128:131]
  ds_read_b64_tr_b16 v[108:109], v8 offset:96
  ds_read_b64_tr_b16 v[110:111], v8 offset:4320
  v_mfma_f32_16x16x32_bf16 v[132:135], v[96:99], a[100:103], v[132:135]
  s_waitcnt vmcnt(8)
  s_barrier
  v_mfma_f32_16x16x32_bf16 v[136:139], v[96:99], a[104:107], v[136:139]
  s_add_u32 m0, s42, 33792
  v_mfma_f32_16x16x32_bf16 v[140:143], v[96:99], a[108:111], v[140:143]
  buffer_load_dwordx4 v4, s[68:71], s40 offen offset:0 lds
  s_waitcnt lgkmcnt(5)
  v_mfma_f32_16x16x32_bf16 v[144:147], v[100:103], a[96:99], v[144:147]
  ds_read_b64_tr_b16 v[96:97], v9 offset:128
  ds_read_b64_tr_b16 v[98:99], v9 offset:4352
  v_mfma_f32_16x16x32_bf16 v[148:151], v[100:103], a[100:103], v[148:151]
  v_mfma_f32_16x16x32_bf16 v[152:155], v[100:103], a[104:107], v[152:155]
  buffer_load_dwordx4 v5, s[68:71], s40 offen offset:1056 lds
  v_mfma_f32_16x16x32_bf16 v[156:159], v[100:103], a[108:111], v[156:159]
  s_waitcnt lgkmcnt(4)
  v_mfma_f32_16x16x32_bf16 v[160:163], v[104:107], a[96:99], v[160:163]
  ds_read_b64_tr_b16 v[100:101], v9 offset:160
  ds_read_b64_tr_b16 v[102:103], v9 offset:4384
  v_mfma_f32_16x16x32_bf16 v[164:167], v[104:107], a[100:103], v[164:167]
  v_mfma_f32_16x16x32_bf16 v[168:171], v[104:107], a[104:107], v[168:171]
  buffer_load_dwordx4 v6, s[68:71], s40 offen offset:2112 lds
  v_mfma_f32_16x16x32_bf16 v[172:175], v[104:107], a[108:111], v[172:175]
  s_waitcnt lgkmcnt(4)
  v_mfma_f32_16x16x32_bf16 v[176:179], v[108:111], a[96:99], v[176:179]
  ds_read_b64_tr_b16 v[104:105], v9 offset:192
  ds_read_b64_tr_b16 v[106:107], v9 offset:4416
  v_mfma_f32_16x16x32_bf16 v[180:183], v[108:111], a[100:103], v[180:183]
  v_mfma_f32_16x16x32_bf16 v[184:187], v[108:111], a[104:107], v[184:187]
  buffer_load_dwordx4 v7, s[68:71], s40 offen offset:3168 lds
  s_add_u32 s40, s40, 262144
  v_mfma_f32_16x16x32_bf16 v[188:191], v[108:111], a[108:111], v[188:191]
  s_waitcnt lgkmcnt(4)
  v_mfma_f32_16x16x32_bf16 v[192:195], v[96:99], a[96:99], v[192:195]
  ds_read_b64_tr_b16 v[108:109], v9 offset:224
  ds_read_b64_tr_b16 v[110:111], v9 offset:4448
  v_mfma_f32_16x16x32_bf16 v[196:199], v[96:99], a[100:103], v[196:199]
  s_add_u32 m0, s42, 38016
  v_mfma_f32_16x16x32_bf16 v[200:203], v[96:99], a[104:107], v[200:203]
  buffer_load_dwordx4 v4, s[68:71], s41 offen offset:0 lds
  v_mfma_f32_16x16x32_bf16 v[204:207], v[96:99], a[108:111], v[204:207]
  s_waitcnt lgkmcnt(4)
  v_mfma_f32_16x16x32_bf16 v[208:211], v[100:103], a[96:99], v[208:211]
  ds_read_b64_tr_b16 v[96:97], v12 offset:33792
  ds_read_b64_tr_b16 v[98:99], v12 offset:38016
  v_mfma_f32_16x16x32_bf16 v[212:215], v[100:103], a[100:103], v[212:215]
  v_mfma_f32_16x16x32_bf16 v[216:219], v[100:103], a[104:107], v[216:219]
  buffer_load_dwordx4 v5, s[68:71], s41 offen offset:1056 lds
  v_mfma_f32_16x16x32_bf16 v[220:223], v[100:103], a[108:111], v[220:223]
  s_waitcnt lgkmcnt(4)
  v_mfma_f32_16x16x32_bf16 v[224:227], v[104:107], a[96:99], v[224:227]
  ds_read_b64_tr_b16 v[100:101], v12 offset:33824
  ds_read_b64_tr_b16 v[102:103], v12 offset:38048
  v_mfma_f32_16x16x32_bf16 v[228:231], v[104:107], a[100:103], v[228:231]
  v_mfma_f32_16x16x32_bf16 v[232:235], v[104:107], a[104:107], v[232:235]
  buffer_load_dwordx4 v6, s[68:71], s41 offen offset:2112 lds
  v_mfma_f32_16x16x32_bf16 v[236:239], v[104:107], a[108:111], v[236:239]
  s_waitcnt lgkmcnt(4)
  v_mfma_f32_16x16x32_bf16 v[240:243], v[108:111], a[96:99], v[240:243]
  ds_read_b64_tr_b16 v[104:105], v12 offset:33856
  ds_read_b64_tr_b16 v[106:107], v12 offset:38080
  v_mfma_f32_16x16x32_bf16 v[244:247], v[108:111], a[100:103], v[244:247]
  v_mfma_f32_16x16x32_bf16 v[248:251], v[108:111], a[104:107], v[248:251]
  buffer_load_dwordx4 v7, s[68:71], s41 offen offset:3168 lds
  s_add_u32 s41, s41, 262144
  v_mfma_f32_16x16x32_bf16 v[252:255], v[108:111], a[108:111], v[252:255]
  s_waitcnt lgkmcnt(4)
  v_mfma_f32_16x16x32_bf16 v[128:131], v[96:99], a[112:115], v[128:131]
  ds_read_b64_tr_b16 v[108:109], v12 offset:33888
  ds_read_b64_tr_b16 v[110:111], v12 offset:38112
  v_mfma_f32_16x16x32_bf16 v[132:135], v[96:99], a[116:119], v[132:135]
  s_waitcnt vmcnt(8)
  s_barrier
  v_mfma_f32_16x16x32_bf16 v[136:139], v[96:99], a[120:123], v[136:139]
  s_add_u32 m0, s42, 0
  v_mfma_f32_16x16x32_bf16 v[140:143], v[96:99], a[124:127], v[140:143]
  buffer_load_dwordx4 v4, s[68:71], s40 offen offset:0 lds
  s_waitcnt lgkmcnt(4)
  v_mfma_f32_16x16x32_bf16 v[144:147], v[100:103], a[112:115], v[144:147]
  ds_read_b64_tr_b16 v[96:97], v13 offset:33920
  ds_read_b64_tr_b16 v[98:99], v13 offset:38144
  v_mfma_f32_16x16x32_bf16 v[148:151], v[100:103], a[116:119], v[148:151]
  v_mfma_f32_16x16x32_bf16 v[152:155], v[100:103], a[120:123], v[152:155]
  buffer_load_dwordx4 v5, s[68:71], s40 offen offset:1056 lds
  v_mfma_f32_16x16x32_bf16 v[156:159], v[100:103], a[124:127], v[156:159]
  s_waitcnt lgkmcnt(4)
  v_mfma_f32_16x16x32_bf16 v[160:163], v[104:107], a[112:115], v[160:163]
  ds_read_b64_tr_b16 v[100:101], v13 offset:33952
  ds_read_b64_tr_b16 v[102:103], v13 offset:38176
  v_mfma_f32_16x16x32_bf16 v[164:167], v[104:107], a[116:119], v[164:167]
  v_mfma_f32_16x16x32_bf16 v[168:171], v[104:107], a[120:123], v[168:171]
  buffer_load_dwordx4 v6, s[68:71], s40 offen offset:2112 lds
  v_mfma_f32_16x16x32_bf16 v[172:175], v[104:107], a[124:127], v[172:175]
  s_waitcnt lgkmcnt(4)
  v_mfma_f32_16x16x32_bf16 v[176:179], v[108:111], a[112:115], v[176:179]
  ds_read_b64_tr_b16 v[104:105], v13 offset:33984
  ds_read_b64_tr_b16 v[106:107], v13 offset:38208
  v_mfma_f32_16x16x32_bf16 v[180:183], v[108:111], a[116:119], v[180:183]
  v_mfma_f32_16x16x32_bf16 v[184:187], v[108:111], a[120:123], v[184:187]
  buffer_load_dwordx4 v7, s[68:71], s40 offen offset:3168 lds
  s_add_u32 s40, s40, 262144
  v_mfma_f32_16x16x32_bf16 v[188:191], v[108:111], a[124:127], v[188:191]
  s_waitcnt lgkmcnt(4)
  v_mfma_f32_16x16x32_bf16 v[192:195], v[96:99], a[112:115], v[192:195]
  ds_read_b64_tr_b16 v[108:109], v13 offset:34016
  ds_read_b64_tr_b16 v[110:111], v13 offset:38240
  v_mfma_f32_16x16x32_bf16 v[196:199], v[96:99], a[116:119], v[196:199]
  s_add_u32 m0, s42, 4224
  v_mfma_f32_16x16x32_bf16 v[200:203], v[96:99], a[120:123], v[200:203]
  buffer_load_dwordx4 v4, s[68:71], s41 offen offset:0 lds
  v_mfma_f32_16x16x32_bf16 v[204:207], v[96:99], a[124:127], v[204:207]
  s_waitcnt lgkmcnt(4)
  v_mfma_f32_16x16x32_bf16 v[208:211], v[100:103], a[112:115], v[208:211]
  ds_read_b64_tr_b16 v[96:97], v12 offset:0
  ds_read_b64_tr_b16 v[98:99], v12 offset:4224
  v_mfma_f32_16x16x32_bf16 v[212:215], v[100:103], a[116:119], v[212:215]
  v_mfma_f32_16x16x32_bf16 v[216:219], v[100:103], a[120:123], v[216:219]
  buffer_load_dwordx4 v5, s[68:71], s41 offen offset:1056 lds
  v_mfma_f32_16x16x32_bf16 v[220:223], v[100:103], a[124:127], v[220:223]
  s_waitcnt lgkmcnt(4)
  v_mfma_f32_16x16x32_bf16 v[224:227], v[104:107], a[112:115], v[224:227]
  ds_read_b64_tr_b16 v[100:101], v12 offset:32
  ds_read_b64_tr_b16 v[102:103], v12 offset:4256
  v_mfma_f32_16x16x32_bf16 v[228:231], v[104:107], a[116:119], v[228:231]
  v_mfma_f32_16x16x32_bf16 v[232:235], v[104:107], a[120:123], v[232:235]
  buffer_load_dwordx4 v6, s[68:71], s41 offen offset:2112 lds
  v_mfma_f32_16x16x32_bf16 v[236:239], v[104:107], a[124:127], v[236:239]
  s_waitcnt lgkmcnt(4)
  v_mfma_f32_16x16x32_bf16 v[240:243], v[108:111], a[112:115], v[240:243]
  ds_read_b64_tr_b16 v[104:105], v12 offset:64
  ds_read_b64_tr_b16 v[106:107], v12 offset:4288
  v_mfma_f32_16x16x32_bf16 v[244:247], v[108:111], a[116:119], v[244:247]
  v_mfma_f32_16x16x32_bf16 v[248:251], v[108:111], a[120:123], v[248:251]
  buffer_load_dwordx4 v7, s[68:71], s41 offen offset:3168 lds
  s_add_u32 s41, s41, 262144
  v_mfma_f32_16x16x32_bf16 v[252:255], v[108:111], a[124:127], v[252:255]
  s_waitcnt lgkmcnt(4)
  v_mfma_f32_16x16x32_bf16 v[128:131], v[96:99], a[128:131], v[128:131]
  ds_read_b64_tr_b16 v[108:109], v12 offset:96
  ds_read_b64_tr_b16 v[110:111], v12 offset:4320
  v_mfma_f32_16x16x32_bf16 v[132:135], v[96:99], a[132:135], v[132:135]
  s_waitcnt vmcnt(8)
  s_barrier
  v_mfma_f32_16x16x32_bf16 v[136:139], v[96:99], a[136:139], v[136:139]
  s_add_u32 m0, s42, 101376
  v_mfma_f32_16x16x32_bf16 v[140:143], v[96:99], a[140:143], v[140:143]
  buffer_load_dwordx4 v4, s[68:71], s40 offen offset:0 lds
  s_waitcnt lgkmcnt(4)
  v_mfma_f32_16x16x32_bf16 v[144:147], v[100:103], a[128:131], v[144:147]
  ds_read_b64_tr_b16 v[96:97], v13 offset:128
  ds_read_b64_tr_b16 v[98:99], v13 offset:4352
  v_mfma_f32_16x16x32_bf16 v[148:151], v[100:103], a[132:135], v[148:151]
  v_mfma_f32_16x16x32_bf16 v[152:155], v[100:103], a[136:139], v[152:155]
  buffer_load_dwordx4 v5, s[68:71], s40 offen offset:1056 lds
  v_mfma_f32_16x16x32_bf16 v[156:159], v[100:103], a[140:143], v[156:159]
  s_waitcnt lgkmcnt(4)
  v_mfma_f32_16x16x32_bf16 v[160:163], v[104:107], a[128:131], v[160:163]
  ds_read_b64_tr_b16 v[100:101], v13 offset:160
  ds_read_b64_tr_b16 v[102:103], v13 offset:4384
  v_mfma_f32_16x16x32_bf16 v[164:167], v[104:107], a[132:135], v[164:167]
  v_mfma_f32_16x16x32_bf16 v[168:171], v[104:107], a[136:139], v[168:171]
  buffer_load_dwordx4 v6, s[68:71], s40 offen offset:2112 lds
  v_mfma_f32_16x16x32_bf16 v[172:175], v[104:107], a[140:143], v[172:175]
  s_waitcnt lgkmcnt(4)
  v_mfma_f32_16x16x32_bf16 v[176:179], v[108:111], a[128:131], v[176:179]
  ds_read_b64_tr_b16 v[104:105], v13 offset:192
  ds_read_b64_tr_b16 v[106:107], v13 offset:4416
  v_mfma_f32_16x16x32_bf16 v[180:183], v[108:111], a[132:135], v[180:183]
  v_mfma_f32_16x16x32_bf16 v[184:187], v[108:111], a[136:139], v[184:187]
  buffer_load_dwordx4 v7, s[68:71], s40 offen offset:3168 lds
  s_add_u32 s40, s40, 262144
  v_mfma_f32_16x16x32_bf16 v[188:191], v[108:111], a[140:143], v[188:191]
  s_waitcnt lgkmcnt(4)
  v_mfma_f32_16x16x32_bf16 v[192:195], v[96:99], a[128:131], v[192:195]
  ds_read_b64_tr_b16 v[108:109], v13 offset:224
  ds_read_b64_tr_b16 v[110:111], v13 offset:4448
  v_mfma_f32_16x16x32_bf16 v[196:199], v[96:99], a[132:135], v[196:199]
  s_add_u32 m0, s42, 105600
  v_mfma_f32_16x16x32_bf16 v[200:203], v[96:99], a[136:139], v[200:203]
  buffer_load_dwordx4 v4, s[68:71], s41 offen offset:0 lds
  v_mfma_f32_16x16x32_bf16 v[204:207], v[96:99], a[140:143], v[204:207]
  s_waitcnt lgkmcnt(4)
  v_mfma_f32_16x16x32_bf16 v[208:211], v[100:103], a[128:131], v[208:211]
  ds_read_b64_tr_b16 v[96:97], v8 offset:33792
  ds_read_b64_tr_b16 v[98:99], v8 offset:38016
  v_mfma_f32_16x16x32_bf16 v[212:215], v[100:103], a[132:135], v[212:215]
  v_mfma_f32_16x16x32_bf16 v[216:219], v[100:103], a[136:139], v[216:219]
  buffer_load_dwordx4 v5, s[68:71], s41 offen offset:1056 lds
  v_mfma_f32_16x16x32_bf16 v[220:223], v[100:103], a[140:143], v[220:223]
  s_waitcnt lgkmcnt(4)
  v_mfma_f32_16x16x32_bf16 v[224:227], v[104:107], a[128:131], v[224:227]
  ds_read_b64_tr_b16 v[100:101], v8 offset:33824
  ds_read_b64_tr_b16 v[102:103], v8 offset:38048
  v_mfma_f32_16x16x32_bf16 v[228:231], v[104:107], a[132:135], v[228:231]
  v_mfma_f32_16x16x32_bf16 v[232:235], v[104:107], a[136:139], v[232:235]
  buffer_load_dwordx4 v6, s[68:71], s41 offen offset:2112 lds
  v_mfma_f32_16x16x32_bf16 v[236:239], v[104:107], a[140:143], v[236:239]
  s_waitcnt lgkmcnt(4)
  v_mfma_f32_16x16x32_bf16 v[240:243], v[108:111], a[128:131], v[240:243]
  ds_read_b64_tr_b16 v[104:105], v8 offset:33856
  ds_read_b64_tr_b16 v[106:107], v8 offset:38080
  v_mfma_f32_16x16x32_bf16 v[244:247], v[108:111], a[132:135], v[244:247]
  v_mfma_f32_16x16x32_bf16 v[248:251], v[108:111], a[136:139], v[248:251]
  buffer_load_dwordx4 v7, s[68:71], s41 offen offset:3168 lds
  s_add_u32 s41, s41, 262144
  v_mfma_f32_16x16x32_bf16 v[252:255], v[108:111], a[140:143], v[252:255]
  s_waitcnt lgkmcnt(4)
  v_mfma_f32_16x16x32_bf16 v[128:131], v[96:99], a[144:147], v[128:131]
  ds_read_b64_tr_b16 v[108:109], v8 offset:33888
  ds_read_b64_tr_b16 v[110:111], v8 offset:38112
  v_mfma_f32_16x16x32_bf16 v[132:135], v[96:99], a[148:151], v[132:135]
  s_waitcnt vmcnt(8)
  s_barrier
  v_mfma_f32_16x16x32_bf16 v[136:139], v[96:99], a[152:155], v[136:139]
  s_add_u32 m0, s42, 67584
  v_mfma_f32_16x16x32_bf16 v[140:143], v[96:99], a[156:159], v[140:143]
  buffer_load_dwordx4 v4, s[68:71], s40 offen offset:0 lds
  s_waitcnt lgkmcnt(4)
  v_mfma_f32_16x16x32_bf16 v[144:147], v[100:103], a[144:147], v[144:147]
  ds_read_b64_tr_b16 v[96:97], v9 offset:33920
  ds_read_b64_tr_b16 v[98:99], v9 offset:38144
  v_mfma_f32_16x16x32_bf16 v[148:151], v[100:103], a[148:151], v[148:151]
  v_mfma_f32_16x16x32_bf16 v[152:155], v[100:103], a[152:155], v[152:155]
  buffer_load_dwordx4 v5, s[68:71], s40 offen offset:1056 lds
  v_mfma_f32_16x16x32_bf16 v[156:159], v[100:103], a[156:159], v[156:159]
  s_waitcnt lgkmcnt(4)
  v_mfma_f32_16x16x32_bf16 v[160:163], v[104:107], a[144:147], v[160:163]
  ds_read_b64_tr_b16 v[100:101], v9 offset:33952
  ds_read_b64_tr_b16 v[102:103], v9 offset:38176
  v_mfma_f32_16x16x32_bf16 v[164:167], v[104:107], a[148:151], v[164:167]
  v_mfma_f32_16x16x32_bf16 v[168:171], v[104:107], a[152:155], v[168:171]
  buffer_load_dwordx4 v6, s[68:71], s40 offen offset:2112 lds
  v_mfma_f32_16x16x32_bf16 v[172:175], v[104:107], a[156:159], v[172:175]
  s_waitcnt lgkmcnt(4)
  v_mfma_f32_16x16x32_bf16 v[176:179], v[108:111], a[144:147], v[176:179]
  ds_read_b64_tr_b16 v[104:105], v9 offset:33984
  ds_read_b64_tr_b16 v[106:107], v9 offset:38208
  v_mfma_f32_16x16x32_bf16 v[180:183], v[108:111], a[148:151], v[180:183]
  v_mfma_f32_16x16x32_bf16 v[184:187], v[108:111], a[152:155], v[184:187]
  buffer_load_dwordx4 v7, s[68:71], s40 offen offset:3168 lds
  s_add_u32 s40, s40, 262144
  v_mfma_f32_16x16x32_bf16 v[188:191], v[108:111], a[156:159], v[188:191]
  s_waitcnt lgkmcnt(4)
  v_mfma_f32_16x16x32_bf16 v[192:195], v[96:99], a[144:147], v[192:195]
  ds_read_b64_tr_b16 v[108:109], v9 offset:34016
  ds_read_b64_tr_b16 v[110:111], v9 offset:38240
  v_mfma_f32_16x16x32_bf16 v[196:199], v[96:99], a[148:151], v[196:199]
  s_add_u32 m0, s42, 71808
  v_mfma_f32_16x16x32_bf16 v[200:203], v[96:99], a[152:155], v[200:203]
  buffer_load_dwordx4 v4, s[68:71], s41 offen offset:0 lds
  v_mfma_f32_16x16x32_bf16 v[204:207], v[96:99], a[156:159], v[204:207]
  s_waitcnt lgkmcnt(4)
  v_mfma_f32_16x16x32_bf16 v[208:211], v[100:103], a[144:147], v[208:211]
  ds_read_b64_tr_b16 v[96:97], v8 offset:0
  ds_read_b64_tr_b16 v[98:99], v8 offset:4224
  v_mfma_f32_16x16x32_bf16 v[212:215], v[100:103], a[148:151], v[212:215]
  v_mfma_f32_16x16x32_bf16 v[216:219], v[100:103], a[152:155], v[216:219]
  buffer_load_dwordx4 v5, s[68:71], s41 offen offset:1056 lds
  v_mfma_f32_16x16x32_bf16 v[220:223], v[100:103], a[156:159], v[220:223]
  s_waitcnt lgkmcnt(4)
  v_mfma_f32_16x16x32_bf16 v[224:227], v[104:107], a[144:147], v[224:227]
  ds_read_b64_tr_b16 v[100:101], v8 offset:32
  ds_read_b64_tr_b16 v[102:103], v8 offset:4256
  v_mfma_f32_16x16x32_bf16 v[228:231], v[104:107], a[148:151], v[228:231]
  v_mfma_f32_16x16x32_bf16 v[232:235], v[104:107], a[152:155], v[232:235]
  buffer_load_dwordx4 v6, s[68:71], s41 offen offset:2112 lds
  v_mfma_f32_16x16x32_bf16 v[236:239], v[104:107], a[156:159], v[236:239]
  s_waitcnt lgkmcnt(4)
  v_mfma_f32_16x16x32_bf16 v[240:243], v[108:111], a[144:147], v[240:243]
  ds_read_b64_tr_b16 v[104:105], v8 offset:64
  ds_read_b64_tr_b16 v[106:107], v8 offset:4288
  v_mfma_f32_16x16x32_bf16 v[244:247], v[108:111], a[148:151], v[244:247]
  v_mfma_f32_16x16x32_bf16 v[248:251], v[108:111], a[152:155], v[248:251]
  buffer_load_dwordx4 v7, s[68:71], s41 offen offset:3168 lds
  s_add_u32 s41, s41, 262144
  v_mfma_f32_16x16x32_bf16 v[252:255], v[108:111], a[156:159], v[252:255]
  s_waitcnt lgkmcnt(4)
  v_mfma_f32_16x16x32_bf16 v[128:131], v[96:99], a[160:163], v[128:131]
  ds_read_b64_tr_b16 v[108:109], v8 offset:96
  ds_read_b64_tr_b16 v[110:111], v8 offset:4320
  v_mfma_f32_16x16x32_bf16 v[132:135], v[96:99], a[164:167], v[132:135]
  s_waitcnt vmcnt(8)
  s_barrier
  v_mfma_f32_16x16x32_bf16 v[136:139], v[96:99], a[168:171], v[136:139]
  s_add_u32 m0, s42, 33792
  v_mfma_f32_16x16x32_bf16 v[140:143], v[96:99], a[172:175], v[140:143]
  buffer_load_dwordx4 v4, s[68:71], s40 offen offset:0 lds
  s_waitcnt lgkmcnt(4)
  v_mfma_f32_16x16x32_bf16 v[144:147], v[100:103], a[160:163], v[144:147]
  ds_read_b64_tr_b16 v[96:97], v9 offset:128
  ds_read_b64_tr_b16 v[98:99], v9 offset:4352
  v_mfma_f32_16x16x32_bf16 v[148:151], v[100:103], a[164:167], v[148:151]
  v_mfma_f32_16x16x32_bf16 v[152:155], v[100:103], a[168:171], v[152:155]
  buffer_load_dwordx4 v5, s[68:71], s40 offen offset:1056 lds
  v_mfma_f32_16x16x32_bf16 v[156:159], v[100:103], a[172:175], v[156:159]
  s_waitcnt lgkmcnt(4)
  v_mfma_f32_16x16x32_bf16 v[160:163], v[104:107], a[160:163], v[160:163]
  ds_read_b64_tr_b16 v[100:101], v9 offset:160
  ds_read_b64_tr_b16 v[102:103], v9 offset:4384
  v_mfma_f32_16x16x32_bf16 v[164:167], v[104:107], a[164:167], v[164:167]
  v_mfma_f32_16x16x32_bf16 v[168:171], v[104:107], a[168:171], v[168:171]
  buffer_load_dwordx4 v6, s[68:71], s40 offen offset:2112 lds
  v_mfma_f32_16x16x32_bf16 v[172:175], v[104:107], a[172:175], v[172:175]
  s_waitcnt lgkmcnt(4)
  v_mfma_f32_16x16x32_bf16 v[176:179], v[108:111], a[160:163], v[176:179]
  ds_read_b64_tr_b16 v[104:105], v9 offset:192
  ds_read_b64_tr_b16 v[106:107], v9 offset:4416
  v_mfma_f32_16x16x32_bf16 v[180:183], v[108:111], a[164:167], v[180:183]
  v_mfma_f32_16x16x32_bf16 v[184:187], v[108:111], a[168:171], v[184:187]
  buffer_load_dwordx4 v7, s[68:71], s40 offen offset:3168 lds
  s_add_u32 s40, s40, 262144
  v_mfma_f32_16x16x32_bf16 v[188:191], v[108:111], a[172:175], v[188:191]
  s_waitcnt lgkmcnt(4)
  v_mfma_f32_16x16x32_bf16 v[192:195], v[96:99], a[160:163], v[192:195]
  ds_read_b64_tr_b16 v[108:109], v9 offset:224
  ds_read_b64_tr_b16 v[110:111], v9 offset:4448
  v_mfma_f32_16x16x32_bf16 v[196:199], v[96:99], a[164:167], v[196:199]
  s_add_u32 m0, s42, 38016
  v_mfma_f32_16x16x32_bf16 v[200:203], v[96:99], a[168:171], v[200:203]
  buffer_load_dwordx4 v4, s[68:71], s41 offen offset:0 lds
  v_mfma_f32_16x16x32_bf16 v[204:207], v[96:99], a[172:175], v[204:207]
  s_waitcnt lgkmcnt(4)
  v_mfma_f32_16x16x32_bf16 v[208:211], v[100:103], a[160:163], v[208:211]
  ds_read_b64_tr_b16 v[96:97], v12 offset:33792
  ds_read_b64_tr_b16 v[98:99], v12 offset:38016
  v_mfma_f32_16x16x32_bf16 v[212:215], v[100:103], a[164:167], v[212:215]
  v_mfma_f32_16x16x32_bf16 v[216:219], v[100:103], a[168:171], v[216:219]
  buffer_load_dwordx4 v5, s[68:71], s41 offen offset:1056 lds
  v_mfma_f32_16x16x32_bf16 v[220:223], v[100:103], a[172:175], v[220:223]
  s_waitcnt lgkmcnt(4)
  v_mfma_f32_16x16x32_bf16 v[224:227], v[104:107], a[160:163], v[224:227]
  ds_read_b64_tr_b16 v[100:101], v12 offset:33824
  ds_read_b64_tr_b16 v[102:103], v12 offset:38048
  v_mfma_f32_16x16x32_bf16 v[228:231], v[104:107], a[164:167], v[228:231]
  v_mfma_f32_16x16x32_bf16 v[232:235], v[104:107], a[168:171], v[232:235]
  buffer_load_dwordx4 v6, s[68:71], s41 offen offset:2112 lds
  v_mfma_f32_16x16x32_bf16 v[236:239], v[104:107], a[172:175], v[236:239]
  s_waitcnt lgkmcnt(4)
  v_mfma_f32_16x16x32_bf16 v[240:243], v[108:111], a[160:163], v[240:243]
  ds_read_b64_tr_b16 v[104:105], v12 offset:33856
  ds_read_b64_tr_b16 v[106:107], v12 offset:38080
  v_mfma_f32_16x16x32_bf16 v[244:247], v[108:111], a[164:167], v[244:247]
  v_mfma_f32_16x16x32_bf16 v[248:251], v[108:111], a[168:171], v[248:251]
  buffer_load_dwordx4 v7, s[68:71], s41 offen offset:3168 lds
  s_add_u32 s41, s41, 262144
  v_mfma_f32_16x16x32_bf16 v[252:255], v[108:111], a[172:175], v[252:255]
  s_waitcnt lgkmcnt(4)
  v_mfma_f32_16x16x32_bf16 v[128:131], v[96:99], a[176:179], v[128:131]
  ds_read_b64_tr_b16 v[108:109], v12 offset:33888
  ds_read_b64_tr_b16 v[110:111], v12 offset:38112
  v_mfma_f32_16x16x32_bf16 v[132:135], v[96:99], a[180:183], v[132:135]
  s_waitcnt vmcnt(8)
  s_barrier
  v_mfma_f32_16x16x32_bf16 v[136:139], v[96:99], a[184:187], v[136:139]
  s_add_u32 m0, s23, 0
  v_mfma_f32_16x16x32_bf16 v[140:143], v[96:99], a[188:191], v[140:143]
  buffer_load_dwordx4 v124, s[4:7], s20 offen offset:0 lds
  s_waitcnt lgkmcnt(4)
  v_mfma_f32_16x16x32_bf16 v[144:147], v[100:103], a[176:179], v[144:147]
  ds_read_b64_tr_b16 v[96:97], v13 offset:33920
  ds_read_b64_tr_b16 v[98:99], v13 offset:38144
  v_mfma_f32_16x16x32_bf16 v[148:151], v[100:103], a[180:183], v[148:151]
  v_mfma_f32_16x16x32_bf16 v[152:155], v[100:103], a[184:187], v[152:155]
  buffer_load_dwordx4 v125, s[4:7], s20 offen offset:1056 lds
  v_mfma_f32_16x16x32_bf16 v[156:159], v[100:103], a[188:191], v[156:159]
  s_waitcnt lgkmcnt(4)
  v_mfma_f32_16x16x32_bf16 v[160:163], v[104:107], a[176:179], v[160:163]
  ds_read_b64_tr_b16 v[100:101], v13 offset:33952
  ds_read_b64_tr_b16 v[102:103], v13 offset:38176
  v_mfma_f32_16x16x32_bf16 v[164:167], v[104:107], a[180:183], v[164:167]
  v_mfma_f32_16x16x32_bf16 v[168:171], v[104:107], a[184:187], v[168:171]
  buffer_load_dwordx4 v126, s[4:7], s20 offen offset:2112 lds
  v_mfma_f32_16x16x32_bf16 v[172:175], v[104:107], a[188:191], v[172:175]
  s_waitcnt lgkmcnt(4)
  v_mfma_f32_16x16x32_bf16 v[176:179], v[108:111], a[176:179], v[176:179]
  ds_read_b64_tr_b16 v[104:105], v13 offset:33984
  ds_read_b64_tr_b16 v[106:107], v13 offset:38208
  v_mfma_f32_16x16x32_bf16 v[180:183], v[108:111], a[180:183], v[180:183]
  v_mfma_f32_16x16x32_bf16 v[184:187], v[108:111], a[184:187], v[184:187]
  buffer_load_dwordx4 v127, s[4:7], s20 offen offset:3168 lds
  s_add_u32 s20, s20, 16384
  v_mfma_f32_16x16x32_bf16 v[188:191], v[108:111], a[188:191], v[188:191]
  s_waitcnt lgkmcnt(4)
  v_mfma_f32_16x16x32_bf16 v[192:195], v[96:99], a[176:179], v[192:195]
  ds_read_b64_tr_b16 v[108:109], v13 offset:34016
  ds_read_b64_tr_b16 v[110:111], v13 offset:38240
  v_mfma_f32_16x16x32_bf16 v[196:199], v[96:99], a[180:183], v[196:199]
  s_add_u32 m0, s23, 4224
  v_mfma_f32_16x16x32_bf16 v[200:203], v[96:99], a[184:187], v[200:203]
  buffer_load_dwordx4 v124, s[4:7], s26 offen offset:0 lds
  v_mfma_f32_16x16x32_bf16 v[204:207], v[96:99], a[188:191], v[204:207]
  s_waitcnt lgkmcnt(4)
  v_mfma_f32_16x16x32_bf16 v[208:211], v[100:103], a[176:179], v[208:211]
  ds_read_b64_tr_b16 v[96:97], v12 offset:0
  ds_read_b64_tr_b16 v[98:99], v12 offset:4224
  v_mfma_f32_16x16x32_bf16 v[212:215], v[100:103], a[180:183], v[212:215]
  v_mfma_f32_16x16x32_bf16 v[216:219], v[100:103], a[184:187], v[216:219]
  buffer_load_dwordx4 v125, s[4:7], s26 offen offset:1056 lds
  v_mfma_f32_16x16x32_bf16 v[220:223], v[100:103], a[188:191], v[220:223]
  s_waitcnt lgkmcnt(4)
  v_mfma_f32_16x16x32_bf16 v[224:227], v[104:107], a[176:179], v[224:227]
  ds_read_b64_tr_b16 v[100:101], v12 offset:32
  ds_read_b64_tr_b16 v[102:103], v12 offset:4256
  v_mfma_f32_16x16x32_bf16 v[228:231], v[104:107], a[180:183], v[228:231]
  v_mfma_f32_16x16x32_bf16 v[232:235], v[104:107], a[184:187], v[232:235]
  buffer_load_dwordx4 v126, s[4:7], s26 offen offset:2112 lds
  v_mfma_f32_16x16x32_bf16 v[236:239], v[104:107], a[188:191], v[236:239]
  s_waitcnt lgkmcnt(4)
  v_mfma_f32_16x16x32_bf16 v[240:243], v[108:111], a[176:179], v[240:243]
  ds_read_b64_tr_b16 v[104:105], v12 offset:64
  ds_read_b64_tr_b16 v[106:107], v12 offset:4288
  v_mfma_f32_16x16x32_bf16 v[244:247], v[108:111], a[180:183], v[244:247]
  v_mfma_f32_16x16x32_bf16 v[248:251], v[108:111], a[184:187], v[248:251]
  buffer_load_dwordx4 v127, s[4:7], s26 offen offset:3168 lds
  s_add_u32 s26, s26, 16384
  v_mfma_f32_16x16x32_bf16 v[252:255], v[108:111], a[188:191], v[252:255]
  s_waitcnt lgkmcnt(4)
  v_mfma_f32_16x16x32_bf16 v[128:131], v[96:99], a[192:195], v[128:131]
  ds_read_b64_tr_b16 v[108:109], v12 offset:96
  ds_read_b64_tr_b16 v[110:111], v12 offset:4320
  v_mfma_f32_16x16x32_bf16 v[132:135], v[96:99], a[196:199], v[132:135]
  s_waitcnt vmcnt(8)
  s_barrier
  v_mfma_f32_16x16x32_bf16 v[136:139], v[96:99], a[200:203], v[136:139]
  v_mfma_f32_16x16x32_bf16 v[140:143], v[96:99], a[204:207], v[140:143]
  s_waitcnt lgkmcnt(4)
  v_mfma_f32_16x16x32_bf16 v[144:147], v[100:103], a[192:195], v[144:147]
  ds_read_b64_tr_b16 v[96:97], v13 offset:128
  ds_read_b64_tr_b16 v[98:99], v13 offset:4352
  v_mfma_f32_16x16x32_bf16 v[148:151], v[100:103], a[196:199], v[148:151]
  v_mfma_f32_16x16x32_bf16 v[152:155], v[100:103], a[200:203], v[152:155]
  v_mfma_f32_16x16x32_bf16 v[156:159], v[100:103], a[204:207], v[156:159]
  s_waitcnt lgkmcnt(4)
  v_mfma_f32_16x16x32_bf16 v[160:163], v[104:107], a[192:195], v[160:163]
  ds_read_b64_tr_b16 v[100:101], v13 offset:160
  ds_read_b64_tr_b16 v[102:103], v13 offset:4384
  v_mfma_f32_16x16x32_bf16 v[164:167], v[104:107], a[196:199], v[164:167]
  v_mfma_f32_16x16x32_bf16 v[168:171], v[104:107], a[200:203], v[168:171]
  v_mfma_f32_16x16x32_bf16 v[172:175], v[104:107], a[204:207], v[172:175]
  s_waitcnt lgkmcnt(4)
  v_mfma_f32_16x16x32_bf16 v[176:179], v[108:111], a[192:195], v[176:179]
  ds_read_b64_tr_b16 v[104:105], v13 offset:192
  ds_read_b64_tr_b16 v[106:107], v13 offset:4416
  v_mfma_f32_16x16x32_bf16 v[180:183], v[108:111], a[196:199], v[180:183]
  v_mfma_f32_16x16x32_bf16 v[184:187], v[108:111], a[200:203], v[184:187]
  v_mfma_f32_16x16x32_bf16 v[188:191], v[108:111], a[204:207], v[188:191]
  s_waitcnt lgkmcnt(4)
  v_mfma_f32_16x16x32_bf16 v[192:195], v[96:99], a[192:195], v[192:195]
  ds_read_b64_tr_b16 v[108:109], v13 offset:224
  ds_read_b64_tr_b16 v[110:111], v13 offset:4448
  v_mfma_f32_16x16x32_bf16 v[196:199], v[96:99], a[196:199], v[196:199]
  v_mfma_f32_16x16x32_bf16 v[200:203], v[96:99], a[200:203], v[200:203]
  v_mfma_f32_16x16x32_bf16 v[204:207], v[96:99], a[204:207], v[204:207]
  s_waitcnt lgkmcnt(4)
  v_mfma_f32_16x16x32_bf16 v[208:211], v[100:103], a[192:195], v[208:211]
  ds_read_b64_tr_b16 v[96:97], v8 offset:33792
  ds_read_b64_tr_b16 v[98:99], v8 offset:38016
  v_mfma_f32_16x16x32_bf16 v[212:215], v[100:103], a[196:199], v[212:215]
  v_mfma_f32_16x16x32_bf16 v[216:219], v[100:103], a[200:203], v[216:219]
  v_mfma_f32_16x16x32_bf16 v[220:223], v[100:103], a[204:207], v[220:223]
  s_waitcnt lgkmcnt(4)
  v_mfma_f32_16x16x32_bf16 v[224:227], v[104:107], a[192:195], v[224:227]
  ds_read_b64_tr_b16 v[100:101], v8 offset:33824
  ds_read_b64_tr_b16 v[102:103], v8 offset:38048
  v_mfma_f32_16x16x32_bf16 v[228:231], v[104:107], a[196:199], v[228:231]
  v_mfma_f32_16x16x32_bf16 v[232:235], v[104:107], a[200:203], v[232:235]
  v_mfma_f32_16x16x32_bf16 v[236:239], v[104:107], a[204:207], v[236:239]
  s_waitcnt lgkmcnt(4)
  v_mfma_f32_16x16x32_bf16 v[240:243], v[108:111], a[192:195], v[240:243]
  ds_read_b64_tr_b16 v[104:105], v8 offset:33856
  ds_read_b64_tr_b16 v[106:107], v8 offset:38080
  v_mfma_f32_16x16x32_bf16 v[244:247], v[108:111], a[196:199], v[244:247]
  v_mfma_f32_16x16x32_bf16 v[248:251], v[108:111], a[200:203], v[248:251]
  v_mfma_f32_16x16x32_bf16 v[252:255], v[108:111], a[204:207], v[252:255]
  s_waitcnt lgkmcnt(4)
  v_mfma_f32_16x16x32_bf16 v[128:131], v[96:99], a[208:211], v[128:131]
  ds_read_b64_tr_b16 v[108:109], v8 offset:33888
  ds_read_b64_tr_b16 v[110:111], v8 offset:38112
  v_mfma_f32_16x16x32_bf16 v[132:135], v[96:99], a[212:215], v[132:135]
  s_barrier
  v_mfma_f32_16x16x32_bf16 v[136:139], v[96:99], a[216:219], v[136:139]
  v_mfma_f32_16x16x32_bf16 v[140:143], v[96:99], a[220:223], v[140:143]
  s_waitcnt lgkmcnt(4)
  v_mfma_f32_16x16x32_bf16 v[144:147], v[100:103], a[208:211], v[144:147]
  ds_read_b64_tr_b16 v[96:97], v9 offset:33920
  ds_read_b64_tr_b16 v[98:99], v9 offset:38144
  v_mfma_f32_16x16x32_bf16 v[148:151], v[100:103], a[212:215], v[148:151]
  v_mfma_f32_16x16x32_bf16 v[152:155], v[100:103], a[216:219], v[152:155]
  v_mfma_f32_16x16x32_bf16 v[156:159], v[100:103], a[220:223], v[156:159]
  s_waitcnt lgkmcnt(4)
  v_mfma_f32_16x16x32_bf16 v[160:163], v[104:107], a[208:211], v[160:163]
  ds_read_b64_tr_b16 v[100:101], v9 offset:33952
  ds_read_b64_tr_b16 v[102:103], v9 offset:38176
  v_mfma_f32_16x16x32_bf16 v[164:167], v[104:107], a[212:215], v[164:167]
  v_mfma_f32_16x16x32_bf16 v[168:171], v[104:107], a[216:219], v[168:171]
  v_mfma_f32_16x16x32_bf16 v[172:175], v[104:107], a[220:223], v[172:175]
  s_waitcnt lgkmcnt(4)
  v_mfma_f32_16x16x32_bf16 v[176:179], v[108:111], a[208:211], v[176:179]
  ds_read_b64_tr_b16 v[104:105], v9 offset:33984
  ds_read_b64_tr_b16 v[106:107], v9 offset:38208
  v_mfma_f32_16x16x32_bf16 v[180:183], v[108:111], a[212:215], v[180:183]
  v_mfma_f32_16x16x32_bf16 v[184:187], v[108:111], a[216:219], v[184:187]
  v_mfma_f32_16x16x32_bf16 v[188:191], v[108:111], a[220:223], v[188:191]
  s_waitcnt lgkmcnt(4)
  v_mfma_f32_16x16x32_bf16 v[192:195], v[96:99], a[208:211], v[192:195]
  ds_read_b64_tr_b16 v[108:109], v9 offset:34016
  ds_read_b64_tr_b16 v[110:111], v9 offset:38240
  v_mfma_f32_16x16x32_bf16 v[196:199], v[96:99], a[212:215], v[196:199]
  v_mfma_f32_16x16x32_bf16 v[200:203], v[96:99], a[216:219], v[200:203]
  v_mfma_f32_16x16x32_bf16 v[204:207], v[96:99], a[220:223], v[204:207]
  s_waitcnt lgkmcnt(4)
  v_mfma_f32_16x16x32_bf16 v[208:211], v[100:103], a[208:211], v[208:211]
  v_mfma_f32_16x16x32_bf16 v[212:215], v[100:103], a[212:215], v[212:215]
  v_mfma_f32_16x16x32_bf16 v[216:219], v[100:103], a[216:219], v[216:219]
  v_mfma_f32_16x16x32_bf16 v[220:223], v[100:103], a[220:223], v[220:223]
  s_waitcnt lgkmcnt(2)
  v_mfma_f32_16x16x32_bf16 v[224:227], v[104:107], a[208:211], v[224:227]
  v_mfma_f32_16x16x32_bf16 v[228:231], v[104:107], a[212:215], v[228:231]
  v_mfma_f32_16x16x32_bf16 v[232:235], v[104:107], a[216:219], v[232:235]
  v_mfma_f32_16x16x32_bf16 v[236:239], v[104:107], a[220:223], v[236:239]
  s_waitcnt lgkmcnt(0)
  v_mfma_f32_16x16x32_bf16 v[240:243], v[108:111], a[208:211], v[240:243]
  v_mfma_f32_16x16x32_bf16 v[244:247], v[108:111], a[212:215], v[244:247]
  v_mfma_f32_16x16x32_bf16 v[248:251], v[108:111], a[216:219], v[248:251]
  v_mfma_f32_16x16x32_bf16 v[252:255], v[108:111], a[220:223], v[252:255]
  s_nop 7
  v_and_b32 v1, 15, v0
  v_lshlrev_b32 v1, 4, v1
  v_bfe_u32 v2, v0, 4, 1
  v_lshl_add_u32 v1, v2, 3, v1
  v_lshrrev_b32 v2, 5, v0
  v_lshl_add_u32 v1, v2, 8, v1
  s_lshl_b32 s36, s33, 15
  s_add_u32 s36, s36, 98304
  s_lshl_b32 s37, s32, 12
  s_add_u32 s37, s37, s36
  v_add_u32 v3, s37, v1
  v_cvt_pk_bf16_f32 v96, v128, v129
  v_cvt_pk_bf16_f32 v97, v130, v131
  ds_write_b64 v3, v[96:97] offset:0
  v_cvt_pk_bf16_f32 v98, v132, v133
  v_cvt_pk_bf16_f32 v99, v134, v135
  ds_write_b64 v3, v[98:99] offset:8192
  v_cvt_pk_bf16_f32 v100, v136, v137
  v_cvt_pk_bf16_f32 v101, v138, v139
  ds_write_b64 v3, v[100:101] offset:16384
  v_cvt_pk_bf16_f32 v102, v140, v141
  v_cvt_pk_bf16_f32 v103, v142, v143
  ds_write_b64 v3, v[102:103] offset:24576
  v_cvt_pk_bf16_f32 v104, v144, v145
  v_cvt_pk_bf16_f32 v105, v146, v147
  ds_write_b64 v3, v[104:105] offset:512
  v_cvt_pk_bf16_f32 v106, v148, v149
  v_cvt_pk_bf16_f32 v107, v150, v151
  ds_write_b64 v3, v[106:107] offset:8704
  v_cvt_pk_bf16_f32 v108, v152, v153
  v_cvt_pk_bf16_f32 v109, v154, v155
  ds_write_b64 v3, v[108:109] offset:16896
  v_cvt_pk_bf16_f32 v110, v156, v157
  v_cvt_pk_bf16_f32 v111, v158, v159
  ds_write_b64 v3, v[110:111] offset:25088
  v_cvt_pk_bf16_f32 v96, v160, v161
  v_cvt_pk_bf16_f32 v97, v162, v163
  ds_write_b64 v3, v[96:97] offset:1024
  v_cvt_pk_bf16_f32 v98, v164, v165
  v_cvt_pk_bf16_f32 v99, v166, v167
  ds_write_b64 v3, v[98:99] offset:9216
  v_cvt_pk_bf16_f32 v100, v168, v169
  v_cvt_pk_bf16_f32 v101, v170, v171
  ds_write_b64 v3, v[100:101] offset:17408
  v_cvt_pk_bf16_f32 v102, v172, v173
  v_cvt_pk_bf16_f32 v103, v174, v175
  ds_write_b64 v3, v[102:103] offset:25600
  v_cvt_pk_bf16_f32 v104, v176, v177
  v_cvt_pk_bf16_f32 v105, v178, v179
  ds_write_b64 v3, v[104:105] offset:1536
  v_cvt_pk_bf16_f32 v106, v180, v181
  v_cvt_pk_bf16_f32 v107, v182, v183
  ds_write_b64 v3, v[106:107] offset:9728
  v_cvt_pk_bf16_f32 v108, v184, v185
  v_cvt_pk_bf16_f32 v109, v186, v187
  ds_write_b64 v3, v[108:109] offset:17920
  v_cvt_pk_bf16_f32 v110, v188, v189
  v_cvt_pk_bf16_f32 v111, v190, v191
  ds_write_b64 v3, v[110:111] offset:26112
  v_cvt_pk_bf16_f32 v96, v192, v193
  v_cvt_pk_bf16_f32 v97, v194, v195
  ds_write_b64 v3, v[96:97] offset:2048
  v_cvt_pk_bf16_f32 v98, v196, v197
  v_cvt_pk_bf16_f32 v99, v198, v199
  ds_write_b64 v3, v[98:99] offset:10240
  v_cvt_pk_bf16_f32 v100, v200, v201
  v_cvt_pk_bf16_f32 v101, v202, v203
  ds_write_b64 v3, v[100:101] offset:18432
  v_cvt_pk_bf16_f32 v102, v204, v205
  v_cvt_pk_bf16_f32 v103, v206, v207
  ds_write_b64 v3, v[102:103] offset:26624
  v_cvt_pk_bf16_f32 v104, v208, v209
  v_cvt_pk_bf16_f32 v105, v210, v211
  ds_write_b64 v3, v[104:105] offset:2560
  v_cvt_pk_bf16_f32 v106, v212, v213
  v_cvt_pk_bf16_f32 v107, v214, v215
  ds_write_b64 v3, v[106:107] offset:10752
  v_cvt_pk_bf16_f32 v108, v216, v217
  v_cvt_pk_bf16_f32 v109, v218, v219
  ds_write_b64 v3, v[108:109] offset:18944
  v_cvt_pk_bf16_f32 v110, v220, v221
  v_cvt_pk_bf16_f32 v111, v222, v223
  ds_write_b64 v3, v[110:111] offset:27136
  v_cvt_pk_bf16_f32 v96, v224, v225
  v_cvt_pk_bf16_f32 v97, v226, v227
  ds_write_b64 v3, v[96:97] offset:3072
  v_cvt_pk_bf16_f32 v98, v228, v229
  v_cvt_pk_bf16_f32 v99, v230, v231
  ds_write_b64 v3, v[98:99] offset:11264
  v_cvt_pk_bf16_f32 v100, v232, v233
  v_cvt_pk_bf16_f32 v101, v234, v235
  ds_write_b64 v3, v[100:101] offset:19456
  v_cvt_pk_bf16_f32 v102, v236, v237
  v_cvt_pk_bf16_f32 v103, v238, v239
  ds_write_b64 v3, v[102:103] offset:27648
  v_cvt_pk_bf16_f32 v104, v240, v241
  v_cvt_pk_bf16_f32 v105, v242, v243
  ds_write_b64 v3, v[104:105] offset:3584
  v_cvt_pk_bf16_f32 v106, v244, v245
  v_cvt_pk_bf16_f32 v107, v246, v247
  ds_write_b64 v3, v[106:107] offset:11776
  v_cvt_pk_bf16_f32 v108, v248, v249
  v_cvt_pk_bf16_f32 v109, v250, v251
  ds_write_b64 v3, v[108:109] offset:19968
  v_cvt_pk_bf16_f32 v110, v252, v253
  v_cvt_pk_bf16_f32 v111, v254, v255
  ds_write_b64 v3, v[110:111] offset:28160
  s_mov_b32 s39, s36
  v_and_b32 v1, 15, v0
  v_lshrrev_b32 v2, 4, v0
  v_and_b32 v3, 1, v0
  v_lshrrev_b32 v4, 1, v1
  v_mul_u32_u24 v4, 1056, v4
  v_lshl_add_u32 v4, v3, 9, v4
  v_xor_b32 v5, v2, v3
  v_lshl_add_u32 v4, v5, 4, v4
  s_mul_i32 s36, s32, 16896
  v_add_u32 v12, s36, v4
  v_bfe_u32 v3, v0, 2, 1
  v_bfe_u32 v4, v0, 3, 1
  v_lshl_add_u32 v4, v2, 1, v4
  v_mul_u32_u24 v4, 1088, v4
  v_lshl_add_u32 v4, v3, 9, v4
  v_and_b32 v5, 3, v0
  v_lshl_add_u32 v4, v5, 3, v4
  s_mul_i32 s36, s32, 17408
  s_add_u32 s36, s36, 67584
  v_add_u32 v4, s36, v4
  v_lshl_add_u32 v13, v3, 5, v4
  v_xor_b32 v5, 1, v3
  v_lshl_add_u32 v14, v5, 5, v4
  v_lshrrev_b32 v2, 5, v0
  v_and_b32 v1, 31, v0
  v_lshlrev_b32 v3, 1, v2
  v_xor_b32 v3, v1, v3
  v_lshlrev_b32 v3, 4, v3
  v_lshl_add_u32 v3, v2, 9, v3
  s_lshl_b32 s36, s33, 13
  v_add_u32 v3, s36, v3
  v_add_u32 v8, 256, v3
  v_add_u32 v9, 192, v3
  v_add_u32 v10, 128, v3
  v_add_u32 v11, 64, v3
  v_lshlrev_b32 v6, 4, v0
  v_add_u32 v6, s39, v6
  s_waitcnt lgkmcnt(0)
  s_waitcnt vmcnt(0)
  s_barrier
  ds_read_b128 v[128:131], v6 offset:0
  ds_read_b128 v[160:163], v6 offset:8192
  ds_read_b128 v[192:195], v6 offset:16384
  ds_read_b128 v[224:227], v6 offset:24576
  ds_read_b128 v[96:99], v12 offset:0
  ds_read_b128 v[132:135], v6 offset:1024
  ds_read_b128 v[164:167], v6 offset:9216
  ds_read_b128 v[196:199], v6 offset:17408
  ds_read_b128 v[228:231], v6 offset:25600
  ds_read_b128 v[100:103], v12 offset:64
  s_waitcnt lgkmcnt(5)
  v_mfma_f32_16x16x32_bf16 v[16:19], v[96:99], v[128:131], 0
  ds_read_b128 v[136:139], v6 offset:2048
  ds_read_b128 v[168:171], v6 offset:10240
  ds_read_b128 v[200:203], v6 offset:18432
  ds_read_b128 v[232:235], v6 offset:26624
  ds_read_b128 v[104:107], v12 offset:128
  v_mfma_f32_16x16x32_bf16 v[20:23], v[96:99], v[160:163], 0
  v_mfma_f32_16x16x32_bf16 v[24:27], v[96:99], v[192:195], 0
  s_add_u32 m0, s23, 33792
  s_nop 0
  buffer_load_dwordx4 v124, s[4:7], s20 offen offset:0 lds
  v_mfma_f32_16x16x32_bf16 v[28:31], v[96:99], v[224:227], 0
  s_waitcnt lgkmcnt(5)
  v_mfma_f32_16x16x32_bf16 v[16:19], v[100:103], v[132:135], v[16:19]
  ds_read_b128 v[140:143], v6 offset:3072
  ds_read_b128 v[172:175], v6 offset:11264
  ds_read_b128 v[204:207], v6 offset:19456
  ds_read_b128 v[236:239], v6 offset:27648
  ds_read_b128 v[108:111], v12 offset:192
  v_mfma_f32_16x16x32_bf16 v[20:23], v[100:103], v[164:167], v[20:23]
  v_mfma_f32_16x16x32_bf16 v[24:27], v[100:103], v[196:199], v[24:27]
  buffer_load_dwordx4 v125, s[4:7], s20 offen offset:1056 lds
  v_mfma_f32_16x16x32_bf16 v[28:31], v[100:103], v[228:231], v[28:31]
  s_waitcnt lgkmcnt(5)
  v_mfma_f32_16x16x32_bf16 v[16:19], v[104:107], v[136:139], v[16:19]
  ds_read_b128 v[144:147], v6 offset:4096
  ds_read_b128 v[176:179], v6 offset:12288
  ds_read_b128 v[208:211], v6 offset:20480
  ds_read_b128 v[240:243], v6 offset:28672
  ds_read_b128 v[96:99], v12 offset:256
  v_mfma_f32_16x16x32_bf16 v[20:23], v[104:107], v[168:171], v[20:23]
  v_mfma_f32_16x16x32_bf16 v[24:27], v[104:107], v[200:203], v[24:27]
  buffer_load_dwordx4 v126, s[4:7], s20 offen offset:2112 lds
  v_mfma_f32_16x16x32_bf16 v[28:31], v[104:107], v[232:235], v[28:31]
  s_waitcnt lgkmcnt(5)
  v_mfma_f32_16x16x32_bf16 v[16:19], v[108:111], v[140:143], v[16:19]
  ds_read_b128 v[148:151], v6 offset:5120
  ds_read_b128 v[180:183], v6 offset:13312
  ds_read_b128 v[212:215], v6 offset:21504
  ds_read_b128 v[244:247], v6 offset:29696
  ds_read_b128 v[100:103], v12 offset:320
  v_mfma_f32_16x16x32_bf16 v[20:23], v[108:111], v[172:175], v[20:23]
  v_mfma_f32_16x16x32_bf16 v[24:27], v[108:111], v[204:207], v[24:27]
  buffer_load_dwordx4 v127, s[4:7], s20 offen offset:3168 lds
  s_add_u32 s20, s20, 16384
  v_mfma_f32_16x16x32_bf16 v[28:31], v[108:111], v[236:239], v[28:31]
  s_waitcnt lgkmcnt(5)
  v_mfma_f32_16x16x32_bf16 v[16:19], v[96:99], v[144:147], v[16:19]
  ds_read_b128 v[152:155], v6 offset:6144
  ds_read_b128 v[184:187], v6 offset:14336
  ds_read_b128 v[216:219], v6 offset:22528
  ds_read_b128 v[248:251], v6 offset:30720
  ds_read_b128 v[104:107], v12 offset:384
  v_mfma_f32_16x16x32_bf16 v[20:23], v[96:99], v[176:179], v[20:23]
  v_mfma_f32_16x16x32_bf16 v[24:27], v[96:99], v[208:211], v[24:27]
  s_add_u32 m0, s23, 38016
  s_nop 0
  buffer_load_dwordx4 v124, s[4:7], s26 offen offset:0 lds
  v_mfma_f32_16x16x32_bf16 v[28:31], v[96:99], v[240:243], v[28:31]
  s_waitcnt lgkmcnt(5)
  v_mfma_f32_16x16x32_bf16 v[16:19], v[100:103], v[148:151], v[16:19]
  ds_read_b128 v[156:159], v6 offset:7168
  ds_read_b128 v[188:191], v6 offset:15360
  ds_read_b128 v[220:223], v6 offset:23552
  ds_read_b128 v[252:255], v6 offset:31744
  ds_read_b128 v[108:111], v12 offset:448
  ds_read_b128 v[96:99], v12 offset:8448
  v_mfma_f32_16x16x32_bf16 v[20:23], v[100:103], v[180:183], v[20:23]
  v_mfma_f32_16x16x32_bf16 v[24:27], v[100:103], v[212:215], v[24:27]
  buffer_load_dwordx4 v125, s[4:7], s26 offen offset:1056 lds
  v_mfma_f32_16x16x32_bf16 v[28:31], v[100:103], v[244:247], v[28:31]
  s_waitcnt lgkmcnt(6)
  v_mfma_f32_16x16x32_bf16 v[16:19], v[104:107], v[152:155], v[16:19]
  ds_read_b128 v[100:103], v12 offset:8512
  v_mfma_f32_16x16x32_bf16 v[20:23], v[104:107], v[184:187], v[20:23]
  v_mfma_f32_16x16x32_bf16 v[24:27], v[104:107], v[216:219], v[24:27]
  buffer_load_dwordx4 v126, s[4:7], s26 offen offset:2112 lds
  v_mfma_f32_16x16x32_bf16 v[28:31], v[104:107], v[248:251], v[28:31]
  s_waitcnt lgkmcnt(2)
  v_mfma_f32_16x16x32_bf16 v[16:19], v[108:111], v[156:159], v[16:19]
  ds_read_b128 v[104:107], v12 offset:8576
  v_mfma_f32_16x16x32_bf16 v[20:23], v[108:111], v[188:191], v[20:23]
  v_mfma_f32_16x16x32_bf16 v[24:27], v[108:111], v[220:223], v[24:27]
  buffer_load_dwordx4 v127, s[4:7], s26 offen offset:3168 lds
  s_add_u32 s26, s26, 16384
  v_mfma_f32_16x16x32_bf16 v[28:31], v[108:111], v[252:255], v[28:31]
  s_waitcnt lgkmcnt(2)
  s_barrier
  v_mfma_f32_16x16x32_bf16 v[32:35], v[96:99], v[128:131], 0
  ds_read_b128 v[108:111], v12 offset:8640
  v_mfma_f32_16x16x32_bf16 v[36:39], v[96:99], v[160:163], 0
  v_mfma_f32_16x16x32_bf16 v[40:43], v[96:99], v[192:195], 0
  s_add_u32 m0, s28, 67584
  s_nop 0
  buffer_load_dwordx4 v8, s[8:11], s21 offen offset:0 lds
  v_mfma_f32_16x16x32_bf16 v[44:47], v[96:99], v[224:227], 0
  s_waitcnt lgkmcnt(2)
  v_mfma_f32_16x16x32_bf16 v[32:35], v[100:103], v[132:135], v[32:35]
  ds_read_b128 v[96:99], v12 offset:8704
  v_mfma_f32_16x16x32_bf16 v[36:39], v[100:103], v[164:167], v[36:39]
  v_mfma_f32_16x16x32_bf16 v[40:43], v[100:103], v[196:199], v[40:43]
  buffer_load_dwordx4 v9, s[8:11], s21 offen offset:1088 lds
  v_mfma_f32_16x16x32_bf16 v[44:47], v[100:103], v[228:231], v[44:47]
  s_waitcnt lgkmcnt(2)
  v_mfma_f32_16x16x32_bf16 v[32:35], v[104:107], v[136:139], v[32:35]
  ds_read_b128 v[100:103], v12 offset:8768
  v_mfma_f32_16x16x32_bf16 v[36:39], v[104:107], v[168:171], v[36:39]
  v_mfma_f32_16x16x32_bf16 v[40:43], v[104:107], v[200:203], v[40:43]
  buffer_load_dwordx4 v10, s[8:11], s21 offen offset:2176 lds
  v_mfma_f32_16x16x32_bf16 v[44:47], v[104:107], v[232:235], v[44:47]
  s_waitcnt lgkmcnt(2)
  v_mfma_f32_16x16x32_bf16 v[32:35], v[108:111], v[140:143], v[32:35]
  ds_read_b128 v[104:107], v12 offset:8832
  v_mfma_f32_16x16x32_bf16 v[36:39], v[108:111], v[172:175], v[36:39]
  v_mfma_f32_16x16x32_bf16 v[40:43], v[108:111], v[204:207], v[40:43]
  buffer_load_dwordx4 v11, s[8:11], s21 offen offset:3264 lds
  s_add_u32 s21, s21, 16384
  v_mfma_f32_16x16x32_bf16 v[44:47], v[108:111], v[236:239], v[44:47]
  s_waitcnt lgkmcnt(2)
  v_mfma_f32_16x16x32_bf16 v[32:35], v[96:99], v[144:147], v[32:35]
  ds_read_b128 v[108:111], v12 offset:8896
  v_mfma_f32_16x16x32_bf16 v[36:39], v[96:99], v[176:179], v[36:39]
  v_mfma_f32_16x16x32_bf16 v[40:43], v[96:99], v[208:211], v[40:43]
  s_add_u32 m0, s28, 71936
  s_nop 0
  buffer_load_dwordx4 v8, s[8:11], s27 offen offset:0 lds
  v_mfma_f32_16x16x32_bf16 v[44:47], v[96:99], v[240:243], v[44:47]
  s_waitcnt lgkmcnt(2)
  v_mfma_f32_16x16x32_bf16 v[32:35], v[100:103], v[148:151], v[32:35]
  v_mfma_f32_16x16x32_bf16 v[36:39], v[100:103], v[180:183], v[36:39]
  v_mfma_f32_16x16x32_bf16 v[40:43], v[100:103], v[212:215], v[40:43]
  buffer_load_dwordx4 v9, s[8:11], s27 offen offset:1088 lds
  v_mfma_f32_16x16x32_bf16 v[44:47], v[100:103], v[244:247], v[44:47]
  s_waitcnt lgkmcnt(1)
  v_mfma_f32_16x16x32_bf16 v[32:35], v[104:107], v[152:155], v[32:35]
  v_mfma_f32_16x16x32_bf16 v[36:39], v[104:107], v[184:187], v[36:39]
  v_mfma_f32_16x16x32_bf16 v[40:43], v[104:107], v[216:219], v[40:43]
  buffer_load_dwordx4 v10, s[8:11], s27 offen offset:2176 lds
  v_mfma_f32_16x16x32_bf16 v[44:47], v[104:107], v[248:251], v[44:47]
  s_waitcnt lgkmcnt(0)
  v_mfma_f32_16x16x32_bf16 v[32:35], v[108:111], v[156:159], v[32:35]
  v_mfma_f32_16x16x32_bf16 v[36:39], v[108:111], v[188:191], v[36:39]
  v_mfma_f32_16x16x32_bf16 v[40:43], v[108:111], v[220:223], v[40:43]
  buffer_load_dwordx4 v11, s[8:11], s27 offen offset:3264 lds
  s_add_u32 s27, s27, 16384
  v_mfma_f32_16x16x32_bf16 v[44:47], v[108:111], v[252:255], v[44:47]
  s_nop 7
  v_max3_f32 v112, v16, v17, v18
  v_max3_f32 v113, v20, v21, v22
  v_max3_f32 v114, v24, v25, v26
  v_max3_f32 v115, v28, v29, v30
  v_max3_f32 v112, v112, v19, v32
  v_max3_f32 v113, v113, v23, v36
  v_max3_f32 v114, v114, v27, v40
  v_max3_f32 v115, v115, v31, v44
  v_max3_f32 v112, v112, v33, v34
  v_max3_f32 v113, v113, v37, v38
  v_max3_f32 v114, v114, v41, v42
  v_max3_f32 v115, v115, v45, v46
  v_max_f32 v112, v112, v35
  v_max_f32 v113, v113, v39
  v_max_f32 v114, v114, v43
  v_max_f32 v115, v115, v47
  v_mov_b32 v116, v112
  v_mov_b32 v117, v113
  v_mov_b32 v118, v114
  v_mov_b32 v119, v115
  s_nop 0
  v_permlane32_swap_b32 v112, v116
  v_permlane32_swap_b32 v113, v117
  v_permlane32_swap_b32 v114, v118
  v_permlane32_swap_b32 v115, v119
  s_nop 0
  v_max_f32 v112, v112, v116
  v_max_f32 v113, v113, v117
  v_max_f32 v114, v114, v118
  v_max_f32 v115, v115, v119
  v_mov_b32 v116, v112
  v_mov_b32 v117, v113
  v_mov_b32 v118, v114
  v_mov_b32 v119, v115
  s_nop 0
  v_permlane16_swap_b32 v112, v116
  v_permlane16_swap_b32 v113, v117
  v_permlane16_swap_b32 v114, v118
  v_permlane16_swap_b32 v115, v119
  s_nop 0
  v_max_f32 v112, v112, v116
  v_max_f32 v113, v113, v117
  v_max_f32 v114, v114, v118
  v_max_f32 v115, v115, v119
  v_sub_f32 v48, 0, v112
  v_sub_f32 v16, v16, v112
  v_sub_f32 v32, v32, v112
  v_sub_f32 v49, 0, v112
  v_sub_f32 v17, v17, v112
  v_sub_f32 v33, v33, v112
  v_sub_f32 v50, 0, v112
  v_sub_f32 v18, v18, v112
  v_sub_f32 v34, v34, v112
  v_sub_f32 v51, 0, v112
  v_sub_f32 v19, v19, v112
  v_sub_f32 v35, v35, v112
  v_mov_b32 v120, 0
  v_sub_f32 v52, 0, v113
  v_sub_f32 v20, v20, v113
  v_sub_f32 v36, v36, v113
  v_sub_f32 v53, 0, v113
  v_sub_f32 v21, v21, v113
  v_sub_f32 v37, v37, v113
  v_sub_f32 v54, 0, v113
  v_sub_f32 v22, v22, v113
  v_sub_f32 v38, v38, v113
  v_sub_f32 v55, 0, v113
  v_sub_f32 v23, v23, v113
  v_sub_f32 v39, v39, v113
  v_mov_b32 v121, 0
  v_sub_f32 v56, 0, v114
  v_sub_f32 v24, v24, v114
  v_sub_f32 v40, v40, v114
  v_sub_f32 v57, 0, v114
  v_sub_f32 v25, v25, v114
  v_sub_f32 v41, v41, v114
  v_sub_f32 v58, 0, v114
  v_sub_f32 v26, v26, v114
  v_sub_f32 v42, v42, v114
  v_sub_f32 v59, 0, v114
  v_sub_f32 v27, v27, v114
  v_sub_f32 v43, v43, v114
  v_mov_b32 v122, 0
  v_sub_f32 v60, 0, v115
  v_sub_f32 v28, v28, v115
  v_sub_f32 v44, v44, v115
  v_sub_f32 v61, 0, v115
  v_sub_f32 v29, v29, v115
  v_sub_f32 v45, v45, v115
  v_sub_f32 v62, 0, v115
  v_sub_f32 v30, v30, v115
  v_sub_f32 v46, v46, v115
  v_sub_f32 v63, 0, v115
  v_sub_f32 v31, v31, v115
  v_sub_f32 v47, v47, v115
  v_mov_b32 v123, 0
  v_exp_f32 v112, v16
  v_exp_f32 v113, v17
  v_exp_f32 v114, v18
  v_exp_f32 v115, v19
  v_add_f32 v116, v112, v113
  v_cvt_pk_bf16_f32 v64, v112, v113
  v_exp_f32 v112, v20
  v_exp_f32 v113, v21
  v_add_f32 v116, v116, v114
  v_add_f32 v116, v116, v115
  v_cvt_pk_bf16_f32 v65, v114, v115
  v_exp_f32 v114, v22
  v_exp_f32 v115, v23
  v_add_f32 v117, v112, v113
  v_cvt_pk_bf16_f32 v68, v112, v113
  v_exp_f32 v112, v24
  v_exp_f32 v113, v25
  v_add_f32 v117, v117, v114
  v_add_f32 v117, v117, v115
  v_cvt_pk_bf16_f32 v69, v114, v115
  v_exp_f32 v114, v26
  v_exp_f32 v115, v27
  v_add_f32 v118, v112, v113
  v_cvt_pk_bf16_f32 v72, v112, v113
  v_exp_f32 v112, v28
  v_exp_f32 v113, v29
  v_add_f32 v118, v118, v114
  v_add_f32 v118, v118, v115
  v_cvt_pk_bf16_f32 v73, v114, v115
  v_exp_f32 v114, v30
  v_exp_f32 v115, v31
  v_add_f32 v119, v112, v113
  v_cvt_pk_bf16_f32 v76, v112, v113
  v_add_f32 v119, v119, v114
  v_add_f32 v119, v119, v115
  v_cvt_pk_bf16_f32 v77, v114, v115
  v_exp_f32 v112, v32
  v_exp_f32 v113, v33
  v_exp_f32 v114, v34
  v_exp_f32 v115, v35
  v_add_f32 v116, v116, v112
  v_add_f32 v116, v116, v113
  v_cvt_pk_bf16_f32 v66, v112, v113
  v_exp_f32 v112, v36
  v_exp_f32 v113, v37
  v_add_f32 v116, v116, v114
  v_add_f32 v116, v116, v115
  v_cvt_pk_bf16_f32 v67, v114, v115
  v_exp_f32 v114, v38
  v_exp_f32 v115, v39
  v_add_f32 v117, v117, v112
  v_add_f32 v117, v117, v113
  v_cvt_pk_bf16_f32 v70, v112, v113
  v_exp_f32 v112, v40
  v_exp_f32 v113, v41
  v_add_f32 v117, v117, v114
  v_add_f32 v117, v117, v115
  v_cvt_pk_bf16_f32 v71, v114, v115
  v_exp_f32 v114, v42
  v_exp_f32 v115, v43
  v_add_f32 v118, v118, v112
  v_add_f32 v118, v118, v113
  v_cvt_pk_bf16_f32 v74, v112, v113
  v_exp_f32 v112, v44
  v_exp_f32 v113, v45
  v_add_f32 v118, v118, v114
  v_add_f32 v118, v118, v115
  v_cvt_pk_bf16_f32 v75, v114, v115
  v_exp_f32 v114, v46
  v_exp_f32 v115, v47
  v_add_f32 v119, v119, v112
  v_add_f32 v119, v119, v113
  v_cvt_pk_bf16_f32 v78, v112, v113
  v_add_f32 v119, v119, v114
  v_add_f32 v119, v119, v115
  v_cvt_pk_bf16_f32 v79, v114, v115
  v_add_f32 v120, v120, v116
  v_add_f32 v121, v121, v117
  v_add_f32 v122, v122, v118
  v_add_f32 v123, v123, v119
  s_waitcnt vmcnt(8)
  s_barrier
  s_add_u32 m0, s23, 0
  s_nop 0
  buffer_load_dwordx4 v124, s[4:7], s20 offen offset:0 lds
  buffer_load_dwordx4 v125, s[4:7], s20 offen offset:1056 lds
  s_cmp_ge_u32 s22, 2
  s_cselect_b32 s72, s8, s4
  s_cselect_b32 s73, s9, s5
  s_cselect_b32 s74, s10, s6
  s_cselect_b32 s75, s11, s7
  s_cselect_b32 s36, 2, 1
  s_lshl_b32 s36, s36, 7
  v_and_b32 v3, 3, v0
  s_lshl_b32 s37, s35, 2
  v_add_u32 v3, s37, v3
  v_lshlrev_b32 v3, 7, v3
  v_add_u32 v3, s36, v3
  s_lshl_b32 s29, s32, 19
  s_add_u32 s29, s29, 98304
  ds_read_b128 v[96:99], v12 offset:33792
  ds_read_b128 v[100:103], v12 offset:33856
  ds_read_b128 v[104:107], v12 offset:33920
  ds_read_b128 v[108:111], v12 offset:33984
  s_waitcnt lgkmcnt(2)
  v_mfma_f32_16x16x32_bf16 v[16:19], v[96:99], v[128:131], v[48:51]
  buffer_load_dwordx4 v126, s[4:7], s20 offen offset:2112 lds
  v_mfma_f32_16x16x32_bf16 v[16:19], v[100:103], v[132:135], v[16:19]
  v_mfma_f32_16x16x32_bf16 v[20:23], v[96:99], v[160:163], v[52:55]
  v_mfma_f32_16x16x32_bf16 v[20:23], v[100:103], v[164:167], v[20:23]
  v_mfma_f32_16x16x32_bf16 v[24:27], v[96:99], v[192:195], v[56:59]
  v_mfma_f32_16x16x32_bf16 v[24:27], v[100:103], v[196:199], v[24:27]
  v_mfma_f32_16x16x32_bf16 v[28:31], v[96:99], v[224:227], v[60:63]
  buffer_load_dwordx4 v127, s[4:7], s20 offen offset:3168 lds
  s_add_u32 s20, s20, 16384
  v_mfma_f32_16x16x32_bf16 v[28:31], v[100:103], v[228:231], v[28:31]
  ds_read_b128 v[96:99], v12 offset:34048
  ds_read_b128 v[100:103], v12 offset:34112
  s_waitcnt lgkmcnt(2)
  v_mfma_f32_16x16x32_bf16 v[16:19], v[104:107], v[136:139], v[16:19]
  v_mfma_f32_16x16x32_bf16 v[16:19], v[108:111], v[140:143], v[16:19]
  v_mfma_f32_16x16x32_bf16 v[20:23], v[104:107], v[168:171], v[20:23]
  v_mfma_f32_16x16x32_bf16 v[20:23], v[108:111], v[172:175], v[20:23]
  s_add_u32 m0, s23, 4224
  v_mfma_f32_16x16x32_bf16 v[24:27], v[104:107], v[200:203], v[24:27]
  buffer_load_dwordx4 v124, s[4:7], s26 offen offset:0 lds
  v_mfma_f32_16x16x32_bf16 v[24:27], v[108:111], v[204:207], v[24:27]
  v_mfma_f32_16x16x32_bf16 v[28:31], v[104:107], v[232:235], v[28:31]
  ds_read_b128 v[104:107], v12 offset:34176
  v_mfma_f32_16x16x32_bf16 v[28:31], v[108:111], v[236:239], v[28:31]
  ds_read_b128 v[108:111], v12 offset:34240
  s_waitcnt lgkmcnt(2)
  v_mfma_f32_16x16x32_bf16 v[16:19], v[96:99], v[144:147], v[16:19]
  v_mfma_f32_16x16x32_bf16 v[16:19], v[100:103], v[148:151], v[16:19]
  v_mfma_f32_16x16x32_bf16 v[20:23], v[96:99], v[176:179], v[20:23]
  buffer_load_dwordx4 v125, s[4:7], s26 offen offset:1056 lds
  v_mfma_f32_16x16x32_bf16 v[20:23], v[100:103], v[180:183], v[20:23]
  v_mfma_f32_16x16x32_bf16 v[24:27], v[96:99], v[208:211], v[24:27]
  v_mfma_f32_16x16x32_bf16 v[24:27], v[100:103], v[212:215], v[24:27]
  v_mfma_f32_16x16x32_bf16 v[28:31], v[96:99], v[240:243], v[28:31]
  ds_read_b128 v[96:99], v12 offset:42240
  v_mfma_f32_16x16x32_bf16 v[28:31], v[100:103], v[244:247], v[28:31]
  ds_read_b128 v[100:103], v12 offset:42304
  s_waitcnt lgkmcnt(2)
  v_mfma_f32_16x16x32_bf16 v[16:19], v[104:107], v[152:155], v[16:19]
  buffer_load_dwordx4 v126, s[4:7], s26 offen offset:2112 lds
  v_mfma_f32_16x16x32_bf16 v[16:19], v[108:111], v[156:159], v[16:19]
  v_mfma_f32_16x16x32_bf16 v[20:23], v[104:107], v[184:187], v[20:23]
  v_mfma_f32_16x16x32_bf16 v[20:23], v[108:111], v[188:191], v[20:23]
  v_mfma_f32_16x16x32_bf16 v[24:27], v[104:107], v[216:219], v[24:27]
  v_mfma_f32_16x16x32_bf16 v[24:27], v[108:111], v[220:223], v[24:27]
  v_mfma_f32_16x16x32_bf16 v[28:31], v[104:107], v[248:251], v[28:31]
  buffer_load_dwordx4 v127, s[4:7], s26 offen offset:3168 lds
  s_add_u32 s26, s26, 16384
  v_mfma_f32_16x16x32_bf16 v[28:31], v[108:111], v[252:255], v[28:31]
  ds_read_b128 v[104:107], v12 offset:42368
  ds_read_b128 v[108:111], v12 offset:42432
  s_waitcnt lgkmcnt(2)
  v_mfma_f32_16x16x32_bf16 v[32:35], v[96:99], v[128:131], v[48:51]
  v_mfma_f32_16x16x32_bf16 v[32:35], v[100:103], v[132:135], v[32:35]
  v_mfma_f32_16x16x32_bf16 v[36:39], v[96:99], v[160:163], v[52:55]
  v_exp_f32 v112, v16
  v_mfma_f32_16x16x32_bf16 v[36:39], v[100:103], v[164:167], v[36:39]
  v_exp_f32 v113, v17
  v_mfma_f32_16x16x32_bf16 v[40:43], v[96:99], v[192:195], v[56:59]
  v_exp_f32 v114, v18
  v_mfma_f32_16x16x32_bf16 v[40:43], v[100:103], v[196:199], v[40:43]
  v_exp_f32 v115, v19
  v_mfma_f32_16x16x32_bf16 v[44:47], v[96:99], v[224:227], v[60:63]
  ds_read_b128 v[96:99], v12 offset:42496
  v_add_f32 v116, v112, v113
  v_mfma_f32_16x16x32_bf16 v[44:47], v[100:103], v[228:231], v[44:47]
  ds_read_b128 v[100:103], v12 offset:42560
  s_waitcnt lgkmcnt(2)
  v_mfma_f32_16x16x32_bf16 v[32:35], v[104:107], v[136:139], v[32:35]
  v_cvt_pk_bf16_f32 v80, v112, v113
  v_mfma_f32_16x16x32_bf16 v[32:35], v[108:111], v[140:143], v[32:35]
  v_exp_f32 v112, v20
  v_mfma_f32_16x16x32_bf16 v[36:39], v[104:107], v[168:171], v[36:39]
  v_exp_f32 v113, v21
  v_mfma_f32_16x16x32_bf16 v[36:39], v[108:111], v[172:175], v[36:39]
  v_add_f32 v116, v116, v114
  v_add_f32 v116, v116, v115
  v_mfma_f32_16x16x32_bf16 v[40:43], v[104:107], v[200:203], v[40:43]
  v_cvt_pk_bf16_f32 v81, v114, v115
  v_add_f32 v117, v112, v113
  v_mfma_f32_16x16x32_bf16 v[40:43], v[108:111], v[204:207], v[40:43]
  v_exp_f32 v114, v22
  v_mfma_f32_16x16x32_bf16 v[44:47], v[104:107], v[232:235], v[44:47]
  ds_read_b128 v[104:107], v12 offset:42624
  v_cvt_pk_bf16_f32 v84, v112, v113
  v_mfma_f32_16x16x32_bf16 v[44:47], v[108:111], v[236:239], v[44:47]
  ds_read_b128 v[108:111], v12 offset:42688
  s_waitcnt lgkmcnt(2)
  v_mfma_f32_16x16x32_bf16 v[32:35], v[96:99], v[144:147], v[32:35]
  v_mfma_f32_16x16x32_bf16 v[32:35], v[100:103], v[148:151], v[32:35]
  v_exp_f32 v115, v23
  v_mfma_f32_16x16x32_bf16 v[36:39], v[96:99], v[176:179], v[36:39]
  s_waitcnt vmcnt(8)
  s_barrier
  v_mfma_f32_16x16x32_bf16 v[36:39], v[100:103], v[180:183], v[36:39]
  s_add_u32 m0, s28, 102400
  v_add_f32 v117, v117, v114
  v_mfma_f32_16x16x32_bf16 v[40:43], v[96:99], v[208:211], v[40:43]
  buffer_load_dwordx4 v8, s[8:11], s21 offen offset:0 lds
  v_mfma_f32_16x16x32_bf16 v[40:43], v[100:103], v[212:215], v[40:43]
  v_exp_f32 v112, v24
  v_mfma_f32_16x16x32_bf16 v[44:47], v[96:99], v[240:243], v[44:47]
  ds_read_b64_tr_b16 v[96:97], v13 offset:0
  ds_read_b64_tr_b16 v[98:99], v13 offset:8704
  v_mfma_f32_16x16x32_bf16 v[44:47], v[100:103], v[244:247], v[44:47]
  ds_read_b64_tr_b16 v[100:101], v14 offset:0
  ds_read_b64_tr_b16 v[102:103], v14 offset:8704
  s_waitcnt lgkmcnt(4)
  v_mfma_f32_16x16x32_bf16 v[32:35], v[104:107], v[152:155], v[32:35]
  v_add_f32 v117, v117, v115
  v_mfma_f32_16x16x32_bf16 v[32:35], v[108:111], v[156:159], v[32:35]
  v_exp_f32 v113, v25
  v_mfma_f32_16x16x32_bf16 v[36:39], v[104:107], v[184:187], v[36:39]
  buffer_load_dwordx4 v9, s[8:11], s21 offen offset:1088 lds
  v_mfma_f32_16x16x32_bf16 v[36:39], v[108:111], v[188:191], v[36:39]
  v_cvt_pk_bf16_f32 v85, v114, v115
  v_add_f32 v118, v112, v113
  v_mfma_f32_16x16x32_bf16 v[40:43], v[104:107], v[216:219], v[40:43]
  v_exp_f32 v114, v26
  v_mfma_f32_16x16x32_bf16 v[40:43], v[108:111], v[220:223], v[40:43]
  v_exp_f32 v115, v27
  v_mfma_f32_16x16x32_bf16 v[44:47], v[104:107], v[248:251], v[44:47]
  ds_read_b64_tr_b16 v[104:105], v13 offset:64
  ds_read_b64_tr_b16 v[106:107], v13 offset:8768
  v_mfma_f32_16x16x32_bf16 v[44:47], v[108:111], v[252:255], v[44:47]
  ds_read_b64_tr_b16 v[108:109], v14 offset:64
  ds_read_b64_tr_b16 v[110:111], v14 offset:8768
  s_waitcnt lgkmcnt(4)
  v_mfma_f32_16x16x32_bf16 a[0:3], v[96:99], v[64:67], 0
  buffer_load_dwordx4 v10, s[8:11], s21 offen offset:2176 lds
  v_mfma_f32_16x16x32_bf16 a[4:7], v[96:99], v[68:71], 0
  v_cvt_pk_bf16_f32 v88, v112, v113
  v_add_f32 v118, v118, v114
  v_mfma_f32_16x16x32_bf16 a[8:11], v[96:99], v[72:75], 0
  v_exp_f32 v112, v28
  v_mfma_f32_16x16x32_bf16 a[12:15], v[96:99], v[76:79], 0
  ds_read_b64_tr_b16 v[96:97], v13 offset:128
  ds_read_b64_tr_b16 v[98:99], v13 offset:8832
  v_mfma_f32_16x16x32_bf16 a[16:19], v[100:103], v[64:67], 0
  v_exp_f32 v113, v29
  v_mfma_f32_16x16x32_bf16 a[20:23], v[100:103], v[68:71], 0
  v_add_f32 v118, v118, v115
  v_cvt_pk_bf16_f32 v89, v114, v115
  v_mfma_f32_16x16x32_bf16 a[24:27], v[100:103], v[72:75], 0
  buffer_load_dwordx4 v11, s[8:11], s21 offen offset:3264 lds
  s_add_u32 s21, s21, 16384
  v_mfma_f32_16x16x32_bf16 a[28:31], v[100:103], v[76:79], 0
  ds_read_b64_tr_b16 v[100:101], v14 offset:128
  ds_read_b64_tr_b16 v[102:103], v14 offset:8832
  s_waitcnt lgkmcnt(4)
  v_mfma_f32_16x16x32_bf16 a[32:35], v[104:107], v[64:67], 0
  v_exp_f32 v114, v30
  v_mfma_f32_16x16x32_bf16 a[36:39], v[104:107], v[68:71], 0
  v_exp_f32 v115, v31
  v_mfma_f32_16x16x32_bf16 a[40:43], v[104:107], v[72:75], 0
  v_add_f32 v119, v112, v113
  v_cvt_pk_bf16_f32 v92, v112, v113
  v_mfma_f32_16x16x32_bf16 a[44:47], v[104:107], v[76:79], 0
  s_add_u32 m0, s28, 106752
  ds_read_b64_tr_b16 v[104:105], v13 offset:192
  v_mfma_f32_16x16x32_bf16 a[48:51], v[108:111], v[64:67], 0
  buffer_load_dwordx4 v8, s[8:11], s27 offen offset:0 lds
  v_mfma_f32_16x16x32_bf16 a[52:55], v[108:111], v[68:71], 0
  ds_read_b64_tr_b16 v[106:107], v13 offset:8896
  v_add_f32 v119, v119, v114
  v_mfma_f32_16x16x32_bf16 a[56:59], v[108:111], v[72:75], 0
  v_exp_f32 v112, v32
  v_mfma_f32_16x16x32_bf16 a[60:63], v[108:111], v[76:79], 0
  ds_read_b64_tr_b16 v[108:109], v14 offset:192
  ds_read_b64_tr_b16 v[110:111], v14 offset:8896
  s_waitcnt lgkmcnt(4)
  v_mfma_f32_16x16x32_bf16 a[64:67], v[96:99], v[64:67], 0
  v_exp_f32 v113, v33
  v_mfma_f32_16x16x32_bf16 a[68:71], v[96:99], v[68:71], 0
  v_add_f32 v119, v119, v115
  v_cvt_pk_bf16_f32 v93, v114, v115
  v_mfma_f32_16x16x32_bf16 a[72:75], v[96:99], v[72:75], 0
  buffer_load_dwordx4 v9, s[8:11], s27 offen offset:1088 lds
  v_mfma_f32_16x16x32_bf16 a[76:79], v[96:99], v[76:79], 0
  ds_read_b64_tr_b16 v[96:97], v13 offset:256
  ds_read_b64_tr_b16 v[98:99], v13 offset:8960
  v_mfma_f32_16x16x32_bf16 a[80:83], v[100:103], v[64:67], 0
  v_exp_f32 v114, v34
  v_mfma_f32_16x16x32_bf16 a[84:87], v[100:103], v[68:71], 0
  v_exp_f32 v115, v35
  v_mfma_f32_16x16x32_bf16 a[88:91], v[100:103], v[72:75], 0
  v_add_f32 v116, v116, v112
  v_add_f32 v116, v116, v113
  v_mfma_f32_16x16x32_bf16 a[92:95], v[100:103], v[76:79], 0
  ds_read_b64_tr_b16 v[100:101], v14 offset:256
  ds_read_b64_tr_b16 v[102:103], v14 offset:8960
  s_waitcnt lgkmcnt(4)
  v_mfma_f32_16x16x32_bf16 a[96:99], v[104:107], v[64:67], 0
  buffer_load_dwordx4 v10, s[8:11], s27 offen offset:2176 lds
  v_mfma_f32_16x16x32_bf16 a[100:103], v[104:107], v[68:71], 0
  v_cvt_pk_bf16_f32 v82, v112, v113
  v_add_f32 v116, v116, v114
  v_mfma_f32_16x16x32_bf16 a[104:107], v[104:107], v[72:75], 0
  v_exp_f32 v112, v36
  v_mfma_f32_16x16x32_bf16 a[108:111], v[104:107], v[76:79], 0
  ds_read_b64_tr_b16 v[104:105], v13 offset:320
  ds_read_b64_tr_b16 v[106:107], v13 offset:9024
  v_mfma_f32_16x16x32_bf16 a[112:115], v[108:111], v[64:67], 0
  v_exp_f32 v113, v37
  v_mfma_f32_16x16x32_bf16 a[116:119], v[108:111], v[68:71], 0
  v_add_f32 v116, v116, v115
  v_cvt_pk_bf16_f32 v83, v114, v115
  v_mfma_f32_16x16x32_bf16 a[120:123], v[108:111], v[72:75], 0
  buffer_load_dwordx4 v11, s[8:11], s27 offen offset:3264 lds
  s_add_u32 s27, s27, 16384
  v_mfma_f32_16x16x32_bf16 a[124:127], v[108:111], v[76:79], 0
  ds_read_b64_tr_b16 v[108:109], v14 offset:320
  ds_read_b64_tr_b16 v[110:111], v14 offset:9024
  s_waitcnt lgkmcnt(4)
  v_mfma_f32_16x16x32_bf16 a[128:131], v[96:99], v[64:67], 0
  v_exp_f32 v114, v38
  v_mfma_f32_16x16x32_bf16 a[132:135], v[96:99], v[68:71], 0
  v_exp_f32 v115, v39
  v_mfma_f32_16x16x32_bf16 a[136:139], v[96:99], v[72:75], 0
  v_add_f32 v117, v117, v112
  v_add_f32 v117, v117, v113
  v_mfma_f32_16x16x32_bf16 a[140:143], v[96:99], v[76:79], 0
  ds_read_b64_tr_b16 v[96:97], v13 offset:384
  ds_read_b64_tr_b16 v[98:99], v13 offset:9088
  v_mfma_f32_16x16x32_bf16 a[144:147], v[100:103], v[64:67], 0
  v_cvt_pk_bf16_f32 v86, v112, v113
  v_add_f32 v117, v117, v114
  v_mfma_f32_16x16x32_bf16 a[148:151], v[100:103], v[68:71], 0
  v_exp_f32 v112, v40
  v_mfma_f32_16x16x32_bf16 a[152:155], v[100:103], v[72:75], 0
  v_exp_f32 v113, v41
  v_mfma_f32_16x16x32_bf16 a[156:159], v[100:103], v[76:79], 0
  ds_read_b64_tr_b16 v[100:101], v14 offset:384
  ds_read_b64_tr_b16 v[102:103], v14 offset:9088
  s_waitcnt lgkmcnt(4)
  v_mfma_f32_16x16x32_bf16 a[160:163], v[104:107], v[64:67], 0
  v_add_f32 v117, v117, v115
  v_cvt_pk_bf16_f32 v87, v114, v115
  v_mfma_f32_16x16x32_bf16 a[164:167], v[104:107], v[68:71], 0
  v_exp_f32 v114, v42
  v_mfma_f32_16x16x32_bf16 a[168:171], v[104:107], v[72:75], 0
  v_exp_f32 v115, v43
  v_mfma_f32_16x16x32_bf16 a[172:175], v[104:107], v[76:79], 0
  ds_read_b64_tr_b16 v[104:105], v13 offset:448
  ds_read_b64_tr_b16 v[106:107], v13 offset:9152
  v_mfma_f32_16x16x32_bf16 a[176:179], v[108:111], v[64:67], 0
  v_add_f32 v118, v118, v112
  v_add_f32 v118, v118, v113
  v_mfma_f32_16x16x32_bf16 a[180:183], v[108:111], v[68:71], 0
  v_cvt_pk_bf16_f32 v90, v112, v113
  v_add_f32 v118, v118, v114
  v_mfma_f32_16x16x32_bf16 a[184:187], v[108:111], v[72:75], 0
  v_exp_f32 v112, v44
  v_mfma_f32_16x16x32_bf16 a[188:191], v[108:111], v[76:79], 0
  buffer_load_dword v15, v3, s[72:75], s29 offen
  s_waitcnt lgkmcnt(2)
  v_mfma_f32_16x16x32_bf16 a[192:195], v[96:99], v[64:67], 0
  s_add_u32 s29, s29, 16384
  ds_read_b64_tr_b16 v[108:109], v14 offset:448
  v_mfma_f32_16x16x32_bf16 a[196:199], v[96:99], v[68:71], 0
  s_waitcnt vmcnt(9)
  s_barrier
  v_mfma_f32_16x16x32_bf16 a[200:203], v[96:99], v[72:75], 0
  s_add_u32 m0, s23, 33792
  ds_read_b64_tr_b16 v[110:111], v14 offset:9152
  v_mfma_f32_16x16x32_bf16 a[204:207], v[96:99], v[76:79], 0
  buffer_load_dwordx4 v124, s[4:7], s20 offen offset:0 lds
  v_mfma_f32_16x16x32_bf16 a[208:211], v[100:103], v[64:67], 0
  ds_read_b128 v[96:99], v12 offset:0
  v_add_f32 v118, v118, v115
  v_mfma_f32_16x16x32_bf16 a[212:215], v[100:103], v[68:71], 0
  v_exp_f32 v113, v45
  v_mfma_f32_16x16x32_bf16 a[216:219], v[100:103], v[72:75], 0
  v_cvt_pk_bf16_f32 v91, v114, v115
  v_add_f32 v119, v119, v112
  v_mfma_f32_16x16x32_bf16 a[220:223], v[100:103], v[76:79], 0
  ds_read_b128 v[100:103], v12 offset:64
  s_waitcnt lgkmcnt(2)
  v_mfma_f32_16x16x32_bf16 a[224:227], v[104:107], v[64:67], 0
  v_exp_f32 v114, v46
  v_mfma_f32_16x16x32_bf16 a[228:231], v[104:107], v[68:71], 0
  buffer_load_dwordx4 v125, s[4:7], s20 offen offset:1056 lds
  v_mfma_f32_16x16x32_bf16 a[232:235], v[104:107], v[72:75], 0
  v_exp_f32 v115, v47
  v_mfma_f32_16x16x32_bf16 a[236:239], v[104:107], v[76:79], 0
  ds_read_b128 v[104:107], v12 offset:128
  v_mfma_f32_16x16x32_bf16 a[240:243], v[108:111], v[64:67], 0
  v_add_f32 v119, v119, v113
  v_cvt_pk_bf16_f32 v94, v112, v113
  v_mfma_f32_16x16x32_bf16 a[244:247], v[108:111], v[68:71], 0
  v_add_f32 v119, v119, v114
  v_add_f32 v119, v119, v115
  v_mfma_f32_16x16x32_bf16 a[248:251], v[108:111], v[72:75], 0
  v_cvt_pk_bf16_f32 v95, v114, v115
  v_mfma_f32_16x16x32_bf16 a[252:255], v[108:111], v[76:79], 0
  ds_read_b128 v[108:111], v12 offset:192
  v_max3_f32 v4, v116, v117, v118
  v_max_f32 v4, v4, v119
  v_cmp_lt_f32 vcc, s25, v4
  s_cbranch_vccnz TR_1
RET_2:
  s_mov_b32 s24, 14
.p2align 3
K1_LOOP:
  s_waitcnt lgkmcnt(2)
  v_mfma_f32_16x16x32_bf16 v[16:19], v[96:99], v[128:131], v[48:51]
  buffer_load_dwordx4 v126, s[4:7], s20 offen offset:2112 lds
  v_mfma_f32_16x16x32_bf16 v[16:19], v[100:103], v[132:135], v[16:19]
  v_mfma_f32_16x16x32_bf16 v[20:23], v[96:99], v[160:163], v[52:55]
  v_mfma_f32_16x16x32_bf16 v[20:23], v[100:103], v[164:167], v[20:23]
  v_mfma_f32_16x16x32_bf16 v[24:27], v[96:99], v[192:195], v[56:59]
  v_mfma_f32_16x16x32_bf16 v[24:27], v[100:103], v[196:199], v[24:27]
  v_add_f32 v120, v120, v116
  v_mfma_f32_16x16x32_bf16 v[28:31], v[96:99], v[224:227], v[60:63]
  buffer_load_dwordx4 v127, s[4:7], s20 offen offset:3168 lds
  s_add_u32 s20, s20, 16384
  v_mfma_f32_16x16x32_bf16 v[28:31], v[100:103], v[228:231], v[28:31]
  ds_read_b128 v[96:99], v12 offset:256
  ds_read_b128 v[100:103], v12 offset:320
  s_waitcnt lgkmcnt(2)
  v_mfma_f32_16x16x32_bf16 v[16:19], v[104:107], v[136:139], v[16:19]
  v_mfma_f32_16x16x32_bf16 v[16:19], v[108:111], v[140:143], v[16:19]
  v_add_f32 v121, v121, v117
  v_mfma_f32_16x16x32_bf16 v[20:23], v[104:107], v[168:171], v[20:23]
  v_mfma_f32_16x16x32_bf16 v[20:23], v[108:111], v[172:175], v[20:23]
  s_add_u32 m0, s23, 38016
  v_mfma_f32_16x16x32_bf16 v[24:27], v[104:107], v[200:203], v[24:27]
  buffer_load_dwordx4 v124, s[4:7], s26 offen offset:0 lds
  v_mfma_f32_16x16x32_bf16 v[24:27], v[108:111], v[204:207], v[24:27]
  v_mfma_f32_16x16x32_bf16 v[28:31], v[104:107], v[232:235], v[28:31]
  v_add_f32 v122, v122, v118
  ds_read_b128 v[104:107], v12 offset:384
  v_mfma_f32_16x16x32_bf16 v[28:31], v[108:111], v[236:239], v[28:31]
  ds_read_b128 v[108:111], v12 offset:448
  s_waitcnt lgkmcnt(2)
  v_mfma_f32_16x16x32_bf16 v[16:19], v[96:99], v[144:147], v[16:19]
  v_mfma_f32_16x16x32_bf16 v[16:19], v[100:103], v[148:151], v[16:19]
  v_mfma_f32_16x16x32_bf16 v[20:23], v[96:99], v[176:179], v[20:23]
  buffer_load_dwordx4 v125, s[4:7], s26 offen offset:1056 lds
  v_mfma_f32_16x16x32_bf16 v[20:23], v[100:103], v[180:183], v[20:23]
  v_mfma_f32_16x16x32_bf16 v[24:27], v[96:99], v[208:211], v[24:27]
  v_mfma_f32_16x16x32_bf16 v[24:27], v[100:103], v[212:215], v[24:27]
  v_add_f32 v123, v123, v119
  v_mfma_f32_16x16x32_bf16 v[28:31], v[96:99], v[240:243], v[28:31]
  ds_read_b128 v[96:99], v12 offset:8448
  v_mfma_f32_16x16x32_bf16 v[28:31], v[100:103], v[244:247], v[28:31]
  ds_read_b128 v[100:103], v12 offset:8512
  s_waitcnt lgkmcnt(2)
  v_mfma_f32_16x16x32_bf16 v[16:19], v[104:107], v[152:155], v[16:19]
  buffer_load_dwordx4 v126, s[4:7], s26 offen offset:2112 lds
  v_mfma_f32_16x16x32_bf16 v[16:19], v[108:111], v[156:159], v[16:19]
  v_mfma_f32_16x16x32_bf16 v[20:23], v[104:107], v[184:187], v[20:23]
  v_mfma_f32_16x16x32_bf16 v[20:23], v[108:111], v[188:191], v[20:23]
  v_mfma_f32_16x16x32_bf16 v[24:27], v[104:107], v[216:219], v[24:27]
  v_mfma_f32_16x16x32_bf16 v[24:27], v[108:111], v[220:223], v[24:27]
  v_mfma_f32_16x16x32_bf16 v[28:31], v[104:107], v[248:251], v[28:31]
  buffer_load_dwordx4 v127, s[4:7], s26 offen offset:3168 lds
  s_add_u32 s26, s26, 16384
  v_mfma_f32_16x16x32_bf16 v[28:31], v[108:111], v[252:255], v[28:31]
  ds_read_b128 v[104:107], v12 offset:8576
  ds_read_b128 v[108:111], v12 offset:8640
  s_waitcnt lgkmcnt(2)
  v_mfma_f32_16x16x32_bf16 v[32:35], v[96:99], v[128:131], v[48:51]
  v_mfma_f32_16x16x32_bf16 v[32:35], v[100:103], v[132:135], v[32:35]
  v_mfma_f32_16x16x32_bf16 v[36:39], v[96:99], v[160:163], v[52:55]
  v_exp_f32 v112, v16
  v_mfma_f32_16x16x32_bf16 v[36:39], v[100:103], v[164:167], v[36:39]
  v_exp_f32 v113, v17
  v_mfma_f32_16x16x32_bf16 v[40:43], v[96:99], v[192:195], v[56:59]
  v_exp_f32 v114, v18
  v_mfma_f32_16x16x32_bf16 v[40:43], v[100:103], v[196:199], v[40:43]
  v_exp_f32 v115, v19
  v_mfma_f32_16x16x32_bf16 v[44:47], v[96:99], v[224:227], v[60:63]
  ds_read_b128 v[96:99], v12 offset:8704
  v_add_f32 v116, v112, v113
  v_mfma_f32_16x16x32_bf16 v[44:47], v[100:103], v[228:231], v[44:47]
  ds_read_b128 v[100:103], v12 offset:8768
  s_waitcnt lgkmcnt(2)
  v_mfma_f32_16x16x32_bf16 v[32:35], v[104:107], v[136:139], v[32:35]
  v_cvt_pk_bf16_f32 v64, v112, v113
  v_mfma_f32_16x16x32_bf16 v[32:35], v[108:111], v[140:143], v[32:35]
  v_exp_f32 v112, v20
  v_mfma_f32_16x16x32_bf16 v[36:39], v[104:107], v[168:171], v[36:39]
  v_exp_f32 v113, v21
  v_mfma_f32_16x16x32_bf16 v[36:39], v[108:111], v[172:175], v[36:39]
  v_add_f32 v116, v116, v114
  v_add_f32 v116, v116, v115
  v_mfma_f32_16x16x32_bf16 v[40:43], v[104:107], v[200:203], v[40:43]
  v_cvt_pk_bf16_f32 v65, v114, v115
  v_add_f32 v117, v112, v113
  v_mfma_f32_16x16x32_bf16 v[40:43], v[108:111], v[204:207], v[40:43]
  v_exp_f32 v114, v22
  v_mfma_f32_16x16x32_bf16 v[44:47], v[104:107], v[232:235], v[44:47]
  ds_read_b128 v[104:107], v12 offset:8832
  v_cvt_pk_bf16_f32 v68, v112, v113
  v_mfma_f32_16x16x32_bf16 v[44:47], v[108:111], v[236:239], v[44:47]
  ds_read_b128 v[108:111], v12 offset:8896
  s_waitcnt lgkmcnt(2)
  v_mfma_f32_16x16x32_bf16 v[32:35], v[96:99], v[144:147], v[32:35]
  v_mfma_f32_16x16x32_bf16 v[32:35], v[100:103], v[148:151], v[32:35]
  v_exp_f32 v115, v23
  v_mfma_f32_16x16x32_bf16 v[36:39], v[96:99], v[176:179], v[36:39]
  s_waitcnt vmcnt(9)
  s_barrier
  v_mfma_f32_16x16x32_bf16 v[36:39], v[100:103], v[180:183], v[36:39]
  s_add_u32 m0, s28, 67584
  v_add_f32 v117, v117, v114
  v_mfma_f32_16x16x32_bf16 v[40:43], v[96:99], v[208:211], v[40:43]
  buffer_load_dwordx4 v8, s[8:11], s21 offen offset:0 lds
  v_mfma_f32_16x16x32_bf16 v[40:43], v[100:103], v[212:215], v[40:43]
  v_exp_f32 v112, v24
  v_mfma_f32_16x16x32_bf16 v[44:47], v[96:99], v[240:243], v[44:47]
  ds_read_b64_tr_b16 v[96:97], v13 offset:34816
  ds_read_b64_tr_b16 v[98:99], v13 offset:43520
  v_mfma_f32_16x16x32_bf16 v[44:47], v[100:103], v[244:247], v[44:47]
  ds_read_b64_tr_b16 v[100:101], v14 offset:34816
  ds_read_b64_tr_b16 v[102:103], v14 offset:43520
  s_waitcnt lgkmcnt(4)
  v_mfma_f32_16x16x32_bf16 v[32:35], v[104:107], v[152:155], v[32:35]
  v_add_f32 v117, v117, v115
  v_mfma_f32_16x16x32_bf16 v[32:35], v[108:111], v[156:159], v[32:35]
  v_exp_f32 v113, v25
  v_mfma_f32_16x16x32_bf16 v[36:39], v[104:107], v[184:187], v[36:39]
  buffer_load_dwordx4 v9, s[8:11], s21 offen offset:1088 lds
  v_mfma_f32_16x16x32_bf16 v[36:39], v[108:111], v[188:191], v[36:39]
  v_cvt_pk_bf16_f32 v69, v114, v115
  v_add_f32 v118, v112, v113
  v_mfma_f32_16x16x32_bf16 v[40:43], v[104:107], v[216:219], v[40:43]
  v_exp_f32 v114, v26
  v_mfma_f32_16x16x32_bf16 v[40:43], v[108:111], v[220:223], v[40:43]
  v_exp_f32 v115, v27
  v_mfma_f32_16x16x32_bf16 v[44:47], v[104:107], v[248:251], v[44:47]
  ds_read_b64_tr_b16 v[104:105], v13 offset:34880
  ds_read_b64_tr_b16 v[106:107], v13 offset:43584
  v_mfma_f32_16x16x32_bf16 v[44:47], v[108:111], v[252:255], v[44:47]
  ds_read_b64_tr_b16 v[108:109], v14 offset:34880
  ds_read_b64_tr_b16 v[110:111], v14 offset:43584
  s_waitcnt lgkmcnt(4)
  v_mfma_f32_16x16x32_bf16 a[0:3], v[96:99], v[80:83], a[0:3]
  buffer_load_dwordx4 v10, s[8:11], s21 offen offset:2176 lds
  v_mfma_f32_16x16x32_bf16 a[4:7], v[96:99], v[84:87], a[4:7]
  v_cvt_pk_bf16_f32 v72, v112, v113
  v_add_f32 v118, v118, v114
  v_mfma_f32_16x16x32_bf16 a[8:11], v[96:99], v[88:91], a[8:11]
  v_exp_f32 v112, v28
  v_mfma_f32_16x16x32_bf16 a[12:15], v[96:99], v[92:95], a[12:15]
  ds_read_b64_tr_b16 v[96:97], v13 offset:34944
  ds_read_b64_tr_b16 v[98:99], v13 offset:43648
  v_mfma_f32_16x16x32_bf16 a[16:19], v[100:103], v[80:83], a[16:19]
  v_exp_f32 v113, v29
  v_mfma_f32_16x16x32_bf16 a[20:23], v[100:103], v[84:87], a[20:23]
  v_add_f32 v118, v118, v115
  v_cvt_pk_bf16_f32 v73, v114, v115
  v_mfma_f32_16x16x32_bf16 a[24:27], v[100:103], v[88:91], a[24:27]
  buffer_load_dwordx4 v11, s[8:11], s21 offen offset:3264 lds
  s_add_u32 s21, s21, 16384
  v_mfma_f32_16x16x32_bf16 a[28:31], v[100:103], v[92:95], a[28:31]
  ds_read_b64_tr_b16 v[100:101], v14 offset:34944
  ds_read_b64_tr_b16 v[102:103], v14 offset:43648
  s_waitcnt lgkmcnt(4)
  v_mfma_f32_16x16x32_bf16 a[32:35], v[104:107], v[80:83], a[32:35]
  v_exp_f32 v114, v30
  v_mfma_f32_16x16x32_bf16 a[36:39], v[104:107], v[84:87], a[36:39]
  v_exp_f32 v115, v31
  v_mfma_f32_16x16x32_bf16 a[40:43], v[104:107], v[88:91], a[40:43]
  v_add_f32 v119, v112, v113
  v_cvt_pk_bf16_f32 v76, v112, v113
  v_mfma_f32_16x16x32_bf16 a[44:47], v[104:107], v[92:95], a[44:47]
  s_add_u32 m0, s28, 71936
  ds_read_b64_tr_b16 v[104:105], v13 offset:35008
  v_mfma_f32_16x16x32_bf16 a[48:51], v[108:111], v[80:83], a[48:51]
  buffer_load_dwordx4 v8, s[8:11], s27 offen offset:0 lds
  v_mfma_f32_16x16x32_bf16 a[52:55], v[108:111], v[84:87], a[52:55]
  ds_read_b64_tr_b16 v[106:107], v13 offset:43712
  v_add_f32 v119, v119, v114
  v_mfma_f32_16x16x32_bf16 a[56:59], v[108:111], v[88:91], a[56:59]
  v_exp_f32 v112, v32
  v_mfma_f32_16x16x32_bf16 a[60:63], v[108:111], v[92:95], a[60:63]
  ds_read_b64_tr_b16 v[108:109], v14 offset:35008
  ds_read_b64_tr_b16 v[110:111], v14 offset:43712
  s_waitcnt lgkmcnt(4)
  v_mfma_f32_16x16x32_bf16 a[64:67], v[96:99], v[80:83], a[64:67]
  v_exp_f32 v113, v33
  v_mfma_f32_16x16x32_bf16 a[68:71], v[96:99], v[84:87], a[68:71]
  v_add_f32 v119, v119, v115
  v_cvt_pk_bf16_f32 v77, v114, v115
  v_mfma_f32_16x16x32_bf16 a[72:75], v[96:99], v[88:91], a[72:75]
  buffer_load_dwordx4 v9, s[8:11], s27 offen offset:1088 lds
  v_mfma_f32_16x16x32_bf16 a[76:79], v[96:99], v[92:95], a[76:79]
  ds_read_b64_tr_b16 v[96:97], v13 offset:35072
  ds_read_b64_tr_b16 v[98:99], v13 offset:43776
  v_mfma_f32_16x16x32_bf16 a[80:83], v[100:103], v[80:83], a[80:83]
  v_exp_f32 v114, v34
  v_mfma_f32_16x16x32_bf16 a[84:87], v[100:103], v[84:87], a[84:87]
  v_exp_f32 v115, v35
  v_mfma_f32_16x16x32_bf16 a[88:91], v[100:103], v[88:91], a[88:91]
  v_add_f32 v116, v116, v112
  v_add_f32 v116, v116, v113
  v_mfma_f32_16x16x32_bf16 a[92:95], v[100:103], v[92:95], a[92:95]
  ds_read_b64_tr_b16 v[100:101], v14 offset:35072
  ds_read_b64_tr_b16 v[102:103], v14 offset:43776
  s_waitcnt lgkmcnt(4)
  v_mfma_f32_16x16x32_bf16 a[96:99], v[104:107], v[80:83], a[96:99]
  buffer_load_dwordx4 v10, s[8:11], s27 offen offset:2176 lds
  v_mfma_f32_16x16x32_bf16 a[100:103], v[104:107], v[84:87], a[100:103]
  v_cvt_pk_bf16_f32 v66, v112, v113
  v_add_f32 v116, v116, v114
  v_mfma_f32_16x16x32_bf16 a[104:107], v[104:107], v[88:91], a[104:107]
  v_exp_f32 v112, v36
  v_mfma_f32_16x16x32_bf16 a[108:111], v[104:107], v[92:95], a[108:111]
  ds_read_b64_tr_b16 v[104:105], v13 offset:35136
  ds_read_b64_tr_b16 v[106:107], v13 offset:43840
  v_mfma_f32_16x16x32_bf16 a[112:115], v[108:111], v[80:83], a[112:115]
  v_exp_f32 v113, v37
  v_mfma_f32_16x16x32_bf16 a[116:119], v[108:111], v[84:87], a[116:119]
  v_add_f32 v116, v116, v115
  v_cvt_pk_bf16_f32 v67, v114, v115
  v_mfma_f32_16x16x32_bf16 a[120:123], v[108:111], v[88:91], a[120:123]
  buffer_load_dwordx4 v11, s[8:11], s27 offen offset:3264 lds
  s_add_u32 s27, s27, 16384
  v_mfma_f32_16x16x32_bf16 a[124:127], v[108:111], v[92:95], a[124:127]
  ds_read_b64_tr_b16 v[108:109], v14 offset:35136
  ds_read_b64_tr_b16 v[110:111], v14 offset:43840
  s_waitcnt lgkmcnt(4)
  v_mfma_f32_16x16x32_bf16 a[128:131], v[96:99], v[80:83], a[128:131]
  v_exp_f32 v114, v38
  v_mfma_f32_16x16x32_bf16 a[132:135], v[96:99], v[84:87], a[132:135]
  v_exp_f32 v115, v39
  v_mfma_f32_16x16x32_bf16 a[136:139], v[96:99], v[88:91], a[136:139]
  v_add_f32 v117, v117, v112
  v_add_f32 v117, v117, v113
  v_mfma_f32_16x16x32_bf16 a[140:143], v[96:99], v[92:95], a[140:143]
  ds_read_b64_tr_b16 v[96:97], v13 offset:35200
  ds_read_b64_tr_b16 v[98:99], v13 offset:43904
  v_mfma_f32_16x16x32_bf16 a[144:147], v[100:103], v[80:83], a[144:147]
  v_cvt_pk_bf16_f32 v70, v112, v113
  v_add_f32 v117, v117, v114
  v_mfma_f32_16x16x32_bf16 a[148:151], v[100:103], v[84:87], a[148:151]
  v_exp_f32 v112, v40
  v_mfma_f32_16x16x32_bf16 a[152:155], v[100:103], v[88:91], a[152:155]
  v_exp_f32 v113, v41
  v_mfma_f32_16x16x32_bf16 a[156:159], v[100:103], v[92:95], a[156:159]
  ds_read_b64_tr_b16 v[100:101], v14 offset:35200
  ds_read_b64_tr_b16 v[102:103], v14 offset:43904
  s_waitcnt lgkmcnt(4)
  v_mfma_f32_16x16x32_bf16 a[160:163], v[104:107], v[80:83], a[160:163]
  v_add_f32 v117, v117, v115
  v_cvt_pk_bf16_f32 v71, v114, v115
  v_mfma_f32_16x16x32_bf16 a[164:167], v[104:107], v[84:87], a[164:167]
  v_exp_f32 v114, v42
  v_mfma_f32_16x16x32_bf16 a[168:171], v[104:107], v[88:91], a[168:171]
  v_exp_f32 v115, v43
  v_mfma_f32_16x16x32_bf16 a[172:175], v[104:107], v[92:95], a[172:175]
  ds_read_b64_tr_b16 v[104:105], v13 offset:35264
  ds_read_b64_tr_b16 v[106:107], v13 offset:43968
  v_mfma_f32_16x16x32_bf16 a[176:179], v[108:111], v[80:83], a[176:179]
  v_add_f32 v118, v118, v112
  v_add_f32 v118, v118, v113
  v_mfma_f32_16x16x32_bf16 a[180:183], v[108:111], v[84:87], a[180:183]
  v_cvt_pk_bf16_f32 v74, v112, v113
  v_add_f32 v118, v118, v114
  v_mfma_f32_16x16x32_bf16 a[184:187], v[108:111], v[88:91], a[184:187]
  v_exp_f32 v112, v44
  v_mfma_f32_16x16x32_bf16 a[188:191], v[108:111], v[92:95], a[188:191]
  buffer_load_dword v15, v3, s[72:75], s29 offen
  s_waitcnt lgkmcnt(2)
  v_mfma_f32_16x16x32_bf16 a[192:195], v[96:99], v[80:83], a[192:195]
  s_add_u32 s29, s29, 16384
  ds_read_b64_tr_b16 v[108:109], v14 offset:35264
  v_mfma_f32_16x16x32_bf16 a[196:199], v[96:99], v[84:87], a[196:199]
  s_waitcnt vmcnt(9)
  s_barrier
  v_mfma_f32_16x16x32_bf16 a[200:203], v[96:99], v[88:91], a[200:203]
  s_add_u32 m0, s23, 0
  ds_read_b64_tr_b16 v[110:111], v14 offset:43968
  v_mfma_f32_16x16x32_bf16 a[204:207], v[96:99], v[92:95], a[204:207]
  buffer_load_dwordx4 v124, s[4:7], s20 offen offset:0 lds
  v_mfma_f32_16x16x32_bf16 a[208:211], v[100:103], v[80:83], a[208:211]
  ds_read_b128 v[96:99], v12 offset:33792
  v_add_f32 v118, v118, v115
  v_mfma_f32_16x16x32_bf16 a[212:215], v[100:103], v[84:87], a[212:215]
  v_exp_f32 v113, v45
  v_mfma_f32_16x16x32_bf16 a[216:219], v[100:103], v[88:91], a[216:219]
  v_cvt_pk_bf16_f32 v75, v114, v115
  v_add_f32 v119, v119, v112
  v_mfma_f32_16x16x32_bf16 a[220:223], v[100:103], v[92:95], a[220:223]
  ds_read_b128 v[100:103], v12 offset:33856
  s_waitcnt lgkmcnt(2)
  v_mfma_f32_16x16x32_bf16 a[224:227], v[104:107], v[80:83], a[224:227]
  v_exp_f32 v114, v46
  v_mfma_f32_16x16x32_bf16 a[228:231], v[104:107], v[84:87], a[228:231]
  buffer_load_dwordx4 v125, s[4:7], s20 offen offset:1056 lds
  v_mfma_f32_16x16x32_bf16 a[232:235], v[104:107], v[88:91], a[232:235]
  v_exp_f32 v115, v47
  v_mfma_f32_16x16x32_bf16 a[236:239], v[104:107], v[92:95], a[236:239]
  ds_read_b128 v[104:107], v12 offset:33920
  v_mfma_f32_16x16x32_bf16 a[240:243], v[108:111], v[80:83], a[240:243]
  v_add_f32 v119, v119, v113
  v_cvt_pk_bf16_f32 v78, v112, v113
  v_mfma_f32_16x16x32_bf16 a[244:247], v[108:111], v[84:87], a[244:247]
  v_add_f32 v119, v119, v114
  v_add_f32 v119, v119, v115
  v_mfma_f32_16x16x32_bf16 a[248:251], v[108:111], v[88:91], a[248:251]
  v_cvt_pk_bf16_f32 v79, v114, v115
  v_mfma_f32_16x16x32_bf16 a[252:255], v[108:111], v[92:95], a[252:255]
  ds_read_b128 v[108:111], v12 offset:33984
  v_max3_f32 v4, v116, v117, v118
  v_max_f32 v4, v4, v119
  v_cmp_lt_f32 vcc, s25, v4
  s_cbranch_vccnz TR_3
RET_4:
  s_waitcnt lgkmcnt(2)
  v_mfma_f32_16x16x32_bf16 v[16:19], v[96:99], v[128:131], v[48:51]
  buffer_load_dwordx4 v126, s[4:7], s20 offen offset:2112 lds
  v_mfma_f32_16x16x32_bf16 v[16:19], v[100:103], v[132:135], v[16:19]
  v_mfma_f32_16x16x32_bf16 v[20:23], v[96:99], v[160:163], v[52:55]
  v_mfma_f32_16x16x32_bf16 v[20:23], v[100:103], v[164:167], v[20:23]
  v_mfma_f32_16x16x32_bf16 v[24:27], v[96:99], v[192:195], v[56:59]
  v_mfma_f32_16x16x32_bf16 v[24:27], v[100:103], v[196:199], v[24:27]
  v_add_f32 v120, v120, v116
  v_mfma_f32_16x16x32_bf16 v[28:31], v[96:99], v[224:227], v[60:63]
  buffer_load_dwordx4 v127, s[4:7], s20 offen offset:3168 lds
  s_add_u32 s20, s20, 16384
  v_mfma_f32_16x16x32_bf16 v[28:31], v[100:103], v[228:231], v[28:31]
  ds_read_b128 v[96:99], v12 offset:34048
  ds_read_b128 v[100:103], v12 offset:34112
  s_waitcnt lgkmcnt(2)
  v_mfma_f32_16x16x32_bf16 v[16:19], v[104:107], v[136:139], v[16:19]
  v_mfma_f32_16x16x32_bf16 v[16:19], v[108:111], v[140:143], v[16:19]
  v_add_f32 v121, v121, v117
  v_mfma_f32_16x16x32_bf16 v[20:23], v[104:107], v[168:171], v[20:23]
  v_mfma_f32_16x16x32_bf16 v[20:23], v[108:111], v[172:175], v[20:23]
  s_add_u32 m0, s23, 4224
  v_mfma_f32_16x16x32_bf16 v[24:27], v[104:107], v[200:203], v[24:27]
  buffer_load_dwordx4 v124, s[4:7], s26 offen offset:0 lds
  v_mfma_f32_16x16x32_bf16 v[24:27], v[108:111], v[204:207], v[24:27]
  v_mfma_f32_16x16x32_bf16 v[28:31], v[104:107], v[232:235], v[28:31]
  v_add_f32 v122, v122, v118
  ds_read_b128 v[104:107], v12 offset:34176
  v_mfma_f32_16x16x32_bf16 v[28:31], v[108:111], v[236:239], v[28:31]
  ds_read_b128 v[108:111], v12 offset:34240
  s_waitcnt lgkmcnt(2)
  v_mfma_f32_16x16x32_bf16 v[16:19], v[96:99], v[144:147], v[16:19]
  v_mfma_f32_16x16x32_bf16 v[16:19], v[100:103], v[148:151], v[16:19]
  v_mfma_f32_16x16x32_bf16 v[20:23], v[96:99], v[176:179], v[20:23]
  buffer_load_dwordx4 v125, s[4:7], s26 offen offset:1056 lds
  v_mfma_f32_16x16x32_bf16 v[20:23], v[100:103], v[180:183], v[20:23]
  v_mfma_f32_16x16x32_bf16 v[24:27], v[96:99], v[208:211], v[24:27]
  v_mfma_f32_16x16x32_bf16 v[24:27], v[100:103], v[212:215], v[24:27]
  v_add_f32 v123, v123, v119
  v_mfma_f32_16x16x32_bf16 v[28:31], v[96:99], v[240:243], v[28:31]
  ds_read_b128 v[96:99], v12 offset:42240
  v_mfma_f32_16x16x32_bf16 v[28:31], v[100:103], v[244:247], v[28:31]
  ds_read_b128 v[100:103], v12 offset:42304
  s_waitcnt lgkmcnt(2)
  v_mfma_f32_16x16x32_bf16 v[16:19], v[104:107], v[152:155], v[16:19]
  buffer_load_dwordx4 v126, s[4:7], s26 offen offset:2112 lds
  v_mfma_f32_16x16x32_bf16 v[16:19], v[108:111], v[156:159], v[16:19]
  v_mfma_f32_16x16x32_bf16 v[20:23], v[104:107], v[184:187], v[20:23]
  v_mfma_f32_16x16x32_bf16 v[20:23], v[108:111], v[188:191], v[20:23]
  v_mfma_f32_16x16x32_bf16 v[24:27], v[104:107], v[216:219], v[24:27]
  v_mfma_f32_16x16x32_bf16 v[24:27], v[108:111], v[220:223], v[24:27]
  v_mfma_f32_16x16x32_bf16 v[28:31], v[104:107], v[248:251], v[28:31]
  buffer_load_dwordx4 v127, s[4:7], s26 offen offset:3168 lds
  s_add_u32 s26, s26, 16384
  v_mfma_f32_16x16x32_bf16 v[28:31], v[108:111], v[252:255], v[28:31]
  ds_read_b128 v[104:107], v12 offset:42368
  ds_read_b128 v[108:111], v12 offset:42432
  s_waitcnt lgkmcnt(2)
  v_mfma_f32_16x16x32_bf16 v[32:35], v[96:99], v[128:131], v[48:51]
  v_mfma_f32_16x16x32_bf16 v[32:35], v[100:103], v[132:135], v[32:35]
  v_mfma_f32_16x16x32_bf16 v[36:39], v[96:99], v[160:163], v[52:55]
  v_exp_f32 v112, v16
  v_mfma_f32_16x16x32_bf16 v[36:39], v[100:103], v[164:167], v[36:39]
  v_exp_f32 v113, v17
  v_mfma_f32_16x16x32_bf16 v[40:43], v[96:99], v[192:195], v[56:59]
  v_exp_f32 v114, v18
  v_mfma_f32_16x16x32_bf16 v[40:43], v[100:103], v[196:199], v[40:43]
  v_exp_f32 v115, v19
  v_mfma_f32_16x16x32_bf16 v[44:47], v[96:99], v[224:227], v[60:63]
  ds_read_b128 v[96:99], v12 offset:42496
  v_add_f32 v116, v112, v113
  v_mfma_f32_16x16x32_bf16 v[44:47], v[100:103], v[228:231], v[44:47]
  ds_read_b128 v[100:103], v12 offset:42560
  s_waitcnt lgkmcnt(2)
  v_mfma_f32_16x16x32_bf16 v[32:35], v[104:107], v[136:139], v[32:35]
  v_cvt_pk_bf16_f32 v80, v112, v113
  v_mfma_f32_16x16x32_bf16 v[32:35], v[108:111], v[140:143], v[32:35]
  v_exp_f32 v112, v20
  v_mfma_f32_16x16x32_bf16 v[36:39], v[104:107], v[168:171], v[36:39]
  v_exp_f32 v113, v21
  v_mfma_f32_16x16x32_bf16 v[36:39], v[108:111], v[172:175], v[36:39]
  v_add_f32 v116, v116, v114
  v_add_f32 v116, v116, v115
  v_mfma_f32_16x16x32_bf16 v[40:43], v[104:107], v[200:203], v[40:43]
  v_cvt_pk_bf16_f32 v81, v114, v115
  v_add_f32 v117, v112, v113
  v_mfma_f32_16x16x32_bf16 v[40:43], v[108:111], v[204:207], v[40:43]
  v_exp_f32 v114, v22
  v_mfma_f32_16x16x32_bf16 v[44:47], v[104:107], v[232:235], v[44:47]
  ds_read_b128 v[104:107], v12 offset:42624
  v_cvt_pk_bf16_f32 v84, v112, v113
  v_mfma_f32_16x16x32_bf16 v[44:47], v[108:111], v[236:239], v[44:47]
  ds_read_b128 v[108:111], v12 offset:42688
  s_waitcnt lgkmcnt(2)
  v_mfma_f32_16x16x32_bf16 v[32:35], v[96:99], v[144:147], v[32:35]
  v_mfma_f32_16x16x32_bf16 v[32:35], v[100:103], v[148:151], v[32:35]
  v_exp_f32 v115, v23
  v_mfma_f32_16x16x32_bf16 v[36:39], v[96:99], v[176:179], v[36:39]
  s_waitcnt vmcnt(9)
  s_barrier
  v_mfma_f32_16x16x32_bf16 v[36:39], v[100:103], v[180:183], v[36:39]
  s_add_u32 m0, s28, 102400
  v_add_f32 v117, v117, v114
  v_mfma_f32_16x16x32_bf16 v[40:43], v[96:99], v[208:211], v[40:43]
  buffer_load_dwordx4 v8, s[8:11], s21 offen offset:0 lds
  v_mfma_f32_16x16x32_bf16 v[40:43], v[100:103], v[212:215], v[40:43]
  v_exp_f32 v112, v24
  v_mfma_f32_16x16x32_bf16 v[44:47], v[96:99], v[240:243], v[44:47]
  ds_read_b64_tr_b16 v[96:97], v13 offset:0
  ds_read_b64_tr_b16 v[98:99], v13 offset:8704
  v_mfma_f32_16x16x32_bf16 v[44:47], v[100:103], v[244:247], v[44:47]
  ds_read_b64_tr_b16 v[100:101], v14 offset:0
  ds_read_b64_tr_b16 v[102:103], v14 offset:8704
  s_waitcnt lgkmcnt(4)
  v_mfma_f32_16x16x32_bf16 v[32:35], v[104:107], v[152:155], v[32:35]
  v_add_f32 v117, v117, v115
  v_mfma_f32_16x16x32_bf16 v[32:35], v[108:111], v[156:159], v[32:35]
  v_exp_f32 v113, v25
  v_mfma_f32_16x16x32_bf16 v[36:39], v[104:107], v[184:187], v[36:39]
  buffer_load_dwordx4 v9, s[8:11], s21 offen offset:1088 lds
  v_mfma_f32_16x16x32_bf16 v[36:39], v[108:111], v[188:191], v[36:39]
  v_cvt_pk_bf16_f32 v85, v114, v115
  v_add_f32 v118, v112, v113
  v_mfma_f32_16x16x32_bf16 v[40:43], v[104:107], v[216:219], v[40:43]
  v_exp_f32 v114, v26
  v_mfma_f32_16x16x32_bf16 v[40:43], v[108:111], v[220:223], v[40:43]
  v_exp_f32 v115, v27
  v_mfma_f32_16x16x32_bf16 v[44:47], v[104:107], v[248:251], v[44:47]
  ds_read_b64_tr_b16 v[104:105], v13 offset:64
  ds_read_b64_tr_b16 v[106:107], v13 offset:8768
  v_mfma_f32_16x16x32_bf16 v[44:47], v[108:111], v[252:255], v[44:47]
  ds_read_b64_tr_b16 v[108:109], v14 offset:64
  ds_read_b64_tr_b16 v[110:111], v14 offset:8768
  s_waitcnt lgkmcnt(4)
  v_mfma_f32_16x16x32_bf16 a[0:3], v[96:99], v[64:67], a[0:3]
  buffer_load_dwordx4 v10, s[8:11], s21 offen offset:2176 lds
  v_mfma_f32_16x16x32_bf16 a[4:7], v[96:99], v[68:71], a[4:7]
  v_cvt_pk_bf16_f32 v88, v112, v113
  v_add_f32 v118, v118, v114
  v_mfma_f32_16x16x32_bf16 a[8:11], v[96:99], v[72:75], a[8:11]
  v_exp_f32 v112, v28
  v_mfma_f32_16x16x32_bf16 a[12:15], v[96:99], v[76:79], a[12:15]
  ds_read_b64_tr_b16 v[96:97], v13 offset:128
  ds_read_b64_tr_b16 v[98:99], v13 offset:8832
  v_mfma_f32_16x16x32_bf16 a[16:19], v[100:103], v[64:67], a[16:19]
  v_exp_f32 v113, v29
  v_mfma_f32_16x16x32_bf16 a[20:23], v[100:103], v[68:71], a[20:23]
  v_add_f32 v118, v118, v115
  v_cvt_pk_bf16_f32 v89, v114, v115
  v_mfma_f32_16x16x32_bf16 a[24:27], v[100:103], v[72:75], a[24:27]
  buffer_load_dwordx4 v11, s[8:11], s21 offen offset:3264 lds
  s_add_u32 s21, s21, 16384
  v_mfma_f32_16x16x32_bf16 a[28:31], v[100:103], v[76:79], a[28:31]
  ds_read_b64_tr_b16 v[100:101], v14 offset:128
  ds_read_b64_tr_b16 v[102:103], v14 offset:8832
  s_waitcnt lgkmcnt(4)
  v_mfma_f32_16x16x32_bf16 a[32:35], v[104:107], v[64:67], a[32:35]
  v_exp_f32 v114, v30
  v_mfma_f32_16x16x32_bf16 a[36:39], v[104:107], v[68:71], a[36:39]
  v_exp_f32 v115, v31
  v_mfma_f32_16x16x32_bf16 a[40:43], v[104:107], v[72:75], a[40:43]
  v_add_f32 v119, v112, v113
  v_cvt_pk_bf16_f32 v92, v112, v113
  v_mfma_f32_16x16x32_bf16 a[44:47], v[104:107], v[76:79], a[44:47]
  s_add_u32 m0, s28, 106752
  ds_read_b64_tr_b16 v[104:105], v13 offset:192
  v_mfma_f32_16x16x32_bf16 a[48:51], v[108:111], v[64:67], a[48:51]
  buffer_load_dwordx4 v8, s[8:11], s27 offen offset:0 lds
  v_mfma_f32_16x16x32_bf16 a[52:55], v[108:111], v[68:71], a[52:55]
  ds_read_b64_tr_b16 v[106:107], v13 offset:8896
  v_add_f32 v119, v119, v114
  v_mfma_f32_16x16x32_bf16 a[56:59], v[108:111], v[72:75], a[56:59]
  v_exp_f32 v112, v32
  v_mfma_f32_16x16x32_bf16 a[60:63], v[108:111], v[76:79], a[60:63]
  ds_read_b64_tr_b16 v[108:109], v14 offset:192
  ds_read_b64_tr_b16 v[110:111], v14 offset:8896
  s_waitcnt lgkmcnt(4)
  v_mfma_f32_16x16x32_bf16 a[64:67], v[96:99], v[64:67], a[64:67]
  v_exp_f32 v113, v33
  v_mfma_f32_16x16x32_bf16 a[68:71], v[96:99], v[68:71], a[68:71]
  v_add_f32 v119, v119, v115
  v_cvt_pk_bf16_f32 v93, v114, v115
  v_mfma_f32_16x16x32_bf16 a[72:75], v[96:99], v[72:75], a[72:75]
  buffer_load_dwordx4 v9, s[8:11], s27 offen offset:1088 lds
  v_mfma_f32_16x16x32_bf16 a[76:79], v[96:99], v[76:79], a[76:79]
  ds_read_b64_tr_b16 v[96:97], v13 offset:256
  ds_read_b64_tr_b16 v[98:99], v13 offset:8960
  v_mfma_f32_16x16x32_bf16 a[80:83], v[100:103], v[64:67], a[80:83]
  v_exp_f32 v114, v34
  v_mfma_f32_16x16x32_bf16 a[84:87], v[100:103], v[68:71], a[84:87]
  v_exp_f32 v115, v35
  v_mfma_f32_16x16x32_bf16 a[88:91], v[100:103], v[72:75], a[88:91]
  v_add_f32 v116, v116, v112
  v_add_f32 v116, v116, v113
  v_mfma_f32_16x16x32_bf16 a[92:95], v[100:103], v[76:79], a[92:95]
  ds_read_b64_tr_b16 v[100:101], v14 offset:256
  ds_read_b64_tr_b16 v[102:103], v14 offset:8960
  s_waitcnt lgkmcnt(4)
  v_mfma_f32_16x16x32_bf16 a[96:99], v[104:107], v[64:67], a[96:99]
  buffer_load_dwordx4 v10, s[8:11], s27 offen offset:2176 lds
  v_mfma_f32_16x16x32_bf16 a[100:103], v[104:107], v[68:71], a[100:103]
  v_cvt_pk_bf16_f32 v82, v112, v113
  v_add_f32 v116, v116, v114
  v_mfma_f32_16x16x32_bf16 a[104:107], v[104:107], v[72:75], a[104:107]
  v_exp_f32 v112, v36
  v_mfma_f32_16x16x32_bf16 a[108:111], v[104:107], v[76:79], a[108:111]
  ds_read_b64_tr_b16 v[104:105], v13 offset:320
  ds_read_b64_tr_b16 v[106:107], v13 offset:9024
  v_mfma_f32_16x16x32_bf16 a[112:115], v[108:111], v[64:67], a[112:115]
  v_exp_f32 v113, v37
  v_mfma_f32_16x16x32_bf16 a[116:119], v[108:111], v[68:71], a[116:119]
  v_add_f32 v116, v116, v115
  v_cvt_pk_bf16_f32 v83, v114, v115
  v_mfma_f32_16x16x32_bf16 a[120:123], v[108:111], v[72:75], a[120:123]
  buffer_load_dwordx4 v11, s[8:11], s27 offen offset:3264 lds
  s_add_u32 s27, s27, 16384
  v_mfma_f32_16x16x32_bf16 a[124:127], v[108:111], v[76:79], a[124:127]
  ds_read_b64_tr_b16 v[108:109], v14 offset:320
  ds_read_b64_tr_b16 v[110:111], v14 offset:9024
  s_waitcnt lgkmcnt(4)
  v_mfma_f32_16x16x32_bf16 a[128:131], v[96:99], v[64:67], a[128:131]
  v_exp_f32 v114, v38
  v_mfma_f32_16x16x32_bf16 a[132:135], v[96:99], v[68:71], a[132:135]
  v_exp_f32 v115, v39
  v_mfma_f32_16x16x32_bf16 a[136:139], v[96:99], v[72:75], a[136:139]
  v_add_f32 v117, v117, v112
  v_add_f32 v117, v117, v113
  v_mfma_f32_16x16x32_bf16 a[140:143], v[96:99], v[76:79], a[140:143]
  ds_read_b64_tr_b16 v[96:97], v13 offset:384
  ds_read_b64_tr_b16 v[98:99], v13 offset:9088
  v_mfma_f32_16x16x32_bf16 a[144:147], v[100:103], v[64:67], a[144:147]
  v_cvt_pk_bf16_f32 v86, v112, v113
  v_add_f32 v117, v117, v114
  v_mfma_f32_16x16x32_bf16 a[148:151], v[100:103], v[68:71], a[148:151]
  v_exp_f32 v112, v40
  v_mfma_f32_16x16x32_bf16 a[152:155], v[100:103], v[72:75], a[152:155]
  v_exp_f32 v113, v41
  v_mfma_f32_16x16x32_bf16 a[156:159], v[100:103], v[76:79], a[156:159]
  ds_read_b64_tr_b16 v[100:101], v14 offset:384
  ds_read_b64_tr_b16 v[102:103], v14 offset:9088
  s_waitcnt lgkmcnt(4)
  v_mfma_f32_16x16x32_bf16 a[160:163], v[104:107], v[64:67], a[160:163]
  v_add_f32 v117, v117, v115
  v_cvt_pk_bf16_f32 v87, v114, v115
  v_mfma_f32_16x16x32_bf16 a[164:167], v[104:107], v[68:71], a[164:167]
  v_exp_f32 v114, v42
  v_mfma_f32_16x16x32_bf16 a[168:171], v[104:107], v[72:75], a[168:171]
  v_exp_f32 v115, v43
  v_mfma_f32_16x16x32_bf16 a[172:175], v[104:107], v[76:79], a[172:175]
  ds_read_b64_tr_b16 v[104:105], v13 offset:448
  ds_read_b64_tr_b16 v[106:107], v13 offset:9152
  v_mfma_f32_16x16x32_bf16 a[176:179], v[108:111], v[64:67], a[176:179]
  v_add_f32 v118, v118, v112
  v_add_f32 v118, v118, v113
  v_mfma_f32_16x16x32_bf16 a[180:183], v[108:111], v[68:71], a[180:183]
  v_cvt_pk_bf16_f32 v90, v112, v113
  v_add_f32 v118, v118, v114
  v_mfma_f32_16x16x32_bf16 a[184:187], v[108:111], v[72:75], a[184:187]
  v_exp_f32 v112, v44
  v_mfma_f32_16x16x32_bf16 a[188:191], v[108:111], v[76:79], a[188:191]
  buffer_load_dword v15, v3, s[72:75], s29 offen
  s_waitcnt lgkmcnt(2)
  v_mfma_f32_16x16x32_bf16 a[192:195], v[96:99], v[64:67], a[192:195]
  s_add_u32 s29, s29, 16384
  ds_read_b64_tr_b16 v[108:109], v14 offset:448
  v_mfma_f32_16x16x32_bf16 a[196:199], v[96:99], v[68:71], a[196:199]
  s_waitcnt vmcnt(9)
  s_barrier
  v_mfma_f32_16x16x32_bf16 a[200:203], v[96:99], v[72:75], a[200:203]
  s_add_u32 m0, s23, 33792
  ds_read_b64_tr_b16 v[110:111], v14 offset:9152
  v_mfma_f32_16x16x32_bf16 a[204:207], v[96:99], v[76:79], a[204:207]
  buffer_load_dwordx4 v124, s[4:7], s20 offen offset:0 lds
  v_mfma_f32_16x16x32_bf16 a[208:211], v[100:103], v[64:67], a[208:211]
  ds_read_b128 v[96:99], v12 offset:0
  v_add_f32 v118, v118, v115
  v_mfma_f32_16x16x32_bf16 a[212:215], v[100:103], v[68:71], a[212:215]
  v_exp_f32 v113, v45
  v_mfma_f32_16x16x32_bf16 a[216:219], v[100:103], v[72:75], a[216:219]
  v_cvt_pk_bf16_f32 v91, v114, v115
  v_add_f32 v119, v119, v112
  v_mfma_f32_16x16x32_bf16 a[220:223], v[100:103], v[76:79], a[220:223]
  ds_read_b128 v[100:103], v12 offset:64
  s_waitcnt lgkmcnt(2)
  v_mfma_f32_16x16x32_bf16 a[224:227], v[104:107], v[64:67], a[224:227]
  v_exp_f32 v114, v46
  v_mfma_f32_16x16x32_bf16 a[228:231], v[104:107], v[68:71], a[228:231]
  buffer_load_dwordx4 v125, s[4:7], s20 offen offset:1056 lds
  v_mfma_f32_16x16x32_bf16 a[232:235], v[104:107], v[72:75], a[232:235]
  v_exp_f32 v115, v47
  v_mfma_f32_16x16x32_bf16 a[236:239], v[104:107], v[76:79], a[236:239]
  ds_read_b128 v[104:107], v12 offset:128
  v_mfma_f32_16x16x32_bf16 a[240:243], v[108:111], v[64:67], a[240:243]
  v_add_f32 v119, v119, v113
  v_cvt_pk_bf16_f32 v94, v112, v113
  v_mfma_f32_16x16x32_bf16 a[244:247], v[108:111], v[68:71], a[244:247]
  v_add_f32 v119, v119, v114
  v_add_f32 v119, v119, v115
  v_mfma_f32_16x16x32_bf16 a[248:251], v[108:111], v[72:75], a[248:251]
  v_cvt_pk_bf16_f32 v95, v114, v115
  v_mfma_f32_16x16x32_bf16 a[252:255], v[108:111], v[76:79], a[252:255]
  ds_read_b128 v[108:111], v12 offset:192
  v_max3_f32 v4, v116, v117, v118
  v_max_f32 v4, v4, v119
  v_cmp_lt_f32 vcc, s25, v4
  s_cbranch_vccnz TR_5
RET_6:
  s_cmp_lg_u32 s24, 3
  s_cbranch_scc1 K1_NCW2
  s_getpc_b64 s[76:77]
K1_PC2:
  s_mov_b32 s78, K1_END - K1_PC2
  s_mov_b32 s79, 0x20000
  s_lshr_b32 s38, s2, 3
  s_lshl_b32 s38, s38, 15
  s_lshl_b32 s39, s22, 13
  s_add_u32 s38, s38, s39
  v_lshlrev_b32 v2, 7, v0
  buffer_load_dword v7, v2, s[76:79], s38 offen
K1_NCW2:
  s_sub_u32 s24, s24, 1
  s_cmp_lg_u32 s24, 0
  s_cbranch_scc1 K1_LOOP
  s_mul_i32 s38, s34, 458752
  s_add_u32 s12, s54, s38
  s_addc_u32 s13, s55, 0
  s_mov_b32 s14, 458752
  s_mov_b32 s15, 0x20000
  s_mul_i32 s38, s35, 14336
  s_lshl_b32 s39, s22, 12
  s_add_u32 s38, s38, s39
  v_and_b32 v4, 31, v0
  v_lshlrev_b32 v4, 7, v4
  buffer_load_dword v15, v4, s[12:15], s38 offen
  v_min_u32 v1, 7, v0
  v_mul_u32_u24 v1, 14336, v1
  v_lshlrev_b32 v1, 7, v1
  v_add_u32 v1, 8388608, v1
  v_mov_b32 v2, 1048576
  v_cmp_eq_u32 vcc, 8, v0
  s_nop 1
  v_cndmask_b32 v1, v1, v2, vcc
  v_mov_b32 v2, 3145728
  v_cmp_eq_u32 vcc, 9, v0
  s_nop 1
  v_cndmask_b32 v1, v1, v2, vcc
  s_mul_i32 s38, s35, 57344
  buffer_load_dword v6, v1, s[16:19], s38 offen
  s_mov_b32 s72, s66
  s_mov_b32 s73, s67
  s_mov_b32 s74, 1835008
  s_mov_b32 s75, 0x20000
  v_mov_b32 v2, 0
  buffer_load_dword v7, v2, s[72:75], s38 offen
  s_waitcnt lgkmcnt(2)
  v_mfma_f32_16x16x32_bf16 v[16:19], v[96:99], v[128:131], v[48:51]
  buffer_load_dwordx4 v126, s[4:7], s20 offen offset:2112 lds
  v_mfma_f32_16x16x32_bf16 v[16:19], v[100:103], v[132:135], v[16:19]
  v_mfma_f32_16x16x32_bf16 v[20:23], v[96:99], v[160:163], v[52:55]
  v_mfma_f32_16x16x32_bf16 v[20:23], v[100:103], v[164:167], v[20:23]
  v_mfma_f32_16x16x32_bf16 v[24:27], v[96:99], v[192:195], v[56:59]
  v_mfma_f32_16x16x32_bf16 v[24:27], v[100:103], v[196:199], v[24:27]
  v_add_f32 v120, v120, v116
  v_mfma_f32_16x16x32_bf16 v[28:31], v[96:99], v[224:227], v[60:63]
  buffer_load_dwordx4 v127, s[4:7], s20 offen offset:3168 lds
  s_add_u32 s20, s20, 16384
  v_mfma_f32_16x16x32_bf16 v[28:31], v[100:103], v[228:231], v[28:31]
  ds_read_b128 v[96:99], v12 offset:256
  ds_read_b128 v[100:103], v12 offset:320
  s_waitcnt lgkmcnt(2)
  v_mfma_f32_16x16x32_bf16 v[16:19], v[104:107], v[136:139], v[16:19]
  v_mfma_f32_16x16x32_bf16 v[16:19], v[108:111], v[140:143], v[16:19]
  v_add_f32 v121, v121, v117
  v_mfma_f32_16x16x32_bf16 v[20:23], v[104:107], v[168:171], v[20:23]
  v_mfma_f32_16x16x32_bf16 v[20:23], v[108:111], v[172:175], v[20:23]
  s_add_u32 m0, s23, 38016
  v_mfma_f32_16x16x32_bf16 v[24:27], v[104:107], v[200:203], v[24:27]
  buffer_load_dwordx4 v124, s[4:7], s26 offen offset:0 lds
  v_mfma_f32_16x16x32_bf16 v[24:27], v[108:111], v[204:207], v[24:27]
  v_mfma_f32_16x16x32_bf16 v[28:31], v[104:107], v[232:235], v[28:31]
  v_add_f32 v122, v122, v118
  ds_read_b128 v[104:107], v12 offset:384
  v_mfma_f32_16x16x32_bf16 v[28:31], v[108:111], v[236:239], v[28:31]
  ds_read_b128 v[108:111], v12 offset:448
  s_waitcnt lgkmcnt(2)
  v_mfma_f32_16x16x32_bf16 v[16:19], v[96:99], v[144:147], v[16:19]
  v_mfma_f32_16x16x32_bf16 v[16:19], v[100:103], v[148:151], v[16:19]
  v_mfma_f32_16x16x32_bf16 v[20:23], v[96:99], v[176:179], v[20:23]
  buffer_load_dwordx4 v125, s[4:7], s26 offen offset:1056 lds
  v_mfma_f32_16x16x32_bf16 v[20:23], v[100:103], v[180:183], v[20:23]
  v_mfma_f32_16x16x32_bf16 v[24:27], v[96:99], v[208:211], v[24:27]
  v_mfma_f32_16x16x32_bf16 v[24:27], v[100:103], v[212:215], v[24:27]
  v_add_f32 v123, v123, v119
  v_mfma_f32_16x16x32_bf16 v[28:31], v[96:99], v[240:243], v[28:31]
  ds_read_b128 v[96:99], v12 offset:8448
  v_mfma_f32_16x16x32_bf16 v[28:31], v[100:103], v[244:247], v[28:31]
  ds_read_b128 v[100:103], v12 offset:8512
  s_waitcnt lgkmcnt(2)
  v_mfma_f32_16x16x32_bf16 v[16:19], v[104:107], v[152:155], v[16:19]
  buffer_load_dwordx4 v126, s[4:7], s26 offen offset:2112 lds
  v_mfma_f32_16x16x32_bf16 v[16:19], v[108:111], v[156:159], v[16:19]
  v_mfma_f32_16x16x32_bf16 v[20:23], v[104:107], v[184:187], v[20:23]
  v_mfma_f32_16x16x32_bf16 v[20:23], v[108:111], v[188:191], v[20:23]
  v_mfma_f32_16x16x32_bf16 v[24:27], v[104:107], v[216:219], v[24:27]
  v_mfma_f32_16x16x32_bf16 v[24:27], v[108:111], v[220:223], v[24:27]
  v_mfma_f32_16x16x32_bf16 v[28:31], v[104:107], v[248:251], v[28:31]
  buffer_load_dwordx4 v127, s[4:7], s26 offen offset:3168 lds
  s_add_u32 s26, s26, 16384
  v_mfma_f32_16x16x32_bf16 v[28:31], v[108:111], v[252:255], v[28:31]
  ds_read_b128 v[104:107], v12 offset:8576
  ds_read_b128 v[108:111], v12 offset:8640
  s_waitcnt lgkmcnt(2)
  v_mfma_f32_16x16x32_bf16 v[32:35], v[96:99], v[128:131], v[48:51]
  v_mfma_f32_16x16x32_bf16 v[32:35], v[100:103], v[132:135], v[32:35]
  v_mfma_f32_16x16x32_bf16 v[36:39], v[96:99], v[160:163], v[52:55]
  v_exp_f32 v112, v16
  v_mfma_f32_16x16x32_bf16 v[36:39], v[100:103], v[164:167], v[36:39]
  v_exp_f32 v113, v17
  v_mfma_f32_16x16x32_bf16 v[40:43], v[96:99], v[192:195], v[56:59]
  v_exp_f32 v114, v18
  v_mfma_f32_16x16x32_bf16 v[40:43], v[100:103], v[196:199], v[40:43]
  v_exp_f32 v115, v19
  v_mfma_f32_16x16x32_bf16 v[44:47], v[96:99], v[224:227], v[60:63]
  ds_read_b128 v[96:99], v12 offset:8704
  v_add_f32 v116, v112, v113
  v_mfma_f32_16x16x32_bf16 v[44:47], v[100:103], v[228:231], v[44:47]
  ds_read_b128 v[100:103], v12 offset:8768
  s_waitcnt lgkmcnt(2)
  v_mfma_f32_16x16x32_bf16 v[32:35], v[104:107], v[136:139], v[32:35]
  v_cvt_pk_bf16_f32 v64, v112, v113
  v_mfma_f32_16x16x32_bf16 v[32:35], v[108:111], v[140:143], v[32:35]
  v_exp_f32 v112, v20
  v_mfma_f32_16x16x32_bf16 v[36:39], v[104:107], v[168:171], v[36:39]
  v_exp_f32 v113, v21
  v_mfma_f32_16x16x32_bf16 v[36:39], v[108:111], v[172:175], v[36:39]
  v_add_f32 v116, v116, v114
  v_add_f32 v116, v116, v115
  v_mfma_f32_16x16x32_bf16 v[40:43], v[104:107], v[200:203], v[40:43]
  v_cvt_pk_bf16_f32 v65, v114, v115
  v_add_f32 v117, v112, v113
  v_mfma_f32_16x16x32_bf16 v[40:43], v[108:111], v[204:207], v[40:43]
  v_exp_f32 v114, v22
  v_mfma_f32_16x16x32_bf16 v[44:47], v[104:107], v[232:235], v[44:47]
  ds_read_b128 v[104:107], v12 offset:8832
  v_cvt_pk_bf16_f32 v68, v112, v113
  v_mfma_f32_16x16x32_bf16 v[44:47], v[108:111], v[236:239], v[44:47]
  ds_read_b128 v[108:111], v12 offset:8896
  s_waitcnt lgkmcnt(2)
  v_mfma_f32_16x16x32_bf16 v[32:35], v[96:99], v[144:147], v[32:35]
  v_mfma_f32_16x16x32_bf16 v[32:35], v[100:103], v[148:151], v[32:35]
  v_exp_f32 v115, v23
  v_mfma_f32_16x16x32_bf16 v[36:39], v[96:99], v[176:179], v[36:39]
  s_waitcnt vmcnt(12)
  s_barrier
  v_mfma_f32_16x16x32_bf16 v[36:39], v[100:103], v[180:183], v[36:39]
  s_add_u32 m0, s28, 67584
  v_add_f32 v117, v117, v114
  v_mfma_f32_16x16x32_bf16 v[40:43], v[96:99], v[208:211], v[40:43]
  buffer_load_dwordx4 v8, s[8:11], s21 offen offset:0 lds
  v_mfma_f32_16x16x32_bf16 v[40:43], v[100:103], v[212:215], v[40:43]
  v_exp_f32 v112, v24
  v_mfma_f32_16x16x32_bf16 v[44:47], v[96:99], v[240:243], v[44:47]
  ds_read_b64_tr_b16 v[96:97], v13 offset:34816
  ds_read_b64_tr_b16 v[98:99], v13 offset:43520
  v_mfma_f32_16x16x32_bf16 v[44:47], v[100:103], v[244:247], v[44:47]
  ds_read_b64_tr_b16 v[100:101], v14 offset:34816
  ds_read_b64_tr_b16 v[102:103], v14 offset:43520
  s_waitcnt lgkmcnt(4)
  v_mfma_f32_16x16x32_bf16 v[32:35], v[104:107], v[152:155], v[32:35]
  v_add_f32 v117, v117, v115
  v_mfma_f32_16x16x32_bf16 v[32:35], v[108:111], v[156:159], v[32:35]
  v_exp_f32 v113, v25
  v_mfma_f32_16x16x32_bf16 v[36:39], v[104:107], v[184:187], v[36:39]
  buffer_load_dwordx4 v9, s[8:11], s21 offen offset:1088 lds
  v_mfma_f32_16x16x32_bf16 v[36:39], v[108:111], v[188:191], v[36:39]
  v_cvt_pk_bf16_f32 v69, v114, v115
  v_add_f32 v118, v112, v113
  v_mfma_f32_16x16x32_bf16 v[40:43], v[104:107], v[216:219], v[40:43]
  v_exp_f32 v114, v26
  v_mfma_f32_16x16x32_bf16 v[40:43], v[108:111], v[220:223], v[40:43]
  v_exp_f32 v115, v27
  v_mfma_f32_16x16x32_bf16 v[44:47], v[104:107], v[248:251], v[44:47]
  ds_read_b64_tr_b16 v[104:105], v13 offset:34880
  ds_read_b64_tr_b16 v[106:107], v13 offset:43584
  v_mfma_f32_16x16x32_bf16 v[44:47], v[108:111], v[252:255], v[44:47]
  ds_read_b64_tr_b16 v[108:109], v14 offset:34880
  ds_read_b64_tr_b16 v[110:111], v14 offset:43584
  s_waitcnt lgkmcnt(4)
  v_mfma_f32_16x16x32_bf16 a[0:3], v[96:99], v[80:83], a[0:3]
  buffer_load_dwordx4 v10, s[8:11], s21 offen offset:2176 lds
  v_mfma_f32_16x16x32_bf16 a[4:7], v[96:99], v[84:87], a[4:7]
  v_cvt_pk_bf16_f32 v72, v112, v113
  v_add_f32 v118, v118, v114
  v_mfma_f32_16x16x32_bf16 a[8:11], v[96:99], v[88:91], a[8:11]
  v_exp_f32 v112, v28
  v_mfma_f32_16x16x32_bf16 a[12:15], v[96:99], v[92:95], a[12:15]
  ds_read_b64_tr_b16 v[96:97], v13 offset:34944
  ds_read_b64_tr_b16 v[98:99], v13 offset:43648
  v_mfma_f32_16x16x32_bf16 a[16:19], v[100:103], v[80:83], a[16:19]
  v_exp_f32 v113, v29
  v_mfma_f32_16x16x32_bf16 a[20:23], v[100:103], v[84:87], a[20:23]
  v_add_f32 v118, v118, v115
  v_cvt_pk_bf16_f32 v73, v114, v115
  v_mfma_f32_16x16x32_bf16 a[24:27], v[100:103], v[88:91], a[24:27]
  buffer_load_dwordx4 v11, s[8:11], s21 offen offset:3264 lds
  s_add_u32 s21, s21, 16384
  v_mfma_f32_16x16x32_bf16 a[28:31], v[100:103], v[92:95], a[28:31]
  ds_read_b64_tr_b16 v[100:101], v14 offset:34944
  ds_read_b64_tr_b16 v[102:103], v14 offset:43648
  s_waitcnt lgkmcnt(4)
  v_mfma_f32_16x16x32_bf16 a[32:35], v[104:107], v[80:83], a[32:35]
  v_exp_f32 v114, v30
  v_mfma_f32_16x16x32_bf16 a[36:39], v[104:107], v[84:87], a[36:39]
  v_exp_f32 v115, v31
  v_mfma_f32_16x16x32_bf16 a[40:43], v[104:107], v[88:91], a[40:43]
  v_add_f32 v119, v112, v113
  v_cvt_pk_bf16_f32 v76, v112, v113
  v_mfma_f32_16x16x32_bf16 a[44:47], v[104:107], v[92:95], a[44:47]
  s_add_u32 m0, s28, 71936
  ds_read_b64_tr_b16 v[104:105], v13 offset:35008
  v_mfma_f32_16x16x32_bf16 a[48:51], v[108:111], v[80:83], a[48:51]
  buffer_load_dwordx4 v8, s[8:11], s27 offen offset:0 lds
  v_mfma_f32_16x16x32_bf16 a[52:55], v[108:111], v[84:87], a[52:55]
  ds_read_b64_tr_b16 v[106:107], v13 offset:43712
  v_add_f32 v119, v119, v114
  v_mfma_f32_16x16x32_bf16 a[56:59], v[108:111], v[88:91], a[56:59]
  v_exp_f32 v112, v32
  v_mfma_f32_16x16x32_bf16 a[60:63], v[108:111], v[92:95], a[60:63]
  ds_read_b64_tr_b16 v[108:109], v14 offset:35008
  ds_read_b64_tr_b16 v[110:111], v14 offset:43712
  s_waitcnt lgkmcnt(4)
  v_mfma_f32_16x16x32_bf16 a[64:67], v[96:99], v[80:83], a[64:67]
  v_exp_f32 v113, v33
  v_mfma_f32_16x16x32_bf16 a[68:71], v[96:99], v[84:87], a[68:71]
  v_add_f32 v119, v119, v115
  v_cvt_pk_bf16_f32 v77, v114, v115
  v_mfma_f32_16x16x32_bf16 a[72:75], v[96:99], v[88:91], a[72:75]
  buffer_load_dwordx4 v9, s[8:11], s27 offen offset:1088 lds
  v_mfma_f32_16x16x32_bf16 a[76:79], v[96:99], v[92:95], a[76:79]
  ds_read_b64_tr_b16 v[96:97], v13 offset:35072
  ds_read_b64_tr_b16 v[98:99], v13 offset:43776
  v_mfma_f32_16x16x32_bf16 a[80:83], v[100:103], v[80:83], a[80:83]
  v_exp_f32 v114, v34
  v_mfma_f32_16x16x32_bf16 a[84:87], v[100:103], v[84:87], a[84:87]
  v_exp_f32 v115, v35
  v_mfma_f32_16x16x32_bf16 a[88:91], v[100:103], v[88:91], a[88:91]
  v_add_f32 v116, v116, v112
  v_add_f32 v116, v116, v113
  v_mfma_f32_16x16x32_bf16 a[92:95], v[100:103], v[92:95], a[92:95]
  ds_read_b64_tr_b16 v[100:101], v14 offset:35072
  ds_read_b64_tr_b16 v[102:103], v14 offset:43776
  s_waitcnt lgkmcnt(4)
  v_mfma_f32_16x16x32_bf16 a[96:99], v[104:107], v[80:83], a[96:99]
  buffer_load_dwordx4 v10, s[8:11], s27 offen offset:2176 lds
  v_mfma_f32_16x16x32_bf16 a[100:103], v[104:107], v[84:87], a[100:103]
  v_cvt_pk_bf16_f32 v66, v112, v113
  v_add_f32 v116, v116, v114
  v_mfma_f32_16x16x32_bf16 a[104:107], v[104:107], v[88:91], a[104:107]
  v_exp_f32 v112, v36
  v_mfma_f32_16x16x32_bf16 a[108:111], v[104:107], v[92:95], a[108:111]
  ds_read_b64_tr_b16 v[104:105], v13 offset:35136
  ds_read_b64_tr_b16 v[106:107], v13 offset:43840
  v_mfma_f32_16x16x32_bf16 a[112:115], v[108:111], v[80:83], a[112:115]
  v_exp_f32 v113, v37
  v_mfma_f32_16x16x32_bf16 a[116:119], v[108:111], v[84:87], a[116:119]
  v_add_f32 v116, v116, v115
  v_cvt_pk_bf16_f32 v67, v114, v115
  v_mfma_f32_16x16x32_bf16 a[120:123], v[108:111], v[88:91], a[120:123]
  buffer_load_dwordx4 v11, s[8:11], s27 offen offset:3264 lds
  s_add_u32 s27, s27, 16384
  v_mfma_f32_16x16x32_bf16 a[124:127], v[108:111], v[92:95], a[124:127]
  ds_read_b64_tr_b16 v[108:109], v14 offset:35136
  ds_read_b64_tr_b16 v[110:111], v14 offset:43840
  s_waitcnt lgkmcnt(4)
  v_mfma_f32_16x16x32_bf16 a[128:131], v[96:99], v[80:83], a[128:131]
  v_exp_f32 v114, v38
  v_mfma_f32_16x16x32_bf16 a[132:135], v[96:99], v[84:87], a[132:135]
  v_exp_f32 v115, v39
  v_mfma_f32_16x16x32_bf16 a[136:139], v[96:99], v[88:91], a[136:139]
  v_add_f32 v117, v117, v112
  v_add_f32 v117, v117, v113
  v_mfma_f32_16x16x32_bf16 a[140:143], v[96:99], v[92:95], a[140:143]
  ds_read_b64_tr_b16 v[96:97], v13 offset:35200
  ds_read_b64_tr_b16 v[98:99], v13 offset:43904
  v_mfma_f32_16x16x32_bf16 a[144:147], v[100:103], v[80:83], a[144:147]
  v_cvt_pk_bf16_f32 v70, v112, v113
  v_add_f32 v117, v117, v114
  v_mfma_f32_16x16x32_bf16 a[148:151], v[100:103], v[84:87], a[148:151]
  v_exp_f32 v112, v40
  v_mfma_f32_16x16x32_bf16 a[152:155], v[100:103], v[88:91], a[152:155]
  v_exp_f32 v113, v41
  v_mfma_f32_16x16x32_bf16 a[156:159], v[100:103], v[92:95], a[156:159]
  ds_read_b64_tr_b16 v[100:101], v14 offset:35200
  ds_read_b64_tr_b16 v[102:103], v14 offset:43904
  s_waitcnt lgkmcnt(4)
  v_mfma_f32_16x16x32_bf16 a[160:163], v[104:107], v[80:83], a[160:163]
  v_add_f32 v117, v117, v115
  v_cvt_pk_bf16_f32 v71, v114, v115
  v_mfma_f32_16x16x32_bf16 a[164:167], v[104:107], v[84:87], a[164:167]
  v_exp_f32 v114, v42
  v_mfma_f32_16x16x32_bf16 a[168:171], v[104:107], v[88:91], a[168:171]
  v_exp_f32 v115, v43
  v_mfma_f32_16x16x32_bf16 a[172:175], v[104:107], v[92:95], a[172:175]
  ds_read_b64_tr_b16 v[104:105], v13 offset:35264
  ds_read_b64_tr_b16 v[106:107], v13 offset:43968
  v_mfma_f32_16x16x32_bf16 a[176:179], v[108:111], v[80:83], a[176:179]
  v_add_f32 v118, v118, v112
  v_add_f32 v118, v118, v113
  v_mfma_f32_16x16x32_bf16 a[180:183], v[108:111], v[84:87], a[180:183]
  v_cvt_pk_bf16_f32 v74, v112, v113
  v_add_f32 v118, v118, v114
  v_mfma_f32_16x16x32_bf16 a[184:187], v[108:111], v[88:91], a[184:187]
  v_exp_f32 v112, v44
  v_mfma_f32_16x16x32_bf16 a[188:191], v[108:111], v[92:95], a[188:191]
  ds_read_b64_tr_b16 v[108:109], v14 offset:35264
  ds_read_b64_tr_b16 v[110:111], v14 offset:43968
  s_waitcnt lgkmcnt(4)
  v_mfma_f32_16x16x32_bf16 a[192:195], v[96:99], v[80:83], a[192:195]
  v_exp_f32 v113, v45
  v_mfma_f32_16x16x32_bf16 a[196:199], v[96:99], v[84:87], a[196:199]
  s_waitcnt vmcnt(8)
  s_barrier
  v_mfma_f32_16x16x32_bf16 a[200:203], v[96:99], v[88:91], a[200:203]
  v_add_f32 v118, v118, v115
  v_cvt_pk_bf16_f32 v75, v114, v115
  v_mfma_f32_16x16x32_bf16 a[204:207], v[96:99], v[92:95], a[204:207]
  ds_read_b128 v[96:99], v12 offset:33792
  v_mfma_f32_16x16x32_bf16 a[208:211], v[100:103], v[80:83], a[208:211]
  v_exp_f32 v114, v46
  v_mfma_f32_16x16x32_bf16 a[212:215], v[100:103], v[84:87], a[212:215]
  v_exp_f32 v115, v47
  v_mfma_f32_16x16x32_bf16 a[216:219], v[100:103], v[88:91], a[216:219]
  v_add_f32 v119, v119, v112
  v_add_f32 v119, v119, v113
  v_mfma_f32_16x16x32_bf16 a[220:223], v[100:103], v[92:95], a[220:223]
  ds_read_b128 v[100:103], v12 offset:33856
  s_waitcnt lgkmcnt(2)
  v_mfma_f32_16x16x32_bf16 a[224:227], v[104:107], v[80:83], a[224:227]
  v_cvt_pk_bf16_f32 v78, v112, v113
  v_add_f32 v119, v119, v114
  v_mfma_f32_16x16x32_bf16 a[228:231], v[104:107], v[84:87], a[228:231]
  v_add_f32 v119, v119, v115
  v_cvt_pk_bf16_f32 v79, v114, v115
  v_mfma_f32_16x16x32_bf16 a[232:235], v[104:107], v[88:91], a[232:235]
  v_max3_f32 v4, v116, v117, v118
  v_mfma_f32_16x16x32_bf16 a[236:239], v[104:107], v[92:95], a[236:239]
  ds_read_b128 v[104:107], v12 offset:33920
  v_mfma_f32_16x16x32_bf16 a[240:243], v[108:111], v[80:83], a[240:243]
  v_max_f32 v4, v4, v119
  v_mfma_f32_16x16x32_bf16 a[244:247], v[108:111], v[84:87], a[244:247]
  v_cmp_lt_f32 vcc, s25, v4
  v_mfma_f32_16x16x32_bf16 a[248:251], v[108:111], v[88:91], a[248:251]
  v_mfma_f32_16x16x32_bf16 a[252:255], v[108:111], v[92:95], a[252:255]
  ds_read_b128 v[108:111], v12 offset:33984
  s_cbranch_vccnz TR_7
RET_8:
  s_waitcnt lgkmcnt(2)
  v_mfma_f32_16x16x32_bf16 v[16:19], v[96:99], v[128:131], v[48:51]
  v_mfma_f32_16x16x32_bf16 v[16:19], v[100:103], v[132:135], v[16:19]
  v_mfma_f32_16x16x32_bf16 v[20:23], v[96:99], v[160:163], v[52:55]
  v_mfma_f32_16x16x32_bf16 v[20:23], v[100:103], v[164:167], v[20:23]
  v_mfma_f32_16x16x32_bf16 v[24:27], v[96:99], v[192:195], v[56:59]
  v_mfma_f32_16x16x32_bf16 v[24:27], v[100:103], v[196:199], v[24:27]
  v_add_f32 v120, v120, v116
  v_mfma_f32_16x16x32_bf16 v[28:31], v[96:99], v[224:227], v[60:63]
  ds_read_b128 v[96:99], v12 offset:34048
  v_mfma_f32_16x16x32_bf16 v[28:31], v[100:103], v[228:231], v[28:31]
  ds_read_b128 v[100:103], v12 offset:34112
  s_waitcnt lgkmcnt(2)
  v_mfma_f32_16x16x32_bf16 v[16:19], v[104:107], v[136:139], v[16:19]
  v_mfma_f32_16x16x32_bf16 v[16:19], v[108:111], v[140:143], v[16:19]
  v_add_f32 v121, v121, v117
  v_mfma_f32_16x16x32_bf16 v[20:23], v[104:107], v[168:171], v[20:23]
  v_mfma_f32_16x16x32_bf16 v[20:23], v[108:111], v[172:175], v[20:23]
  v_mfma_f32_16x16x32_bf16 v[24:27], v[104:107], v[200:203], v[24:27]
  v_mfma_f32_16x16x32_bf16 v[24:27], v[108:111], v[204:207], v[24:27]
  v_mfma_f32_16x16x32_bf16 v[28:31], v[104:107], v[232:235], v[28:31]
  v_add_f32 v122, v122, v118
  ds_read_b128 v[104:107], v12 offset:34176
  v_mfma_f32_16x16x32_bf16 v[28:31], v[108:111], v[236:239], v[28:31]
  ds_read_b128 v[108:111], v12 offset:34240
  s_waitcnt lgkmcnt(2)
  v_mfma_f32_16x16x32_bf16 v[16:19], v[96:99], v[144:147], v[16:19]
  v_mfma_f32_16x16x32_bf16 v[16:19], v[100:103], v[148:151], v[16:19]
  v_mfma_f32_16x16x32_bf16 v[20:23], v[96:99], v[176:179], v[20:23]
  v_mfma_f32_16x16x32_bf16 v[20:23], v[100:103], v[180:183], v[20:23]
  v_mfma_f32_16x16x32_bf16 v[24:27], v[96:99], v[208:211], v[24:27]
  v_mfma_f32_16x16x32_bf16 v[24:27], v[100:103], v[212:215], v[24:27]
  v_add_f32 v123, v123, v119
  v_mfma_f32_16x16x32_bf16 v[28:31], v[96:99], v[240:243], v[28:31]
  ds_read_b128 v[96:99], v12 offset:42240
  v_mfma_f32_16x16x32_bf16 v[28:31], v[100:103], v[244:247], v[28:31]
  ds_read_b128 v[100:103], v12 offset:42304
  s_waitcnt lgkmcnt(2)
  v_mfma_f32_16x16x32_bf16 v[16:19], v[104:107], v[152:155], v[16:19]
  v_mfma_f32_16x16x32_bf16 v[16:19], v[108:111], v[156:159], v[16:19]
  v_mfma_f32_16x16x32_bf16 v[20:23], v[104:107], v[184:187], v[20:23]
  v_mfma_f32_16x16x32_bf16 v[20:23], v[108:111], v[188:191], v[20:23]
  v_mfma_f32_16x16x32_bf16 v[24:27], v[104:107], v[216:219], v[24:27]
  v_mfma_f32_16x16x32_bf16 v[24:27], v[108:111], v[220:223], v[24:27]
  v_mfma_f32_16x16x32_bf16 v[28:31], v[104:107], v[248:251], v[28:31]
  ds_read_b128 v[104:107], v12 offset:42368
  v_mfma_f32_16x16x32_bf16 v[28:31], v[108:111], v[252:255], v[28:31]
  ds_read_b128 v[108:111], v12 offset:42432
  s_waitcnt lgkmcnt(2)
  v_mfma_f32_16x16x32_bf16 v[32:35], v[96:99], v[128:131], v[48:51]
  v_mfma_f32_16x16x32_bf16 v[32:35], v[100:103], v[132:135], v[32:35]
  v_mfma_f32_16x16x32_bf16 v[36:39], v[96:99], v[160:163], v[52:55]
  v_exp_f32 v112, v16
  v_mfma_f32_16x16x32_bf16 v[36:39], v[100:103], v[164:167], v[36:39]
  v_exp_f32 v113, v17
  v_mfma_f32_16x16x32_bf16 v[40:43], v[96:99], v[192:195], v[56:59]
  v_exp_f32 v114, v18
  v_mfma_f32_16x16x32_bf16 v[40:43], v[100:103], v[196:199], v[40:43]
  v_exp_f32 v115, v19
  v_mfma_f32_16x16x32_bf16 v[44:47], v[96:99], v[224:227], v[60:63]
  ds_read_b128 v[96:99], v12 offset:42496
  v_add_f32 v116, v112, v113
  v_mfma_f32_16x16x32_bf16 v[44:47], v[100:103], v[228:231], v[44:47]
  ds_read_b128 v[100:103], v12 offset:42560
  s_waitcnt lgkmcnt(2)
  v_mfma_f32_16x16x32_bf16 v[32:35], v[104:107], v[136:139], v[32:35]
  v_cvt_pk_bf16_f32 v80, v112, v113
  v_mfma_f32_16x16x32_bf16 v[32:35], v[108:111], v[140:143], v[32:35]
  v_exp_f32 v112, v20
  v_mfma_f32_16x16x32_bf16 v[36:39], v[104:107], v[168:171], v[36:39]
  v_exp_f32 v113, v21
  v_mfma_f32_16x16x32_bf16 v[36:39], v[108:111], v[172:175], v[36:39]
  v_add_f32 v116, v116, v114
  v_add_f32 v116, v116, v115
  v_mfma_f32_16x16x32_bf16 v[40:43], v[104:107], v[200:203], v[40:43]
  v_cvt_pk_bf16_f32 v81, v114, v115
  v_add_f32 v117, v112, v113
  v_mfma_f32_16x16x32_bf16 v[40:43], v[108:111], v[204:207], v[40:43]
  v_exp_f32 v114, v22
  v_mfma_f32_16x16x32_bf16 v[44:47], v[104:107], v[232:235], v[44:47]
  ds_read_b128 v[104:107], v12 offset:42624
  v_cvt_pk_bf16_f32 v84, v112, v113
  v_mfma_f32_16x16x32_bf16 v[44:47], v[108:111], v[236:239], v[44:47]
  ds_read_b128 v[108:111], v12 offset:42688
  s_waitcnt lgkmcnt(2)
  v_mfma_f32_16x16x32_bf16 v[32:35], v[96:99], v[144:147], v[32:35]
  v_mfma_f32_16x16x32_bf16 v[32:35], v[100:103], v[148:151], v[32:35]
  v_exp_f32 v115, v23
  v_mfma_f32_16x16x32_bf16 v[36:39], v[96:99], v[176:179], v[36:39]
  s_waitcnt vmcnt(0)
  s_barrier
  v_mfma_f32_16x16x32_bf16 v[36:39], v[100:103], v[180:183], v[36:39]
  s_add_u32 m0, s28, 102400
  v_add_f32 v117, v117, v114
  v_mfma_f32_16x16x32_bf16 v[40:43], v[96:99], v[208:211], v[40:43]
  buffer_load_dwordx4 v8, s[8:11], s21 offen offset:0 lds
  v_mfma_f32_16x16x32_bf16 v[40:43], v[100:103], v[212:215], v[40:43]
  v_exp_f32 v112, v24
  v_mfma_f32_16x16x32_bf16 v[44:47], v[96:99], v[240:243], v[44:47]
  ds_read_b64_tr_b16 v[96:97], v13 offset:0
  ds_read_b64_tr_b16 v[98:99], v13 offset:8704
  v_mfma_f32_16x16x32_bf16 v[44:47], v[100:103], v[244:247], v[44:47]
  ds_read_b64_tr_b16 v[100:101], v14 offset:0
  ds_read_b64_tr_b16 v[102:103], v14 offset:8704
  s_waitcnt lgkmcnt(4)
  v_mfma_f32_16x16x32_bf16 v[32:35], v[104:107], v[152:155], v[32:35]
  v_add_f32 v117, v117, v115
  v_mfma_f32_16x16x32_bf16 v[32:35], v[108:111], v[156:159], v[32:35]
  v_exp_f32 v113, v25
  v_mfma_f32_16x16x32_bf16 v[36:39], v[104:107], v[184:187], v[36:39]
  buffer_load_dwordx4 v9, s[8:11], s21 offen offset:1088 lds
  v_mfma_f32_16x16x32_bf16 v[36:39], v[108:111], v[188:191], v[36:39]
  v_cvt_pk_bf16_f32 v85, v114, v115
  v_add_f32 v118, v112, v113
  v_mfma_f32_16x16x32_bf16 v[40:43], v[104:107], v[216:219], v[40:43]
  v_exp_f32 v114, v26
  v_mfma_f32_16x16x32_bf16 v[40:43], v[108:111], v[220:223], v[40:43]
  v_exp_f32 v115, v27
  v_mfma_f32_16x16x32_bf16 v[44:47], v[104:107], v[248:251], v[44:47]
  ds_read_b64_tr_b16 v[104:105], v13 offset:64
  ds_read_b64_tr_b16 v[106:107], v13 offset:8768
  v_mfma_f32_16x16x32_bf16 v[44:47], v[108:111], v[252:255], v[44:47]
  ds_read_b64_tr_b16 v[108:109], v14 offset:64
  ds_read_b64_tr_b16 v[110:111], v14 offset:8768
  s_waitcnt lgkmcnt(4)
  v_mfma_f32_16x16x32_bf16 a[0:3], v[96:99], v[64:67], a[0:3]
  buffer_load_dwordx4 v10, s[8:11], s21 offen offset:2176 lds
  v_mfma_f32_16x16x32_bf16 a[4:7], v[96:99], v[68:71], a[4:7]
  v_cvt_pk_bf16_f32 v88, v112, v113
  v_add_f32 v118, v118, v114
  v_mfma_f32_16x16x32_bf16 a[8:11], v[96:99], v[72:75], a[8:11]
  v_exp_f32 v112, v28
  v_mfma_f32_16x16x32_bf16 a[12:15], v[96:99], v[76:79], a[12:15]
  ds_read_b64_tr_b16 v[96:97], v13 offset:128
  ds_read_b64_tr_b16 v[98:99], v13 offset:8832
  v_mfma_f32_16x16x32_bf16 a[16:19], v[100:103], v[64:67], a[16:19]
  v_exp_f32 v113, v29
  v_mfma_f32_16x16x32_bf16 a[20:23], v[100:103], v[68:71], a[20:23]
  v_add_f32 v118, v118, v115
  v_cvt_pk_bf16_f32 v89, v114, v115
  v_mfma_f32_16x16x32_bf16 a[24:27], v[100:103], v[72:75], a[24:27]
  buffer_load_dwordx4 v11, s[8:11], s21 offen offset:3264 lds
  s_add_u32 s21, s21, 16384
  v_mfma_f32_16x16x32_bf16 a[28:31], v[100:103], v[76:79], a[28:31]
  ds_read_b64_tr_b16 v[100:101], v14 offset:128
  ds_read_b64_tr_b16 v[102:103], v14 offset:8832
  s_waitcnt lgkmcnt(4)
  v_mfma_f32_16x16x32_bf16 a[32:35], v[104:107], v[64:67], a[32:35]
  v_exp_f32 v114, v30
  v_mfma_f32_16x16x32_bf16 a[36:39], v[104:107], v[68:71], a[36:39]
  v_exp_f32 v115, v31
  v_mfma_f32_16x16x32_bf16 a[40:43], v[104:107], v[72:75], a[40:43]
  v_add_f32 v119, v112, v113
  v_cvt_pk_bf16_f32 v92, v112, v113
  v_mfma_f32_16x16x32_bf16 a[44:47], v[104:107], v[76:79], a[44:47]
  s_add_u32 m0, s28, 106752
  ds_read_b64_tr_b16 v[104:105], v13 offset:192
  v_mfma_f32_16x16x32_bf16 a[48:51], v[108:111], v[64:67], a[48:51]
  buffer_load_dwordx4 v8, s[8:11], s27 offen offset:0 lds
  v_mfma_f32_16x16x32_bf16 a[52:55], v[108:111], v[68:71], a[52:55]
  ds_read_b64_tr_b16 v[106:107], v13 offset:8896
  v_add_f32 v119, v119, v114
  v_mfma_f32_16x16x32_bf16 a[56:59], v[108:111], v[72:75], a[56:59]
  v_exp_f32 v112, v32
  v_mfma_f32_16x16x32_bf16 a[60:63], v[108:111], v[76:79], a[60:63]
  ds_read_b64_tr_b16 v[108:109], v14 offset:192
  ds_read_b64_tr_b16 v[110:111], v14 offset:8896
  s_waitcnt lgkmcnt(4)
  v_mfma_f32_16x16x32_bf16 a[64:67], v[96:99], v[64:67], a[64:67]
  v_exp_f32 v113, v33
  v_mfma_f32_16x16x32_bf16 a[68:71], v[96:99], v[68:71], a[68:71]
  v_add_f32 v119, v119, v115
  v_cvt_pk_bf16_f32 v93, v114, v115
  v_mfma_f32_16x16x32_bf16 a[72:75], v[96:99], v[72:75], a[72:75]
  buffer_load_dwordx4 v9, s[8:11], s27 offen offset:1088 lds
  v_mfma_f32_16x16x32_bf16 a[76:79], v[96:99], v[76:79], a[76:79]
  ds_read_b64_tr_b16 v[96:97], v13 offset:256
  ds_read_b64_tr_b16 v[98:99], v13 offset:8960
  v_mfma_f32_16x16x32_bf16 a[80:83], v[100:103], v[64:67], a[80:83]
  v_exp_f32 v114, v34
  v_mfma_f32_16x16x32_bf16 a[84:87], v[100:103], v[68:71], a[84:87]
  v_exp_f32 v115, v35
  v_mfma_f32_16x16x32_bf16 a[88:91], v[100:103], v[72:75], a[88:91]
  v_add_f32 v116, v116, v112
  v_add_f32 v116, v116, v113
  v_mfma_f32_16x16x32_bf16 a[92:95], v[100:103], v[76:79], a[92:95]
  ds_read_b64_tr_b16 v[100:101], v14 offset:256
  ds_read_b64_tr_b16 v[102:103], v14 offset:8960
  s_waitcnt lgkmcnt(4)
  v_mfma_f32_16x16x32_bf16 a[96:99], v[104:107], v[64:67], a[96:99]
  buffer_load_dwordx4 v10, s[8:11], s27 offen offset:2176 lds
  v_mfma_f32_16x16x32_bf16 a[100:103], v[104:107], v[68:71], a[100:103]
  v_cvt_pk_bf16_f32 v82, v112, v113
  v_add_f32 v116, v116, v114
  v_mfma_f32_16x16x32_bf16 a[104:107], v[104:107], v[72:75], a[104:107]
  v_exp_f32 v112, v36
  v_mfma_f32_16x16x32_bf16 a[108:111], v[104:107], v[76:79], a[108:111]
  ds_read_b64_tr_b16 v[104:105], v13 offset:320
  ds_read_b64_tr_b16 v[106:107], v13 offset:9024
  v_mfma_f32_16x16x32_bf16 a[112:115], v[108:111], v[64:67], a[112:115]
  v_exp_f32 v113, v37
  v_mfma_f32_16x16x32_bf16 a[116:119], v[108:111], v[68:71], a[116:119]
  v_add_f32 v116, v116, v115
  v_cvt_pk_bf16_f32 v83, v114, v115
  v_mfma_f32_16x16x32_bf16 a[120:123], v[108:111], v[72:75], a[120:123]
  buffer_load_dwordx4 v11, s[8:11], s27 offen offset:3264 lds
  s_add_u32 s27, s27, 16384
  v_mfma_f32_16x16x32_bf16 a[124:127], v[108:111], v[76:79], a[124:127]
  ds_read_b64_tr_b16 v[108:109], v14 offset:320
  ds_read_b64_tr_b16 v[110:111], v14 offset:9024
  s_waitcnt lgkmcnt(4)
  v_mfma_f32_16x16x32_bf16 a[128:131], v[96:99], v[64:67], a[128:131]
  v_exp_f32 v114, v38
  v_mfma_f32_16x16x32_bf16 a[132:135], v[96:99], v[68:71], a[132:135]
  v_exp_f32 v115, v39
  v_mfma_f32_16x16x32_bf16 a[136:139], v[96:99], v[72:75], a[136:139]
  v_add_f32 v117, v117, v112
  v_add_f32 v117, v117, v113
  v_mfma_f32_16x16x32_bf16 a[140:143], v[96:99], v[76:79], a[140:143]
  ds_read_b64_tr_b16 v[96:97], v13 offset:384
  ds_read_b64_tr_b16 v[98:99], v13 offset:9088
  v_mfma_f32_16x16x32_bf16 a[144:147], v[100:103], v[64:67], a[144:147]
  v_cvt_pk_bf16_f32 v86, v112, v113
  v_add_f32 v117, v117, v114
  v_mfma_f32_16x16x32_bf16 a[148:151], v[100:103], v[68:71], a[148:151]
  v_exp_f32 v112, v40
  v_mfma_f32_16x16x32_bf16 a[152:155], v[100:103], v[72:75], a[152:155]
  v_exp_f32 v113, v41
  v_mfma_f32_16x16x32_bf16 a[156:159], v[100:103], v[76:79], a[156:159]
  ds_read_b64_tr_b16 v[100:101], v14 offset:384
  ds_read_b64_tr_b16 v[102:103], v14 offset:9088
  s_waitcnt lgkmcnt(4)
  v_mfma_f32_16x16x32_bf16 a[160:163], v[104:107], v[64:67], a[160:163]
  v_add_f32 v117, v117, v115
  v_cvt_pk_bf16_f32 v87, v114, v115
  v_mfma_f32_16x16x32_bf16 a[164:167], v[104:107], v[68:71], a[164:167]
  v_exp_f32 v114, v42
  v_mfma_f32_16x16x32_bf16 a[168:171], v[104:107], v[72:75], a[168:171]
  v_exp_f32 v115, v43
  v_mfma_f32_16x16x32_bf16 a[172:175], v[104:107], v[76:79], a[172:175]
  ds_read_b64_tr_b16 v[104:105], v13 offset:448
  ds_read_b64_tr_b16 v[106:107], v13 offset:9152
  v_mfma_f32_16x16x32_bf16 a[176:179], v[108:111], v[64:67], a[176:179]
  v_add_f32 v118, v118, v112
  v_add_f32 v118, v118, v113
  v_mfma_f32_16x16x32_bf16 a[180:183], v[108:111], v[68:71], a[180:183]
  v_cvt_pk_bf16_f32 v90, v112, v113
  v_add_f32 v118, v118, v114
  v_mfma_f32_16x16x32_bf16 a[184:187], v[108:111], v[72:75], a[184:187]
  v_exp_f32 v112, v44
  v_mfma_f32_16x16x32_bf16 a[188:191], v[108:111], v[76:79], a[188:191]
  ds_read_b64_tr_b16 v[108:109], v14 offset:448
  ds_read_b64_tr_b16 v[110:111], v14 offset:9152
  s_waitcnt lgkmcnt(4)
  v_mfma_f32_16x16x32_bf16 a[192:195], v[96:99], v[64:67], a[192:195]
  v_exp_f32 v113, v45
  v_mfma_f32_16x16x32_bf16 a[196:199], v[96:99], v[68:71], a[196:199]
  s_waitcnt vmcnt(0)
  s_barrier
  v_mfma_f32_16x16x32_bf16 a[200:203], v[96:99], v[72:75], a[200:203]
  v_add_f32 v118, v118, v115
  v_cvt_pk_bf16_f32 v91, v114, v115
  v_mfma_f32_16x16x32_bf16 a[204:207], v[96:99], v[76:79], a[204:207]
  ds_read_b64_tr_b16 v[96:97], v13 offset:34816
  ds_read_b64_tr_b16 v[98:99], v13 offset:43520
  v_mfma_f32_16x16x32_bf16 a[208:211], v[100:103], v[64:67], a[208:211]
  v_exp_f32 v114, v46
  v_mfma_f32_16x16x32_bf16 a[212:215], v[100:103], v[68:71], a[212:215]
  v_exp_f32 v115, v47
  v_mfma_f32_16x16x32_bf16 a[216:219], v[100:103], v[72:75], a[216:219]
  v_add_f32 v119, v119, v112
  v_add_f32 v119, v119, v113
  v_mfma_f32_16x16x32_bf16 a[220:223], v[100:103], v[76:79], a[220:223]
  ds_read_b64_tr_b16 v[100:101], v14 offset:34816
  ds_read_b64_tr_b16 v[102:103], v14 offset:43520
  s_waitcnt lgkmcnt(4)
  v_mfma_f32_16x16x32_bf16 a[224:227], v[104:107], v[64:67], a[224:227]
  v_cvt_pk_bf16_f32 v94, v112, v113
  v_add_f32 v119, v119, v114
  v_mfma_f32_16x16x32_bf16 a[228:231], v[104:107], v[68:71], a[228:231]
  v_add_f32 v119, v119, v115
  v_cvt_pk_bf16_f32 v95, v114, v115
  v_mfma_f32_16x16x32_bf16 a[232:235], v[104:107], v[72:75], a[232:235]
  v_max3_f32 v4, v116, v117, v118
  v_mfma_f32_16x16x32_bf16 a[236:239], v[104:107], v[76:79], a[236:239]
  ds_read_b64_tr_b16 v[104:105], v13 offset:34880
  ds_read_b64_tr_b16 v[106:107], v13 offset:43584
  v_mfma_f32_16x16x32_bf16 a[240:243], v[108:111], v[64:67], a[240:243]
  v_max_f32 v4, v4, v119
  v_mfma_f32_16x16x32_bf16 a[244:247], v[108:111], v[68:71], a[244:247]
  v_cmp_lt_f32 vcc, s25, v4
  v_mfma_f32_16x16x32_bf16 a[248:251], v[108:111], v[72:75], a[248:251]
  v_mfma_f32_16x16x32_bf16 a[252:255], v[108:111], v[76:79], a[252:255]
  ds_read_b64_tr_b16 v[108:109], v14 offset:34880
  ds_read_b64_tr_b16 v[110:111], v14 offset:43584
  s_cbranch_vccnz TR_9
RET_10:
  s_waitcnt lgkmcnt(4)
  v_mfma_f32_16x16x32_bf16 a[0:3], v[96:99], v[80:83], a[0:3]
  s_mul_i32 s42, s22, 7168
  s_mov_b32 s40, 0
  v_mfma_f32_16x16x32_bf16 a[4:7], v[96:99], v[84:87], a[4:7]
  v_add_f32 v120, v120, v116
  s_mul_i32 s38, s22, 448
  v_mfma_f32_16x16x32_bf16 a[8:11], v[96:99], v[88:91], a[8:11]
  s_add_u32 s38, s38, 0
  v_add_u32 v64, s38, v0
  v_mfma_f32_16x16x32_bf16 a[12:15], v[96:99], v[92:95], a[12:15]
  v_add_f32 v121, v121, v117
  ds_read_b64_tr_b16 v[96:97], v13 offset:34944
  v_mfma_f32_16x16x32_bf16 a[16:19], v[100:103], v[80:83], a[16:19]
  ds_read_b64_tr_b16 v[98:99], v13 offset:43648
  v_mul_u32_u24 v1, 18725, v64
  v_mfma_f32_16x16x32_bf16 a[20:23], v[100:103], v[84:87], a[20:23]
  v_add_f32 v122, v122, v118
  v_lshrrev_b32 v1, 20, v1
  v_mfma_f32_16x16x32_bf16 a[24:27], v[100:103], v[88:91], a[24:27]
  v_bfe_u32 v15, v1, 1, 1
  v_bfe_u32 v1, v1, 3, 1
  v_mfma_f32_16x16x32_bf16 a[28:31], v[100:103], v[92:95], a[28:31]
  v_add_f32 v123, v123, v119
  ds_read_b64_tr_b16 v[100:101], v14 offset:34944
  s_waitcnt lgkmcnt(3)
  v_mfma_f32_16x16x32_bf16 a[32:35], v[104:107], v[80:83], a[32:35]
  ds_read_b64_tr_b16 v[102:103], v14 offset:43648
  v_lshl_or_b32 v15, v1, 1, v15
  v_mfma_f32_16x16x32_bf16 a[36:39], v[104:107], v[84:87], a[36:39]
  v_lshlrev_b32 v15, 5, v15
  v_lshlrev_b32 v64, 4, v64
  v_mfma_f32_16x16x32_bf16 a[40:43], v[104:107], v[88:91], a[40:43]
  v_xor_b32 v64, v64, v15
  s_mul_i32 s38, s22, 448
  v_mfma_f32_16x16x32_bf16 a[44:47], v[104:107], v[92:95], a[44:47]
  ds_read_b64_tr_b16 v[104:105], v13 offset:35008
  ds_read_b64_tr_b16 v[106:107], v13 offset:43712
  v_mfma_f32_16x16x32_bf16 a[48:51], v[108:111], v[80:83], a[48:51]
  s_add_u32 s38, s38, 64
  v_add_u32 v65, s38, v0
  v_mfma_f32_16x16x32_bf16 a[52:55], v[108:111], v[84:87], a[52:55]
  v_mul_u32_u24 v1, 18725, v65
  v_lshrrev_b32 v1, 20, v1
  v_mfma_f32_16x16x32_bf16 a[56:59], v[108:111], v[88:91], a[56:59]
  v_bfe_u32 v15, v1, 1, 1
  v_bfe_u32 v1, v1, 3, 1
  v_mfma_f32_16x16x32_bf16 a[60:63], v[108:111], v[92:95], a[60:63]
  ds_read_b64_tr_b16 v[108:109], v14 offset:35008
  ds_read_b64_tr_b16 v[110:111], v14 offset:43712
  s_waitcnt lgkmcnt(4)
  v_mfma_f32_16x16x32_bf16 a[64:67], v[96:99], v[80:83], a[64:67]
  v_lshl_or_b32 v15, v1, 1, v15
  v_lshlrev_b32 v15, 5, v15
  v_mfma_f32_16x16x32_bf16 a[68:71], v[96:99], v[84:87], a[68:71]
  v_lshlrev_b32 v65, 4, v65
  v_xor_b32 v65, v65, v15
  v_mfma_f32_16x16x32_bf16 a[72:75], v[96:99], v[88:91], a[72:75]
  v_subrev_u32 v65, 1024, v65
  s_mul_i32 s38, s22, 448
  v_mfma_f32_16x16x32_bf16 a[76:79], v[96:99], v[92:95], a[76:79]
  ds_read_b64_tr_b16 v[96:97], v13 offset:35072
  ds_read_b64_tr_b16 v[98:99], v13 offset:43776
  v_mfma_f32_16x16x32_bf16 a[80:83], v[100:103], v[80:83], a[80:83]
  s_add_u32 s38, s38, 128
  v_add_u32 v66, s38, v0
  v_mfma_f32_16x16x32_bf16 a[84:87], v[100:103], v[84:87], a[84:87]
  v_mul_u32_u24 v1, 18725, v66
  v_lshrrev_b32 v1, 20, v1
  v_mfma_f32_16x16x32_bf16 a[88:91], v[100:103], v[88:91], a[88:91]
  v_bfe_u32 v15, v1, 1, 1
  v_bfe_u32 v1, v1, 3, 1
  v_mfma_f32_16x16x32_bf16 a[92:95], v[100:103], v[92:95], a[92:95]
  ds_read_b64_tr_b16 v[100:101], v14 offset:35072
  ds_read_b64_tr_b16 v[102:103], v14 offset:43776
  s_waitcnt lgkmcnt(4)
  v_mfma_f32_16x16x32_bf16 a[96:99], v[104:107], v[80:83], a[96:99]
  v_lshl_or_b32 v15, v1, 1, v15
  v_lshlrev_b32 v15, 5, v15
  v_mfma_f32_16x16x32_bf16 a[100:103], v[104:107], v[84:87], a[100:103]
  v_lshlrev_b32 v66, 4, v66
  v_xor_b32 v66, v66, v15
  v_mfma_f32_16x16x32_bf16 a[104:107], v[104:107], v[88:91], a[104:107]
  v_subrev_u32 v66, 2048, v66
  s_mul_i32 s38, s22, 448
  v_mfma_f32_16x16x32_bf16 a[108:111], v[104:107], v[92:95], a[108:111]
  ds_read_b64_tr_b16 v[104:105], v13 offset:35136
  ds_read_b64_tr_b16 v[106:107], v13 offset:43840
  v_mfma_f32_16x16x32_bf16 a[112:115], v[108:111], v[80:83], a[112:115]
  s_add_u32 s38, s38, 192
  v_add_u32 v67, s38, v0
  v_mfma_f32_16x16x32_bf16 a[116:119], v[108:111], v[84:87], a[116:119]
  v_mul_u32_u24 v1, 18725, v67
  v_lshrrev_b32 v1, 20, v1
  v_mfma_f32_16x16x32_bf16 a[120:123], v[108:111], v[88:91], a[120:123]
  v_bfe_u32 v15, v1, 1, 1
  v_bfe_u32 v1, v1, 3, 1
  v_mfma_f32_16x16x32_bf16 a[124:127], v[108:111], v[92:95], a[124:127]
  ds_read_b64_tr_b16 v[108:109], v14 offset:35136
  ds_read_b64_tr_b16 v[110:111], v14 offset:43840
  s_waitcnt lgkmcnt(4)
  v_mfma_f32_16x16x32_bf16 a[128:131], v[96:99], v[80:83], a[128:131]
  v_lshl_or_b32 v15, v1, 1, v15
  v_lshlrev_b32 v15, 5, v15
  v_mfma_f32_16x16x32_bf16 a[132:135], v[96:99], v[84:87], a[132:135]
  v_lshlrev_b32 v67, 4, v67
  v_xor_b32 v67, v67, v15
  v_mfma_f32_16x16x32_bf16 a[136:139], v[96:99], v[88:91], a[136:139]
  v_subrev_u32 v67, 3072, v67
  s_mul_i32 s38, s22, 448
  v_mfma_f32_16x16x32_bf16 a[140:143], v[96:99], v[92:95], a[140:143]
  ds_read_b64_tr_b16 v[96:97], v13 offset:35200
  ds_read_b64_tr_b16 v[98:99], v13 offset:43904
  v_mfma_f32_16x16x32_bf16 a[144:147], v[100:103], v[80:83], a[144:147]
  s_add_u32 s38, s38, 256
  v_add_u32 v68, s38, v0
  v_mfma_f32_16x16x32_bf16 a[148:151], v[100:103], v[84:87], a[148:151]
  v_mul_u32_u24 v1, 18725, v68
  v_lshrrev_b32 v1, 20, v1
  v_mfma_f32_16x16x32_bf16 a[152:155], v[100:103], v[88:91], a[152:155]
  v_bfe_u32 v15, v1, 1, 1
  v_bfe_u32 v1, v1, 3, 1
  v_mfma_f32_16x16x32_bf16 a[156:159], v[100:103], v[92:95], a[156:159]
  ds_read_b64_tr_b16 v[100:101], v14 offset:35200
  ds_read_b64_tr_b16 v[102:103], v14 offset:43904
  s_waitcnt lgkmcnt(4)
  v_mfma_f32_16x16x32_bf16 a[160:163], v[104:107], v[80:83], a[160:163]
  v_lshl_or_b32 v15, v1, 1, v15
  v_lshlrev_b32 v15, 5, v15
  v_mfma_f32_16x16x32_bf16 a[164:167], v[104:107], v[84:87], a[164:167]
  v_lshlrev_b32 v68, 4, v68
  v_xor_b32 v68, v68, v15
  v_mfma_f32_16x16x32_bf16 a[168:171], v[104:107], v[88:91], a[168:171]
  s_mul_i32 s38, s22, 448
  s_add_u32 s38, s38, 320
  v_mfma_f32_16x16x32_bf16 a[172:175], v[104:107], v[92:95], a[172:175]
  ds_read_b64_tr_b16 v[104:105], v13 offset:35264
  ds_read_b64_tr_b16 v[106:107], v13 offset:43968
  v_mfma_f32_16x16x32_bf16 a[176:179], v[108:111], v[80:83], a[176:179]
  v_add_u32 v69, s38, v0
  v_mul_u32_u24 v1, 18725, v69
  v_mfma_f32_16x16x32_bf16 a[180:183], v[108:111], v[84:87], a[180:183]
  v_lshrrev_b32 v1, 20, v1
  v_bfe_u32 v15, v1, 1, 1
  v_mfma_f32_16x16x32_bf16 a[184:187], v[108:111], v[88:91], a[184:187]
  v_bfe_u32 v1, v1, 3, 1
  v_lshl_or_b32 v15, v1, 1, v15
  v_mfma_f32_16x16x32_bf16 a[188:191], v[108:111], v[92:95], a[188:191]
  ds_read_b64_tr_b16 v[108:109], v14 offset:35264
  ds_read_b64_tr_b16 v[110:111], v14 offset:43968
  s_waitcnt lgkmcnt(4)
  v_mfma_f32_16x16x32_bf16 a[192:195], v[96:99], v[80:83], a[192:195]
  v_lshlrev_b32 v15, 5, v15
  v_lshlrev_b32 v69, 4, v69
  v_mfma_f32_16x16x32_bf16 a[196:199], v[96:99], v[84:87], a[196:199]
  v_xor_b32 v69, v69, v15
  v_subrev_u32 v69, 1024, v69
  v_mfma_f32_16x16x32_bf16 a[200:203], v[96:99], v[88:91], a[200:203]
  s_mul_i32 s38, s22, 448
  s_add_u32 s38, s38, 384
  v_mfma_f32_16x16x32_bf16 a[204:207], v[96:99], v[92:95], a[204:207]
  v_add_u32 v70, s38, v0
  v_mfma_f32_16x16x32_bf16 a[208:211], v[100:103], v[80:83], a[208:211]
  v_mul_u32_u24 v1, 18725, v70
  v_lshrrev_b32 v1, 20, v1
  v_mfma_f32_16x16x32_bf16 a[212:215], v[100:103], v[84:87], a[212:215]
  v_bfe_u32 v15, v1, 1, 1
  v_bfe_u32 v1, v1, 3, 1
  v_mfma_f32_16x16x32_bf16 a[216:219], v[100:103], v[88:91], a[216:219]
  v_lshl_or_b32 v15, v1, 1, v15
  v_lshlrev_b32 v15, 5, v15
  v_mfma_f32_16x16x32_bf16 a[220:223], v[100:103], v[92:95], a[220:223]
  v_lshlrev_b32 v70, 4, v70
  s_waitcnt lgkmcnt(0)
  v_mfma_f32_16x16x32_bf16 a[224:227], v[104:107], v[80:83], a[224:227]
  v_xor_b32 v70, v70, v15
  v_subrev_u32 v70, 2048, v70
  v_mfma_f32_16x16x32_bf16 a[228:231], v[104:107], v[84:87], a[228:231]
  s_add_u32 m0, s42, 0
  s_nop 0
  v_mfma_f32_16x16x32_bf16 a[232:235], v[104:107], v[88:91], a[232:235]
  buffer_load_dwordx4 v64, s[12:15], s40 offen offset:0 lds
  buffer_load_dwordx4 v65, s[12:15], s40 offen offset:1024 lds
  v_mfma_f32_16x16x32_bf16 a[236:239], v[104:107], v[92:95], a[236:239]
  buffer_load_dwordx4 v66, s[12:15], s40 offen offset:2048 lds
  v_mfma_f32_16x16x32_bf16 a[240:243], v[108:111], v[80:83], a[240:243]
  buffer_load_dwordx4 v67, s[12:15], s40 offen offset:3072 lds
  s_add_u32 m0, s42, 4096
  v_mfma_f32_16x16x32_bf16 a[244:247], v[108:111], v[84:87], a[244:247]
  s_nop 0
  buffer_load_dwordx4 v68, s[12:15], s40 offen offset:0 lds
  v_mfma_f32_16x16x32_bf16 a[248:251], v[108:111], v[88:91], a[248:251]
  buffer_load_dwordx4 v69, s[12:15], s40 offen offset:1024 lds
  buffer_load_dwordx4 v70, s[12:15], s40 offen offset:2048 lds
  v_mfma_f32_16x16x32_bf16 a[252:255], v[108:111], v[92:95], a[252:255]
  s_add_u32 s40, s40, 28672
  s_add_u32 m0, s42, 28672
  s_nop 0
  buffer_load_dwordx4 v64, s[12:15], s40 offen offset:0 lds
  buffer_load_dwordx4 v65, s[12:15], s40 offen offset:1024 lds
  buffer_load_dwordx4 v66, s[12:15], s40 offen offset:2048 lds
  buffer_load_dwordx4 v67, s[12:15], s40 offen offset:3072 lds
  s_add_u32 m0, s42, 32768
  s_nop 0
  buffer_load_dwordx4 v68, s[12:15], s40 offen offset:0 lds
  buffer_load_dwordx4 v69, s[12:15], s40 offen offset:1024 lds
  buffer_load_dwordx4 v70, s[12:15], s40 offen offset:2048 lds
  s_add_u32 s40, s40, 28672
K1_EPI:
  v_mov_b32 v4, v120
  s_nop 1
  v_permlane32_swap_b32 v120, v4
  s_nop 1
  v_add_f32 v120, v120, v4
  v_mov_b32 v4, v120
  s_nop 1
  v_permlane16_swap_b32 v120, v4
  s_nop 1
  v_add_f32 v120, v120, v4
  v_mov_b32 v4, v121
  s_nop 1
  v_permlane32_swap_b32 v121, v4
  s_nop 1
  v_add_f32 v121, v121, v4
  v_mov_b32 v4, v121
  s_nop 1
  v_permlane16_swap_b32 v121, v4
  s_nop 1
  v_add_f32 v121, v121, v4
  v_mov_b32 v4, v122
  s_nop 1
  v_permlane32_swap_b32 v122, v4
  s_nop 1
  v_add_f32 v122, v122, v4
  v_mov_b32 v4, v122
  s_nop 1
  v_permlane16_swap_b32 v122, v4
  s_nop 1
  v_add_f32 v122, v122, v4
  v_mov_b32 v4, v123
  s_nop 1
  v_permlane32_swap_b32 v123, v4
  s_nop 1
  v_add_f32 v123, v123, v4
  v_mov_b32 v4, v123
  s_nop 1
  v_permlane16_swap_b32 v123, v4
  s_nop 1
  v_add_f32 v123, v123, v4
  v_lshlrev_b32 v1, 2, v0
  s_lshl_b32 s36, s22, 11
  s_add_u32 s37, s36, 57344
  v_add_u32 v2, s37, v1
  ds_write_b32 v2, v48 offset:0
  ds_write_b32 v2, v120 offset:1024
  ds_write_b32 v2, v52 offset:256
  ds_write_b32 v2, v121 offset:1280
  ds_write_b32 v2, v56 offset:512
  ds_write_b32 v2, v122 offset:1536
  ds_write_b32 v2, v60 offset:768
  ds_write_b32 v2, v123 offset:1792
  s_xor_b32 s36, s36, 2048
  s_add_u32 s37, s36, 57344
  v_add_u32 v2, s37, v1
  v_lshlrev_b32 v1, 4, v0
  s_lshl_b32 s36, s22, 14
  s_add_u32 s37, s36, 67584
  v_add_u32 v6, s37, v1
  s_xor_b32 s36, s36, 16384
  s_add_u32 s37, s36, 67584
  v_add_u32 v7, s37, v1
  s_waitcnt lgkmcnt(0)
  s_barrier
  s_cmp_eq_u32 s32, 0
  s_cbranch_scc0 K1_MG1
  ds_read_b32 v16, v2 offset:0
  ds_read_b32 v20, v2 offset:1024
  ds_read_b32 v17, v2 offset:256
  ds_read_b32 v21, v2 offset:1280
  ds_read_b32 v18, v2 offset:512
  ds_read_b32 v22, v2 offset:1536
  ds_read_b32 v19, v2 offset:768
  ds_read_b32 v23, v2 offset:1792
  ds_write_b128 v6, a[128:131] offset:0
  v_accvgpr_read_b32 v128, a0
  v_accvgpr_read_b32 v129, a1
  v_accvgpr_read_b32 v130, a2
  v_accvgpr_read_b32 v131, a3
  v_accvgpr_read_b32 v132, a4
  v_accvgpr_read_b32 v133, a5
  v_accvgpr_read_b32 v134, a6
  v_accvgpr_read_b32 v135, a7
  v_accvgpr_read_b32 v136, a8
  ds_write_b128 v6, a[132:135] offset:1024
  v_accvgpr_read_b32 v137, a9
  v_accvgpr_read_b32 v138, a10
  v_accvgpr_read_b32 v139, a11
  v_accvgpr_read_b32 v140, a12
  v_accvgpr_read_b32 v141, a13
  v_accvgpr_read_b32 v142, a14
  v_accvgpr_read_b32 v143, a15
  v_accvgpr_read_b32 v144, a16
  v_accvgpr_read_b32 v145, a17
  s_add_u32 m0, s42, 133120
  s_nop 0
  buffer_load_dwordx4 v64, s[12:15], s40 offen offset:0 lds
  ds_write_b128 v6, a[136:139] offset:2048
  v_accvgpr_read_b32 v146, a18
  v_accvgpr_read_b32 v147, a19
  v_accvgpr_read_b32 v148, a20
  v_accvgpr_read_b32 v149, a21
  v_accvgpr_read_b32 v150, a22
  v_accvgpr_read_b32 v151, a23
  v_accvgpr_read_b32 v152, a24
  v_accvgpr_read_b32 v153, a25
  v_accvgpr_read_b32 v154, a26
  ds_write_b128 v6, a[140:143] offset:3072
  v_accvgpr_read_b32 v155, a27
  v_accvgpr_read_b32 v156, a28
  v_accvgpr_read_b32 v157, a29
  v_accvgpr_read_b32 v158, a30
  v_accvgpr_read_b32 v159, a31
  s_waitcnt lgkmcnt(4)
  v_min_f32 v104, v48, v16
  v_min_f32 v108, v52, v17
  v_min_f32 v112, v56, v18
  buffer_load_dwordx4 v65, s[12:15], s40 offen offset:1024 lds
  ds_write_b128 v6, a[144:147] offset:4096
  v_min_f32 v116, v60, v19
  v_sub_f32 v105, v104, v48
  v_sub_f32 v106, v104, v16
  v_sub_f32 v109, v108, v52
  v_sub_f32 v110, v108, v17
  v_sub_f32 v113, v112, v56
  v_sub_f32 v114, v112, v18
  v_sub_f32 v117, v116, v60
  v_sub_f32 v118, v116, v19
  ds_write_b128 v6, a[148:151] offset:5120
  v_exp_f32 v105, v105
  v_exp_f32 v106, v106
  v_exp_f32 v109, v109
  v_exp_f32 v110, v110
  v_exp_f32 v113, v113
  v_exp_f32 v114, v114
  v_exp_f32 v117, v117
  v_exp_f32 v118, v118
  v_mul_f32 v107, v105, v120
  buffer_load_dwordx4 v66, s[12:15], s40 offen offset:2048 lds
  ds_write_b128 v6, a[152:155] offset:6144
  v_mul_f32 v111, v109, v121
  v_mul_f32 v115, v113, v122
  v_mul_f32 v119, v117, v123
  v_fmac_f32 v107, v106, v20
  v_fmac_f32 v111, v110, v21
  v_fmac_f32 v115, v114, v22
  v_fmac_f32 v119, v118, v23
  v_rcp_f32 v107, v107
  v_rcp_f32 v111, v111
  ds_write_b128 v6, a[156:159] offset:7168
  v_rcp_f32 v115, v115
  v_rcp_f32 v119, v119
  s_nop 0
  v_mul_f32 v24, v105, v107
  v_mul_f32 v32, v106, v107
  v_mul_f32 v26, v109, v111
  v_mul_f32 v34, v110, v111
  v_mul_f32 v28, v113, v115
  v_mul_f32 v36, v114, v115
  buffer_load_dwordx4 v67, s[12:15], s40 offen offset:3072 lds
  ds_write_b128 v6, a[160:163] offset:8192
  v_mul_f32 v30, v117, v119
  v_mul_f32 v38, v118, v119
  v_pk_mul_f32 v[128:129], v[128:129], v[24:25] op_sel_hi:[1,0]
  v_pk_mul_f32 v[130:131], v[130:131], v[24:25] op_sel_hi:[1,0]
  v_pk_mul_f32 v[132:133], v[132:133], v[26:27] op_sel_hi:[1,0]
  v_pk_mul_f32 v[134:135], v[134:135], v[26:27] op_sel_hi:[1,0]
  v_pk_mul_f32 v[136:137], v[136:137], v[28:29] op_sel_hi:[1,0]
  v_pk_mul_f32 v[138:139], v[138:139], v[28:29] op_sel_hi:[1,0]
  v_pk_mul_f32 v[140:141], v[140:141], v[30:31] op_sel_hi:[1,0]
  ds_write_b128 v6, a[164:167] offset:9216
  v_pk_mul_f32 v[142:143], v[142:143], v[30:31] op_sel_hi:[1,0]
  v_pk_mul_f32 v[144:145], v[144:145], v[24:25] op_sel_hi:[1,0]
  v_pk_mul_f32 v[146:147], v[146:147], v[24:25] op_sel_hi:[1,0]
  v_pk_mul_f32 v[148:149], v[148:149], v[26:27] op_sel_hi:[1,0]
  v_pk_mul_f32 v[150:151], v[150:151], v[26:27] op_sel_hi:[1,0]
  v_pk_mul_f32 v[152:153], v[152:153], v[28:29] op_sel_hi:[1,0]
  v_pk_mul_f32 v[154:155], v[154:155], v[28:29] op_sel_hi:[1,0]
  v_pk_mul_f32 v[156:157], v[156:157], v[30:31] op_sel_hi:[1,0]
  v_pk_mul_f32 v[158:159], v[158:159], v[30:31] op_sel_hi:[1,0]
  s_add_u32 m0, s42, 137216
  s_nop 0
  buffer_load_dwordx4 v68, s[12:15], s40 offen offset:0 lds
  ds_write_b128 v6, a[168:171] offset:10240
  v_accvgpr_read_b32 v160, a32
  v_accvgpr_read_b32 v161, a33
  v_accvgpr_read_b32 v162, a34
  v_accvgpr_read_b32 v163, a35
  v_pk_mul_f32 v[160:161], v[160:161], v[24:25] op_sel_hi:[1,0]
  v_pk_mul_f32 v[162:163], v[162:163], v[24:25] op_sel_hi:[1,0]
  v_accvgpr_read_b32 v164, a36
  v_accvgpr_read_b32 v165, a37
  ds_write_b128 v6, a[172:175] offset:11264
  v_accvgpr_read_b32 v166, a38
  v_accvgpr_read_b32 v167, a39
  v_pk_mul_f32 v[164:165], v[164:165], v[26:27] op_sel_hi:[1,0]
  v_pk_mul_f32 v[166:167], v[166:167], v[26:27] op_sel_hi:[1,0]
  v_accvgpr_read_b32 v168, a40
  v_accvgpr_read_b32 v169, a41
  v_accvgpr_read_b32 v170, a42
  v_accvgpr_read_b32 v171, a43
  buffer_load_dwordx4 v69, s[12:15], s40 offen offset:1024 lds
  ds_write_b128 v6, a[176:179] offset:12288
  v_pk_mul_f32 v[168:169], v[168:169], v[28:29] op_sel_hi:[1,0]
  v_pk_mul_f32 v[170:171], v[170:171], v[28:29] op_sel_hi:[1,0]
  v_accvgpr_read_b32 v172, a44
  v_accvgpr_read_b32 v173, a45
  v_accvgpr_read_b32 v174, a46
  v_accvgpr_read_b32 v175, a47
  v_pk_mul_f32 v[172:173], v[172:173], v[30:31] op_sel_hi:[1,0]
  v_pk_mul_f32 v[174:175], v[174:175], v[30:31] op_sel_hi:[1,0]
  ds_write_b128 v6, a[180:183] offset:13312
  v_accvgpr_read_b32 v176, a48
  v_accvgpr_read_b32 v177, a49
  v_accvgpr_read_b32 v178, a50
  v_accvgpr_read_b32 v179, a51
  v_pk_mul_f32 v[176:177], v[176:177], v[24:25] op_sel_hi:[1,0]
  v_pk_mul_f32 v[178:179], v[178:179], v[24:25] op_sel_hi:[1,0]
  v_accvgpr_read_b32 v180, a52
  v_accvgpr_read_b32 v181, a53
  buffer_load_dwordx4 v70, s[12:15], s40 offen offset:2048 lds
  s_add_u32 s40, s40, 28672
  ds_write_b128 v6, a[184:187] offset:14336
  v_accvgpr_read_b32 v182, a54
  v_accvgpr_read_b32 v183, a55
  v_pk_mul_f32 v[180:181], v[180:181], v[26:27] op_sel_hi:[1,0]
  v_pk_mul_f32 v[182:183], v[182:183], v[26:27] op_sel_hi:[1,0]
  v_accvgpr_read_b32 v184, a56
  v_accvgpr_read_b32 v185, a57
  v_accvgpr_read_b32 v186, a58
  v_accvgpr_read_b32 v187, a59
  ds_write_b128 v6, a[188:191] offset:15360
  v_pk_mul_f32 v[184:185], v[184:185], v[28:29] op_sel_hi:[1,0]
  v_pk_mul_f32 v[186:187], v[186:187], v[28:29] op_sel_hi:[1,0]
  v_accvgpr_read_b32 v188, a60
  v_accvgpr_read_b32 v189, a61
  v_accvgpr_read_b32 v190, a62
  v_accvgpr_read_b32 v191, a63
  v_pk_mul_f32 v[188:189], v[188:189], v[30:31] op_sel_hi:[1,0]
  v_pk_mul_f32 v[190:191], v[190:191], v[30:31] op_sel_hi:[1,0]
  s_waitcnt lgkmcnt(0)
  s_barrier
  ds_read_b128 v[72:75], v7 offset:0
  ds_read_b128 v[76:79], v7 offset:1024
  ds_read_b128 v[80:83], v7 offset:2048
  ds_read_b128 v[84:87], v7 offset:3072
  ds_read_b128 v[88:91], v7 offset:4096
  ds_read_b128 v[92:95], v7 offset:5120
  ds_read_b128 v[96:99], v7 offset:6144
  ds_read_b128 v[100:103], v7 offset:7168
  s_waitcnt lgkmcnt(7)
  v_pk_fma_f32 v[128:129], v[72:73], v[32:33], v[128:129] op_sel_hi:[1,0,1]
  v_pk_fma_f32 v[130:131], v[74:75], v[32:33], v[130:131] op_sel_hi:[1,0,1]
  v_cvt_pk_bf16_f32 v128, v128, v129
  v_cvt_pk_bf16_f32 v129, v130, v131
  s_waitcnt lgkmcnt(6)
  v_pk_fma_f32 v[132:133], v[76:77], v[34:35], v[132:133] op_sel_hi:[1,0,1]
  v_pk_fma_f32 v[134:135], v[78:79], v[34:35], v[134:135] op_sel_hi:[1,0,1]
  v_cvt_pk_bf16_f32 v132, v132, v133
  v_cvt_pk_bf16_f32 v133, v134, v135
  s_waitcnt lgkmcnt(5)
  v_pk_fma_f32 v[136:137], v[80:81], v[36:37], v[136:137] op_sel_hi:[1,0,1]
  v_pk_fma_f32 v[138:139], v[82:83], v[36:37], v[138:139] op_sel_hi:[1,0,1]
  v_cvt_pk_bf16_f32 v136, v136, v137
  v_cvt_pk_bf16_f32 v137, v138, v139
  s_waitcnt lgkmcnt(4)
  v_pk_fma_f32 v[140:141], v[84:85], v[38:39], v[140:141] op_sel_hi:[1,0,1]
  v_pk_fma_f32 v[142:143], v[86:87], v[38:39], v[142:143] op_sel_hi:[1,0,1]
  v_cvt_pk_bf16_f32 v140, v140, v141
  v_cvt_pk_bf16_f32 v141, v142, v143
  s_waitcnt lgkmcnt(3)
  v_pk_fma_f32 v[144:145], v[88:89], v[32:33], v[144:145] op_sel_hi:[1,0,1]
  v_pk_fma_f32 v[146:147], v[90:91], v[32:33], v[146:147] op_sel_hi:[1,0,1]
  v_cvt_pk_bf16_f32 v144, v144, v145
  v_cvt_pk_bf16_f32 v145, v146, v147
  s_waitcnt lgkmcnt(2)
  v_pk_fma_f32 v[148:149], v[92:93], v[34:35], v[148:149] op_sel_hi:[1,0,1]
  v_pk_fma_f32 v[150:151], v[94:95], v[34:35], v[150:151] op_sel_hi:[1,0,1]
  v_cvt_pk_bf16_f32 v148, v148, v149
  v_cvt_pk_bf16_f32 v149, v150, v151
  s_waitcnt lgkmcnt(1)
  v_pk_fma_f32 v[152:153], v[96:97], v[36:37], v[152:153] op_sel_hi:[1,0,1]
  v_pk_fma_f32 v[154:155], v[98:99], v[36:37], v[154:155] op_sel_hi:[1,0,1]
  v_cvt_pk_bf16_f32 v152, v152, v153
  v_cvt_pk_bf16_f32 v153, v154, v155
  s_waitcnt lgkmcnt(0)
  v_pk_fma_f32 v[156:157], v[100:101], v[38:39], v[156:157] op_sel_hi:[1,0,1]
  v_pk_fma_f32 v[158:159], v[102:103], v[38:39], v[158:159] op_sel_hi:[1,0,1]
  v_cvt_pk_bf16_f32 v156, v156, v157
  v_cvt_pk_bf16_f32 v157, v158, v159
  ds_read_b128 v[72:75], v7 offset:8192
  ds_read_b128 v[76:79], v7 offset:9216
  ds_read_b128 v[80:83], v7 offset:10240
  ds_read_b128 v[84:87], v7 offset:11264
  ds_read_b128 v[88:91], v7 offset:12288
  ds_read_b128 v[92:95], v7 offset:13312
  ds_read_b128 v[96:99], v7 offset:14336
  ds_read_b128 v[100:103], v7 offset:15360
  s_waitcnt lgkmcnt(7)
  v_pk_fma_f32 v[160:161], v[72:73], v[32:33], v[160:161] op_sel_hi:[1,0,1]
  v_pk_fma_f32 v[162:163], v[74:75], v[32:33], v[162:163] op_sel_hi:[1,0,1]
  v_cvt_pk_bf16_f32 v160, v160, v161
  v_cvt_pk_bf16_f32 v161, v162, v163
  s_waitcnt lgkmcnt(6)
  v_pk_fma_f32 v[164:165], v[76:77], v[34:35], v[164:165] op_sel_hi:[1,0,1]
  v_pk_fma_f32 v[166:167], v[78:79], v[34:35], v[166:167] op_sel_hi:[1,0,1]
  v_cvt_pk_bf16_f32 v164, v164, v165
  v_cvt_pk_bf16_f32 v165, v166, v167
  s_waitcnt lgkmcnt(5)
  v_pk_fma_f32 v[168:169], v[80:81], v[36:37], v[168:169] op_sel_hi:[1,0,1]
  v_pk_fma_f32 v[170:171], v[82:83], v[36:37], v[170:171] op_sel_hi:[1,0,1]
  v_cvt_pk_bf16_f32 v168, v168, v169
  v_cvt_pk_bf16_f32 v169, v170, v171
  s_waitcnt lgkmcnt(4)
  v_pk_fma_f32 v[172:173], v[84:85], v[38:39], v[172:173] op_sel_hi:[1,0,1]
  v_pk_fma_f32 v[174:175], v[86:87], v[38:39], v[174:175] op_sel_hi:[1,0,1]
  v_cvt_pk_bf16_f32 v172, v172, v173
  v_cvt_pk_bf16_f32 v173, v174, v175
  s_waitcnt lgkmcnt(3)
  v_pk_fma_f32 v[176:177], v[88:89], v[32:33], v[176:177] op_sel_hi:[1,0,1]
  v_pk_fma_f32 v[178:179], v[90:91], v[32:33], v[178:179] op_sel_hi:[1,0,1]
  v_cvt_pk_bf16_f32 v176, v176, v177
  v_cvt_pk_bf16_f32 v177, v178, v179
  s_waitcnt lgkmcnt(2)
  v_pk_fma_f32 v[180:181], v[92:93], v[34:35], v[180:181] op_sel_hi:[1,0,1]
  v_pk_fma_f32 v[182:183], v[94:95], v[34:35], v[182:183] op_sel_hi:[1,0,1]
  v_cvt_pk_bf16_f32 v180, v180, v181
  v_cvt_pk_bf16_f32 v181, v182, v183
  s_waitcnt lgkmcnt(1)
  v_pk_fma_f32 v[184:185], v[96:97], v[36:37], v[184:185] op_sel_hi:[1,0,1]
  v_pk_fma_f32 v[186:187], v[98:99], v[36:37], v[186:187] op_sel_hi:[1,0,1]
  v_cvt_pk_bf16_f32 v184, v184, v185
  v_cvt_pk_bf16_f32 v185, v186, v187
  s_waitcnt lgkmcnt(0)
  v_pk_fma_f32 v[188:189], v[100:101], v[38:39], v[188:189] op_sel_hi:[1,0,1]
  v_pk_fma_f32 v[190:191], v[102:103], v[38:39], v[190:191] op_sel_hi:[1,0,1]
  v_cvt_pk_bf16_f32 v188, v188, v189
  v_cvt_pk_bf16_f32 v189, v190, v191
  s_barrier
  ds_write_b128 v6, a[192:195] offset:0
  v_accvgpr_read_b32 v192, a64
  v_accvgpr_read_b32 v193, a65
  v_accvgpr_read_b32 v194, a66
  v_accvgpr_read_b32 v195, a67
  v_pk_mul_f32 v[192:193], v[192:193], v[24:25] op_sel_hi:[1,0]
  v_pk_mul_f32 v[194:195], v[194:195], v[24:25] op_sel_hi:[1,0]
  ds_write_b128 v6, a[196:199] offset:1024
  v_accvgpr_read_b32 v196, a68
  v_accvgpr_read_b32 v197, a69
  v_accvgpr_read_b32 v198, a70
  v_accvgpr_read_b32 v199, a71
  v_pk_mul_f32 v[196:197], v[196:197], v[26:27] op_sel_hi:[1,0]
  v_pk_mul_f32 v[198:199], v[198:199], v[26:27] op_sel_hi:[1,0]
  ds_write_b128 v6, a[200:203] offset:2048
  v_accvgpr_read_b32 v200, a72
  v_accvgpr_read_b32 v201, a73
  v_accvgpr_read_b32 v202, a74
  v_accvgpr_read_b32 v203, a75
  v_pk_mul_f32 v[200:201], v[200:201], v[28:29] op_sel_hi:[1,0]
  v_pk_mul_f32 v[202:203], v[202:203], v[28:29] op_sel_hi:[1,0]
  ds_write_b128 v6, a[204:207] offset:3072
  v_accvgpr_read_b32 v204, a76
  v_accvgpr_read_b32 v205, a77
  v_accvgpr_read_b32 v206, a78
  v_accvgpr_read_b32 v207, a79
  v_pk_mul_f32 v[204:205], v[204:205], v[30:31] op_sel_hi:[1,0]
  v_pk_mul_f32 v[206:207], v[206:207], v[30:31] op_sel_hi:[1,0]
  ds_write_b128 v6, a[208:211] offset:4096
  v_accvgpr_read_b32 v208, a80
  v_accvgpr_read_b32 v209, a81
  v_accvgpr_read_b32 v210, a82
  v_accvgpr_read_b32 v211, a83
  v_pk_mul_f32 v[208:209], v[208:209], v[24:25] op_sel_hi:[1,0]
  v_pk_mul_f32 v[210:211], v[210:211], v[24:25] op_sel_hi:[1,0]
  ds_write_b128 v6, a[212:215] offset:5120
  v_accvgpr_read_b32 v212, a84
  v_accvgpr_read_b32 v213, a85
  v_accvgpr_read_b32 v214, a86
  v_accvgpr_read_b32 v215, a87
  v_pk_mul_f32 v[212:213], v[212:213], v[26:27] op_sel_hi:[1,0]
  v_pk_mul_f32 v[214:215], v[214:215], v[26:27] op_sel_hi:[1,0]
  ds_write_b128 v6, a[216:219] offset:6144
  v_accvgpr_read_b32 v216, a88
  v_accvgpr_read_b32 v217, a89
  v_accvgpr_read_b32 v218, a90
  v_accvgpr_read_b32 v219, a91
  v_pk_mul_f32 v[216:217], v[216:217], v[28:29] op_sel_hi:[1,0]
  v_pk_mul_f32 v[218:219], v[218:219], v[28:29] op_sel_hi:[1,0]
  ds_write_b128 v6, a[220:223] offset:7168
  v_accvgpr_read_b32 v220, a92
  v_accvgpr_read_b32 v221, a93
  v_accvgpr_read_b32 v222, a94
  v_accvgpr_read_b32 v223, a95
  v_pk_mul_f32 v[220:221], v[220:221], v[30:31] op_sel_hi:[1,0]
  v_pk_mul_f32 v[222:223], v[222:223], v[30:31] op_sel_hi:[1,0]
  ds_write_b128 v6, a[224:227] offset:8192
  v_accvgpr_read_b32 v224, a96
  v_accvgpr_read_b32 v225, a97
  v_accvgpr_read_b32 v226, a98
  v_accvgpr_read_b32 v227, a99
  v_pk_mul_f32 v[224:225], v[224:225], v[24:25] op_sel_hi:[1,0]
  v_pk_mul_f32 v[226:227], v[226:227], v[24:25] op_sel_hi:[1,0]
  ds_write_b128 v6, a[228:231] offset:9216
  v_accvgpr_read_b32 v228, a100
  v_accvgpr_read_b32 v229, a101
  v_accvgpr_read_b32 v230, a102
  v_accvgpr_read_b32 v231, a103
  v_pk_mul_f32 v[228:229], v[228:229], v[26:27] op_sel_hi:[1,0]
  v_pk_mul_f32 v[230:231], v[230:231], v[26:27] op_sel_hi:[1,0]
  ds_write_b128 v6, a[232:235] offset:10240
  v_accvgpr_read_b32 v232, a104
  v_accvgpr_read_b32 v233, a105
  v_accvgpr_read_b32 v234, a106
  v_accvgpr_read_b32 v235, a107
  v_pk_mul_f32 v[232:233], v[232:233], v[28:29] op_sel_hi:[1,0]
  v_pk_mul_f32 v[234:235], v[234:235], v[28:29] op_sel_hi:[1,0]
  ds_write_b128 v6, a[236:239] offset:11264
  v_accvgpr_read_b32 v236, a108
  v_accvgpr_read_b32 v237, a109
  v_accvgpr_read_b32 v238, a110
  v_accvgpr_read_b32 v239, a111
  v_pk_mul_f32 v[236:237], v[236:237], v[30:31] op_sel_hi:[1,0]
  v_pk_mul_f32 v[238:239], v[238:239], v[30:31] op_sel_hi:[1,0]
  ds_write_b128 v6, a[240:243] offset:12288
  v_accvgpr_read_b32 v240, a112
  v_accvgpr_read_b32 v241, a113
  v_accvgpr_read_b32 v242, a114
  v_accvgpr_read_b32 v243, a115
  v_pk_mul_f32 v[240:241], v[240:241], v[24:25] op_sel_hi:[1,0]
  v_pk_mul_f32 v[242:243], v[242:243], v[24:25] op_sel_hi:[1,0]
  ds_write_b128 v6, a[244:247] offset:13312
  v_accvgpr_read_b32 v244, a116
  v_accvgpr_read_b32 v245, a117
  v_accvgpr_read_b32 v246, a118
  v_accvgpr_read_b32 v247, a119
  v_pk_mul_f32 v[244:245], v[244:245], v[26:27] op_sel_hi:[1,0]
  v_pk_mul_f32 v[246:247], v[246:247], v[26:27] op_sel_hi:[1,0]
  ds_write_b128 v6, a[248:251] offset:14336
  v_accvgpr_read_b32 v248, a120
  v_accvgpr_read_b32 v249, a121
  v_accvgpr_read_b32 v250, a122
  v_accvgpr_read_b32 v251, a123
  v_pk_mul_f32 v[248:249], v[248:249], v[28:29] op_sel_hi:[1,0]
  v_pk_mul_f32 v[250:251], v[250:251], v[28:29] op_sel_hi:[1,0]
  ds_write_b128 v6, a[252:255] offset:15360
  v_accvgpr_read_b32 v252, a124
  v_accvgpr_read_b32 v253, a125
  v_accvgpr_read_b32 v254, a126
  v_accvgpr_read_b32 v255, a127
  v_pk_mul_f32 v[252:253], v[252:253], v[30:31] op_sel_hi:[1,0]
  v_pk_mul_f32 v[254:255], v[254:255], v[30:31] op_sel_hi:[1,0]
  s_waitcnt lgkmcnt(0)
  s_barrier
  ds_read_b128 v[72:75], v7 offset:0
  ds_read_b128 v[76:79], v7 offset:1024
  ds_read_b128 v[80:83], v7 offset:2048
  ds_read_b128 v[84:87], v7 offset:3072
  ds_read_b128 v[88:91], v7 offset:4096
  ds_read_b128 v[92:95], v7 offset:5120
  ds_read_b128 v[96:99], v7 offset:6144
  ds_read_b128 v[100:103], v7 offset:7168
  s_waitcnt lgkmcnt(7)
  v_pk_fma_f32 v[192:193], v[72:73], v[32:33], v[192:193] op_sel_hi:[1,0,1]
  v_pk_fma_f32 v[194:195], v[74:75], v[32:33], v[194:195] op_sel_hi:[1,0,1]
  v_cvt_pk_bf16_f32 v192, v192, v193
  v_cvt_pk_bf16_f32 v193, v194, v195
  s_waitcnt lgkmcnt(6)
  v_pk_fma_f32 v[196:197], v[76:77], v[34:35], v[196:197] op_sel_hi:[1,0,1]
  v_pk_fma_f32 v[198:199], v[78:79], v[34:35], v[198:199] op_sel_hi:[1,0,1]
  v_cvt_pk_bf16_f32 v196, v196, v197
  v_cvt_pk_bf16_f32 v197, v198, v199
  s_waitcnt lgkmcnt(5)
  v_pk_fma_f32 v[200:201], v[80:81], v[36:37], v[200:201] op_sel_hi:[1,0,1]
  v_pk_fma_f32 v[202:203], v[82:83], v[36:37], v[202:203] op_sel_hi:[1,0,1]
  v_cvt_pk_bf16_f32 v200, v200, v201
  v_cvt_pk_bf16_f32 v201, v202, v203
  s_waitcnt lgkmcnt(4)
  v_pk_fma_f32 v[204:205], v[84:85], v[38:39], v[204:205] op_sel_hi:[1,0,1]
  v_pk_fma_f32 v[206:207], v[86:87], v[38:39], v[206:207] op_sel_hi:[1,0,1]
  v_cvt_pk_bf16_f32 v204, v204, v205
  v_cvt_pk_bf16_f32 v205, v206, v207
  s_waitcnt lgkmcnt(3)
  v_pk_fma_f32 v[208:209], v[88:89], v[32:33], v[208:209] op_sel_hi:[1,0,1]
  v_pk_fma_f32 v[210:211], v[90:91], v[32:33], v[210:211] op_sel_hi:[1,0,1]
  v_cvt_pk_bf16_f32 v208, v208, v209
  v_cvt_pk_bf16_f32 v209, v210, v211
  s_waitcnt lgkmcnt(2)
  v_pk_fma_f32 v[212:213], v[92:93], v[34:35], v[212:213] op_sel_hi:[1,0,1]
  v_pk_fma_f32 v[214:215], v[94:95], v[34:35], v[214:215] op_sel_hi:[1,0,1]
  v_cvt_pk_bf16_f32 v212, v212, v213
  v_cvt_pk_bf16_f32 v213, v214, v215
  s_waitcnt lgkmcnt(1)
  v_pk_fma_f32 v[216:217], v[96:97], v[36:37], v[216:217] op_sel_hi:[1,0,1]
  v_pk_fma_f32 v[218:219], v[98:99], v[36:37], v[218:219] op_sel_hi:[1,0,1]
  v_cvt_pk_bf16_f32 v216, v216, v217
  v_cvt_pk_bf16_f32 v217, v218, v219
  s_waitcnt lgkmcnt(0)
  v_pk_fma_f32 v[220:221], v[100:101], v[38:39], v[220:221] op_sel_hi:[1,0,1]
  v_pk_fma_f32 v[222:223], v[102:103], v[38:39], v[222:223] op_sel_hi:[1,0,1]
  v_cvt_pk_bf16_f32 v220, v220, v221
  v_cvt_pk_bf16_f32 v221, v222, v223
  ds_read_b128 v[72:75], v7 offset:8192
  ds_read_b128 v[76:79], v7 offset:9216
  ds_read_b128 v[80:83], v7 offset:10240
  ds_read_b128 v[84:87], v7 offset:11264
  ds_read_b128 v[88:91], v7 offset:12288
  ds_read_b128 v[92:95], v7 offset:13312
  ds_read_b128 v[96:99], v7 offset:14336
  ds_read_b128 v[100:103], v7 offset:15360
  s_waitcnt lgkmcnt(7)
  v_pk_fma_f32 v[224:225], v[72:73], v[32:33], v[224:225] op_sel_hi:[1,0,1]
  v_pk_fma_f32 v[226:227], v[74:75], v[32:33], v[226:227] op_sel_hi:[1,0,1]
  v_cvt_pk_bf16_f32 v224, v224, v225
  v_cvt_pk_bf16_f32 v225, v226, v227
  s_waitcnt lgkmcnt(6)
  v_pk_fma_f32 v[228:229], v[76:77], v[34:35], v[228:229] op_sel_hi:[1,0,1]
  v_pk_fma_f32 v[230:231], v[78:79], v[34:35], v[230:231] op_sel_hi:[1,0,1]
  v_cvt_pk_bf16_f32 v228, v228, v229
  v_cvt_pk_bf16_f32 v229, v230, v231
  s_waitcnt lgkmcnt(5)
  v_pk_fma_f32 v[232:233], v[80:81], v[36:37], v[232:233] op_sel_hi:[1,0,1]
  v_pk_fma_f32 v[234:235], v[82:83], v[36:37], v[234:235] op_sel_hi:[1,0,1]
  v_cvt_pk_bf16_f32 v232, v232, v233
  v_cvt_pk_bf16_f32 v233, v234, v235
  s_waitcnt lgkmcnt(4)
  v_pk_fma_f32 v[236:237], v[84:85], v[38:39], v[236:237] op_sel_hi:[1,0,1]
  v_pk_fma_f32 v[238:239], v[86:87], v[38:39], v[238:239] op_sel_hi:[1,0,1]
  v_cvt_pk_bf16_f32 v236, v236, v237
  v_cvt_pk_bf16_f32 v237, v238, v239
  s_waitcnt lgkmcnt(3)
  v_pk_fma_f32 v[240:241], v[88:89], v[32:33], v[240:241] op_sel_hi:[1,0,1]
  v_pk_fma_f32 v[242:243], v[90:91], v[32:33], v[242:243] op_sel_hi:[1,0,1]
  v_cvt_pk_bf16_f32 v240, v240, v241
  v_cvt_pk_bf16_f32 v241, v242, v243
  s_waitcnt lgkmcnt(2)
  v_pk_fma_f32 v[244:245], v[92:93], v[34:35], v[244:245] op_sel_hi:[1,0,1]
  v_pk_fma_f32 v[246:247], v[94:95], v[34:35], v[246:247] op_sel_hi:[1,0,1]
  v_cvt_pk_bf16_f32 v244, v244, v245
  v_cvt_pk_bf16_f32 v245, v246, v247
  s_waitcnt lgkmcnt(1)
  v_pk_fma_f32 v[248:249], v[96:97], v[36:37], v[248:249] op_sel_hi:[1,0,1]
  v_pk_fma_f32 v[250:251], v[98:99], v[36:37], v[250:251] op_sel_hi:[1,0,1]
  v_cvt_pk_bf16_f32 v248, v248, v249
  v_cvt_pk_bf16_f32 v249, v250, v251
  s_waitcnt lgkmcnt(0)
  v_pk_fma_f32 v[252:253], v[100:101], v[38:39], v[252:253] op_sel_hi:[1,0,1]
  v_pk_fma_f32 v[254:255], v[102:103], v[38:39], v[254:255] op_sel_hi:[1,0,1]
  v_cvt_pk_bf16_f32 v252, v252, v253
  v_cvt_pk_bf16_f32 v253, v254, v255
  s_branch K1_MGJ
K1_MG1:
  ds_read_b32 v16, v2 offset:0
  ds_read_b32 v20, v2 offset:1024
  ds_read_b32 v17, v2 offset:256
  ds_read_b32 v21, v2 offset:1280
  ds_read_b32 v18, v2 offset:512
  ds_read_b32 v22, v2 offset:1536
  ds_read_b32 v19, v2 offset:768
  ds_read_b32 v23, v2 offset:1792
  ds_write_b128 v6, a[0:3] offset:0
  v_accvgpr_read_b32 v128, a128
  v_accvgpr_read_b32 v129, a129
  v_accvgpr_read_b32 v130, a130
  v_accvgpr_read_b32 v131, a131
  v_accvgpr_read_b32 v132, a132
  v_accvgpr_read_b32 v133, a133
  v_accvgpr_read_b32 v134, a134
  v_accvgpr_read_b32 v135, a135
  v_accvgpr_read_b32 v136, a136
  ds_write_b128 v6, a[4:7] offset:1024
  v_accvgpr_read_b32 v137, a137
  v_accvgpr_read_b32 v138, a138
  v_accvgpr_read_b32 v139, a139
  v_accvgpr_read_b32 v140, a140
  v_accvgpr_read_b32 v141, a141
  v_accvgpr_read_b32 v142, a142
  v_accvgpr_read_b32 v143, a143
  v_accvgpr_read_b32 v144, a144
  v_accvgpr_read_b32 v145, a145
  s_add_u32 m0, s42, 133120
  s_nop 0
  buffer_load_dwordx4 v64, s[12:15], s40 offen offset:0 lds
  ds_write_b128 v6, a[8:11] offset:2048
  v_accvgpr_read_b32 v146, a146
  v_accvgpr_read_b32 v147, a147
  v_accvgpr_read_b32 v148, a148
  v_accvgpr_read_b32 v149, a149
  v_accvgpr_read_b32 v150, a150
  v_accvgpr_read_b32 v151, a151
  v_accvgpr_read_b32 v152, a152
  v_accvgpr_read_b32 v153, a153
  v_accvgpr_read_b32 v154, a154
  ds_write_b128 v6, a[12:15] offset:3072
  v_accvgpr_read_b32 v155, a155
  v_accvgpr_read_b32 v156, a156
  v_accvgpr_read_b32 v157, a157
  v_accvgpr_read_b32 v158, a158
  v_accvgpr_read_b32 v159, a159
  s_waitcnt lgkmcnt(4)
  v_min_f32 v104, v48, v16
  v_min_f32 v108, v52, v17
  v_min_f32 v112, v56, v18
  buffer_load_dwordx4 v65, s[12:15], s40 offen offset:1024 lds
  ds_write_b128 v6, a[16:19] offset:4096
  v_min_f32 v116, v60, v19
  v_sub_f32 v105, v104, v48
  v_sub_f32 v106, v104, v16
  v_sub_f32 v109, v108, v52
  v_sub_f32 v110, v108, v17
  v_sub_f32 v113, v112, v56
  v_sub_f32 v114, v112, v18
  v_sub_f32 v117, v116, v60
  v_sub_f32 v118, v116, v19
  ds_write_b128 v6, a[20:23] offset:5120
  v_exp_f32 v105, v105
  v_exp_f32 v106, v106
  v_exp_f32 v109, v109
  v_exp_f32 v110, v110
  v_exp_f32 v113, v113
  v_exp_f32 v114, v114
  v_exp_f32 v117, v117
  v_exp_f32 v118, v118
  v_mul_f32 v107, v105, v120
  buffer_load_dwordx4 v66, s[12:15], s40 offen offset:2048 lds
  ds_write_b128 v6, a[24:27] offset:6144
  v_mul_f32 v111, v109, v121
  v_mul_f32 v115, v113, v122
  v_mul_f32 v119, v117, v123
  v_fmac_f32 v107, v106, v20
  v_fmac_f32 v111, v110, v21
  v_fmac_f32 v115, v114, v22
  v_fmac_f32 v119, v118, v23
  v_rcp_f32 v107, v107
  v_rcp_f32 v111, v111
  ds_write_b128 v6, a[28:31] offset:7168
  v_rcp_f32 v115, v115
  v_rcp_f32 v119, v119
  s_nop 0
  v_mul_f32 v24, v105, v107
  v_mul_f32 v32, v106, v107
  v_mul_f32 v26, v109, v111
  v_mul_f32 v34, v110, v111
  v_mul_f32 v28, v113, v115
  v_mul_f32 v36, v114, v115
  buffer_load_dwordx4 v67, s[12:15], s40 offen offset:3072 lds
  ds_write_b128 v6, a[32:35] offset:8192
  v_mul_f32 v30, v117, v119
  v_mul_f32 v38, v118, v119
  v_pk_mul_f32 v[128:129], v[128:129], v[24:25] op_sel_hi:[1,0]
  v_pk_mul_f32 v[130:131], v[130:131], v[24:25] op_sel_hi:[1,0]
  v_pk_mul_f32 v[132:133], v[132:133], v[26:27] op_sel_hi:[1,0]
  v_pk_mul_f32 v[134:135], v[134:135], v[26:27] op_sel_hi:[1,0]
  v_pk_mul_f32 v[136:137], v[136:137], v[28:29] op_sel_hi:[1,0]
  v_pk_mul_f32 v[138:139], v[138:139], v[28:29] op_sel_hi:[1,0]
  v_pk_mul_f32 v[140:141], v[140:141], v[30:31] op_sel_hi:[1,0]
  ds_write_b128 v6, a[36:39] offset:9216
  v_pk_mul_f32 v[142:143], v[142:143], v[30:31] op_sel_hi:[1,0]
  v_pk_mul_f32 v[144:145], v[144:145], v[24:25] op_sel_hi:[1,0]
  v_pk_mul_f32 v[146:147], v[146:147], v[24:25] op_sel_hi:[1,0]
  v_pk_mul_f32 v[148:149], v[148:149], v[26:27] op_sel_hi:[1,0]
  v_pk_mul_f32 v[150:151], v[150:151], v[26:27] op_sel_hi:[1,0]
  v_pk_mul_f32 v[152:153], v[152:153], v[28:29] op_sel_hi:[1,0]
  v_pk_mul_f32 v[154:155], v[154:155], v[28:29] op_sel_hi:[1,0]
  v_pk_mul_f32 v[156:157], v[156:157], v[30:31] op_sel_hi:[1,0]
  v_pk_mul_f32 v[158:159], v[158:159], v[30:31] op_sel_hi:[1,0]
  s_add_u32 m0, s42, 137216
  s_nop 0
  buffer_load_dwordx4 v68, s[12:15], s40 offen offset:0 lds
  ds_write_b128 v6, a[40:43] offset:10240
  v_accvgpr_read_b32 v160, a160
  v_accvgpr_read_b32 v161, a161
  v_accvgpr_read_b32 v162, a162
  v_accvgpr_read_b32 v163, a163
  v_pk_mul_f32 v[160:161], v[160:161], v[24:25] op_sel_hi:[1,0]
  v_pk_mul_f32 v[162:163], v[162:163], v[24:25] op_sel_hi:[1,0]
  v_accvgpr_read_b32 v164, a164
  v_accvgpr_read_b32 v165, a165
  ds_write_b128 v6, a[44:47] offset:11264
  v_accvgpr_read_b32 v166, a166
  v_accvgpr_read_b32 v167, a167
  v_pk_mul_f32 v[164:165], v[164:165], v[26:27] op_sel_hi:[1,0]
  v_pk_mul_f32 v[166:167], v[166:167], v[26:27] op_sel_hi:[1,0]
  v_accvgpr_read_b32 v168, a168
  v_accvgpr_read_b32 v169, a169
  v_accvgpr_read_b32 v170, a170
  v_accvgpr_read_b32 v171, a171
  buffer_load_dwordx4 v69, s[12:15], s40 offen offset:1024 lds
  ds_write_b128 v6, a[48:51] offset:12288
  v_pk_mul_f32 v[168:169], v[168:169], v[28:29] op_sel_hi:[1,0]
  v_pk_mul_f32 v[170:171], v[170:171], v[28:29] op_sel_hi:[1,0]
  v_accvgpr_read_b32 v172, a172
  v_accvgpr_read_b32 v173, a173
  v_accvgpr_read_b32 v174, a174
  v_accvgpr_read_b32 v175, a175
  v_pk_mul_f32 v[172:173], v[172:173], v[30:31] op_sel_hi:[1,0]
  v_pk_mul_f32 v[174:175], v[174:175], v[30:31] op_sel_hi:[1,0]
  ds_write_b128 v6, a[52:55] offset:13312
  v_accvgpr_read_b32 v176, a176
  v_accvgpr_read_b32 v177, a177
  v_accvgpr_read_b32 v178, a178
  v_accvgpr_read_b32 v179, a179
  v_pk_mul_f32 v[176:177], v[176:177], v[24:25] op_sel_hi:[1,0]
  v_pk_mul_f32 v[178:179], v[178:179], v[24:25] op_sel_hi:[1,0]
  v_accvgpr_read_b32 v180, a180
  v_accvgpr_read_b32 v181, a181
  buffer_load_dwordx4 v70, s[12:15], s40 offen offset:2048 lds
  s_add_u32 s40, s40, 28672
  ds_write_b128 v6, a[56:59] offset:14336
  v_accvgpr_read_b32 v182, a182
  v_accvgpr_read_b32 v183, a183
  v_pk_mul_f32 v[180:181], v[180:181], v[26:27] op_sel_hi:[1,0]
  v_pk_mul_f32 v[182:183], v[182:183], v[26:27] op_sel_hi:[1,0]
  v_accvgpr_read_b32 v184, a184
  v_accvgpr_read_b32 v185, a185
  v_accvgpr_read_b32 v186, a186
  v_accvgpr_read_b32 v187, a187
  ds_write_b128 v6, a[60:63] offset:15360
  v_pk_mul_f32 v[184:185], v[184:185], v[28:29] op_sel_hi:[1,0]
  v_pk_mul_f32 v[186:187], v[186:187], v[28:29] op_sel_hi:[1,0]
  v_accvgpr_read_b32 v188, a188
  v_accvgpr_read_b32 v189, a189
  v_accvgpr_read_b32 v190, a190
  v_accvgpr_read_b32 v191, a191
  v_pk_mul_f32 v[188:189], v[188:189], v[30:31] op_sel_hi:[1,0]
  v_pk_mul_f32 v[190:191], v[190:191], v[30:31] op_sel_hi:[1,0]
  s_waitcnt lgkmcnt(0)
  s_barrier
  ds_read_b128 v[72:75], v7 offset:0
  ds_read_b128 v[76:79], v7 offset:1024
  ds_read_b128 v[80:83], v7 offset:2048
  ds_read_b128 v[84:87], v7 offset:3072
  ds_read_b128 v[88:91], v7 offset:4096
  ds_read_b128 v[92:95], v7 offset:5120
  ds_read_b128 v[96:99], v7 offset:6144
  ds_read_b128 v[100:103], v7 offset:7168
  s_waitcnt lgkmcnt(7)
  v_pk_fma_f32 v[128:129], v[72:73], v[32:33], v[128:129] op_sel_hi:[1,0,1]
  v_pk_fma_f32 v[130:131], v[74:75], v[32:33], v[130:131] op_sel_hi:[1,0,1]
  v_cvt_pk_bf16_f32 v128, v128, v129
  v_cvt_pk_bf16_f32 v129, v130, v131
  s_waitcnt lgkmcnt(6)
  v_pk_fma_f32 v[132:133], v[76:77], v[34:35], v[132:133] op_sel_hi:[1,0,1]
  v_pk_fma_f32 v[134:135], v[78:79], v[34:35], v[134:135] op_sel_hi:[1,0,1]
  v_cvt_pk_bf16_f32 v132, v132, v133
  v_cvt_pk_bf16_f32 v133, v134, v135
  s_waitcnt lgkmcnt(5)
  v_pk_fma_f32 v[136:137], v[80:81], v[36:37], v[136:137] op_sel_hi:[1,0,1]
  v_pk_fma_f32 v[138:139], v[82:83], v[36:37], v[138:139] op_sel_hi:[1,0,1]
  v_cvt_pk_bf16_f32 v136, v136, v137
  v_cvt_pk_bf16_f32 v137, v138, v139
  s_waitcnt lgkmcnt(4)
  v_pk_fma_f32 v[140:141], v[84:85], v[38:39], v[140:141] op_sel_hi:[1,0,1]
  v_pk_fma_f32 v[142:143], v[86:87], v[38:39], v[142:143] op_sel_hi:[1,0,1]
  v_cvt_pk_bf16_f32 v140, v140, v141
  v_cvt_pk_bf16_f32 v141, v142, v143
  s_waitcnt lgkmcnt(3)
  v_pk_fma_f32 v[144:145], v[88:89], v[32:33], v[144:145] op_sel_hi:[1,0,1]
  v_pk_fma_f32 v[146:147], v[90:91], v[32:33], v[146:147] op_sel_hi:[1,0,1]
  v_cvt_pk_bf16_f32 v144, v144, v145
  v_cvt_pk_bf16_f32 v145, v146, v147
  s_waitcnt lgkmcnt(2)
  v_pk_fma_f32 v[148:149], v[92:93], v[34:35], v[148:149] op_sel_hi:[1,0,1]
  v_pk_fma_f32 v[150:151], v[94:95], v[34:35], v[150:151] op_sel_hi:[1,0,1]
  v_cvt_pk_bf16_f32 v148, v148, v149
  v_cvt_pk_bf16_f32 v149, v150, v151
  s_waitcnt lgkmcnt(1)
  v_pk_fma_f32 v[152:153], v[96:97], v[36:37], v[152:153] op_sel_hi:[1,0,1]
  v_pk_fma_f32 v[154:155], v[98:99], v[36:37], v[154:155] op_sel_hi:[1,0,1]
  v_cvt_pk_bf16_f32 v152, v152, v153
  v_cvt_pk_bf16_f32 v153, v154, v155
  s_waitcnt lgkmcnt(0)
  v_pk_fma_f32 v[156:157], v[100:101], v[38:39], v[156:157] op_sel_hi:[1,0,1]
  v_pk_fma_f32 v[158:159], v[102:103], v[38:39], v[158:159] op_sel_hi:[1,0,1]
  v_cvt_pk_bf16_f32 v156, v156, v157
  v_cvt_pk_bf16_f32 v157, v158, v159
  ds_read_b128 v[72:75], v7 offset:8192
  ds_read_b128 v[76:79], v7 offset:9216
  ds_read_b128 v[80:83], v7 offset:10240
  ds_read_b128 v[84:87], v7 offset:11264
  ds_read_b128 v[88:91], v7 offset:12288
  ds_read_b128 v[92:95], v7 offset:13312
  ds_read_b128 v[96:99], v7 offset:14336
  ds_read_b128 v[100:103], v7 offset:15360
  s_waitcnt lgkmcnt(7)
  v_pk_fma_f32 v[160:161], v[72:73], v[32:33], v[160:161] op_sel_hi:[1,0,1]
  v_pk_fma_f32 v[162:163], v[74:75], v[32:33], v[162:163] op_sel_hi:[1,0,1]
  v_cvt_pk_bf16_f32 v160, v160, v161
  v_cvt_pk_bf16_f32 v161, v162, v163
  s_waitcnt lgkmcnt(6)
  v_pk_fma_f32 v[164:165], v[76:77], v[34:35], v[164:165] op_sel_hi:[1,0,1]
  v_pk_fma_f32 v[166:167], v[78:79], v[34:35], v[166:167] op_sel_hi:[1,0,1]
  v_cvt_pk_bf16_f32 v164, v164, v165
  v_cvt_pk_bf16_f32 v165, v166, v167
  s_waitcnt lgkmcnt(5)
  v_pk_fma_f32 v[168:169], v[80:81], v[36:37], v[168:169] op_sel_hi:[1,0,1]
  v_pk_fma_f32 v[170:171], v[82:83], v[36:37], v[170:171] op_sel_hi:[1,0,1]
  v_cvt_pk_bf16_f32 v168, v168, v169
  v_cvt_pk_bf16_f32 v169, v170, v171
  s_waitcnt lgkmcnt(4)
  v_pk_fma_f32 v[172:173], v[84:85], v[38:39], v[172:173] op_sel_hi:[1,0,1]
  v_pk_fma_f32 v[174:175], v[86:87], v[38:39], v[174:175] op_sel_hi:[1,0,1]
  v_cvt_pk_bf16_f32 v172, v172, v173
  v_cvt_pk_bf16_f32 v173, v174, v175
  s_waitcnt lgkmcnt(3)
  v_pk_fma_f32 v[176:177], v[88:89], v[32:33], v[176:177] op_sel_hi:[1,0,1]
  v_pk_fma_f32 v[178:179], v[90:91], v[32:33], v[178:179] op_sel_hi:[1,0,1]
  v_cvt_pk_bf16_f32 v176, v176, v177
  v_cvt_pk_bf16_f32 v177, v178, v179
  s_waitcnt lgkmcnt(2)
  v_pk_fma_f32 v[180:181], v[92:93], v[34:35], v[180:181] op_sel_hi:[1,0,1]
  v_pk_fma_f32 v[182:183], v[94:95], v[34:35], v[182:183] op_sel_hi:[1,0,1]
  v_cvt_pk_bf16_f32 v180, v180, v181
  v_cvt_pk_bf16_f32 v181, v182, v183
  s_waitcnt lgkmcnt(1)
  v_pk_fma_f32 v[184:185], v[96:97], v[36:37], v[184:185] op_sel_hi:[1,0,1]
  v_pk_fma_f32 v[186:187], v[98:99], v[36:37], v[186:187] op_sel_hi:[1,0,1]
  v_cvt_pk_bf16_f32 v184, v184, v185
  v_cvt_pk_bf16_f32 v185, v186, v187
  s_waitcnt lgkmcnt(0)
  v_pk_fma_f32 v[188:189], v[100:101], v[38:39], v[188:189] op_sel_hi:[1,0,1]
  v_pk_fma_f32 v[190:191], v[102:103], v[38:39], v[190:191] op_sel_hi:[1,0,1]
  v_cvt_pk_bf16_f32 v188, v188, v189
  v_cvt_pk_bf16_f32 v189, v190, v191
  s_barrier
  ds_write_b128 v6, a[64:67] offset:0
  v_accvgpr_read_b32 v192, a192
  v_accvgpr_read_b32 v193, a193
  v_accvgpr_read_b32 v194, a194
  v_accvgpr_read_b32 v195, a195
  v_pk_mul_f32 v[192:193], v[192:193], v[24:25] op_sel_hi:[1,0]
  v_pk_mul_f32 v[194:195], v[194:195], v[24:25] op_sel_hi:[1,0]
  ds_write_b128 v6, a[68:71] offset:1024
  v_accvgpr_read_b32 v196, a196
  v_accvgpr_read_b32 v197, a197
  v_accvgpr_read_b32 v198, a198
  v_accvgpr_read_b32 v199, a199
  v_pk_mul_f32 v[196:197], v[196:197], v[26:27] op_sel_hi:[1,0]
  v_pk_mul_f32 v[198:199], v[198:199], v[26:27] op_sel_hi:[1,0]
  ds_write_b128 v6, a[72:75] offset:2048
  v_accvgpr_read_b32 v200, a200
  v_accvgpr_read_b32 v201, a201
  v_accvgpr_read_b32 v202, a202
  v_accvgpr_read_b32 v203, a203
  v_pk_mul_f32 v[200:201], v[200:201], v[28:29] op_sel_hi:[1,0]
  v_pk_mul_f32 v[202:203], v[202:203], v[28:29] op_sel_hi:[1,0]
  ds_write_b128 v6, a[76:79] offset:3072
  v_accvgpr_read_b32 v204, a204
  v_accvgpr_read_b32 v205, a205
  v_accvgpr_read_b32 v206, a206
  v_accvgpr_read_b32 v207, a207
  v_pk_mul_f32 v[204:205], v[204:205], v[30:31] op_sel_hi:[1,0]
  v_pk_mul_f32 v[206:207], v[206:207], v[30:31] op_sel_hi:[1,0]
  ds_write_b128 v6, a[80:83] offset:4096
  v_accvgpr_read_b32 v208, a208
  v_accvgpr_read_b32 v209, a209
  v_accvgpr_read_b32 v210, a210
  v_accvgpr_read_b32 v211, a211
  v_pk_mul_f32 v[208:209], v[208:209], v[24:25] op_sel_hi:[1,0]
  v_pk_mul_f32 v[210:211], v[210:211], v[24:25] op_sel_hi:[1,0]
  ds_write_b128 v6, a[84:87] offset:5120
  v_accvgpr_read_b32 v212, a212
  v_accvgpr_read_b32 v213, a213
  v_accvgpr_read_b32 v214, a214
  v_accvgpr_read_b32 v215, a215
  v_pk_mul_f32 v[212:213], v[212:213], v[26:27] op_sel_hi:[1,0]
  v_pk_mul_f32 v[214:215], v[214:215], v[26:27] op_sel_hi:[1,0]
  ds_write_b128 v6, a[88:91] offset:6144
  v_accvgpr_read_b32 v216, a216
  v_accvgpr_read_b32 v217, a217
  v_accvgpr_read_b32 v218, a218
  v_accvgpr_read_b32 v219, a219
  v_pk_mul_f32 v[216:217], v[216:217], v[28:29] op_sel_hi:[1,0]
  v_pk_mul_f32 v[218:219], v[218:219], v[28:29] op_sel_hi:[1,0]
  ds_write_b128 v6, a[92:95] offset:7168
  v_accvgpr_read_b32 v220, a220
  v_accvgpr_read_b32 v221, a221
  v_accvgpr_read_b32 v222, a222
  v_accvgpr_read_b32 v223, a223
  v_pk_mul_f32 v[220:221], v[220:221], v[30:31] op_sel_hi:[1,0]
  v_pk_mul_f32 v[222:223], v[222:223], v[30:31] op_sel_hi:[1,0]
  ds_write_b128 v6, a[96:99] offset:8192
  v_accvgpr_read_b32 v224, a224
  v_accvgpr_read_b32 v225, a225
  v_accvgpr_read_b32 v226, a226
  v_accvgpr_read_b32 v227, a227
  v_pk_mul_f32 v[224:225], v[224:225], v[24:25] op_sel_hi:[1,0]
  v_pk_mul_f32 v[226:227], v[226:227], v[24:25] op_sel_hi:[1,0]
  ds_write_b128 v6, a[100:103] offset:9216
  v_accvgpr_read_b32 v228, a228
  v_accvgpr_read_b32 v229, a229
  v_accvgpr_read_b32 v230, a230
  v_accvgpr_read_b32 v231, a231
  v_pk_mul_f32 v[228:229], v[228:229], v[26:27] op_sel_hi:[1,0]
  v_pk_mul_f32 v[230:231], v[230:231], v[26:27] op_sel_hi:[1,0]
  ds_write_b128 v6, a[104:107] offset:10240
  v_accvgpr_read_b32 v232, a232
  v_accvgpr_read_b32 v233, a233
  v_accvgpr_read_b32 v234, a234
  v_accvgpr_read_b32 v235, a235
  v_pk_mul_f32 v[232:233], v[232:233], v[28:29] op_sel_hi:[1,0]
  v_pk_mul_f32 v[234:235], v[234:235], v[28:29] op_sel_hi:[1,0]
  ds_write_b128 v6, a[108:111] offset:11264
  v_accvgpr_read_b32 v236, a236
  v_accvgpr_read_b32 v237, a237
  v_accvgpr_read_b32 v238, a238
  v_accvgpr_read_b32 v239, a239
  v_pk_mul_f32 v[236:237], v[236:237], v[30:31] op_sel_hi:[1,0]
  v_pk_mul_f32 v[238:239], v[238:239], v[30:31] op_sel_hi:[1,0]
  ds_write_b128 v6, a[112:115] offset:12288
  v_accvgpr_read_b32 v240, a240
  v_accvgpr_read_b32 v241, a241
  v_accvgpr_read_b32 v242, a242
  v_accvgpr_read_b32 v243, a243
  v_pk_mul_f32 v[240:241], v[240:241], v[24:25] op_sel_hi:[1,0]
  v_pk_mul_f32 v[242:243], v[242:243], v[24:25] op_sel_hi:[1,0]
  ds_write_b128 v6, a[116:119] offset:13312
  v_accvgpr_read_b32 v244, a244
  v_accvgpr_read_b32 v245, a245
  v_accvgpr_read_b32 v246, a246
  v_accvgpr_read_b32 v247, a247
  v_pk_mul_f32 v[244:245], v[244:245], v[26:27] op_sel_hi:[1,0]
  v_pk_mul_f32 v[246:247], v[246:247], v[26:27] op_sel_hi:[1,0]
  ds_write_b128 v6, a[120:123] offset:14336
  v_accvgpr_read_b32 v248, a248
  v_accvgpr_read_b32 v249, a249
  v_accvgpr_read_b32 v250, a250
  v_accvgpr_read_b32 v251, a251
  v_pk_mul_f32 v[248:249], v[248:249], v[28:29] op_sel_hi:[1,0]
  v_pk_mul_f32 v[250:251], v[250:251], v[28:29] op_sel_hi:[1,0]
  ds_write_b128 v6, a[124:127] offset:15360
  v_accvgpr_read_b32 v252, a252
  v_accvgpr_read_b32 v253, a253
  v_accvgpr_read_b32 v254, a254
  v_accvgpr_read_b32 v255, a255
  v_pk_mul_f32 v[252:253], v[252:253], v[30:31] op_sel_hi:[1,0]
  v_pk_mul_f32 v[254:255], v[254:255], v[30:31] op_sel_hi:[1,0]
  s_waitcnt lgkmcnt(0)
  s_barrier
  ds_read_b128 v[72:75], v7 offset:0
  ds_read_b128 v[76:79], v7 offset:1024
  ds_read_b128 v[80:83], v7 offset:2048
  ds_read_b128 v[84:87], v7 offset:3072
  ds_read_b128 v[88:91], v7 offset:4096
  ds_read_b128 v[92:95], v7 offset:5120
  ds_read_b128 v[96:99], v7 offset:6144
  ds_read_b128 v[100:103], v7 offset:7168
  s_waitcnt lgkmcnt(7)
  v_pk_fma_f32 v[192:193], v[72:73], v[32:33], v[192:193] op_sel_hi:[1,0,1]
  v_pk_fma_f32 v[194:195], v[74:75], v[32:33], v[194:195] op_sel_hi:[1,0,1]
  v_cvt_pk_bf16_f32 v192, v192, v193
  v_cvt_pk_bf16_f32 v193, v194, v195
  s_waitcnt lgkmcnt(6)
  v_pk_fma_f32 v[196:197], v[76:77], v[34:35], v[196:197] op_sel_hi:[1,0,1]
  v_pk_fma_f32 v[198:199], v[78:79], v[34:35], v[198:199] op_sel_hi:[1,0,1]
  v_cvt_pk_bf16_f32 v196, v196, v197
  v_cvt_pk_bf16_f32 v197, v198, v199
  s_waitcnt lgkmcnt(5)
  v_pk_fma_f32 v[200:201], v[80:81], v[36:37], v[200:201] op_sel_hi:[1,0,1]
  v_pk_fma_f32 v[202:203], v[82:83], v[36:37], v[202:203] op_sel_hi:[1,0,1]
  v_cvt_pk_bf16_f32 v200, v200, v201
  v_cvt_pk_bf16_f32 v201, v202, v203
  s_waitcnt lgkmcnt(4)
  v_pk_fma_f32 v[204:205], v[84:85], v[38:39], v[204:205] op_sel_hi:[1,0,1]
  v_pk_fma_f32 v[206:207], v[86:87], v[38:39], v[206:207] op_sel_hi:[1,0,1]
  v_cvt_pk_bf16_f32 v204, v204, v205
  v_cvt_pk_bf16_f32 v205, v206, v207
  s_waitcnt lgkmcnt(3)
  v_pk_fma_f32 v[208:209], v[88:89], v[32:33], v[208:209] op_sel_hi:[1,0,1]
  v_pk_fma_f32 v[210:211], v[90:91], v[32:33], v[210:211] op_sel_hi:[1,0,1]
  v_cvt_pk_bf16_f32 v208, v208, v209
  v_cvt_pk_bf16_f32 v209, v210, v211
  s_waitcnt lgkmcnt(2)
  v_pk_fma_f32 v[212:213], v[92:93], v[34:35], v[212:213] op_sel_hi:[1,0,1]
  v_pk_fma_f32 v[214:215], v[94:95], v[34:35], v[214:215] op_sel_hi:[1,0,1]
  v_cvt_pk_bf16_f32 v212, v212, v213
  v_cvt_pk_bf16_f32 v213, v214, v215
  s_waitcnt lgkmcnt(1)
  v_pk_fma_f32 v[216:217], v[96:97], v[36:37], v[216:217] op_sel_hi:[1,0,1]
  v_pk_fma_f32 v[218:219], v[98:99], v[36:37], v[218:219] op_sel_hi:[1,0,1]
  v_cvt_pk_bf16_f32 v216, v216, v217
  v_cvt_pk_bf16_f32 v217, v218, v219
  s_waitcnt lgkmcnt(0)
  v_pk_fma_f32 v[220:221], v[100:101], v[38:39], v[220:221] op_sel_hi:[1,0,1]
  v_pk_fma_f32 v[222:223], v[102:103], v[38:39], v[222:223] op_sel_hi:[1,0,1]
  v_cvt_pk_bf16_f32 v220, v220, v221
  v_cvt_pk_bf16_f32 v221, v222, v223
  ds_read_b128 v[72:75], v7 offset:8192
  ds_read_b128 v[76:79], v7 offset:9216
  ds_read_b128 v[80:83], v7 offset:10240
  ds_read_b128 v[84:87], v7 offset:11264
  ds_read_b128 v[88:91], v7 offset:12288
  ds_read_b128 v[92:95], v7 offset:13312
  ds_read_b128 v[96:99], v7 offset:14336
  ds_read_b128 v[100:103], v7 offset:15360
  s_waitcnt lgkmcnt(7)
  v_pk_fma_f32 v[224:225], v[72:73], v[32:33], v[224:225] op_sel_hi:[1,0,1]
  v_pk_fma_f32 v[226:227], v[74:75], v[32:33], v[226:227] op_sel_hi:[1,0,1]
  v_cvt_pk_bf16_f32 v224, v224, v225
  v_cvt_pk_bf16_f32 v225, v226, v227
  s_waitcnt lgkmcnt(6)
  v_pk_fma_f32 v[228:229], v[76:77], v[34:35], v[228:229] op_sel_hi:[1,0,1]
  v_pk_fma_f32 v[230:231], v[78:79], v[34:35], v[230:231] op_sel_hi:[1,0,1]
  v_cvt_pk_bf16_f32 v228, v228, v229
  v_cvt_pk_bf16_f32 v229, v230, v231
  s_waitcnt lgkmcnt(5)
  v_pk_fma_f32 v[232:233], v[80:81], v[36:37], v[232:233] op_sel_hi:[1,0,1]
  v_pk_fma_f32 v[234:235], v[82:83], v[36:37], v[234:235] op_sel_hi:[1,0,1]
  v_cvt_pk_bf16_f32 v232, v232, v233
  v_cvt_pk_bf16_f32 v233, v234, v235
  s_waitcnt lgkmcnt(4)
  v_pk_fma_f32 v[236:237], v[84:85], v[38:39], v[236:237] op_sel_hi:[1,0,1]
  v_pk_fma_f32 v[238:239], v[86:87], v[38:39], v[238:239] op_sel_hi:[1,0,1]
  v_cvt_pk_bf16_f32 v236, v236, v237
  v_cvt_pk_bf16_f32 v237, v238, v239
  s_waitcnt lgkmcnt(3)
  v_pk_fma_f32 v[240:241], v[88:89], v[32:33], v[240:241] op_sel_hi:[1,0,1]
  v_pk_fma_f32 v[242:243], v[90:91], v[32:33], v[242:243] op_sel_hi:[1,0,1]
  v_cvt_pk_bf16_f32 v240, v240, v241
  v_cvt_pk_bf16_f32 v241, v242, v243
  s_waitcnt lgkmcnt(2)
  v_pk_fma_f32 v[244:245], v[92:93], v[34:35], v[244:245] op_sel_hi:[1,0,1]
  v_pk_fma_f32 v[246:247], v[94:95], v[34:35], v[246:247] op_sel_hi:[1,0,1]
  v_cvt_pk_bf16_f32 v244, v244, v245
  v_cvt_pk_bf16_f32 v245, v246, v247
  s_waitcnt lgkmcnt(1)
  v_pk_fma_f32 v[248:249], v[96:97], v[36:37], v[248:249] op_sel_hi:[1,0,1]
  v_pk_fma_f32 v[250:251], v[98:99], v[36:37], v[250:251] op_sel_hi:[1,0,1]
  v_cvt_pk_bf16_f32 v248, v248, v249
  v_cvt_pk_bf16_f32 v249, v250, v251
  s_waitcnt lgkmcnt(0)
  v_pk_fma_f32 v[252:253], v[100:101], v[38:39], v[252:253] op_sel_hi:[1,0,1]
  v_pk_fma_f32 v[254:255], v[102:103], v[38:39], v[254:255] op_sel_hi:[1,0,1]
  v_cvt_pk_bf16_f32 v252, v252, v253
  v_cvt_pk_bf16_f32 v253, v254, v255
K1_MGJ:
  v_and_b32 v1, 15, v0
  v_lshlrev_b32 v1, 4, v1
  v_bfe_u32 v2, v0, 4, 1
  v_lshl_add_u32 v1, v2, 3, v1
  v_lshrrev_b32 v2, 5, v0
  v_lshl_add_u32 v1, v2, 8, v1
  s_lshl_b32 s36, s22, 14
  s_add_u32 s36, s36, 67584
  v_add_u32 v3, s36, v1
  s_barrier
  ds_write_b64 v3, v[128:129] offset:0
  ds_write_b64 v3, v[132:133] offset:1024
  ds_write_b64 v3, v[136:137] offset:2048
  ds_write_b64 v3, v[140:141] offset:3072
  ds_write_b64 v3, v[144:145] offset:512
  ds_write_b64 v3, v[148:149] offset:1536
  ds_write_b64 v3, v[152:153] offset:2560
  ds_write_b64 v3, v[156:157] offset:3584
  ds_write_b64 v3, v[160:161] offset:4096
  ds_write_b64 v3, v[164:165] offset:5120
  ds_write_b64 v3, v[168:169] offset:6144
  ds_write_b64 v3, v[172:173] offset:7168
  ds_write_b64 v3, v[176:177] offset:4608
  ds_write_b64 v3, v[180:181] offset:5632
  ds_write_b64 v3, v[184:185] offset:6656
  ds_write_b64 v3, v[188:189] offset:7680
  ds_write_b64 v3, v[192:193] offset:8192
  ds_write_b64 v3, v[196:197] offset:9216
  ds_write_b64 v3, v[200:201] offset:10240
  ds_write_b64 v3, v[204:205] offset:11264
  ds_write_b64 v3, v[208:209] offset:8704
  ds_write_b64 v3, v[212:213] offset:9728
  ds_write_b64 v3, v[216:217] offset:10752
  ds_write_b64 v3, v[220:221] offset:11776
  ds_write_b64 v3, v[224:225] offset:12288
  ds_write_b64 v3, v[228:229] offset:13312
  ds_write_b64 v3, v[232:233] offset:14336
  ds_write_b64 v3, v[236:237] offset:15360
  ds_write_b64 v3, v[240:241] offset:12800
  ds_write_b64 v3, v[244:245] offset:13824
  ds_write_b64 v3, v[248:249] offset:14848
  ds_write_b64 v3, v[252:253] offset:15872
  v_lshlrev_b32 v14, 4, v0
  v_add_u32 v14, 67584, v14
  s_waitcnt lgkmcnt(0)
  s_barrier
  ds_read_b128 a[0:3], v14 offset:0
  ds_read_b128 a[4:7], v14 offset:1024
  ds_read_b128 a[8:11], v14 offset:2048
  ds_read_b128 a[12:15], v14 offset:3072
  ds_read_b128 a[16:19], v14 offset:4096
  ds_read_b128 a[20:23], v14 offset:5120
  ds_read_b128 a[24:27], v14 offset:6144
  ds_read_b128 a[28:31], v14 offset:7168
  s_waitcnt lgkmcnt(4)
  ds_read_b128 a[32:35], v14 offset:8192
  ds_read_b128 a[36:39], v14 offset:9216
  ds_read_b128 a[40:43], v14 offset:10240
  ds_read_b128 a[44:47], v14 offset:11264
  ds_read_b128 a[48:51], v14 offset:12288
  ds_read_b128 a[52:55], v14 offset:13312
  ds_read_b128 a[56:59], v14 offset:14336
  ds_read_b128 a[60:63], v14 offset:15360
  s_waitcnt lgkmcnt(4)
  ds_read_b128 a[64:67], v14 offset:16384
  ds_read_b128 a[68:71], v14 offset:17408
  ds_read_b128 a[72:75], v14 offset:18432
  ds_read_b128 a[76:79], v14 offset:19456
  ds_read_b128 a[80:83], v14 offset:20480
  ds_read_b128 a[84:87], v14 offset:21504
  ds_read_b128 a[88:91], v14 offset:22528
  ds_read_b128 a[92:95], v14 offset:23552
  s_waitcnt lgkmcnt(4)
  ds_read_b128 a[96:99], v14 offset:24576
  ds_read_b128 a[100:103], v14 offset:25600
  ds_read_b128 a[104:107], v14 offset:26624
  ds_read_b128 a[108:111], v14 offset:27648
  ds_read_b128 a[112:115], v14 offset:28672
  ds_read_b128 a[116:119], v14 offset:29696
  ds_read_b128 a[120:123], v14 offset:30720
  ds_read_b128 a[124:127], v14 offset:31744
  s_waitcnt lgkmcnt(4)
  v_lshrrev_b32 v1, 4, v0
  v_bfe_u32 v2, v0, 2, 2
  v_lshl_add_u32 v2, v1, 3, v2
  v_mul_u32_u24 v2, 896, v2
  v_and_b32 v3, 3, v0
  v_lshl_add_u32 v2, v3, 3, v2
  v_bfe_u32 v3, v0, 3, 1
  v_bfe_u32 v4, v0, 4, 1
  v_lshl_or_b32 v3, v4, 1, v3
  s_mul_i32 s36, s22, 7
  s_add_u32 s37, s36, 0
  v_xor_b32 v4, s37, v3
  v_lshl_add_u32 v16, v4, 5, v2
  v_add_u32 v23, 67584, v16
  v_add_u32 v30, 133120, v16
  s_add_u32 s37, s36, 1
  v_xor_b32 v4, s37, v3
  v_lshl_add_u32 v17, v4, 5, v2
  v_add_u32 v24, 67584, v17
  v_add_u32 v31, 133120, v17
  s_add_u32 s37, s36, 2
  v_xor_b32 v4, s37, v3
  v_lshl_add_u32 v18, v4, 5, v2
  v_add_u32 v25, 67584, v18
  v_add_u32 v32, 133120, v18
  s_add_u32 s37, s36, 3
  v_xor_b32 v4, s37, v3
  v_lshl_add_u32 v19, v4, 5, v2
  v_add_u32 v26, 67584, v19
  v_add_u32 v33, 133120, v19
  s_add_u32 s37, s36, 4
  v_xor_b32 v4, s37, v3
  v_lshl_add_u32 v20, v4, 5, v2
  v_add_u32 v27, 67584, v20
  v_add_u32 v34, 133120, v20
  s_add_u32 s37, s36, 5
  v_xor_b32 v4, s37, v3
  v_lshl_add_u32 v21, v4, 5, v2
  v_add_u32 v28, 67584, v21
  v_add_u32 v35, 133120, v21
  s_add_u32 s37, s36, 6
  v_xor_b32 v4, s37, v3
  v_lshl_add_u32 v22, v4, 5, v2
  v_add_u32 v29, 67584, v22
  v_add_u32 v36, 133120, v22
  s_waitcnt lgkmcnt(0)
  s_waitcnt vmcnt(14)
  s_barrier
  s_add_u32 m0, s42, 67584
  s_nop 0
  buffer_load_dwordx4 v64, s[12:15], s40 offen offset:0 lds
  buffer_load_dwordx4 v65, s[12:15], s40 offen offset:1024 lds
  buffer_load_dwordx4 v66, s[12:15], s40 offen offset:2048 lds
  buffer_load_dwordx4 v67, s[12:15], s40 offen offset:3072 lds
  s_add_u32 m0, s42, 71680
  s_nop 0
  buffer_load_dwordx4 v68, s[12:15], s40 offen offset:0 lds
  buffer_load_dwordx4 v69, s[12:15], s40 offen offset:1024 lds
  buffer_load_dwordx4 v70, s[12:15], s40 offen offset:2048 lds
  s_add_u32 s40, s40, 28672
  ds_read_b64_tr_b16 v[96:97], v16 offset:0
  ds_read_b64_tr_b16 v[98:99], v16 offset:3584
  ds_read_b64_tr_b16 v[100:101], v17 offset:0
  ds_read_b64_tr_b16 v[102:103], v17 offset:3584
  ds_read_b64_tr_b16 v[104:105], v18 offset:0
  ds_read_b64_tr_b16 v[106:107], v18 offset:3584
  s_waitcnt lgkmcnt(4)
  v_mfma_f32_16x16x32_bf16 v[128:131], v[96:99], a[0:3], 0
  ds_read_b64_tr_b16 v[108:109], v19 offset:0
  ds_read_b64_tr_b16 v[110:111], v19 offset:3584
  v_mfma_f32_16x16x32_bf16 v[132:135], v[96:99], a[4:7], 0
  s_waitcnt vmcnt(14)
  s_barrier
  v_mfma_f32_16x16x32_bf16 v[136:139], v[96:99], a[8:11], 0
  ds_read_b128 a[128:131], v14 offset:32768
  v_mfma_f32_16x16x32_bf16 v[140:143], v[96:99], a[12:15], 0
  s_waitcnt lgkmcnt(5)
  v_mfma_f32_16x16x32_bf16 v[144:147], v[100:103], a[0:3], 0
  ds_read_b64_tr_b16 v[96:97], v20 offset:0
  ds_read_b64_tr_b16 v[98:99], v20 offset:3584
  v_mfma_f32_16x16x32_bf16 v[148:151], v[100:103], a[4:7], 0
  v_mfma_f32_16x16x32_bf16 v[152:155], v[100:103], a[8:11], 0
  v_mfma_f32_16x16x32_bf16 v[156:159], v[100:103], a[12:15], 0
  s_waitcnt lgkmcnt(5)
  v_mfma_f32_16x16x32_bf16 v[160:163], v[104:107], a[0:3], 0
  ds_read_b64_tr_b16 v[100:101], v21 offset:0
  ds_read_b64_tr_b16 v[102:103], v21 offset:3584
  v_mfma_f32_16x16x32_bf16 v[164:167], v[104:107], a[4:7], 0
  ds_read_b128 a[132:135], v14 offset:33792
  v_mfma_f32_16x16x32_bf16 v[168:171], v[104:107], a[8:11], 0
  v_mfma_f32_16x16x32_bf16 v[172:175], v[104:107], a[12:15], 0
  s_waitcnt lgkmcnt(6)
  v_mfma_f32_16x16x32_bf16 v[176:179], v[108:111], a[0:3], 0
  ds_read_b64_tr_b16 v[104:105], v22 offset:0
  ds_read_b64_tr_b16 v[106:107], v22 offset:3584
  v_mfma_f32_16x16x32_bf16 v[180:183], v[108:111], a[4:7], 0
  v_mfma_f32_16x16x32_bf16 v[184:187], v[108:111], a[8:11], 0
  v_mfma_f32_16x16x32_bf16 v[188:191], v[108:111], a[12:15], 0
  s_waitcnt lgkmcnt(5)
  v_mfma_f32_16x16x32_bf16 v[192:195], v[96:99], a[0:3], 0
  ds_read_b64_tr_b16 v[108:109], v16 offset:28672
  ds_read_b64_tr_b16 v[110:111], v16 offset:32256
  ds_read_b128 a[136:139], v14 offset:34816
  v_mfma_f32_16x16x32_bf16 v[196:199], v[96:99], a[4:7], 0
  v_mfma_f32_16x16x32_bf16 v[200:203], v[96:99], a[8:11], 0
  v_mfma_f32_16x16x32_bf16 v[204:207], v[96:99], a[12:15], 0
  s_waitcnt lgkmcnt(6)
  v_mfma_f32_16x16x32_bf16 v[208:211], v[100:103], a[0:3], 0
  ds_read_b64_tr_b16 v[96:97], v17 offset:28672
  ds_read_b64_tr_b16 v[98:99], v17 offset:32256
  v_mfma_f32_16x16x32_bf16 v[212:215], v[100:103], a[4:7], 0
  v_mfma_f32_16x16x32_bf16 v[216:219], v[100:103], a[8:11], 0
  v_mfma_f32_16x16x32_bf16 v[220:223], v[100:103], a[12:15], 0
  s_waitcnt lgkmcnt(5)
  ds_read_b128 a[140:143], v14 offset:35840
  v_mfma_f32_16x16x32_bf16 v[224:227], v[104:107], a[0:3], 0
  ds_read_b64_tr_b16 v[100:101], v18 offset:28672
  ds_read_b64_tr_b16 v[102:103], v18 offset:32256
  v_mfma_f32_16x16x32_bf16 v[228:231], v[104:107], a[4:7], 0
  v_mfma_f32_16x16x32_bf16 v[232:235], v[104:107], a[8:11], 0
  v_mfma_f32_16x16x32_bf16 v[236:239], v[104:107], a[12:15], 0
  s_waitcnt lgkmcnt(6)
  v_mfma_f32_16x16x32_bf16 v[128:131], v[108:111], a[16:19], v[128:131]
  ds_read_b64_tr_b16 v[104:105], v19 offset:28672
  ds_read_b64_tr_b16 v[106:107], v19 offset:32256
  v_mfma_f32_16x16x32_bf16 v[132:135], v[108:111], a[20:23], v[132:135]
  s_waitcnt vmcnt(7)
  s_barrier
  v_mfma_f32_16x16x32_bf16 v[136:139], v[108:111], a[24:27], v[136:139]
  s_add_u32 m0, s42, 0
  ds_read_b128 a[144:147], v14 offset:36864
  v_mfma_f32_16x16x32_bf16 v[140:143], v[108:111], a[28:31], v[140:143]
  buffer_load_dwordx4 v64, s[12:15], s40 offen offset:0 lds
  s_waitcnt lgkmcnt(6)
  v_mfma_f32_16x16x32_bf16 v[144:147], v[96:99], a[16:19], v[144:147]
  ds_read_b64_tr_b16 v[108:109], v20 offset:28672
  ds_read_b64_tr_b16 v[110:111], v20 offset:32256
  v_mfma_f32_16x16x32_bf16 v[148:151], v[96:99], a[20:23], v[148:151]
  v_mfma_f32_16x16x32_bf16 v[152:155], v[96:99], a[24:27], v[152:155]
  buffer_load_dwordx4 v65, s[12:15], s40 offen offset:1024 lds
  v_mfma_f32_16x16x32_bf16 v[156:159], v[96:99], a[28:31], v[156:159]
  s_waitcnt lgkmcnt(5)
  v_mfma_f32_16x16x32_bf16 v[160:163], v[100:103], a[16:19], v[160:163]
  ds_read_b64_tr_b16 v[96:97], v21 offset:28672
  ds_read_b64_tr_b16 v[98:99], v21 offset:32256
  v_mfma_f32_16x16x32_bf16 v[164:167], v[100:103], a[20:23], v[164:167]
  ds_read_b128 a[148:151], v14 offset:37888
  v_mfma_f32_16x16x32_bf16 v[168:171], v[100:103], a[24:27], v[168:171]
  buffer_load_dwordx4 v66, s[12:15], s40 offen offset:2048 lds
  v_mfma_f32_16x16x32_bf16 v[172:175], v[100:103], a[28:31], v[172:175]
  s_waitcnt lgkmcnt(6)
  v_mfma_f32_16x16x32_bf16 v[176:179], v[104:107], a[16:19], v[176:179]
  ds_read_b64_tr_b16 v[100:101], v22 offset:28672
  ds_read_b64_tr_b16 v[102:103], v22 offset:32256
  v_mfma_f32_16x16x32_bf16 v[180:183], v[104:107], a[20:23], v[180:183]
  v_mfma_f32_16x16x32_bf16 v[184:187], v[104:107], a[24:27], v[184:187]
  buffer_load_dwordx4 v67, s[12:15], s40 offen offset:3072 lds
  v_mfma_f32_16x16x32_bf16 v[188:191], v[104:107], a[28:31], v[188:191]
  s_waitcnt lgkmcnt(5)
  v_mfma_f32_16x16x32_bf16 v[192:195], v[108:111], a[16:19], v[192:195]
  ds_read_b64_tr_b16 v[104:105], v30 offset:0
  ds_read_b64_tr_b16 v[106:107], v30 offset:3584
  ds_read_b128 a[152:155], v14 offset:38912
  v_mfma_f32_16x16x32_bf16 v[196:199], v[108:111], a[20:23], v[196:199]
  s_add_u32 m0, s42, 4096
  v_mfma_f32_16x16x32_bf16 v[200:203], v[108:111], a[24:27], v[200:203]
  buffer_load_dwordx4 v68, s[12:15], s40 offen offset:0 lds
  v_mfma_f32_16x16x32_bf16 v[204:207], v[108:111], a[28:31], v[204:207]
  s_waitcnt lgkmcnt(6)
  v_mfma_f32_16x16x32_bf16 v[208:211], v[96:99], a[16:19], v[208:211]
  ds_read_b64_tr_b16 v[108:109], v31 offset:0
  ds_read_b64_tr_b16 v[110:111], v31 offset:3584
  v_mfma_f32_16x16x32_bf16 v[212:215], v[96:99], a[20:23], v[212:215]
  v_mfma_f32_16x16x32_bf16 v[216:219], v[96:99], a[24:27], v[216:219]
  buffer_load_dwordx4 v69, s[12:15], s40 offen offset:1024 lds
  v_mfma_f32_16x16x32_bf16 v[220:223], v[96:99], a[28:31], v[220:223]
  s_waitcnt lgkmcnt(5)
  ds_read_b128 a[156:159], v14 offset:39936
  v_mfma_f32_16x16x32_bf16 v[224:227], v[100:103], a[16:19], v[224:227]
  ds_read_b64_tr_b16 v[96:97], v32 offset:0
  ds_read_b64_tr_b16 v[98:99], v32 offset:3584
  v_mfma_f32_16x16x32_bf16 v[228:231], v[100:103], a[20:23], v[228:231]
  v_mfma_f32_16x16x32_bf16 v[232:235], v[100:103], a[24:27], v[232:235]
  buffer_load_dwordx4 v70, s[12:15], s40 offen offset:2048 lds
  s_add_u32 s40, s40, 28672
  v_mfma_f32_16x16x32_bf16 v[236:239], v[100:103], a[28:31], v[236:239]
  s_waitcnt lgkmcnt(6)
  v_mfma_f32_16x16x32_bf16 v[128:131], v[104:107], a[32:35], v[128:131]
  ds_read_b64_tr_b16 v[100:101], v33 offset:0
  ds_read_b64_tr_b16 v[102:103], v33 offset:3584
  v_mfma_f32_16x16x32_bf16 v[132:135], v[104:107], a[36:39], v[132:135]
  s_waitcnt vmcnt(7)
  s_barrier
  v_mfma_f32_16x16x32_bf16 v[136:139], v[104:107], a[40:43], v[136:139]
  s_add_u32 m0, s42, 28672
  ds_read_b128 a[160:163], v14 offset:40960
  v_mfma_f32_16x16x32_bf16 v[140:143], v[104:107], a[44:47], v[140:143]
  buffer_load_dwordx4 v64, s[12:15], s40 offen offset:0 lds
  s_waitcnt lgkmcnt(6)
  v_mfma_f32_16x16x32_bf16 v[144:147], v[108:111], a[32:35], v[144:147]
  ds_read_b64_tr_b16 v[104:105], v34 offset:0
  ds_read_b64_tr_b16 v[106:107], v34 offset:3584
  v_mfma_f32_16x16x32_bf16 v[148:151], v[108:111], a[36:39], v[148:151]
  v_mfma_f32_16x16x32_bf16 v[152:155], v[108:111], a[40:43], v[152:155]
  buffer_load_dwordx4 v65, s[12:15], s40 offen offset:1024 lds
  v_mfma_f32_16x16x32_bf16 v[156:159], v[108:111], a[44:47], v[156:159]
  s_waitcnt lgkmcnt(5)
  v_mfma_f32_16x16x32_bf16 v[160:163], v[96:99], a[32:35], v[160:163]
  ds_read_b64_tr_b16 v[108:109], v35 offset:0
  ds_read_b64_tr_b16 v[110:111], v35 offset:3584
  v_mfma_f32_16x16x32_bf16 v[164:167], v[96:99], a[36:39], v[164:167]
  ds_read_b128 a[164:167], v14 offset:41984
  v_mfma_f32_16x16x32_bf16 v[168:171], v[96:99], a[40:43], v[168:171]
  buffer_load_dwordx4 v66, s[12:15], s40 offen offset:2048 lds
  v_mfma_f32_16x16x32_bf16 v[172:175], v[96:99], a[44:47], v[172:175]
  s_waitcnt lgkmcnt(6)
  v_mfma_f32_16x16x32_bf16 v[176:179], v[100:103], a[32:35], v[176:179]
  ds_read_b64_tr_b16 v[96:97], v36 offset:0
  ds_read_b64_tr_b16 v[98:99], v36 offset:3584
  v_mfma_f32_16x16x32_bf16 v[180:183], v[100:103], a[36:39], v[180:183]
  v_mfma_f32_16x16x32_bf16 v[184:187], v[100:103], a[40:43], v[184:187]
  buffer_load_dwordx4 v67, s[12:15], s40 offen offset:3072 lds
  v_mfma_f32_16x16x32_bf16 v[188:191], v[100:103], a[44:47], v[188:191]
  s_waitcnt lgkmcnt(5)
  v_mfma_f32_16x16x32_bf16 v[192:195], v[104:107], a[32:35], v[192:195]
  ds_read_b64_tr_b16 v[100:101], v23 offset:0
  ds_read_b64_tr_b16 v[102:103], v23 offset:3584
  ds_read_b128 a[168:171], v14 offset:43008
  v_mfma_f32_16x16x32_bf16 v[196:199], v[104:107], a[36:39], v[196:199]
  s_add_u32 m0, s42, 32768
  v_mfma_f32_16x16x32_bf16 v[200:203], v[104:107], a[40:43], v[200:203]
  buffer_load_dwordx4 v68, s[12:15], s40 offen offset:0 lds
  v_mfma_f32_16x16x32_bf16 v[204:207], v[104:107], a[44:47], v[204:207]
  s_waitcnt lgkmcnt(6)
  v_mfma_f32_16x16x32_bf16 v[208:211], v[108:111], a[32:35], v[208:211]
  ds_read_b64_tr_b16 v[104:105], v24 offset:0
  ds_read_b64_tr_b16 v[106:107], v24 offset:3584
  v_mfma_f32_16x16x32_bf16 v[212:215], v[108:111], a[36:39], v[212:215]
  v_mfma_f32_16x16x32_bf16 v[216:219], v[108:111], a[40:43], v[216:219]
  buffer_load_dwordx4 v69, s[12:15], s40 offen offset:1024 lds
  v_mfma_f32_16x16x32_bf16 v[220:223], v[108:111], a[44:47], v[220:223]
  s_waitcnt lgkmcnt(5)
  ds_read_b128 a[172:175], v14 offset:44032
  v_mfma_f32_16x16x32_bf16 v[224:227], v[96:99], a[32:35], v[224:227]
  ds_read_b64_tr_b16 v[108:109], v25 offset:0
  ds_read_b64_tr_b16 v[110:111], v25 offset:3584
  v_mfma_f32_16x16x32_bf16 v[228:231], v[96:99], a[36:39], v[228:231]
  v_mfma_f32_16x16x32_bf16 v[232:235], v[96:99], a[40:43], v[232:235]
  buffer_load_dwordx4 v70, s[12:15], s40 offen offset:2048 lds
  s_add_u32 s40, s40, 28672
  v_mfma_f32_16x16x32_bf16 v[236:239], v[96:99], a[44:47], v[236:239]
  s_waitcnt lgkmcnt(6)
  v_mfma_f32_16x16x32_bf16 v[128:131], v[100:103], a[48:51], v[128:131]
  ds_read_b64_tr_b16 v[96:97], v26 offset:0
  ds_read_b64_tr_b16 v[98:99], v26 offset:3584
  v_mfma_f32_16x16x32_bf16 v[132:135], v[100:103], a[52:55], v[132:135]
  s_waitcnt vmcnt(7)
  s_barrier
  v_mfma_f32_16x16x32_bf16 v[136:139], v[100:103], a[56:59], v[136:139]
  s_add_u32 m0, s42, 133120
  ds_read_b128 a[176:179], v14 offset:45056
  v_mfma_f32_16x16x32_bf16 v[140:143], v[100:103], a[60:63], v[140:143]
  buffer_load_dwordx4 v64, s[12:15], s40 offen offset:0 lds
  s_waitcnt lgkmcnt(6)
  v_mfma_f32_16x16x32_bf16 v[144:147], v[104:107], a[48:51], v[144:147]
  ds_read_b64_tr_b16 v[100:101], v27 offset:0
  ds_read_b64_tr_b16 v[102:103], v27 offset:3584
  v_mfma_f32_16x16x32_bf16 v[148:151], v[104:107], a[52:55], v[148:151]
  v_mfma_f32_16x16x32_bf16 v[152:155], v[104:107], a[56:59], v[152:155]
  buffer_load_dwordx4 v65, s[12:15], s40 offen offset:1024 lds
  v_mfma_f32_16x16x32_bf16 v[156:159], v[104:107], a[60:63], v[156:159]
  s_waitcnt lgkmcnt(5)
  v_mfma_f32_16x16x32_bf16 v[160:163], v[108:111], a[48:51], v[160:163]
  ds_read_b64_tr_b16 v[104:105], v28 offset:0
  ds_read_b64_tr_b16 v[106:107], v28 offset:3584
  v_mfma_f32_16x16x32_bf16 v[164:167], v[108:111], a[52:55], v[164:167]
  ds_read_b128 a[180:183], v14 offset:46080
  v_mfma_f32_16x16x32_bf16 v[168:171], v[108:111], a[56:59], v[168:171]
  buffer_load_dwordx4 v66, s[12:15], s40 offen offset:2048 lds
  v_mfma_f32_16x16x32_bf16 v[172:175], v[108:111], a[60:63], v[172:175]
  s_waitcnt lgkmcnt(6)
  v_mfma_f32_16x16x32_bf16 v[176:179], v[96:99], a[48:51], v[176:179]
  ds_read_b64_tr_b16 v[108:109], v29 offset:0
  ds_read_b64_tr_b16 v[110:111], v29 offset:3584
  v_mfma_f32_16x16x32_bf16 v[180:183], v[96:99], a[52:55], v[180:183]
  v_mfma_f32_16x16x32_bf16 v[184:187], v[96:99], a[56:59], v[184:187]
  buffer_load_dwordx4 v67, s[12:15], s40 offen offset:3072 lds
  v_mfma_f32_16x16x32_bf16 v[188:191], v[96:99], a[60:63], v[188:191]
  s_waitcnt lgkmcnt(5)
  v_mfma_f32_16x16x32_bf16 v[192:195], v[100:103], a[48:51], v[192:195]
  ds_read_b64_tr_b16 v[96:97], v16 offset:0
  ds_read_b64_tr_b16 v[98:99], v16 offset:3584
  ds_read_b128 a[184:187], v14 offset:47104
  v_mfma_f32_16x16x32_bf16 v[196:199], v[100:103], a[52:55], v[196:199]
  s_add_u32 m0, s42, 137216
  v_mfma_f32_16x16x32_bf16 v[200:203], v[100:103], a[56:59], v[200:203]
  buffer_load_dwordx4 v68, s[12:15], s40 offen offset:0 lds
  v_mfma_f32_16x16x32_bf16 v[204:207], v[100:103], a[60:63], v[204:207]
  s_waitcnt lgkmcnt(6)
  v_mfma_f32_16x16x32_bf16 v[208:211], v[104:107], a[48:51], v[208:211]
  ds_read_b64_tr_b16 v[100:101], v17 offset:0
  ds_read_b64_tr_b16 v[102:103], v17 offset:3584
  v_mfma_f32_16x16x32_bf16 v[212:215], v[104:107], a[52:55], v[212:215]
  v_mfma_f32_16x16x32_bf16 v[216:219], v[104:107], a[56:59], v[216:219]
  buffer_load_dwordx4 v69, s[12:15], s40 offen offset:1024 lds
  v_mfma_f32_16x16x32_bf16 v[220:223], v[104:107], a[60:63], v[220:223]
  s_waitcnt lgkmcnt(5)
  ds_read_b128 a[188:191], v14 offset:48128
  v_mfma_f32_16x16x32_bf16 v[224:227], v[108:111], a[48:51], v[224:227]
  ds_read_b64_tr_b16 v[104:105], v18 offset:0
  ds_read_b64_tr_b16 v[106:107], v18 offset:3584
  v_mfma_f32_16x16x32_bf16 v[228:231], v[108:111], a[52:55], v[228:231]
  v_mfma_f32_16x16x32_bf16 v[232:235], v[108:111], a[56:59], v[232:235]
  buffer_load_dwordx4 v70, s[12:15], s40 offen offset:2048 lds
  s_add_u32 s40, s40, 28672
  v_mfma_f32_16x16x32_bf16 v[236:239], v[108:111], a[60:63], v[236:239]
  s_waitcnt lgkmcnt(6)
  v_mfma_f32_16x16x32_bf16 v[128:131], v[96:99], a[64:67], v[128:131]
  ds_read_b64_tr_b16 v[108:109], v19 offset:0
  ds_read_b64_tr_b16 v[110:111], v19 offset:3584
  v_mfma_f32_16x16x32_bf16 v[132:135], v[96:99], a[68:71], v[132:135]
  s_waitcnt vmcnt(7)
  s_barrier
  v_mfma_f32_16x16x32_bf16 v[136:139], v[96:99], a[72:75], v[136:139]
  s_add_u32 m0, s42, 67584
  ds_read_b128 a[192:195], v14 offset:49152
  v_mfma_f32_16x16x32_bf16 v[140:143], v[96:99], a[76:79], v[140:143]
  buffer_load_dwordx4 v64, s[12:15], s40 offen offset:0 lds
  s_waitcnt lgkmcnt(6)
  v_mfma_f32_16x16x32_bf16 v[144:147], v[100:103], a[64:67], v[144:147]
  ds_read_b64_tr_b16 v[96:97], v20 offset:0
  ds_read_b64_tr_b16 v[98:99], v20 offset:3584
  v_mfma_f32_16x16x32_bf16 v[148:151], v[100:103], a[68:71], v[148:151]
  v_mfma_f32_16x16x32_bf16 v[152:155], v[100:103], a[72:75], v[152:155]
  buffer_load_dwordx4 v65, s[12:15], s40 offen offset:1024 lds
  v_mfma_f32_16x16x32_bf16 v[156:159], v[100:103], a[76:79], v[156:159]
  s_waitcnt lgkmcnt(5)
  v_mfma_f32_16x16x32_bf16 v[160:163], v[104:107], a[64:67], v[160:163]
  ds_read_b64_tr_b16 v[100:101], v21 offset:0
  ds_read_b64_tr_b16 v[102:103], v21 offset:3584
  v_mfma_f32_16x16x32_bf16 v[164:167], v[104:107], a[68:71], v[164:167]
  ds_read_b128 a[196:199], v14 offset:50176
  v_mfma_f32_16x16x32_bf16 v[168:171], v[104:107], a[72:75], v[168:171]
  buffer_load_dwordx4 v66, s[12:15], s40 offen offset:2048 lds
  v_mfma_f32_16x16x32_bf16 v[172:175], v[104:107], a[76:79], v[172:175]
  s_waitcnt lgkmcnt(6)
  v_mfma_f32_16x16x32_bf16 v[176:179], v[108:111], a[64:67], v[176:179]
  ds_read_b64_tr_b16 v[104:105], v22 offset:0
  ds_read_b64_tr_b16 v[106:107], v22 offset:3584
  v_mfma_f32_16x16x32_bf16 v[180:183], v[108:111], a[68:71], v[180:183]
  v_mfma_f32_16x16x32_bf16 v[184:187], v[108:111], a[72:75], v[184:187]
  buffer_load_dwordx4 v67, s[12:15], s40 offen offset:3072 lds
  v_mfma_f32_16x16x32_bf16 v[188:191], v[108:111], a[76:79], v[188:191]
  s_waitcnt lgkmcnt(5)
  v_mfma_f32_16x16x32_bf16 v[192:195], v[96:99], a[64:67], v[192:195]
  ds_read_b64_tr_b16 v[108:109], v16 offset:28672
  ds_read_b64_tr_b16 v[110:111], v16 offset:32256
  ds_read_b128 a[200:203], v14 offset:51200
  v_mfma_f32_16x16x32_bf16 v[196:199], v[96:99], a[68:71], v[196:199]
  s_add_u32 m0, s42, 71680
  v_mfma_f32_16x16x32_bf16 v[200:203], v[96:99], a[72:75], v[200:203]
  buffer_load_dwordx4 v68, s[12:15], s40 offen offset:0 lds
  v_mfma_f32_16x16x32_bf16 v[204:207], v[96:99], a[76:79], v[204:207]
  s_waitcnt lgkmcnt(6)
  v_mfma_f32_16x16x32_bf16 v[208:211], v[100:103], a[64:67], v[208:211]
  ds_read_b64_tr_b16 v[96:97], v17 offset:28672
  ds_read_b64_tr_b16 v[98:99], v17 offset:32256
  v_mfma_f32_16x16x32_bf16 v[212:215], v[100:103], a[68:71], v[212:215]
  v_mfma_f32_16x16x32_bf16 v[216:219], v[100:103], a[72:75], v[216:219]
  buffer_load_dwordx4 v69, s[12:15], s40 offen offset:1024 lds
  v_mfma_f32_16x16x32_bf16 v[220:223], v[100:103], a[76:79], v[220:223]
  s_waitcnt lgkmcnt(5)
  ds_read_b128 a[204:207], v14 offset:52224
  v_mfma_f32_16x16x32_bf16 v[224:227], v[104:107], a[64:67], v[224:227]
  ds_read_b64_tr_b16 v[100:101], v18 offset:28672
  ds_read_b64_tr_b16 v[102:103], v18 offset:32256
  v_mfma_f32_16x16x32_bf16 v[228:231], v[104:107], a[68:71], v[228:231]
  v_mfma_f32_16x16x32_bf16 v[232:235], v[104:107], a[72:75], v[232:235]
  buffer_load_dwordx4 v70, s[12:15], s40 offen offset:2048 lds
  s_add_u32 s40, s40, 28672
  v_mfma_f32_16x16x32_bf16 v[236:239], v[104:107], a[76:79], v[236:239]
  s_waitcnt lgkmcnt(6)
  v_mfma_f32_16x16x32_bf16 v[128:131], v[108:111], a[80:83], v[128:131]
  ds_read_b64_tr_b16 v[104:105], v19 offset:28672
  ds_read_b64_tr_b16 v[106:107], v19 offset:32256
  v_mfma_f32_16x16x32_bf16 v[132:135], v[108:111], a[84:87], v[132:135]
  s_waitcnt vmcnt(7)
  s_barrier
  v_mfma_f32_16x16x32_bf16 v[136:139], v[108:111], a[88:91], v[136:139]
  s_add_u32 m0, s42, 0
  ds_read_b128 a[208:211], v14 offset:53248
  v_mfma_f32_16x16x32_bf16 v[140:143], v[108:111], a[92:95], v[140:143]
  buffer_load_dwordx4 v64, s[12:15], s40 offen offset:0 lds
  s_waitcnt lgkmcnt(6)
  v_mfma_f32_16x16x32_bf16 v[144:147], v[96:99], a[80:83], v[144:147]
  ds_read_b64_tr_b16 v[108:109], v20 offset:28672
  ds_read_b64_tr_b16 v[110:111], v20 offset:32256
  v_mfma_f32_16x16x32_bf16 v[148:151], v[96:99], a[84:87], v[148:151]
  v_mfma_f32_16x16x32_bf16 v[152:155], v[96:99], a[88:91], v[152:155]
  buffer_load_dwordx4 v65, s[12:15], s40 offen offset:1024 lds
  v_mfma_f32_16x16x32_bf16 v[156:159], v[96:99], a[92:95], v[156:159]
  s_waitcnt lgkmcnt(5)
  v_mfma_f32_16x16x32_bf16 v[160:163], v[100:103], a[80:83], v[160:163]
  ds_read_b64_tr_b16 v[96:97], v21 offset:28672
  ds_read_b64_tr_b16 v[98:99], v21 offset:32256
  v_mfma_f32_16x16x32_bf16 v[164:167], v[100:103], a[84:87], v[164:167]
  ds_read_b128 a[212:215], v14 offset:54272
  v_mfma_f32_16x16x32_bf16 v[168:171], v[100:103], a[88:91], v[168:171]
  buffer_load_dwordx4 v66, s[12:15], s40 offen offset:2048 lds
  v_mfma_f32_16x16x32_bf16 v[172:175], v[100:103], a[92:95], v[172:175]
  s_waitcnt lgkmcnt(6)
  v_mfma_f32_16x16x32_bf16 v[176:179], v[104:107], a[80:83], v[176:179]
  ds_read_b64_tr_b16 v[100:101], v22 offset:28672
  ds_read_b64_tr_b16 v[102:103], v22 offset:32256
  v_mfma_f32_16x16x32_bf16 v[180:183], v[104:107], a[84:87], v[180:183]
  v_mfma_f32_16x16x32_bf16 v[184:187], v[104:107], a[88:91], v[184:187]
  buffer_load_dwordx4 v67, s[12:15], s40 offen offset:3072 lds
  v_mfma_f32_16x16x32_bf16 v[188:191], v[104:107], a[92:95], v[188:191]
  s_waitcnt lgkmcnt(5)
  v_mfma_f32_16x16x32_bf16 v[192:195], v[108:111], a[80:83], v[192:195]
  ds_read_b64_tr_b16 v[104:105], v30 offset:0
  ds_read_b64_tr_b16 v[106:107], v30 offset:3584
  ds_read_b128 a[216:219], v14 offset:55296
  v_mfma_f32_16x16x32_bf16 v[196:199], v[108:111], a[84:87], v[196:199]
  s_add_u32 m0, s42, 4096
  v_mfma_f32_16x16x32_bf16 v[200:203], v[108:111], a[88:91], v[200:203]
  buffer_load_dwordx4 v68, s[12:15], s40 offen offset:0 lds
  v_mfma_f32_16x16x32_bf16 v[204:207], v[108:111], a[92:95], v[204:207]
  s_waitcnt lgkmcnt(6)
  v_mfma_f32_16x16x32_bf16 v[208:211], v[96:99], a[80:83], v[208:211]
  ds_read_b64_tr_b16 v[108:109], v31 offset:0
  ds_read_b64_tr_b16 v[110:111], v31 offset:3584
  v_mfma_f32_16x16x32_bf16 v[212:215], v[96:99], a[84:87], v[212:215]
  v_mfma_f32_16x16x32_bf16 v[216:219], v[96:99], a[88:91], v[216:219]
  buffer_load_dwordx4 v69, s[12:15], s40 offen offset:1024 lds
  v_mfma_f32_16x16x32_bf16 v[220:223], v[96:99], a[92:95], v[220:223]
  s_waitcnt lgkmcnt(5)
  ds_read_b128 a[220:223], v14 offset:56320
  v_mfma_f32_16x16x32_bf16 v[224:227], v[100:103], a[80:83], v[224:227]
  ds_read_b64_tr_b16 v[96:97], v32 offset:0
  ds_read_b64_tr_b16 v[98:99], v32 offset:3584
  v_mfma_f32_16x16x32_bf16 v[228:231], v[100:103], a[84:87], v[228:231]
  v_mfma_f32_16x16x32_bf16 v[232:235], v[100:103], a[88:91], v[232:235]
  buffer_load_dwordx4 v70, s[12:15], s40 offen offset:2048 lds
  s_add_u32 s40, s40, 28672
  v_mfma_f32_16x16x32_bf16 v[236:239], v[100:103], a[92:95], v[236:239]
  s_waitcnt lgkmcnt(6)
  v_mfma_f32_16x16x32_bf16 v[128:131], v[104:107], a[96:99], v[128:131]
  ds_read_b64_tr_b16 v[100:101], v33 offset:0
  ds_read_b64_tr_b16 v[102:103], v33 offset:3584
  v_mfma_f32_16x16x32_bf16 v[132:135], v[104:107], a[100:103], v[132:135]
  s_waitcnt vmcnt(7)
  s_barrier
  v_mfma_f32_16x16x32_bf16 v[136:139], v[104:107], a[104:107], v[136:139]
  s_add_u32 m0, s42, 28672
  ds_read_b128 a[224:227], v14 offset:57344
  v_mfma_f32_16x16x32_bf16 v[140:143], v[104:107], a[108:111], v[140:143]
  buffer_load_dwordx4 v64, s[12:15], s40 offen offset:0 lds
  s_waitcnt lgkmcnt(6)
  v_mfma_f32_16x16x32_bf16 v[144:147], v[108:111], a[96:99], v[144:147]
  ds_read_b64_tr_b16 v[104:105], v34 offset:0
  ds_read_b64_tr_b16 v[106:107], v34 offset:3584
  v_mfma_f32_16x16x32_bf16 v[148:151], v[108:111], a[100:103], v[148:151]
  v_mfma_f32_16x16x32_bf16 v[152:155], v[108:111], a[104:107], v[152:155]
  buffer_load_dwordx4 v65, s[12:15], s40 offen offset:1024 lds
  v_mfma_f32_16x16x32_bf16 v[156:159], v[108:111], a[108:111], v[156:159]
  s_waitcnt lgkmcnt(5)
  v_mfma_f32_16x16x32_bf16 v[160:163], v[96:99], a[96:99], v[160:163]
  ds_read_b64_tr_b16 v[108:109], v35 offset:0
  ds_read_b64_tr_b16 v[110:111], v35 offset:3584
  v_mfma_f32_16x16x32_bf16 v[164:167], v[96:99], a[100:103], v[164:167]
  ds_read_b128 a[228:231], v14 offset:58368
  v_mfma_f32_16x16x32_bf16 v[168:171], v[96:99], a[104:107], v[168:171]
  buffer_load_dwordx4 v66, s[12:15], s40 offen offset:2048 lds
  v_mfma_f32_16x16x32_bf16 v[172:175], v[96:99], a[108:111], v[172:175]
  s_waitcnt lgkmcnt(6)
  v_mfma_f32_16x16x32_bf16 v[176:179], v[100:103], a[96:99], v[176:179]
  ds_read_b64_tr_b16 v[96:97], v36 offset:0
  ds_read_b64_tr_b16 v[98:99], v36 offset:3584
  v_mfma_f32_16x16x32_bf16 v[180:183], v[100:103], a[100:103], v[180:183]
  v_mfma_f32_16x16x32_bf16 v[184:187], v[100:103], a[104:107], v[184:187]
  buffer_load_dwordx4 v67, s[12:15], s40 offen offset:3072 lds
  v_mfma_f32_16x16x32_bf16 v[188:191], v[100:103], a[108:111], v[188:191]
  s_waitcnt lgkmcnt(5)
  v_mfma_f32_16x16x32_bf16 v[192:195], v[104:107], a[96:99], v[192:195]
  ds_read_b64_tr_b16 v[100:101], v23 offset:0
  ds_read_b64_tr_b16 v[102:103], v23 offset:3584
  ds_read_b128 a[232:235], v14 offset:59392
  v_mfma_f32_16x16x32_bf16 v[196:199], v[104:107], a[100:103], v[196:199]
  s_add_u32 m0, s42, 32768
  v_mfma_f32_16x16x32_bf16 v[200:203], v[104:107], a[104:107], v[200:203]
  buffer_load_dwordx4 v68, s[12:15], s40 offen offset:0 lds
  v_mfma_f32_16x16x32_bf16 v[204:207], v[104:107], a[108:111], v[204:207]
  s_waitcnt lgkmcnt(6)
  v_mfma_f32_16x16x32_bf16 v[208:211], v[108:111], a[96:99], v[208:211]
  ds_read_b64_tr_b16 v[104:105], v24 offset:0
  ds_read_b64_tr_b16 v[106:107], v24 offset:3584
  v_mfma_f32_16x16x32_bf16 v[212:215], v[108:111], a[100:103], v[212:215]
  v_mfma_f32_16x16x32_bf16 v[216:219], v[108:111], a[104:107], v[216:219]
  buffer_load_dwordx4 v69, s[12:15], s40 offen offset:1024 lds
  v_mfma_f32_16x16x32_bf16 v[220:223], v[108:111], a[108:111], v[220:223]
  s_waitcnt lgkmcnt(5)
  ds_read_b128 a[236:239], v14 offset:60416
  v_mfma_f32_16x16x32_bf16 v[224:227], v[96:99], a[96:99], v[224:227]
  ds_read_b64_tr_b16 v[108:109], v25 offset:0
  ds_read_b64_tr_b16 v[110:111], v25 offset:3584
  v_mfma_f32_16x16x32_bf16 v[228:231], v[96:99], a[100:103], v[228:231]
  v_mfma_f32_16x16x32_bf16 v[232:235], v[96:99], a[104:107], v[232:235]
  buffer_load_dwordx4 v70, s[12:15], s40 offen offset:2048 lds
  s_add_u32 s40, s40, 28672
  v_mfma_f32_16x16x32_bf16 v[236:239], v[96:99], a[108:111], v[236:239]
  s_waitcnt lgkmcnt(6)
  v_mfma_f32_16x16x32_bf16 v[128:131], v[100:103], a[112:115], v[128:131]
  ds_read_b64_tr_b16 v[96:97], v26 offset:0
  ds_read_b64_tr_b16 v[98:99], v26 offset:3584
  v_mfma_f32_16x16x32_bf16 v[132:135], v[100:103], a[116:119], v[132:135]
  s_waitcnt vmcnt(7)
  s_barrier
  v_mfma_f32_16x16x32_bf16 v[136:139], v[100:103], a[120:123], v[136:139]
  s_add_u32 m0, s42, 133120
  ds_read_b128 a[240:243], v14 offset:61440
  v_mfma_f32_16x16x32_bf16 v[140:143], v[100:103], a[124:127], v[140:143]
  buffer_load_dwordx4 v64, s[12:15], s40 offen offset:0 lds
  s_waitcnt lgkmcnt(6)
  v_mfma_f32_16x16x32_bf16 v[144:147], v[104:107], a[112:115], v[144:147]
  ds_read_b64_tr_b16 v[100:101], v27 offset:0
  ds_read_b64_tr_b16 v[102:103], v27 offset:3584
  v_mfma_f32_16x16x32_bf16 v[148:151], v[104:107], a[116:119], v[148:151]
  v_mfma_f32_16x16x32_bf16 v[152:155], v[104:107], a[120:123], v[152:155]
  buffer_load_dwordx4 v65, s[12:15], s40 offen offset:1024 lds
  v_mfma_f32_16x16x32_bf16 v[156:159], v[104:107], a[124:127], v[156:159]
  s_waitcnt lgkmcnt(5)
  v_mfma_f32_16x16x32_bf16 v[160:163], v[108:111], a[112:115], v[160:163]
  ds_read_b64_tr_b16 v[104:105], v28 offset:0
  ds_read_b64_tr_b16 v[106:107], v28 offset:3584
  v_mfma_f32_16x16x32_bf16 v[164:167], v[108:111], a[116:119], v[164:167]
  ds_read_b128 a[244:247], v14 offset:62464
  v_mfma_f32_16x16x32_bf16 v[168:171], v[108:111], a[120:123], v[168:171]
  buffer_load_dwordx4 v66, s[12:15], s40 offen offset:2048 lds
  v_mfma_f32_16x16x32_bf16 v[172:175], v[108:111], a[124:127], v[172:175]
  s_waitcnt lgkmcnt(6)
  v_mfma_f32_16x16x32_bf16 v[176:179], v[96:99], a[112:115], v[176:179]
  ds_read_b64_tr_b16 v[108:109], v29 offset:0
  ds_read_b64_tr_b16 v[110:111], v29 offset:3584
  v_mfma_f32_16x16x32_bf16 v[180:183], v[96:99], a[116:119], v[180:183]
  v_mfma_f32_16x16x32_bf16 v[184:187], v[96:99], a[120:123], v[184:187]
  buffer_load_dwordx4 v67, s[12:15], s40 offen offset:3072 lds
  v_mfma_f32_16x16x32_bf16 v[188:191], v[96:99], a[124:127], v[188:191]
  s_waitcnt lgkmcnt(5)
  v_mfma_f32_16x16x32_bf16 v[192:195], v[100:103], a[112:115], v[192:195]
  ds_read_b64_tr_b16 v[96:97], v16 offset:0
  ds_read_b64_tr_b16 v[98:99], v16 offset:3584
  ds_read_b128 a[248:251], v14 offset:63488
  v_mfma_f32_16x16x32_bf16 v[196:199], v[100:103], a[116:119], v[196:199]
  s_add_u32 m0, s42, 137216
  v_mfma_f32_16x16x32_bf16 v[200:203], v[100:103], a[120:123], v[200:203]
  buffer_load_dwordx4 v68, s[12:15], s40 offen offset:0 lds
  v_mfma_f32_16x16x32_bf16 v[204:207], v[100:103], a[124:127], v[204:207]
  s_waitcnt lgkmcnt(6)
  v_mfma_f32_16x16x32_bf16 v[208:211], v[104:107], a[112:115], v[208:211]
  ds_read_b64_tr_b16 v[100:101], v17 offset:0
  ds_read_b64_tr_b16 v[102:103], v17 offset:3584
  v_mfma_f32_16x16x32_bf16 v[212:215], v[104:107], a[116:119], v[212:215]
  v_mfma_f32_16x16x32_bf16 v[216:219], v[104:107], a[120:123], v[216:219]
  buffer_load_dwordx4 v69, s[12:15], s40 offen offset:1024 lds
  v_mfma_f32_16x16x32_bf16 v[220:223], v[104:107], a[124:127], v[220:223]
  s_waitcnt lgkmcnt(5)
  ds_read_b128 a[252:255], v14 offset:64512
  v_mfma_f32_16x16x32_bf16 v[224:227], v[108:111], a[112:115], v[224:227]
  ds_read_b64_tr_b16 v[104:105], v18 offset:0
  ds_read_b64_tr_b16 v[106:107], v18 offset:3584
  v_mfma_f32_16x16x32_bf16 v[228:231], v[108:111], a[116:119], v[228:231]
  v_mfma_f32_16x16x32_bf16 v[232:235], v[108:111], a[120:123], v[232:235]
  buffer_load_dwordx4 v70, s[12:15], s40 offen offset:2048 lds
  s_add_u32 s40, s40, 28672
  v_mfma_f32_16x16x32_bf16 v[236:239], v[108:111], a[124:127], v[236:239]
  s_waitcnt lgkmcnt(6)
  v_mfma_f32_16x16x32_bf16 v[128:131], v[96:99], a[128:131], v[128:131]
  ds_read_b64_tr_b16 v[108:109], v19 offset:0
  ds_read_b64_tr_b16 v[110:111], v19 offset:3584
  v_mfma_f32_16x16x32_bf16 v[132:135], v[96:99], a[132:135], v[132:135]
  s_waitcnt vmcnt(7)
  s_barrier
  v_mfma_f32_16x16x32_bf16 v[136:139], v[96:99], a[136:139], v[136:139]
  s_add_u32 m0, s42, 67584
  v_mfma_f32_16x16x32_bf16 v[140:143], v[96:99], a[140:143], v[140:143]
  buffer_load_dwordx4 v64, s[12:15], s40 offen offset:0 lds
  s_waitcnt lgkmcnt(5)
  v_mfma_f32_16x16x32_bf16 v[144:147], v[100:103], a[128:131], v[144:147]
  ds_read_b64_tr_b16 v[96:97], v20 offset:0
  ds_read_b64_tr_b16 v[98:99], v20 offset:3584
  v_mfma_f32_16x16x32_bf16 v[148:151], v[100:103], a[132:135], v[148:151]
  v_mfma_f32_16x16x32_bf16 v[152:155], v[100:103], a[136:139], v[152:155]
  buffer_load_dwordx4 v65, s[12:15], s40 offen offset:1024 lds
  v_mfma_f32_16x16x32_bf16 v[156:159], v[100:103], a[140:143], v[156:159]
  s_waitcnt lgkmcnt(4)
  v_mfma_f32_16x16x32_bf16 v[160:163], v[104:107], a[128:131], v[160:163]
  ds_read_b64_tr_b16 v[100:101], v21 offset:0
  ds_read_b64_tr_b16 v[102:103], v21 offset:3584
  v_mfma_f32_16x16x32_bf16 v[164:167], v[104:107], a[132:135], v[164:167]
  v_mfma_f32_16x16x32_bf16 v[168:171], v[104:107], a[136:139], v[168:171]
  buffer_load_dwordx4 v66, s[12:15], s40 offen offset:2048 lds
  v_mfma_f32_16x16x32_bf16 v[172:175], v[104:107], a[140:143], v[172:175]
  s_waitcnt lgkmcnt(4)
  v_mfma_f32_16x16x32_bf16 v[176:179], v[108:111], a[128:131], v[176:179]
  ds_read_b64_tr_b16 v[104:105], v22 offset:0
  ds_read_b64_tr_b16 v[106:107], v22 offset:3584
  v_mfma_f32_16x16x32_bf16 v[180:183], v[108:111], a[132:135], v[180:183]
  v_mfma_f32_16x16x32_bf16 v[184:187], v[108:111], a[136:139], v[184:187]
  buffer_load_dwordx4 v67, s[12:15], s40 offen offset:3072 lds
  v_mfma_f32_16x16x32_bf16 v[188:191], v[108:111], a[140:143], v[188:191]
  s_waitcnt lgkmcnt(4)
  v_mfma_f32_16x16x32_bf16 v[192:195], v[96:99], a[128:131], v[192:195]
  ds_read_b64_tr_b16 v[108:109], v16 offset:28672
  ds_read_b64_tr_b16 v[110:111], v16 offset:32256
  v_mfma_f32_16x16x32_bf16 v[196:199], v[96:99], a[132:135], v[196:199]
  s_add_u32 m0, s42, 71680
  v_mfma_f32_16x16x32_bf16 v[200:203], v[96:99], a[136:139], v[200:203]
  buffer_load_dwordx4 v68, s[12:15], s40 offen offset:0 lds
  v_mfma_f32_16x16x32_bf16 v[204:207], v[96:99], a[140:143], v[204:207]
  s_waitcnt lgkmcnt(4)
  v_mfma_f32_16x16x32_bf16 v[208:211], v[100:103], a[128:131], v[208:211]
  ds_read_b64_tr_b16 v[96:97], v17 offset:28672
  ds_read_b64_tr_b16 v[98:99], v17 offset:32256
  v_mfma_f32_16x16x32_bf16 v[212:215], v[100:103], a[132:135], v[212:215]
  v_mfma_f32_16x16x32_bf16 v[216:219], v[100:103], a[136:139], v[216:219]
  buffer_load_dwordx4 v69, s[12:15], s40 offen offset:1024 lds
  v_mfma_f32_16x16x32_bf16 v[220:223], v[100:103], a[140:143], v[220:223]
  s_waitcnt lgkmcnt(4)
  v_mfma_f32_16x16x32_bf16 v[224:227], v[104:107], a[128:131], v[224:227]
  ds_read_b64_tr_b16 v[100:101], v18 offset:28672
  ds_read_b64_tr_b16 v[102:103], v18 offset:32256
  v_mfma_f32_16x16x32_bf16 v[228:231], v[104:107], a[132:135], v[228:231]
  v_mfma_f32_16x16x32_bf16 v[232:235], v[104:107], a[136:139], v[232:235]
  buffer_load_dwordx4 v70, s[12:15], s40 offen offset:2048 lds
  s_add_u32 s40, s40, 28672
  v_mfma_f32_16x16x32_bf16 v[236:239], v[104:107], a[140:143], v[236:239]
  s_waitcnt lgkmcnt(4)
  v_mfma_f32_16x16x32_bf16 v[128:131], v[108:111], a[144:147], v[128:131]
  ds_read_b64_tr_b16 v[104:105], v19 offset:28672
  ds_read_b64_tr_b16 v[106:107], v19 offset:32256
  v_mfma_f32_16x16x32_bf16 v[132:135], v[108:111], a[148:151], v[132:135]
  s_waitcnt vmcnt(7)
  s_barrier
  v_mfma_f32_16x16x32_bf16 v[136:139], v[108:111], a[152:155], v[136:139]
  s_add_u32 m0, s42, 0
  v_mfma_f32_16x16x32_bf16 v[140:143], v[108:111], a[156:159], v[140:143]
  buffer_load_dwordx4 v64, s[12:15], s40 offen offset:0 lds
  s_waitcnt lgkmcnt(4)
  v_mfma_f32_16x16x32_bf16 v[144:147], v[96:99], a[144:147], v[144:147]
  ds_read_b64_tr_b16 v[108:109], v20 offset:28672
  ds_read_b64_tr_b16 v[110:111], v20 offset:32256
  v_mfma_f32_16x16x32_bf16 v[148:151], v[96:99], a[148:151], v[148:151]
  v_mfma_f32_16x16x32_bf16 v[152:155], v[96:99], a[152:155], v[152:155]
  buffer_load_dwordx4 v65, s[12:15], s40 offen offset:1024 lds
  v_mfma_f32_16x16x32_bf16 v[156:159], v[96:99], a[156:159], v[156:159]
  s_waitcnt lgkmcnt(4)
  v_mfma_f32_16x16x32_bf16 v[160:163], v[100:103], a[144:147], v[160:163]
  ds_read_b64_tr_b16 v[96:97], v21 offset:28672
  ds_read_b64_tr_b16 v[98:99], v21 offset:32256
  v_mfma_f32_16x16x32_bf16 v[164:167], v[100:103], a[148:151], v[164:167]
  v_mfma_f32_16x16x32_bf16 v[168:171], v[100:103], a[152:155], v[168:171]
  buffer_load_dwordx4 v66, s[12:15], s40 offen offset:2048 lds
  v_mfma_f32_16x16x32_bf16 v[172:175], v[100:103], a[156:159], v[172:175]
  s_waitcnt lgkmcnt(4)
  v_mfma_f32_16x16x32_bf16 v[176:179], v[104:107], a[144:147], v[176:179]
  ds_read_b64_tr_b16 v[100:101], v22 offset:28672
  ds_read_b64_tr_b16 v[102:103], v22 offset:32256
  v_mfma_f32_16x16x32_bf16 v[180:183], v[104:107], a[148:151], v[180:183]
  v_mfma_f32_16x16x32_bf16 v[184:187], v[104:107], a[152:155], v[184:187]
  buffer_load_dwordx4 v67, s[12:15], s40 offen offset:3072 lds
  v_mfma_f32_16x16x32_bf16 v[188:191], v[104:107], a[156:159], v[188:191]
  s_waitcnt lgkmcnt(4)
  v_mfma_f32_16x16x32_bf16 v[192:195], v[108:111], a[144:147], v[192:195]
  ds_read_b64_tr_b16 v[104:105], v30 offset:0
  ds_read_b64_tr_b16 v[106:107], v30 offset:3584
  v_mfma_f32_16x16x32_bf16 v[196:199], v[108:111], a[148:151], v[196:199]
  s_add_u32 m0, s42, 4096
  v_mfma_f32_16x16x32_bf16 v[200:203], v[108:111], a[152:155], v[200:203]
  buffer_load_dwordx4 v68, s[12:15], s40 offen offset:0 lds
  v_mfma_f32_16x16x32_bf16 v[204:207], v[108:111], a[156:159], v[204:207]
  s_waitcnt lgkmcnt(4)
  v_mfma_f32_16x16x32_bf16 v[208:211], v[96:99], a[144:147], v[208:211]
  ds_read_b64_tr_b16 v[108:109], v31 offset:0
  ds_read_b64_tr_b16 v[110:111], v31 offset:3584
  v_mfma_f32_16x16x32_bf16 v[212:215], v[96:99], a[148:151], v[212:215]
  v_mfma_f32_16x16x32_bf16 v[216:219], v[96:99], a[152:155], v[216:219]
  buffer_load_dwordx4 v69, s[12:15], s40 offen offset:1024 lds
  v_mfma_f32_16x16x32_bf16 v[220:223], v[96:99], a[156:159], v[220:223]
  s_waitcnt lgkmcnt(4)
  v_mfma_f32_16x16x32_bf16 v[224:227], v[100:103], a[144:147], v[224:227]
  ds_read_b64_tr_b16 v[96:97], v32 offset:0
  ds_read_b64_tr_b16 v[98:99], v32 offset:3584
  v_mfma_f32_16x16x32_bf16 v[228:231], v[100:103], a[148:151], v[228:231]
  v_mfma_f32_16x16x32_bf16 v[232:235], v[100:103], a[152:155], v[232:235]
  buffer_load_dwordx4 v70, s[12:15], s40 offen offset:2048 lds
  s_add_u32 s40, s40, 28672
  v_mfma_f32_16x16x32_bf16 v[236:239], v[100:103], a[156:159], v[236:239]
  s_waitcnt lgkmcnt(4)
  v_mfma_f32_16x16x32_bf16 v[128:131], v[104:107], a[160:163], v[128:131]
  ds_read_b64_tr_b16 v[100:101], v33 offset:0
  ds_read_b64_tr_b16 v[102:103], v33 offset:3584
  v_mfma_f32_16x16x32_bf16 v[132:135], v[104:107], a[164:167], v[132:135]
  s_waitcnt vmcnt(7)
  s_barrier
  v_mfma_f32_16x16x32_bf16 v[136:139], v[104:107], a[168:171], v[136:139]
  s_add_u32 m0, s42, 28672
  v_mfma_f32_16x16x32_bf16 v[140:143], v[104:107], a[172:175], v[140:143]
  buffer_load_dwordx4 v64, s[12:15], s40 offen offset:0 lds
  s_waitcnt lgkmcnt(4)
  v_mfma_f32_16x16x32_bf16 v[144:147], v[108:111], a[160:163], v[144:147]
  ds_read_b64_tr_b16 v[104:105], v34 offset:0
  ds_read_b64_tr_b16 v[106:107], v34 offset:3584
  v_mfma_f32_16x16x32_bf16 v[148:151], v[108:111], a[164:167], v[148:151]
  v_mfma_f32_16x16x32_bf16 v[152:155], v[108:111], a[168:171], v[152:155]
  buffer_load_dwordx4 v65, s[12:15], s40 offen offset:1024 lds
  v_mfma_f32_16x16x32_bf16 v[156:159], v[108:111], a[172:175], v[156:159]
  s_waitcnt lgkmcnt(4)
  v_mfma_f32_16x16x32_bf16 v[160:163], v[96:99], a[160:163], v[160:163]
  ds_read_b64_tr_b16 v[108:109], v35 offset:0
  ds_read_b64_tr_b16 v[110:111], v35 offset:3584
  v_mfma_f32_16x16x32_bf16 v[164:167], v[96:99], a[164:167], v[164:167]
  v_mfma_f32_16x16x32_bf16 v[168:171], v[96:99], a[168:171], v[168:171]
  buffer_load_dwordx4 v66, s[12:15], s40 offen offset:2048 lds
  v_mfma_f32_16x16x32_bf16 v[172:175], v[96:99], a[172:175], v[172:175]
  s_waitcnt lgkmcnt(4)
  v_mfma_f32_16x16x32_bf16 v[176:179], v[100:103], a[160:163], v[176:179]
  ds_read_b64_tr_b16 v[96:97], v36 offset:0
  ds_read_b64_tr_b16 v[98:99], v36 offset:3584
  v_mfma_f32_16x16x32_bf16 v[180:183], v[100:103], a[164:167], v[180:183]
  v_mfma_f32_16x16x32_bf16 v[184:187], v[100:103], a[168:171], v[184:187]
  buffer_load_dwordx4 v67, s[12:15], s40 offen offset:3072 lds
  v_mfma_f32_16x16x32_bf16 v[188:191], v[100:103], a[172:175], v[188:191]
  s_waitcnt lgkmcnt(4)
  v_mfma_f32_16x16x32_bf16 v[192:195], v[104:107], a[160:163], v[192:195]
  ds_read_b64_tr_b16 v[100:101], v23 offset:0
  ds_read_b64_tr_b16 v[102:103], v23 offset:3584
  v_mfma_f32_16x16x32_bf16 v[196:199], v[104:107], a[164:167], v[196:199]
  s_add_u32 m0, s42, 32768
  v_mfma_f32_16x16x32_bf16 v[200:203], v[104:107], a[168:171], v[200:203]
  buffer_load_dwordx4 v68, s[12:15], s40 offen offset:0 lds
  v_mfma_f32_16x16x32_bf16 v[204:207], v[104:107], a[172:175], v[204:207]
  s_waitcnt lgkmcnt(4)
  v_mfma_f32_16x16x32_bf16 v[208:211], v[108:111], a[160:163], v[208:211]
  ds_read_b64_tr_b16 v[104:105], v24 offset:0
  ds_read_b64_tr_b16 v[106:107], v24 offset:3584
  v_mfma_f32_16x16x32_bf16 v[212:215], v[108:111], a[164:167], v[212:215]
  v_mfma_f32_16x16x32_bf16 v[216:219], v[108:111], a[168:171], v[216:219]
  buffer_load_dwordx4 v69, s[12:15], s40 offen offset:1024 lds
  v_mfma_f32_16x16x32_bf16 v[220:223], v[108:111], a[172:175], v[220:223]
  s_waitcnt lgkmcnt(4)
  v_mfma_f32_16x16x32_bf16 v[224:227], v[96:99], a[160:163], v[224:227]
  ds_read_b64_tr_b16 v[108:109], v25 offset:0
  ds_read_b64_tr_b16 v[110:111], v25 offset:3584
  v_mfma_f32_16x16x32_bf16 v[228:231], v[96:99], a[164:167], v[228:231]
  v_mfma_f32_16x16x32_bf16 v[232:235], v[96:99], a[168:171], v[232:235]
  buffer_load_dwordx4 v70, s[12:15], s40 offen offset:2048 lds
  s_add_u32 s40, s40, 28672
  v_mfma_f32_16x16x32_bf16 v[236:239], v[96:99], a[172:175], v[236:239]
  s_waitcnt lgkmcnt(4)
  v_mfma_f32_16x16x32_bf16 v[128:131], v[100:103], a[176:179], v[128:131]
  ds_read_b64_tr_b16 v[96:97], v26 offset:0
  ds_read_b64_tr_b16 v[98:99], v26 offset:3584
  v_mfma_f32_16x16x32_bf16 v[132:135], v[100:103], a[180:183], v[132:135]
  s_waitcnt vmcnt(7)
  s_barrier
  v_mfma_f32_16x16x32_bf16 v[136:139], v[100:103], a[184:187], v[136:139]
  s_add_u32 m0, s42, 133120
  v_mfma_f32_16x16x32_bf16 v[140:143], v[100:103], a[188:191], v[140:143]
  buffer_load_dwordx4 v64, s[12:15], s40 offen offset:0 lds
  s_waitcnt lgkmcnt(4)
  v_mfma_f32_16x16x32_bf16 v[144:147], v[104:107], a[176:179], v[144:147]
  ds_read_b64_tr_b16 v[100:101], v27 offset:0
  ds_read_b64_tr_b16 v[102:103], v27 offset:3584
  v_mfma_f32_16x16x32_bf16 v[148:151], v[104:107], a[180:183], v[148:151]
  v_mfma_f32_16x16x32_bf16 v[152:155], v[104:107], a[184:187], v[152:155]
  buffer_load_dwordx4 v65, s[12:15], s40 offen offset:1024 lds
  v_mfma_f32_16x16x32_bf16 v[156:159], v[104:107], a[188:191], v[156:159]
  s_waitcnt lgkmcnt(4)
  v_mfma_f32_16x16x32_bf16 v[160:163], v[108:111], a[176:179], v[160:163]
  ds_read_b64_tr_b16 v[104:105], v28 offset:0
  ds_read_b64_tr_b16 v[106:107], v28 offset:3584
  v_mfma_f32_16x16x32_bf16 v[164:167], v[108:111], a[180:183], v[164:167]
  v_mfma_f32_16x16x32_bf16 v[168:171], v[108:111], a[184:187], v[168:171]
  buffer_load_dwordx4 v66, s[12:15], s40 offen offset:2048 lds
  v_mfma_f32_16x16x32_bf16 v[172:175], v[108:111], a[188:191], v[172:175]
  s_waitcnt lgkmcnt(4)
  v_mfma_f32_16x16x32_bf16 v[176:179], v[96:99], a[176:179], v[176:179]
  ds_read_b64_tr_b16 v[108:109], v29 offset:0
  ds_read_b64_tr_b16 v[110:111], v29 offset:3584
  v_mfma_f32_16x16x32_bf16 v[180:183], v[96:99], a[180:183], v[180:183]
  v_mfma_f32_16x16x32_bf16 v[184:187], v[96:99], a[184:187], v[184:187]
  buffer_load_dwordx4 v67, s[12:15], s40 offen offset:3072 lds
  v_mfma_f32_16x16x32_bf16 v[188:191], v[96:99], a[188:191], v[188:191]
  s_waitcnt lgkmcnt(4)
  v_mfma_f32_16x16x32_bf16 v[192:195], v[100:103], a[176:179], v[192:195]
  ds_read_b64_tr_b16 v[96:97], v16 offset:0
  ds_read_b64_tr_b16 v[98:99], v16 offset:3584
  v_mfma_f32_16x16x32_bf16 v[196:199], v[100:103], a[180:183], v[196:199]
  s_add_u32 m0, s42, 137216
  v_mfma_f32_16x16x32_bf16 v[200:203], v[100:103], a[184:187], v[200:203]
  buffer_load_dwordx4 v68, s[12:15], s40 offen offset:0 lds
  v_mfma_f32_16x16x32_bf16 v[204:207], v[100:103], a[188:191], v[204:207]
  s_waitcnt lgkmcnt(4)
  v_mfma_f32_16x16x32_bf16 v[208:211], v[104:107], a[176:179], v[208:211]
  ds_read_b64_tr_b16 v[100:101], v17 offset:0
  ds_read_b64_tr_b16 v[102:103], v17 offset:3584
  v_mfma_f32_16x16x32_bf16 v[212:215], v[104:107], a[180:183], v[212:215]
  v_mfma_f32_16x16x32_bf16 v[216:219], v[104:107], a[184:187], v[216:219]
  buffer_load_dwordx4 v69, s[12:15], s40 offen offset:1024 lds
  v_mfma_f32_16x16x32_bf16 v[220:223], v[104:107], a[188:191], v[220:223]
  s_waitcnt lgkmcnt(4)
  v_mfma_f32_16x16x32_bf16 v[224:227], v[108:111], a[176:179], v[224:227]
  ds_read_b64_tr_b16 v[104:105], v18 offset:0
  ds_read_b64_tr_b16 v[106:107], v18 offset:3584
  v_mfma_f32_16x16x32_bf16 v[228:231], v[108:111], a[180:183], v[228:231]
  v_mfma_f32_16x16x32_bf16 v[232:235], v[108:111], a[184:187], v[232:235]
  buffer_load_dwordx4 v70, s[12:15], s40 offen offset:2048 lds
  s_add_u32 s40, s40, 28672
  v_mfma_f32_16x16x32_bf16 v[236:239], v[108:111], a[188:191], v[236:239]
  s_waitcnt lgkmcnt(4)
  v_mfma_f32_16x16x32_bf16 v[128:131], v[96:99], a[192:195], v[128:131]
  ds_read_b64_tr_b16 v[108:109], v19 offset:0
  ds_read_b64_tr_b16 v[110:111], v19 offset:3584
  v_mfma_f32_16x16x32_bf16 v[132:135], v[96:99], a[196:199], v[132:135]
  s_waitcnt vmcnt(7)
  s_barrier
  v_mfma_f32_16x16x32_bf16 v[136:139], v[96:99], a[200:203], v[136:139]
  s_add_u32 m0, s42, 67584
  v_mfma_f32_16x16x32_bf16 v[140:143], v[96:99], a[204:207], v[140:143]
  buffer_load_dwordx4 v64, s[12:15], s40 offen offset:0 lds
  s_waitcnt lgkmcnt(4)
  v_mfma_f32_16x16x32_bf16 v[144:147], v[100:103], a[192:195], v[144:147]
  ds_read_b64_tr_b16 v[96:97], v20 offset:0
  ds_read_b64_tr_b16 v[98:99], v20 offset:3584
  v_mfma_f32_16x16x32_bf16 v[148:151], v[100:103], a[196:199], v[148:151]
  v_mfma_f32_16x16x32_bf16 v[152:155], v[100:103], a[200:203], v[152:155]
  buffer_load_dwordx4 v65, s[12:15], s40 offen offset:1024 lds
  v_mfma_f32_16x16x32_bf16 v[156:159], v[100:103], a[204:207], v[156:159]
  s_waitcnt lgkmcnt(4)
  v_mfma_f32_16x16x32_bf16 v[160:163], v[104:107], a[192:195], v[160:163]
  ds_read_b64_tr_b16 v[100:101], v21 offset:0
  ds_read_b64_tr_b16 v[102:103], v21 offset:3584
  v_mfma_f32_16x16x32_bf16 v[164:167], v[104:107], a[196:199], v[164:167]
  v_mfma_f32_16x16x32_bf16 v[168:171], v[104:107], a[200:203], v[168:171]
  buffer_load_dwordx4 v66, s[12:15], s40 offen offset:2048 lds
  v_mfma_f32_16x16x32_bf16 v[172:175], v[104:107], a[204:207], v[172:175]
  s_waitcnt lgkmcnt(4)
  v_mfma_f32_16x16x32_bf16 v[176:179], v[108:111], a[192:195], v[176:179]
  ds_read_b64_tr_b16 v[104:105], v22 offset:0
  ds_read_b64_tr_b16 v[106:107], v22 offset:3584
  v_mfma_f32_16x16x32_bf16 v[180:183], v[108:111], a[196:199], v[180:183]
  v_mfma_f32_16x16x32_bf16 v[184:187], v[108:111], a[200:203], v[184:187]
  buffer_load_dwordx4 v67, s[12:15], s40 offen offset:3072 lds
  v_mfma_f32_16x16x32_bf16 v[188:191], v[108:111], a[204:207], v[188:191]
  s_waitcnt lgkmcnt(4)
  v_mfma_f32_16x16x32_bf16 v[192:195], v[96:99], a[192:195], v[192:195]
  ds_read_b64_tr_b16 v[108:109], v16 offset:28672
  ds_read_b64_tr_b16 v[110:111], v16 offset:32256
  v_mfma_f32_16x16x32_bf16 v[196:199], v[96:99], a[196:199], v[196:199]
  s_add_u32 m0, s42, 71680
  v_mfma_f32_16x16x32_bf16 v[200:203], v[96:99], a[200:203], v[200:203]
  buffer_load_dwordx4 v68, s[12:15], s40 offen offset:0 lds
  v_mfma_f32_16x16x32_bf16 v[204:207], v[96:99], a[204:207], v[204:207]
  s_waitcnt lgkmcnt(4)
  v_mfma_f32_16x16x32_bf16 v[208:211], v[100:103], a[192:195], v[208:211]
  ds_read_b64_tr_b16 v[96:97], v17 offset:28672
  ds_read_b64_tr_b16 v[98:99], v17 offset:32256
  v_mfma_f32_16x16x32_bf16 v[212:215], v[100:103], a[196:199], v[212:215]
  v_mfma_f32_16x16x32_bf16 v[216:219], v[100:103], a[200:203], v[216:219]
  buffer_load_dwordx4 v69, s[12:15], s40 offen offset:1024 lds
  v_mfma_f32_16x16x32_bf16 v[220:223], v[100:103], a[204:207], v[220:223]
  s_waitcnt lgkmcnt(4)
  v_mfma_f32_16x16x32_bf16 v[224:227], v[104:107], a[192:195], v[224:227]
  ds_read_b64_tr_b16 v[100:101], v18 offset:28672
  ds_read_b64_tr_b16 v[102:103], v18 offset:32256
  v_mfma_f32_16x16x32_bf16 v[228:231], v[104:107], a[196:199], v[228:231]
  v_mfma_f32_16x16x32_bf16 v[232:235], v[104:107], a[200:203], v[232:235]
  buffer_load_dwordx4 v70, s[12:15], s40 offen offset:2048 lds
  s_add_u32 s40, s40, 28672
  v_mfma_f32_16x16x32_bf16 v[236:239], v[104:107], a[204:207], v[236:239]
  s_waitcnt lgkmcnt(4)
  v_mfma_f32_16x16x32_bf16 v[128:131], v[108:111], a[208:211], v[128:131]
  ds_read_b64_tr_b16 v[104:105], v19 offset:28672
  ds_read_b64_tr_b16 v[106:107], v19 offset:32256
  v_mfma_f32_16x16x32_bf16 v[132:135], v[108:111], a[212:215], v[132:135]
  s_waitcnt vmcnt(7)
  s_barrier
  v_mfma_f32_16x16x32_bf16 v[136:139], v[108:111], a[216:219], v[136:139]
  v_mfma_f32_16x16x32_bf16 v[140:143], v[108:111], a[220:223], v[140:143]
  s_waitcnt lgkmcnt(4)
  v_mfma_f32_16x16x32_bf16 v[144:147], v[96:99], a[208:211], v[144:147]
  ds_read_b64_tr_b16 v[108:109], v20 offset:28672
  ds_read_b64_tr_b16 v[110:111], v20 offset:32256
  v_mfma_f32_16x16x32_bf16 v[148:151], v[96:99], a[212:215], v[148:151]
  v_mfma_f32_16x16x32_bf16 v[152:155], v[96:99], a[216:219], v[152:155]
  v_mfma_f32_16x16x32_bf16 v[156:159], v[96:99], a[220:223], v[156:159]
  s_waitcnt lgkmcnt(4)
  v_mfma_f32_16x16x32_bf16 v[160:163], v[100:103], a[208:211], v[160:163]
  ds_read_b64_tr_b16 v[96:97], v21 offset:28672
  ds_read_b64_tr_b16 v[98:99], v21 offset:32256
  v_mfma_f32_16x16x32_bf16 v[164:167], v[100:103], a[212:215], v[164:167]
  v_mfma_f32_16x16x32_bf16 v[168:171], v[100:103], a[216:219], v[168:171]
  v_mfma_f32_16x16x32_bf16 v[172:175], v[100:103], a[220:223], v[172:175]
  s_waitcnt lgkmcnt(4)
  v_mfma_f32_16x16x32_bf16 v[176:179], v[104:107], a[208:211], v[176:179]
  ds_read_b64_tr_b16 v[100:101], v22 offset:28672
  ds_read_b64_tr_b16 v[102:103], v22 offset:32256
  v_mfma_f32_16x16x32_bf16 v[180:183], v[104:107], a[212:215], v[180:183]
  v_mfma_f32_16x16x32_bf16 v[184:187], v[104:107], a[216:219], v[184:187]
  v_mfma_f32_16x16x32_bf16 v[188:191], v[104:107], a[220:223], v[188:191]
  s_waitcnt lgkmcnt(4)
  v_mfma_f32_16x16x32_bf16 v[192:195], v[108:111], a[208:211], v[192:195]
  ds_read_b64_tr_b16 v[104:105], v30 offset:0
  ds_read_b64_tr_b16 v[106:107], v30 offset:3584
  v_mfma_f32_16x16x32_bf16 v[196:199], v[108:111], a[212:215], v[196:199]
  v_mfma_f32_16x16x32_bf16 v[200:203], v[108:111], a[216:219], v[200:203]
  v_mfma_f32_16x16x32_bf16 v[204:207], v[108:111], a[220:223], v[204:207]
  s_waitcnt lgkmcnt(4)
  v_mfma_f32_16x16x32_bf16 v[208:211], v[96:99], a[208:211], v[208:211]
  ds_read_b64_tr_b16 v[108:109], v31 offset:0
  ds_read_b64_tr_b16 v[110:111], v31 offset:3584
  v_mfma_f32_16x16x32_bf16 v[212:215], v[96:99], a[212:215], v[212:215]
  v_mfma_f32_16x16x32_bf16 v[216:219], v[96:99], a[216:219], v[216:219]
  v_mfma_f32_16x16x32_bf16 v[220:223], v[96:99], a[220:223], v[220:223]
  s_waitcnt lgkmcnt(4)
  v_mfma_f32_16x16x32_bf16 v[224:227], v[100:103], a[208:211], v[224:227]
  ds_read_b64_tr_b16 v[96:97], v32 offset:0
  ds_read_b64_tr_b16 v[98:99], v32 offset:3584
  v_mfma_f32_16x16x32_bf16 v[228:231], v[100:103], a[212:215], v[228:231]
  v_mfma_f32_16x16x32_bf16 v[232:235], v[100:103], a[216:219], v[232:235]
  v_mfma_f32_16x16x32_bf16 v[236:239], v[100:103], a[220:223], v[236:239]
  s_waitcnt lgkmcnt(4)
  v_mfma_f32_16x16x32_bf16 v[128:131], v[104:107], a[224:227], v[128:131]
  ds_read_b64_tr_b16 v[100:101], v33 offset:0
  ds_read_b64_tr_b16 v[102:103], v33 offset:3584
  v_mfma_f32_16x16x32_bf16 v[132:135], v[104:107], a[228:231], v[132:135]
  s_waitcnt vmcnt(0)
  s_barrier
  v_mfma_f32_16x16x32_bf16 v[136:139], v[104:107], a[232:235], v[136:139]
  v_mfma_f32_16x16x32_bf16 v[140:143], v[104:107], a[236:239], v[140:143]
  s_waitcnt lgkmcnt(4)
  v_mfma_f32_16x16x32_bf16 v[144:147], v[108:111], a[224:227], v[144:147]
  ds_read_b64_tr_b16 v[104:105], v34 offset:0
  ds_read_b64_tr_b16 v[106:107], v34 offset:3584
  v_mfma_f32_16x16x32_bf16 v[148:151], v[108:111], a[228:231], v[148:151]
  v_mfma_f32_16x16x32_bf16 v[152:155], v[108:111], a[232:235], v[152:155]
  v_mfma_f32_16x16x32_bf16 v[156:159], v[108:111], a[236:239], v[156:159]
  s_waitcnt lgkmcnt(4)
  v_mfma_f32_16x16x32_bf16 v[160:163], v[96:99], a[224:227], v[160:163]
  ds_read_b64_tr_b16 v[108:109], v35 offset:0
  ds_read_b64_tr_b16 v[110:111], v35 offset:3584
  v_mfma_f32_16x16x32_bf16 v[164:167], v[96:99], a[228:231], v[164:167]
  v_mfma_f32_16x16x32_bf16 v[168:171], v[96:99], a[232:235], v[168:171]
  v_mfma_f32_16x16x32_bf16 v[172:175], v[96:99], a[236:239], v[172:175]
  s_waitcnt lgkmcnt(4)
  v_mfma_f32_16x16x32_bf16 v[176:179], v[100:103], a[224:227], v[176:179]
  ds_read_b64_tr_b16 v[96:97], v36 offset:0
  ds_read_b64_tr_b16 v[98:99], v36 offset:3584
  v_mfma_f32_16x16x32_bf16 v[180:183], v[100:103], a[228:231], v[180:183]
  v_mfma_f32_16x16x32_bf16 v[184:187], v[100:103], a[232:235], v[184:187]
  v_mfma_f32_16x16x32_bf16 v[188:191], v[100:103], a[236:239], v[188:191]
  s_waitcnt lgkmcnt(4)
  v_mfma_f32_16x16x32_bf16 v[192:195], v[104:107], a[224:227], v[192:195]
  ds_read_b64_tr_b16 v[100:101], v23 offset:0
  ds_read_b64_tr_b16 v[102:103], v23 offset:3584
  v_mfma_f32_16x16x32_bf16 v[196:199], v[104:107], a[228:231], v[196:199]
  v_mfma_f32_16x16x32_bf16 v[200:203], v[104:107], a[232:235], v[200:203]
  v_mfma_f32_16x16x32_bf16 v[204:207], v[104:107], a[236:239], v[204:207]
  s_waitcnt lgkmcnt(4)
  v_mfma_f32_16x16x32_bf16 v[208:211], v[108:111], a[224:227], v[208:211]
  ds_read_b64_tr_b16 v[104:105], v24 offset:0
  ds_read_b64_tr_b16 v[106:107], v24 offset:3584
  v_mfma_f32_16x16x32_bf16 v[212:215], v[108:111], a[228:231], v[212:215]
  v_mfma_f32_16x16x32_bf16 v[216:219], v[108:111], a[232:235], v[216:219]
  v_mfma_f32_16x16x32_bf16 v[220:223], v[108:111], a[236:239], v[220:223]
  s_waitcnt lgkmcnt(4)
  v_mfma_f32_16x16x32_bf16 v[224:227], v[96:99], a[224:227], v[224:227]
  ds_read_b64_tr_b16 v[108:109], v25 offset:0
  ds_read_b64_tr_b16 v[110:111], v25 offset:3584
  v_mfma_f32_16x16x32_bf16 v[228:231], v[96:99], a[228:231], v[228:231]
  v_mfma_f32_16x16x32_bf16 v[232:235], v[96:99], a[232:235], v[232:235]
  v_mfma_f32_16x16x32_bf16 v[236:239], v[96:99], a[236:239], v[236:239]
  s_waitcnt lgkmcnt(4)
  v_mfma_f32_16x16x32_bf16 v[128:131], v[100:103], a[240:243], v[128:131]
  ds_read_b64_tr_b16 v[96:97], v26 offset:0
  ds_read_b64_tr_b16 v[98:99], v26 offset:3584
  v_mfma_f32_16x16x32_bf16 v[132:135], v[100:103], a[244:247], v[132:135]
  v_mfma_f32_16x16x32_bf16 v[136:139], v[100:103], a[248:251], v[136:139]
  s_cmp_eq_u32 s22, 1
  s_cselect_b32 s4, s62, s60
  s_cselect_b32 s5, s63, s61
  v_mfma_f32_16x16x32_bf16 v[140:143], v[100:103], a[252:255], v[140:143]
  s_cmp_ge_u32 s22, 2
  s_cselect_b32 s4, s64, s4
  s_cselect_b32 s5, s65, s5
  s_waitcnt lgkmcnt(4)
  v_mfma_f32_16x16x32_bf16 v[144:147], v[104:107], a[240:243], v[144:147]
  s_mov_b32 s6, 1605632
  s_mov_b32 s7, 0x20000
  ds_read_b64_tr_b16 v[100:101], v27 offset:0
  ds_read_b64_tr_b16 v[102:103], v27 offset:3584
  v_mfma_f32_16x16x32_bf16 v[148:151], v[104:107], a[244:247], v[148:151]
  s_mul_i32 s38, s2, 6272
  v_lshlrev_b32 v4, 7, v0
  v_mfma_f32_16x16x32_bf16 v[152:155], v[104:107], a[248:251], v[152:155]
  v_mfma_f32_16x16x32_bf16 v[156:159], v[104:107], a[252:255], v[156:159]
  buffer_load_dword v250, v4, s[4:7], s38 offen
  s_waitcnt lgkmcnt(4)
  v_mfma_f32_16x16x32_bf16 v[160:163], v[108:111], a[240:243], v[160:163]
  ds_read_b64_tr_b16 v[104:105], v28 offset:0
  ds_read_b64_tr_b16 v[106:107], v28 offset:3584
  v_mfma_f32_16x16x32_bf16 v[164:167], v[108:111], a[244:247], v[164:167]
  v_mfma_f32_16x16x32_bf16 v[168:171], v[108:111], a[248:251], v[168:171]
  v_mfma_f32_16x16x32_bf16 v[172:175], v[108:111], a[252:255], v[172:175]
  s_waitcnt lgkmcnt(4)
  v_mfma_f32_16x16x32_bf16 v[176:179], v[96:99], a[240:243], v[176:179]
  ds_read_b64_tr_b16 v[108:109], v29 offset:0
  ds_read_b64_tr_b16 v[110:111], v29 offset:3584
  v_mfma_f32_16x16x32_bf16 v[180:183], v[96:99], a[244:247], v[180:183]
  v_mfma_f32_16x16x32_bf16 v[184:187], v[96:99], a[248:251], v[184:187]
  v_mfma_f32_16x16x32_bf16 v[188:191], v[96:99], a[252:255], v[188:191]
  s_waitcnt lgkmcnt(4)
  v_mfma_f32_16x16x32_bf16 v[192:195], v[100:103], a[240:243], v[192:195]
  v_mfma_f32_16x16x32_bf16 v[196:199], v[100:103], a[244:247], v[196:199]
  v_mfma_f32_16x16x32_bf16 v[200:203], v[100:103], a[248:251], v[200:203]
  v_mfma_f32_16x16x32_bf16 v[204:207], v[100:103], a[252:255], v[204:207]
  s_waitcnt lgkmcnt(2)
  v_mfma_f32_16x16x32_bf16 v[208:211], v[104:107], a[240:243], v[208:211]
  v_mfma_f32_16x16x32_bf16 v[212:215], v[104:107], a[244:247], v[212:215]
  v_mfma_f32_16x16x32_bf16 v[216:219], v[104:107], a[248:251], v[216:219]
  v_mfma_f32_16x16x32_bf16 v[220:223], v[104:107], a[252:255], v[220:223]
  s_waitcnt lgkmcnt(0)
  v_mfma_f32_16x16x32_bf16 v[224:227], v[108:111], a[240:243], v[224:227]
  v_mfma_f32_16x16x32_bf16 v[228:231], v[108:111], a[244:247], v[228:231]
  v_mfma_f32_16x16x32_bf16 v[232:235], v[108:111], a[248:251], v[232:235]
  v_mfma_f32_16x16x32_bf16 v[236:239], v[108:111], a[252:255], v[236:239]
  s_nop 7
  v_and_b32 v1, 15, v0
  v_mul_u32_u24 v1, 912, v1
  v_lshrrev_b32 v2, 4, v0
  v_lshl_add_u32 v1, v2, 3, v1
  s_mul_i32 s36, s22, 224
  v_add_u32 v1, s36, v1
  v_cvt_pk_bf16_f32 v96, v128, v129
  v_cvt_pk_bf16_f32 v97, v130, v131
  ds_write_b64 v1, v[96:97] offset:0
  v_cvt_pk_bf16_f32 v98, v132, v133
  v_cvt_pk_bf16_f32 v99, v134, v135
  ds_write_b64 v1, v[98:99] offset:14592
  v_cvt_pk_bf16_f32 v100, v136, v137
  v_cvt_pk_bf16_f32 v101, v138, v139
  ds_write_b64 v1, v[100:101] offset:29184
  v_cvt_pk_bf16_f32 v102, v140, v141
  v_cvt_pk_bf16_f32 v103, v142, v143
  ds_write_b64 v1, v[102:103] offset:43776
  v_cvt_pk_bf16_f32 v104, v144, v145
  v_cvt_pk_bf16_f32 v105, v146, v147
  ds_write_b64 v1, v[104:105] offset:32
  v_cvt_pk_bf16_f32 v106, v148, v149
  v_cvt_pk_bf16_f32 v107, v150, v151
  ds_write_b64 v1, v[106:107] offset:14624
  v_cvt_pk_bf16_f32 v108, v152, v153
  v_cvt_pk_bf16_f32 v109, v154, v155
  ds_write_b64 v1, v[108:109] offset:29216
  v_cvt_pk_bf16_f32 v110, v156, v157
  v_cvt_pk_bf16_f32 v111, v158, v159
  ds_write_b64 v1, v[110:111] offset:43808
  v_cvt_pk_bf16_f32 v96, v160, v161
  v_cvt_pk_bf16_f32 v97, v162, v163
  ds_write_b64 v1, v[96:97] offset:64
  v_cvt_pk_bf16_f32 v98, v164, v165
  v_cvt_pk_bf16_f32 v99, v166, v167
  ds_write_b64 v1, v[98:99] offset:14656
  v_cvt_pk_bf16_f32 v100, v168, v169
  v_cvt_pk_bf16_f32 v101, v170, v171
  ds_write_b64 v1, v[100:101] offset:29248
  v_cvt_pk_bf16_f32 v102, v172, v173
  v_cvt_pk_bf16_f32 v103, v174, v175
  ds_write_b64 v1, v[102:103] offset:43840
  v_cvt_pk_bf16_f32 v104, v176, v177
  v_cvt_pk_bf16_f32 v105, v178, v179
  ds_write_b64 v1, v[104:105] offset:96
  v_cvt_pk_bf16_f32 v106, v180, v181
  v_cvt_pk_bf16_f32 v107, v182, v183
  ds_write_b64 v1, v[106:107] offset:14688
  v_cvt_pk_bf16_f32 v108, v184, v185
  v_cvt_pk_bf16_f32 v109, v186, v187
  ds_write_b64 v1, v[108:109] offset:29280
  v_cvt_pk_bf16_f32 v110, v188, v189
  v_cvt_pk_bf16_f32 v111, v190, v191
  ds_write_b64 v1, v[110:111] offset:43872
  v_cvt_pk_bf16_f32 v96, v192, v193
  v_cvt_pk_bf16_f32 v97, v194, v195
  ds_write_b64 v1, v[96:97] offset:128
  v_cvt_pk_bf16_f32 v98, v196, v197
  v_cvt_pk_bf16_f32 v99, v198, v199
  ds_write_b64 v1, v[98:99] offset:14720
  v_cvt_pk_bf16_f32 v100, v200, v201
  v_cvt_pk_bf16_f32 v101, v202, v203
  ds_write_b64 v1, v[100:101] offset:29312
  v_cvt_pk_bf16_f32 v102, v204, v205
  v_cvt_pk_bf16_f32 v103, v206, v207
  ds_write_b64 v1, v[102:103] offset:43904
  v_cvt_pk_bf16_f32 v104, v208, v209
  v_cvt_pk_bf16_f32 v105, v210, v211
  ds_write_b64 v1, v[104:105] offset:160
  v_cvt_pk_bf16_f32 v106, v212, v213
  v_cvt_pk_bf16_f32 v107, v214, v215
  ds_write_b64 v1, v[106:107] offset:14752
  v_cvt_pk_bf16_f32 v108, v216, v217
  v_cvt_pk_bf16_f32 v109, v218, v219
  ds_write_b64 v1, v[108:109] offset:29344
  v_cvt_pk_bf16_f32 v110, v220, v221
  v_cvt_pk_bf16_f32 v111, v222, v223
  ds_write_b64 v1, v[110:111] offset:43936
  v_cvt_pk_bf16_f32 v96, v224, v225
  v_cvt_pk_bf16_f32 v97, v226, v227
  ds_write_b64 v1, v[96:97] offset:192
  v_cvt_pk_bf16_f32 v98, v228, v229
  v_cvt_pk_bf16_f32 v99, v230, v231
  ds_write_b64 v1, v[98:99] offset:14784
  v_cvt_pk_bf16_f32 v100, v232, v233
  v_cvt_pk_bf16_f32 v101, v234, v235
  ds_write_b64 v1, v[100:101] offset:29376
  v_cvt_pk_bf16_f32 v102, v236, v237
  v_cvt_pk_bf16_f32 v103, v238, v239
  ds_write_b64 v1, v[102:103] offset:43968
  s_waitcnt lgkmcnt(0)
  s_barrier
  v_lshlrev_b32 v1, 4, v0
  s_mul_i32 s36, s22, 14592
  v_add_u32 v2, s36, v1
  s_lshl_b32 s36, s35, 6
  s_lshl_b32 s37, s22, 4
  s_add_u32 s36, s36, s37
  s_lshl_b32 s37, s34, 11
  s_add_u32 s36, s36, s37
  s_mul_i32 s36, s36, 896
  s_add_u32 s36, s36, 8388608
  v_cmp_gt_u32 vcc, 56, v0
  s_and_saveexec_b64 s[46:47], vcc
  ds_read_b128 v[128:131], v2 offset:0
  ds_read_b128 v[132:135], v2 offset:912
  ds_read_b128 v[136:139], v2 offset:1824
  ds_read_b128 v[140:143], v2 offset:2736
  ds_read_b128 v[144:147], v2 offset:3648
  ds_read_b128 v[148:151], v2 offset:4560
  ds_read_b128 v[152:155], v2 offset:5472
  ds_read_b128 v[156:159], v2 offset:6384
  ds_read_b128 v[160:163], v2 offset:7296
  ds_read_b128 v[164:167], v2 offset:8208
  ds_read_b128 v[168:171], v2 offset:9120
  ds_read_b128 v[172:175], v2 offset:10032
  ds_read_b128 v[176:179], v2 offset:10944
  ds_read_b128 v[180:183], v2 offset:11856
  ds_read_b128 v[184:187], v2 offset:12768
  ds_read_b128 v[188:191], v2 offset:13680
  s_lshl_b32 s38, s22, 1
  s_add_u32 s39, s38, 0
  s_cmp_eq_u32 s39, s34
  s_cbranch_scc1 K1_SK0
  s_waitcnt lgkmcnt(15)
  s_add_u32 s37, s36, 0
  buffer_store_dwordx4 v[128:131], v1, s[16:19], s37 offen sc1
  s_waitcnt lgkmcnt(14)
  s_add_u32 s37, s36, 896
  buffer_store_dwordx4 v[132:135], v1, s[16:19], s37 offen sc1
  s_waitcnt lgkmcnt(13)
  s_add_u32 s37, s36, 1792
  buffer_store_dwordx4 v[136:139], v1, s[16:19], s37 offen sc1
  s_waitcnt lgkmcnt(12)
  s_add_u32 s37, s36, 2688
  buffer_store_dwordx4 v[140:143], v1, s[16:19], s37 offen sc1
  s_waitcnt lgkmcnt(11)
  s_add_u32 s37, s36, 3584
  buffer_store_dwordx4 v[144:147], v1, s[16:19], s37 offen sc1
  s_waitcnt lgkmcnt(10)
  s_add_u32 s37, s36, 4480
  buffer_store_dwordx4 v[148:151], v1, s[16:19], s37 offen sc1
  s_waitcnt lgkmcnt(9)
  s_add_u32 s37, s36, 5376
  buffer_store_dwordx4 v[152:155], v1, s[16:19], s37 offen sc1
  s_waitcnt lgkmcnt(8)
  s_add_u32 s37, s36, 6272
  buffer_store_dwordx4 v[156:159], v1, s[16:19], s37 offen sc1
K1_SK0:
  s_add_u32 s39, s38, 1
  s_cmp_eq_u32 s39, s34
  s_cbranch_scc1 K1_SK1
  s_waitcnt lgkmcnt(7)
  s_add_u32 s37, s36, 7168
  buffer_store_dwordx4 v[160:163], v1, s[16:19], s37 offen sc1
  s_waitcnt lgkmcnt(6)
  s_add_u32 s37, s36, 8064
  buffer_store_dwordx4 v[164:167], v1, s[16:19], s37 offen sc1
  s_waitcnt lgkmcnt(5)
  s_add_u32 s37, s36, 8960
  buffer_store_dwordx4 v[168:171], v1, s[16:19], s37 offen sc1
  s_waitcnt lgkmcnt(4)
  s_add_u32 s37, s36, 9856
  buffer_store_dwordx4 v[172:175], v1, s[16:19], s37 offen sc1
  s_waitcnt lgkmcnt(3)
  s_add_u32 s37, s36, 10752
  buffer_store_dwordx4 v[176:179], v1, s[16:19], s37 offen sc1
  s_waitcnt lgkmcnt(2)
  s_add_u32 s37, s36, 11648
  buffer_store_dwordx4 v[180:183], v1, s[16:19], s37 offen sc1
  s_waitcnt lgkmcnt(1)
  s_add_u32 s37, s36, 12544
  buffer_store_dwordx4 v[184:187], v1, s[16:19], s37 offen sc1
  s_waitcnt lgkmcnt(0)
  s_add_u32 s37, s36, 13440
  buffer_store_dwordx4 v[188:191], v1, s[16:19], s37 offen sc1
K1_SK1:
  s_waitcnt lgkmcnt(0)
  s_mov_b64 exec, s[46:47]
  v_mov_b32 v5, 147712
  v_mov_b32 v6, 0
  ds_write_b32 v5, v6
  s_waitcnt vmcnt(0) lgkmcnt(0)
  s_barrier
  s_lshl_b32 s39, s35, 7
  s_add_u32 s39, s39, 98304
  s_cmp_lg_u32 s22, 0
  s_cbranch_scc1 KT_NA
  s_mov_b64 exec, 1
  s_lshl_b32 s36, s34, 2
  v_mov_b32 v5, s36
  v_mov_b32 v6, 1
  buffer_store_dword v6, v5, s[16:19], s39 offen sc1
  s_mov_b64 exec, -1
KT_NA:
  s_mov_b32 s4, s44
  s_mov_b32 s5, s45
  s_mov_b32 s6, 1835008
  s_mov_b32 s7, 0x20000
  s_mov_b32 s8, s66
  s_mov_b32 s9, s67
  s_mov_b32 s10, 1835008
  s_mov_b32 s11, 0x20000
  s_mov_b32 s12, s58
  s_mov_b32 s13, s59
  s_mov_b32 s14, 896
  s_mov_b32 s15, 0x20000
  v_lshlrev_b32 v1, 4, v0
  v_cmp_gt_u32 vcc, 56, v0
  v_mov_b32 v2, 0x7fff0000
  s_nop 0
  v_cndmask_b32 v1, v2, v1, vcc
  s_lshl_b32 s36, s35, 6
  s_lshl_b32 s37, s34, 3
  s_add_u32 s36, s36, s37
  s_lshl_b32 s37, s22, 1
  s_add_u32 s46, s36, s37
  s_mul_i32 s47, s46, 896
  buffer_load_dwordx4 v[80:83], v1, s[4:7], s47 offen offset:0
  buffer_load_dwordx4 v[84:87], v1, s[4:7], s47 offen offset:896
  s_mov_b32 s36, 4096
  buffer_load_dwordx4 v[88:91], v1, s[16:19], s36 offen
  s_mov_b32 s36, 5120
  buffer_load_dwordx4 v[92:95], v1, s[16:19], s36 offen
  s_mov_b32 s36, 6144
  buffer_load_dwordx4 v[96:99], v1, s[16:19], s36 offen
  s_mov_b32 s36, 7168
  buffer_load_dwordx4 v[100:103], v1, s[16:19], s36 offen
  buffer_load_dwordx4 v[104:107], v1, s[12:15], 0 offen
  v_mov_b32 v160, 0
  v_mov_b32 v161, 0
  v_mov_b32 v162, 0
  v_mov_b32 v163, 0
  v_mov_b32 v164, 0
  v_mov_b32 v165, 0
  v_mov_b32 v166, 0
  v_mov_b32 v167, 0
  s_lshl_b32 s36, s34, 3
  s_lshl_b32 s37, s22, 1
  s_add_u32 s36, s36, s37
  s_mul_i32 s36, s36, 912
  v_lshlrev_b32 v6, 4, v0
  v_add_u32 v6, s36, v6
  s_mov_b32 exec_hi, 0x00ffffff
  ds_read_b128 v[160:163], v6 offset:0
  ds_read_b128 v[164:167], v6 offset:912
  s_mov_b32 exec_hi, -1
  v_and_b32 v5, 7, v0
  v_lshlrev_b32 v5, 2, v5
  s_mov_b32 s26, 0x400000
  s_lshl_b32 s27, 1, s34
  v_mov_b32 v7, 147712
KT_POLL:
  s_cmp_lg_u32 s22, 0
  s_cbranch_scc1 KT_PL
  buffer_load_dword v6, v5, s[16:19], s39 offen sc1
  s_waitcnt vmcnt(0)
  v_cmp_ne_u32 vcc, 0, v6
  s_nop 4
  s_and_b32 s28, vcc_lo, 0xff
  v_mov_b32 v6, s28
  ds_write_b32 v7, v6
  s_branch KT_PJ
KT_PL:
  ds_read_b32 v6, v7
  s_waitcnt lgkmcnt(0)
  v_readfirstlane_b32 s28, v6
KT_PJ:
  s_andn2_b32 s29, s28, s27
  s_or_b32 s27, s27, s28
  s_bitcmp1_b32 s29, 0
  s_cbranch_scc0 KT_PS0
  s_add_u32 s36, s47, 8388608
  buffer_load_dwordx4 v[16:19], v1, s[16:19], s36 offen offset:0 sc1
  buffer_load_dwordx4 v[48:51], v1, s[16:19], s36 offen offset:896 sc1
KT_PS0:
  s_bitcmp1_b32 s29, 1
  s_cbranch_scc0 KT_PS1
  s_add_u32 s36, s47, 10223616
  buffer_load_dwordx4 v[20:23], v1, s[16:19], s36 offen offset:0 sc1
  buffer_load_dwordx4 v[52:55], v1, s[16:19], s36 offen offset:896 sc1
KT_PS1:
  s_bitcmp1_b32 s29, 2
  s_cbranch_scc0 KT_PS2
  s_add_u32 s36, s47, 12058624
  buffer_load_dwordx4 v[24:27], v1, s[16:19], s36 offen offset:0 sc1
  buffer_load_dwordx4 v[56:59], v1, s[16:19], s36 offen offset:896 sc1
KT_PS2:
  s_bitcmp1_b32 s29, 3
  s_cbranch_scc0 KT_PS3
  s_add_u32 s36, s47, 13893632
  buffer_load_dwordx4 v[28:31], v1, s[16:19], s36 offen offset:0 sc1
  buffer_load_dwordx4 v[60:63], v1, s[16:19], s36 offen offset:896 sc1
KT_PS3:
  s_bitcmp1_b32 s29, 4
  s_cbranch_scc0 KT_PS4
  s_add_u32 s36, s47, 15728640
  buffer_load_dwordx4 v[32:35], v1, s[16:19], s36 offen offset:0 sc1
  buffer_load_dwordx4 v[64:67], v1, s[16:19], s36 offen offset:896 sc1
KT_PS4:
  s_bitcmp1_b32 s29, 5
  s_cbranch_scc0 KT_PS5
  s_add_u32 s36, s47, 17563648
  buffer_load_dwordx4 v[36:39], v1, s[16:19], s36 offen offset:0 sc1
  buffer_load_dwordx4 v[68:71], v1, s[16:19], s36 offen offset:896 sc1
KT_PS5:
  s_bitcmp1_b32 s29, 6
  s_cbranch_scc0 KT_PS6
  s_add_u32 s36, s47, 19398656
  buffer_load_dwordx4 v[40:43], v1, s[16:19], s36 offen offset:0 sc1
  buffer_load_dwordx4 v[72:75], v1, s[16:19], s36 offen offset:896 sc1
KT_PS6:
  s_bitcmp1_b32 s29, 7
  s_cbranch_scc0 KT_PS7
  s_add_u32 s36, s47, 21233664
  buffer_load_dwordx4 v[44:47], v1, s[16:19], s36 offen offset:0 sc1
  buffer_load_dwordx4 v[76:79], v1, s[16:19], s36 offen offset:896 sc1
KT_PS7:
  s_sub_u32 s26, s26, 1
  s_cbranch_scc1 KT_NP
  s_cmp_lg_u32 s27, 0xff
  s_cbranch_scc1 KT_POLL
KT_NP:
  s_waitcnt lgkmcnt(0)
  s_waitcnt vmcnt(0)
  v_lshlrev_b32 v112, 16, v160
  v_and_b32 v113, 0xffff0000, v160
  v_lshlrev_b32 v114, 16, v161
  v_and_b32 v115, 0xffff0000, v161
  v_lshlrev_b32 v116, 16, v162
  v_and_b32 v117, 0xffff0000, v162
  v_lshlrev_b32 v118, 16, v163
  v_and_b32 v119, 0xffff0000, v163
  v_lshlrev_b32 v120, 16, v164
  v_and_b32 v121, 0xffff0000, v164
  v_lshlrev_b32 v122, 16, v165
  v_and_b32 v123, 0xffff0000, v165
  v_lshlrev_b32 v124, 16, v166
  v_and_b32 v125, 0xffff0000, v166
  v_lshlrev_b32 v126, 16, v167
  v_and_b32 v127, 0xffff0000, v167
  s_cmp_eq_u32 s34, 0
  s_cbranch_scc1 KT_AS0
  v_lshlrev_b32 v4, 16, v16
  v_and_b32 v5, 0xffff0000, v16
  v_pk_add_f32 v[112:113], v[112:113], v[4:5]
  v_lshlrev_b32 v4, 16, v17
  v_and_b32 v5, 0xffff0000, v17
  v_pk_add_f32 v[114:115], v[114:115], v[4:5]
  v_lshlrev_b32 v4, 16, v18
  v_and_b32 v5, 0xffff0000, v18
  v_pk_add_f32 v[116:117], v[116:117], v[4:5]
  v_lshlrev_b32 v4, 16, v19
  v_and_b32 v5, 0xffff0000, v19
  v_pk_add_f32 v[118:119], v[118:119], v[4:5]
  v_lshlrev_b32 v6, 16, v48
  v_and_b32 v7, 0xffff0000, v48
  v_pk_add_f32 v[120:121], v[120:121], v[6:7]
  v_lshlrev_b32 v6, 16, v49
  v_and_b32 v7, 0xffff0000, v49
  v_pk_add_f32 v[122:123], v[122:123], v[6:7]
  v_lshlrev_b32 v6, 16, v50
  v_and_b32 v7, 0xffff0000, v50
  v_pk_add_f32 v[124:125], v[124:125], v[6:7]
  v_lshlrev_b32 v6, 16, v51
  v_and_b32 v7, 0xffff0000, v51
  v_pk_add_f32 v[126:127], v[126:127], v[6:7]
KT_AS0:
  s_cmp_eq_u32 s34, 1
  s_cbranch_scc1 KT_AS1
  v_lshlrev_b32 v4, 16, v20
  v_and_b32 v5, 0xffff0000, v20
  v_pk_add_f32 v[112:113], v[112:113], v[4:5]
  v_lshlrev_b32 v4, 16, v21
  v_and_b32 v5, 0xffff0000, v21
  v_pk_add_f32 v[114:115], v[114:115], v[4:5]
  v_lshlrev_b32 v4, 16, v22
  v_and_b32 v5, 0xffff0000, v22
  v_pk_add_f32 v[116:117], v[116:117], v[4:5]
  v_lshlrev_b32 v4, 16, v23
  v_and_b32 v5, 0xffff0000, v23
  v_pk_add_f32 v[118:119], v[118:119], v[4:5]
  v_lshlrev_b32 v6, 16, v52
  v_and_b32 v7, 0xffff0000, v52
  v_pk_add_f32 v[120:121], v[120:121], v[6:7]
  v_lshlrev_b32 v6, 16, v53
  v_and_b32 v7, 0xffff0000, v53
  v_pk_add_f32 v[122:123], v[122:123], v[6:7]
  v_lshlrev_b32 v6, 16, v54
  v_and_b32 v7, 0xffff0000, v54
  v_pk_add_f32 v[124:125], v[124:125], v[6:7]
  v_lshlrev_b32 v6, 16, v55
  v_and_b32 v7, 0xffff0000, v55
  v_pk_add_f32 v[126:127], v[126:127], v[6:7]
KT_AS1:
  s_cmp_eq_u32 s34, 2
  s_cbranch_scc1 KT_AS2
  v_lshlrev_b32 v4, 16, v24
  v_and_b32 v5, 0xffff0000, v24
  v_pk_add_f32 v[112:113], v[112:113], v[4:5]
  v_lshlrev_b32 v4, 16, v25
  v_and_b32 v5, 0xffff0000, v25
  v_pk_add_f32 v[114:115], v[114:115], v[4:5]
  v_lshlrev_b32 v4, 16, v26
  v_and_b32 v5, 0xffff0000, v26
  v_pk_add_f32 v[116:117], v[116:117], v[4:5]
  v_lshlrev_b32 v4, 16, v27
  v_and_b32 v5, 0xffff0000, v27
  v_pk_add_f32 v[118:119], v[118:119], v[4:5]
  v_lshlrev_b32 v6, 16, v56
  v_and_b32 v7, 0xffff0000, v56
  v_pk_add_f32 v[120:121], v[120:121], v[6:7]
  v_lshlrev_b32 v6, 16, v57
  v_and_b32 v7, 0xffff0000, v57
  v_pk_add_f32 v[122:123], v[122:123], v[6:7]
  v_lshlrev_b32 v6, 16, v58
  v_and_b32 v7, 0xffff0000, v58
  v_pk_add_f32 v[124:125], v[124:125], v[6:7]
  v_lshlrev_b32 v6, 16, v59
  v_and_b32 v7, 0xffff0000, v59
  v_pk_add_f32 v[126:127], v[126:127], v[6:7]
KT_AS2:
  s_cmp_eq_u32 s34, 3
  s_cbranch_scc1 KT_AS3
  v_lshlrev_b32 v4, 16, v28
  v_and_b32 v5, 0xffff0000, v28
  v_pk_add_f32 v[112:113], v[112:113], v[4:5]
  v_lshlrev_b32 v4, 16, v29
  v_and_b32 v5, 0xffff0000, v29
  v_pk_add_f32 v[114:115], v[114:115], v[4:5]
  v_lshlrev_b32 v4, 16, v30
  v_and_b32 v5, 0xffff0000, v30
  v_pk_add_f32 v[116:117], v[116:117], v[4:5]
  v_lshlrev_b32 v4, 16, v31
  v_and_b32 v5, 0xffff0000, v31
  v_pk_add_f32 v[118:119], v[118:119], v[4:5]
  v_lshlrev_b32 v6, 16, v60
  v_and_b32 v7, 0xffff0000, v60
  v_pk_add_f32 v[120:121], v[120:121], v[6:7]
  v_lshlrev_b32 v6, 16, v61
  v_and_b32 v7, 0xffff0000, v61
  v_pk_add_f32 v[122:123], v[122:123], v[6:7]
  v_lshlrev_b32 v6, 16, v62
  v_and_b32 v7, 0xffff0000, v62
  v_pk_add_f32 v[124:125], v[124:125], v[6:7]
  v_lshlrev_b32 v6, 16, v63
  v_and_b32 v7, 0xffff0000, v63
  v_pk_add_f32 v[126:127], v[126:127], v[6:7]
KT_AS3:
  s_cmp_eq_u32 s34, 4
  s_cbranch_scc1 KT_AS4
  v_lshlrev_b32 v4, 16, v32
  v_and_b32 v5, 0xffff0000, v32
  v_pk_add_f32 v[112:113], v[112:113], v[4:5]
  v_lshlrev_b32 v4, 16, v33
  v_and_b32 v5, 0xffff0000, v33
  v_pk_add_f32 v[114:115], v[114:115], v[4:5]
  v_lshlrev_b32 v4, 16, v34
  v_and_b32 v5, 0xffff0000, v34
  v_pk_add_f32 v[116:117], v[116:117], v[4:5]
  v_lshlrev_b32 v4, 16, v35
  v_and_b32 v5, 0xffff0000, v35
  v_pk_add_f32 v[118:119], v[118:119], v[4:5]
  v_lshlrev_b32 v6, 16, v64
  v_and_b32 v7, 0xffff0000, v64
  v_pk_add_f32 v[120:121], v[120:121], v[6:7]
  v_lshlrev_b32 v6, 16, v65
  v_and_b32 v7, 0xffff0000, v65
  v_pk_add_f32 v[122:123], v[122:123], v[6:7]
  v_lshlrev_b32 v6, 16, v66
  v_and_b32 v7, 0xffff0000, v66
  v_pk_add_f32 v[124:125], v[124:125], v[6:7]
  v_lshlrev_b32 v6, 16, v67
  v_and_b32 v7, 0xffff0000, v67
  v_pk_add_f32 v[126:127], v[126:127], v[6:7]
KT_AS4:
  s_cmp_eq_u32 s34, 5
  s_cbranch_scc1 KT_AS5
  v_lshlrev_b32 v4, 16, v36
  v_and_b32 v5, 0xffff0000, v36
  v_pk_add_f32 v[112:113], v[112:113], v[4:5]
  v_lshlrev_b32 v4, 16, v37
  v_and_b32 v5, 0xffff0000, v37
  v_pk_add_f32 v[114:115], v[114:115], v[4:5]
  v_lshlrev_b32 v4, 16, v38
  v_and_b32 v5, 0xffff0000, v38
  v_pk_add_f32 v[116:117], v[116:117], v[4:5]
  v_lshlrev_b32 v4, 16, v39
  v_and_b32 v5, 0xffff0000, v39
  v_pk_add_f32 v[118:119], v[118:119], v[4:5]
  v_lshlrev_b32 v6, 16, v68
  v_and_b32 v7, 0xffff0000, v68
  v_pk_add_f32 v[120:121], v[120:121], v[6:7]
  v_lshlrev_b32 v6, 16, v69
  v_and_b32 v7, 0xffff0000, v69
  v_pk_add_f32 v[122:123], v[122:123], v[6:7]
  v_lshlrev_b32 v6, 16, v70
  v_and_b32 v7, 0xffff0000, v70
  v_pk_add_f32 v[124:125], v[124:125], v[6:7]
  v_lshlrev_b32 v6, 16, v71
  v_and_b32 v7, 0xffff0000, v71
  v_pk_add_f32 v[126:127], v[126:127], v[6:7]
KT_AS5:
  s_cmp_eq_u32 s34, 6
  s_cbranch_scc1 KT_AS6
  v_lshlrev_b32 v4, 16, v40
  v_and_b32 v5, 0xffff0000, v40
  v_pk_add_f32 v[112:113], v[112:113], v[4:5]
  v_lshlrev_b32 v4, 16, v41
  v_and_b32 v5, 0xffff0000, v41
  v_pk_add_f32 v[114:115], v[114:115], v[4:5]
  v_lshlrev_b32 v4, 16, v42
  v_and_b32 v5, 0xffff0000, v42
  v_pk_add_f32 v[116:117], v[116:117], v[4:5]
  v_lshlrev_b32 v4, 16, v43
  v_and_b32 v5, 0xffff0000, v43
  v_pk_add_f32 v[118:119], v[118:119], v[4:5]
  v_lshlrev_b32 v6, 16, v72
  v_and_b32 v7, 0xffff0000, v72
  v_pk_add_f32 v[120:121], v[120:121], v[6:7]
  v_lshlrev_b32 v6, 16, v73
  v_and_b32 v7, 0xffff0000, v73
  v_pk_add_f32 v[122:123], v[122:123], v[6:7]
  v_lshlrev_b32 v6, 16, v74
  v_and_b32 v7, 0xffff0000, v74
  v_pk_add_f32 v[124:125], v[124:125], v[6:7]
  v_lshlrev_b32 v6, 16, v75
  v_and_b32 v7, 0xffff0000, v75
  v_pk_add_f32 v[126:127], v[126:127], v[6:7]
KT_AS6:
  s_cmp_eq_u32 s34, 7
  s_cbranch_scc1 KT_AS7
  v_lshlrev_b32 v4, 16, v44
  v_and_b32 v5, 0xffff0000, v44
  v_pk_add_f32 v[112:113], v[112:113], v[4:5]
  v_lshlrev_b32 v4, 16, v45
  v_and_b32 v5, 0xffff0000, v45
  v_pk_add_f32 v[114:115], v[114:115], v[4:5]
  v_lshlrev_b32 v4, 16, v46
  v_and_b32 v5, 0xffff0000, v46
  v_pk_add_f32 v[116:117], v[116:117], v[4:5]
  v_lshlrev_b32 v4, 16, v47
  v_and_b32 v5, 0xffff0000, v47
  v_pk_add_f32 v[118:119], v[118:119], v[4:5]
  v_lshlrev_b32 v6, 16, v76
  v_and_b32 v7, 0xffff0000, v76
  v_pk_add_f32 v[120:121], v[120:121], v[6:7]
  v_lshlrev_b32 v6, 16, v77
  v_and_b32 v7, 0xffff0000, v77
  v_pk_add_f32 v[122:123], v[122:123], v[6:7]
  v_lshlrev_b32 v6, 16, v78
  v_and_b32 v7, 0xffff0000, v78
  v_pk_add_f32 v[124:125], v[124:125], v[6:7]
  v_lshlrev_b32 v6, 16, v79
  v_and_b32 v7, 0xffff0000, v79
  v_pk_add_f32 v[126:127], v[126:127], v[6:7]
KT_AS7:
  v_lshlrev_b32 v144, 16, v88
  v_and_b32 v145, 0xffff0000, v88
  v_lshlrev_b32 v146, 16, v89
  v_and_b32 v147, 0xffff0000, v89
  v_lshlrev_b32 v148, 16, v90
  v_and_b32 v149, 0xffff0000, v90
  v_lshlrev_b32 v150, 16, v91
  v_and_b32 v151, 0xffff0000, v91
  v_lshlrev_b32 v128, 16, v80
  v_and_b32 v129, 0xffff0000, v80
  v_lshlrev_b32 v130, 16, v81
  v_and_b32 v131, 0xffff0000, v81
  v_lshlrev_b32 v132, 16, v82
  v_and_b32 v133, 0xffff0000, v82
  v_lshlrev_b32 v134, 16, v83
  v_and_b32 v135, 0xffff0000, v83
  v_cvt_pk_bf16_f32 v112, v112, v112
  v_lshlrev_b32 v112, 16, v112
  v_mul_f32 v112, v144, v112
  v_cvt_pk_bf16_f32 v112, v112, v112
  v_lshlrev_b32 v112, 16, v112
  v_add_f32 v112, v128, v112
  v_cvt_pk_bf16_f32 v112, v112, v112
  v_lshlrev_b32 v112, 16, v112
  v_cvt_pk_bf16_f32 v113, v113, v113
  v_lshlrev_b32 v113, 16, v113
  v_mul_f32 v113, v145, v113
  v_cvt_pk_bf16_f32 v113, v113, v113
  v_lshlrev_b32 v113, 16, v113
  v_add_f32 v113, v129, v113
  v_cvt_pk_bf16_f32 v113, v113, v113
  v_lshlrev_b32 v113, 16, v113
  v_cvt_pk_bf16_f32 v114, v114, v114
  v_lshlrev_b32 v114, 16, v114
  v_mul_f32 v114, v146, v114
  v_cvt_pk_bf16_f32 v114, v114, v114
  v_lshlrev_b32 v114, 16, v114
  v_add_f32 v114, v130, v114
  v_cvt_pk_bf16_f32 v114, v114, v114
  v_lshlrev_b32 v114, 16, v114
  v_cvt_pk_bf16_f32 v115, v115, v115
  v_lshlrev_b32 v115, 16, v115
  v_mul_f32 v115, v147, v115
  v_cvt_pk_bf16_f32 v115, v115, v115
  v_lshlrev_b32 v115, 16, v115
  v_add_f32 v115, v131, v115
  v_cvt_pk_bf16_f32 v115, v115, v115
  v_lshlrev_b32 v115, 16, v115
  v_cvt_pk_bf16_f32 v116, v116, v116
  v_lshlrev_b32 v116, 16, v116
  v_mul_f32 v116, v148, v116
  v_cvt_pk_bf16_f32 v116, v116, v116
  v_lshlrev_b32 v116, 16, v116
  v_add_f32 v116, v132, v116
  v_cvt_pk_bf16_f32 v116, v116, v116
  v_lshlrev_b32 v116, 16, v116
  v_cvt_pk_bf16_f32 v117, v117, v117
  v_lshlrev_b32 v117, 16, v117
  v_mul_f32 v117, v149, v117
  v_cvt_pk_bf16_f32 v117, v117, v117
  v_lshlrev_b32 v117, 16, v117
  v_add_f32 v117, v133, v117
  v_cvt_pk_bf16_f32 v117, v117, v117
  v_lshlrev_b32 v117, 16, v117
  v_cvt_pk_bf16_f32 v118, v118, v118
  v_lshlrev_b32 v118, 16, v118
  v_mul_f32 v118, v150, v118
  v_cvt_pk_bf16_f32 v118, v118, v118
  v_lshlrev_b32 v118, 16, v118
  v_add_f32 v118, v134, v118
  v_cvt_pk_bf16_f32 v118, v118, v118
  v_lshlrev_b32 v118, 16, v118
  v_cvt_pk_bf16_f32 v119, v119, v119
  v_lshlrev_b32 v119, 16, v119
  v_mul_f32 v119, v151, v119
  v_cvt_pk_bf16_f32 v119, v119, v119
  v_lshlrev_b32 v119, 16, v119
  v_add_f32 v119, v135, v119
  v_cvt_pk_bf16_f32 v119, v119, v119
  v_lshlrev_b32 v119, 16, v119
  v_cvt_pk_bf16_f32 v16, v112, v113
  v_cvt_pk_bf16_f32 v17, v114, v115
  v_cvt_pk_bf16_f32 v18, v116, v117
  v_cvt_pk_bf16_f32 v19, v118, v119
  s_add_u32 s36, s47, 1048576
  buffer_store_dwordx4 v[16:19], v1, s[16:19], s36 offen offset:0 sc1
  v_lshlrev_b32 v136, 16, v84
  v_and_b32 v137, 0xffff0000, v84
  v_lshlrev_b32 v138, 16, v85
  v_and_b32 v139, 0xffff0000, v85
  v_lshlrev_b32 v140, 16, v86
  v_and_b32 v141, 0xffff0000, v86
  v_lshlrev_b32 v142, 16, v87
  v_and_b32 v143, 0xffff0000, v87
  v_cvt_pk_bf16_f32 v120, v120, v120
  v_lshlrev_b32 v120, 16, v120
  v_mul_f32 v120, v144, v120
  v_cvt_pk_bf16_f32 v120, v120, v120
  v_lshlrev_b32 v120, 16, v120
  v_add_f32 v120, v136, v120
  v_cvt_pk_bf16_f32 v120, v120, v120
  v_lshlrev_b32 v120, 16, v120
  v_cvt_pk_bf16_f32 v121, v121, v121
  v_lshlrev_b32 v121, 16, v121
  v_mul_f32 v121, v145, v121
  v_cvt_pk_bf16_f32 v121, v121, v121
  v_lshlrev_b32 v121, 16, v121
  v_add_f32 v121, v137, v121
  v_cvt_pk_bf16_f32 v121, v121, v121
  v_lshlrev_b32 v121, 16, v121
  v_cvt_pk_bf16_f32 v122, v122, v122
  v_lshlrev_b32 v122, 16, v122
  v_mul_f32 v122, v146, v122
  v_cvt_pk_bf16_f32 v122, v122, v122
  v_lshlrev_b32 v122, 16, v122
  v_add_f32 v122, v138, v122
  v_cvt_pk_bf16_f32 v122, v122, v122
  v_lshlrev_b32 v122, 16, v122
  v_cvt_pk_bf16_f32 v123, v123, v123
  v_lshlrev_b32 v123, 16, v123
  v_mul_f32 v123, v147, v123
  v_cvt_pk_bf16_f32 v123, v123, v123
  v_lshlrev_b32 v123, 16, v123
  v_add_f32 v123, v139, v123
  v_cvt_pk_bf16_f32 v123, v123, v123
  v_lshlrev_b32 v123, 16, v123
  v_cvt_pk_bf16_f32 v124, v124, v124
  v_lshlrev_b32 v124, 16, v124
  v_mul_f32 v124, v148, v124
  v_cvt_pk_bf16_f32 v124, v124, v124
  v_lshlrev_b32 v124, 16, v124
  v_add_f32 v124, v140, v124
  v_cvt_pk_bf16_f32 v124, v124, v124
  v_lshlrev_b32 v124, 16, v124
  v_cvt_pk_bf16_f32 v125, v125, v125
  v_lshlrev_b32 v125, 16, v125
  v_mul_f32 v125, v149, v125
  v_cvt_pk_bf16_f32 v125, v125, v125
  v_lshlrev_b32 v125, 16, v125
  v_add_f32 v125, v141, v125
  v_cvt_pk_bf16_f32 v125, v125, v125
  v_lshlrev_b32 v125, 16, v125
  v_cvt_pk_bf16_f32 v126, v126, v126
  v_lshlrev_b32 v126, 16, v126
  v_mul_f32 v126, v150, v126
  v_cvt_pk_bf16_f32 v126, v126, v126
  v_lshlrev_b32 v126, 16, v126
  v_add_f32 v126, v142, v126
  v_cvt_pk_bf16_f32 v126, v126, v126
  v_lshlrev_b32 v126, 16, v126
  v_cvt_pk_bf16_f32 v127, v127, v127
  v_lshlrev_b32 v127, 16, v127
  v_mul_f32 v127, v151, v127
  v_cvt_pk_bf16_f32 v127, v127, v127
  v_lshlrev_b32 v127, 16, v127
  v_add_f32 v127, v143, v127
  v_cvt_pk_bf16_f32 v127, v127, v127
  v_lshlrev_b32 v127, 16, v127
  v_cvt_pk_bf16_f32 v48, v120, v121
  v_cvt_pk_bf16_f32 v49, v122, v123
  v_cvt_pk_bf16_f32 v50, v124, v125
  v_cvt_pk_bf16_f32 v51, v126, v127
  s_add_u32 s36, s47, 1048576
  buffer_store_dwordx4 v[48:51], v1, s[16:19], s36 offen offset:896 sc1
  v_add_f32 v4, v112, v113
  v_add_f32 v4, v4, v114
  v_add_f32 v4, v4, v115
  v_add_f32 v4, v4, v116
  v_add_f32 v4, v4, v117
  v_add_f32 v4, v4, v118
  v_add_f32 v4, v4, v119
  v_add_f32 v5, v120, v121
  v_add_f32 v5, v5, v122
  v_add_f32 v5, v5, v123
  v_add_f32 v5, v5, v124
  v_add_f32 v5, v5, v125
  v_add_f32 v5, v5, v126
  v_add_f32 v5, v5, v127
  s_nop 0
  v_add_f32_dpp v4, v4, v4 quad_perm:[1,0,3,2] row_mask:0xf bank_mask:0xf
  v_add_f32_dpp v5, v5, v5 quad_perm:[1,0,3,2] row_mask:0xf bank_mask:0xf
  s_nop 0
  v_add_f32_dpp v4, v4, v4 quad_perm:[2,3,0,1] row_mask:0xf bank_mask:0xf
  v_add_f32_dpp v5, v5, v5 quad_perm:[2,3,0,1] row_mask:0xf bank_mask:0xf
  s_nop 0
  v_add_f32_dpp v4, v4, v4 row_half_mirror row_mask:0xf bank_mask:0xf
  v_add_f32_dpp v5, v5, v5 row_half_mirror row_mask:0xf bank_mask:0xf
  s_nop 0
  v_add_f32_dpp v4, v4, v4 row_mirror row_mask:0xf bank_mask:0xf
  v_add_f32_dpp v5, v5, v5 row_mirror row_mask:0xf bank_mask:0xf
  v_mov_b32 v6, v4
  v_mov_b32 v7, v5
  s_nop 0
  v_permlane16_swap_b32 v4, v6
  v_permlane16_swap_b32 v5, v7
  s_nop 0
  v_add_f32 v4, v4, v6
  v_add_f32 v5, v5, v7
  v_mov_b32 v6, v4
  v_mov_b32 v7, v5
  s_nop 0
  v_permlane32_swap_b32 v4, v6
  v_permlane32_swap_b32 v5, v7
  s_nop 0
  v_add_f32 v4, v4, v6
  v_add_f32 v5, v5, v7
  v_cmp_gt_u32 vcc, 56, v0
  v_mul_f32 v4, 0x3b124925, v4
  v_sub_f32 v128, v112, v4
  v_sub_f32 v129, v113, v4
  v_sub_f32 v130, v114, v4
  v_sub_f32 v131, v115, v4
  v_sub_f32 v132, v116, v4
  v_sub_f32 v133, v117, v4
  v_sub_f32 v134, v118, v4
  v_sub_f32 v135, v119, v4
  v_mul_f32 v8, v128, v128
  v_fmac_f32 v8, v129, v129
  v_fmac_f32 v8, v130, v130
  v_fmac_f32 v8, v131, v131
  v_fmac_f32 v8, v132, v132
  v_fmac_f32 v8, v133, v133
  v_fmac_f32 v8, v134, v134
  v_fmac_f32 v8, v135, v135
  v_cndmask_b32 v8, 0, v8, vcc
  v_mul_f32 v5, 0x3b124925, v5
  v_sub_f32 v136, v120, v5
  v_sub_f32 v137, v121, v5
  v_sub_f32 v138, v122, v5
  v_sub_f32 v139, v123, v5
  v_sub_f32 v140, v124, v5
  v_sub_f32 v141, v125, v5
  v_sub_f32 v142, v126, v5
  v_sub_f32 v143, v127, v5
  v_mul_f32 v9, v136, v136
  v_fmac_f32 v9, v137, v137
  v_fmac_f32 v9, v138, v138
  v_fmac_f32 v9, v139, v139
  v_fmac_f32 v9, v140, v140
  v_fmac_f32 v9, v141, v141
  v_fmac_f32 v9, v142, v142
  v_fmac_f32 v9, v143, v143
  v_cndmask_b32 v9, 0, v9, vcc
  s_nop 0
  v_add_f32_dpp v8, v8, v8 quad_perm:[1,0,3,2] row_mask:0xf bank_mask:0xf
  v_add_f32_dpp v9, v9, v9 quad_perm:[1,0,3,2] row_mask:0xf bank_mask:0xf
  s_nop 0
  v_add_f32_dpp v8, v8, v8 quad_perm:[2,3,0,1] row_mask:0xf bank_mask:0xf
  v_add_f32_dpp v9, v9, v9 quad_perm:[2,3,0,1] row_mask:0xf bank_mask:0xf
  s_nop 0
  v_add_f32_dpp v8, v8, v8 row_half_mirror row_mask:0xf bank_mask:0xf
  v_add_f32_dpp v9, v9, v9 row_half_mirror row_mask:0xf bank_mask:0xf
  s_nop 0
  v_add_f32_dpp v8, v8, v8 row_mirror row_mask:0xf bank_mask:0xf
  v_add_f32_dpp v9, v9, v9 row_mirror row_mask:0xf bank_mask:0xf
  v_mov_b32 v6, v8
  v_mov_b32 v7, v9
  s_nop 0
  v_permlane16_swap_b32 v8, v6
  v_permlane16_swap_b32 v9, v7
  s_nop 0
  v_add_f32 v8, v8, v6
  v_add_f32 v9, v9, v7
  v_mov_b32 v6, v8
  v_mov_b32 v7, v9
  s_nop 0
  v_permlane32_swap_b32 v8, v6
  v_permlane32_swap_b32 v9, v7
  s_nop 0
  v_add_f32 v8, v8, v6
  v_add_f32 v9, v9, v7
  v_mul_f32 v8, 0x3b124925, v8
  v_add_f32 v8, 0x3727c5ac, v8
  v_rsq_f32 v8, v8
  v_mul_f32 v9, 0x3b124925, v9
  v_add_f32 v9, 0x3727c5ac, v9
  v_rsq_f32 v9, v9
  v_lshlrev_b32 v144, 16, v92
  v_and_b32 v145, 0xffff0000, v92
  v_lshlrev_b32 v146, 16, v93
  v_and_b32 v147, 0xffff0000, v93
  v_lshlrev_b32 v148, 16, v94
  v_and_b32 v149, 0xffff0000, v94
  v_lshlrev_b32 v150, 16, v95
  v_and_b32 v151, 0xffff0000, v95
  v_lshlrev_b32 v152, 16, v96
  v_and_b32 v153, 0xffff0000, v96
  v_lshlrev_b32 v154, 16, v97
  v_and_b32 v155, 0xffff0000, v97
  v_lshlrev_b32 v156, 16, v98
  v_and_b32 v157, 0xffff0000, v98
  v_lshlrev_b32 v158, 16, v99
  v_and_b32 v159, 0xffff0000, v99
  v_mul_f32 v128, v128, v8
  v_fma_f32 v128, v128, v144, v152
  v_cvt_pk_bf16_f32 v128, v128, v128
  v_lshlrev_b32 v128, 16, v128
  v_mul_f32 v129, v129, v8
  v_fma_f32 v129, v129, v145, v153
  v_cvt_pk_bf16_f32 v129, v129, v129
  v_lshlrev_b32 v129, 16, v129
  v_mul_f32 v130, v130, v8
  v_fma_f32 v130, v130, v146, v154
  v_cvt_pk_bf16_f32 v130, v130, v130
  v_lshlrev_b32 v130, 16, v130
  v_mul_f32 v131, v131, v8
  v_fma_f32 v131, v131, v147, v155
  v_cvt_pk_bf16_f32 v131, v131, v131
  v_lshlrev_b32 v131, 16, v131
  v_mul_f32 v132, v132, v8
  v_fma_f32 v132, v132, v148, v156
  v_cvt_pk_bf16_f32 v132, v132, v132
  v_lshlrev_b32 v132, 16, v132
  v_mul_f32 v133, v133, v8
  v_fma_f32 v133, v133, v149, v157
  v_cvt_pk_bf16_f32 v133, v133, v133
  v_lshlrev_b32 v133, 16, v133
  v_mul_f32 v134, v134, v8
  v_fma_f32 v134, v134, v150, v158
  v_cvt_pk_bf16_f32 v134, v134, v134
  v_lshlrev_b32 v134, 16, v134
  v_mul_f32 v135, v135, v8
  v_fma_f32 v135, v135, v151, v159
  v_cvt_pk_bf16_f32 v135, v135, v135
  v_lshlrev_b32 v135, 16, v135
  v_cvt_pk_bf16_f32 v20, v128, v129
  v_cvt_pk_bf16_f32 v21, v130, v131
  v_cvt_pk_bf16_f32 v22, v132, v133
  v_cvt_pk_bf16_f32 v23, v134, v135
  s_add_u32 s36, s47, 3145728
  buffer_store_dwordx4 v[20:23], v1, s[16:19], s36 offen offset:0 sc1
  v_mul_f32 v136, v136, v9
  v_fma_f32 v136, v136, v144, v152
  v_cvt_pk_bf16_f32 v136, v136, v136
  v_lshlrev_b32 v136, 16, v136
  v_mul_f32 v137, v137, v9
  v_fma_f32 v137, v137, v145, v153
  v_cvt_pk_bf16_f32 v137, v137, v137
  v_lshlrev_b32 v137, 16, v137
  v_mul_f32 v138, v138, v9
  v_fma_f32 v138, v138, v146, v154
  v_cvt_pk_bf16_f32 v138, v138, v138
  v_lshlrev_b32 v138, 16, v138
  v_mul_f32 v139, v139, v9
  v_fma_f32 v139, v139, v147, v155
  v_cvt_pk_bf16_f32 v139, v139, v139
  v_lshlrev_b32 v139, 16, v139
  v_mul_f32 v140, v140, v9
  v_fma_f32 v140, v140, v148, v156
  v_cvt_pk_bf16_f32 v140, v140, v140
  v_lshlrev_b32 v140, 16, v140
  v_mul_f32 v141, v141, v9
  v_fma_f32 v141, v141, v149, v157
  v_cvt_pk_bf16_f32 v141, v141, v141
  v_lshlrev_b32 v141, 16, v141
  v_mul_f32 v142, v142, v9
  v_fma_f32 v142, v142, v150, v158
  v_cvt_pk_bf16_f32 v142, v142, v142
  v_lshlrev_b32 v142, 16, v142
  v_mul_f32 v143, v143, v9
  v_fma_f32 v143, v143, v151, v159
  v_cvt_pk_bf16_f32 v143, v143, v143
  v_lshlrev_b32 v143, 16, v143
  v_cvt_pk_bf16_f32 v52, v136, v137
  v_cvt_pk_bf16_f32 v53, v138, v139
  v_cvt_pk_bf16_f32 v54, v140, v141
  v_cvt_pk_bf16_f32 v55, v142, v143
  s_add_u32 s36, s47, 3145728
  buffer_store_dwordx4 v[52:55], v1, s[16:19], s36 offen offset:896 sc1
  v_lshlrev_b32 v144, 16, v100
  v_and_b32 v145, 0xffff0000, v100
  v_lshlrev_b32 v146, 16, v101
  v_and_b32 v147, 0xffff0000, v101
  v_lshlrev_b32 v148, 16, v102
  v_and_b32 v149, 0xffff0000, v102
  v_lshlrev_b32 v150, 16, v103
  v_and_b32 v151, 0xffff0000, v103
  v_mul_f32 v152, v144, v128
  v_cvt_pk_bf16_f32 v152, v152, v152
  v_lshlrev_b32 v152, 16, v152
  v_add_f32 v152, v152, v112
  v_mul_f32 v153, v145, v129
  v_cvt_pk_bf16_f32 v153, v153, v153
  v_lshlrev_b32 v153, 16, v153
  v_add_f32 v153, v153, v113
  v_mul_f32 v154, v146, v130
  v_cvt_pk_bf16_f32 v154, v154, v154
  v_lshlrev_b32 v154, 16, v154
  v_add_f32 v154, v154, v114
  v_mul_f32 v155, v147, v131
  v_cvt_pk_bf16_f32 v155, v155, v155
  v_lshlrev_b32 v155, 16, v155
  v_add_f32 v155, v155, v115
  v_mul_f32 v156, v148, v132
  v_cvt_pk_bf16_f32 v156, v156, v156
  v_lshlrev_b32 v156, 16, v156
  v_add_f32 v156, v156, v116
  v_mul_f32 v157, v149, v133
  v_cvt_pk_bf16_f32 v157, v157, v157
  v_lshlrev_b32 v157, 16, v157
  v_add_f32 v157, v157, v117
  v_mul_f32 v158, v150, v134
  v_cvt_pk_bf16_f32 v158, v158, v158
  v_lshlrev_b32 v158, 16, v158
  v_add_f32 v158, v158, v118
  v_mul_f32 v159, v151, v135
  v_cvt_pk_bf16_f32 v159, v159, v159
  v_lshlrev_b32 v159, 16, v159
  v_add_f32 v159, v159, v119
  v_cvt_pk_bf16_f32 v24, v152, v153
  v_cvt_pk_bf16_f32 v25, v154, v155
  v_cvt_pk_bf16_f32 v26, v156, v157
  v_cvt_pk_bf16_f32 v27, v158, v159
  buffer_store_dwordx4 v[24:27], v1, s[8:11], s47 offen offset:0 sc1
  v_mul_f32 v152, v144, v136
  v_cvt_pk_bf16_f32 v152, v152, v152
  v_lshlrev_b32 v152, 16, v152
  v_add_f32 v152, v152, v120
  v_mul_f32 v153, v145, v137
  v_cvt_pk_bf16_f32 v153, v153, v153
  v_lshlrev_b32 v153, 16, v153
  v_add_f32 v153, v153, v121
  v_mul_f32 v154, v146, v138
  v_cvt_pk_bf16_f32 v154, v154, v154
  v_lshlrev_b32 v154, 16, v154
  v_add_f32 v154, v154, v122
  v_mul_f32 v155, v147, v139
  v_cvt_pk_bf16_f32 v155, v155, v155
  v_lshlrev_b32 v155, 16, v155
  v_add_f32 v155, v155, v123
  v_mul_f32 v156, v148, v140
  v_cvt_pk_bf16_f32 v156, v156, v156
  v_lshlrev_b32 v156, 16, v156
  v_add_f32 v156, v156, v124
  v_mul_f32 v157, v149, v141
  v_cvt_pk_bf16_f32 v157, v157, v157
  v_lshlrev_b32 v157, 16, v157
  v_add_f32 v157, v157, v125
  v_mul_f32 v158, v150, v142
  v_cvt_pk_bf16_f32 v158, v158, v158
  v_lshlrev_b32 v158, 16, v158
  v_add_f32 v158, v158, v126
  v_mul_f32 v159, v151, v143
  v_cvt_pk_bf16_f32 v159, v159, v159
  v_lshlrev_b32 v159, 16, v159
  v_add_f32 v159, v159, v127
  v_cvt_pk_bf16_f32 v56, v152, v153
  v_cvt_pk_bf16_f32 v57, v154, v155
  v_cvt_pk_bf16_f32 v58, v156, v157
  v_cvt_pk_bf16_f32 v59, v158, v159
  buffer_store_dwordx4 v[56:59], v1, s[8:11], s47 offen offset:896 sc1
  v_lshlrev_b32 v144, 16, v104
  v_and_b32 v145, 0xffff0000, v104
  v_lshlrev_b32 v146, 16, v105
  v_and_b32 v147, 0xffff0000, v105
  v_lshlrev_b32 v148, 16, v106
  v_and_b32 v149, 0xffff0000, v106
  v_lshlrev_b32 v150, 16, v107
  v_and_b32 v151, 0xffff0000, v107
  v_mul_f32 v4, v128, v144
  v_fmac_f32 v4, v129, v145
  v_fmac_f32 v4, v130, v146
  v_fmac_f32 v4, v131, v147
  v_fmac_f32 v4, v132, v148
  v_fmac_f32 v4, v133, v149
  v_fmac_f32 v4, v134, v150
  v_fmac_f32 v4, v135, v151
  v_mul_f32 v5, v136, v144
  v_fmac_f32 v5, v137, v145
  v_fmac_f32 v5, v138, v146
  v_fmac_f32 v5, v139, v147
  v_fmac_f32 v5, v140, v148
  v_fmac_f32 v5, v141, v149
  v_fmac_f32 v5, v142, v150
  v_fmac_f32 v5, v143, v151
  s_nop 0
  v_add_f32_dpp v4, v4, v4 quad_perm:[1,0,3,2] row_mask:0xf bank_mask:0xf
  v_add_f32_dpp v5, v5, v5 quad_perm:[1,0,3,2] row_mask:0xf bank_mask:0xf
  s_nop 0
  v_add_f32_dpp v4, v4, v4 quad_perm:[2,3,0,1] row_mask:0xf bank_mask:0xf
  v_add_f32_dpp v5, v5, v5 quad_perm:[2,3,0,1] row_mask:0xf bank_mask:0xf
  s_nop 0
  v_add_f32_dpp v4, v4, v4 row_half_mirror row_mask:0xf bank_mask:0xf
  v_add_f32_dpp v5, v5, v5 row_half_mirror row_mask:0xf bank_mask:0xf
  s_nop 0
  v_add_f32_dpp v4, v4, v4 row_mirror row_mask:0xf bank_mask:0xf
  v_add_f32_dpp v5, v5, v5 row_mirror row_mask:0xf bank_mask:0xf
  v_mov_b32 v6, v4
  v_mov_b32 v7, v5
  s_nop 0
  v_permlane16_swap_b32 v4, v6
  v_permlane16_swap_b32 v5, v7
  s_nop 0
  v_add_f32 v4, v4, v6
  v_add_f32 v5, v5, v7
  v_mov_b32 v6, v4
  v_mov_b32 v7, v5
  s_nop 0
  v_permlane32_swap_b32 v4, v6
  v_permlane32_swap_b32 v5, v7
  s_nop 0
  v_add_f32 v4, v4, v6
  v_add_f32 v5, v5, v7
  v_cvt_pk_bf16_f32 v4, v4, v4
  v_lshlrev_b32 v4, 16, v4
  v_cvt_pk_bf16_f32 v5, v5, v5
  v_lshlrev_b32 v5, 16, v5
  s_waitcnt vmcnt(0)
  s_lshl_b32 s36, s22, 3
  s_add_u32 s36, s36, 147456
  v_mov_b32 v8, s36
  s_mov_b64 exec, 1
  ds_write_b64 v8, v[4:5]
  s_mov_b64 exec, -1
  s_waitcnt lgkmcnt(0)
  s_barrier
  s_cmp_lg_u32 s22, 0
  s_cbranch_scc1 KT_NR
  v_and_b32 v8, 1, v0
  v_lshlrev_b32 v8, 4, v8
  v_add_u32 v9, 147456, v8
  ds_read_b128 v[4:7], v9
  v_lshrrev_b32 v9, 1, v0
  v_lshl_add_u32 v8, v9, 13, v8
  s_lshl_b32 s36, s46, 2
  s_add_u32 s36, s36, 131072
  s_waitcnt lgkmcnt(0)
  s_mov_b64 exec, 0xffff
  buffer_store_dwordx4 v[4:7], v8, s[16:19], s36 offen sc1
  s_mov_b64 exec, -1
KT_NR:
  s_and_b32 s24, s2, 7
  s_lshr_b32 s25, s2, 3
  s_cmp_ge_u32 s2, 160
  s_cbranch_scc1 K1_TE
  s_cmp_ge_u32 s2, 128
  s_cbranch_scc1 KT_RD
  s_lshr_b32 s26, s25, 2
  s_lshl_b32 s26, s26, 3
  s_add_u32 s26, s26, s24
  s_cmp_ge_u32 s26, 28
  s_cbranch_scc1 K1_TE
  s_lshl_b32 s26, s26, 2
  s_and_b32 s25, s25, 3
  s_add_u32 s45, s26, s25
  s_branch KT_RJ
KT_RD:
  s_cmp_ge_u32 s24, 7
  s_cbranch_scc1 K1_TE
  s_sub_u32 s25, s25, 16
  s_lshl_b32 s24, s24, 2
  s_add_u32 s45, s24, s25
KT_RJ:
  s_lshl_b32 s25, s45, 5
  v_mov_b32 v201, 0x7fffffff
  s_cmp_eq_u32 s22, 0
  s_cbranch_scc1 KT_RP0
  v_lshrrev_b32 v4, 1, v0
  v_and_b32 v6, 1, v0
  s_sub_u32 s26, s22, 1
  s_cmp_ge_u32 s2, 128
  s_cbranch_scc1 KT_SD
  v_mul_u32_u24 v5, 3584, v4
  v_lshl_add_u32 v5, v6, 4, v5
  v_add_u32 v5, s25, v5
  s_mov_b32 s70, 1605632
  s_mov_b32 s71, 0x20000
KT_GL:
  s_cmp_ge_u32 s26, 14
  s_cselect_b32 s68, s62, s60
  s_cselect_b32 s69, s63, s61
  s_cselect_b32 s27, 14, 0
  s_sub_u32 s27, s26, s27
  s_mul_i32 s27, s27, 114688
  s_lshl_b32 s28, s26, 10
  s_add_u32 m0, s28, 65536
  s_add_u32 s26, s26, 3
  buffer_load_dwordx4 v5, s[68:71], s27 offen lds
  s_cmp_lt_u32 s26, 28
  s_cbranch_scc1 KT_GL
  s_branch KT_RB
KT_SD:
  s_mov_b32 s68, s64
  s_mov_b32 s69, s65
  s_mov_b32 s70, 1605632
  s_mov_b32 s71, 0x20000
  v_mul_u32_u24 v5, 896, v4
  v_lshl_add_u32 v5, v6, 4, v5
  v_add_u32 v5, s25, v5
KT_DL:
  s_mul_i32 s27, s26, 28672
  s_lshl_b32 s28, s26, 10
  s_add_u32 m0, s28, 65536
  s_add_u32 s26, s26, 3
  buffer_load_dwordx4 v5, s[68:71], s27 offen lds
  s_cmp_lt_u32 s26, 56
  s_cbranch_scc1 KT_DL
  s_branch KT_RB
KT_RP0:
  v_lshlrev_b32 v3, 4, v0
  s_and_b32 s24, s2, 7
  s_lshl_b32 s24, s24, 13
  s_add_u32 s24, s24, 131072
  s_add_u32 s27, s24, 4096
  s_mov_b32 s26, 0x40000
KT_RPOLL:
  buffer_load_dwordx4 v[16:19], v3, s[16:19], s24 offen offset:0 sc1
  buffer_load_dwordx4 v[20:23], v3, s[16:19], s24 offen offset:1024 sc1
  buffer_load_dwordx4 v[24:27], v3, s[16:19], s24 offen offset:2048 sc1
  buffer_load_dwordx4 v[28:31], v3, s[16:19], s24 offen offset:3072 sc1
  buffer_load_dwordx4 v[32:35], v3, s[16:19], s27 offen offset:0 sc1
  buffer_load_dwordx4 v[36:39], v3, s[16:19], s27 offen offset:1024 sc1
  buffer_load_dwordx4 v[40:43], v3, s[16:19], s27 offen offset:2048 sc1
  buffer_load_dwordx4 v[44:47], v3, s[16:19], s27 offen offset:3072 sc1
  s_waitcnt vmcnt(0)
  v_max3_u32 v7, v16, v17, v18
  v_max3_u32 v7, v7, v19, v20
  v_max3_u32 v7, v7, v21, v22
  v_max3_u32 v7, v7, v23, v24
  v_max3_u32 v7, v7, v25, v26
  v_max3_u32 v7, v7, v27, v28
  v_max3_u32 v7, v7, v29, v30
  v_max3_u32 v7, v7, v31, v32
  v_max3_u32 v7, v7, v33, v34
  v_max3_u32 v7, v7, v35, v36
  v_max3_u32 v7, v7, v37, v38
  v_max3_u32 v7, v7, v39, v40
  v_max3_u32 v7, v7, v41, v42
  v_max3_u32 v7, v7, v43, v44
  v_max3_u32 v7, v7, v45, v46
  v_max_u32 v7, v7, v47
  v_cmp_eq_u32 vcc, -1, v7
  s_sub_u32 s26, s26, 1
  s_cbranch_scc1 KT_RGOT
  s_cbranch_vccnz KT_RPOLL
KT_RGOT:
  v_add_u32 v3, 139264, v3
  ds_write_b128 v3, v[16:19] offset:0
  ds_write_b128 v3, v[20:23] offset:1024
  ds_write_b128 v3, v[24:27] offset:2048
  ds_write_b128 v3, v[28:31] offset:3072
  ds_write_b128 v3, v[32:35] offset:4096
  ds_write_b128 v3, v[36:39] offset:5120
  ds_write_b128 v3, v[40:43] offset:6144
  ds_write_b128 v3, v[44:47] offset:7168
  s_waitcnt lgkmcnt(0)
KT_RB:
  s_barrier
  s_lshl_b32 s36, s22, 6
  v_add_u32 v10, s36, v0
  v_lshlrev_b32 v3, 5, v10
  v_add_u32 v3, 139264, v3
  ds_read_b128 v[16:19], v3
  ds_read_b128 v[20:23], v3 offset:16
  s_waitcnt lgkmcnt(0)
  v_lshlrev_b32 v6, 3, v10
  v_sub_u32 v6, 2047, v6
  v_ashrrev_i32 v7, 31, v16
  v_or_b32 v7, 0x80000000, v7
  v_xor_b32 v16, v16, v7
  v_and_b32 v16, 0xffff0000, v16
  v_subrev_u32 v7, 0, v6
  v_or_b32 v16, v16, v7
  v_ashrrev_i32 v7, 31, v17
  v_or_b32 v7, 0x80000000, v7
  v_xor_b32 v17, v17, v7
  v_and_b32 v17, 0xffff0000, v17
  v_subrev_u32 v7, 1, v6
  v_or_b32 v17, v17, v7
  v_ashrrev_i32 v7, 31, v18
  v_or_b32 v7, 0x80000000, v7
  v_xor_b32 v18, v18, v7
  v_and_b32 v18, 0xffff0000, v18
  v_subrev_u32 v7, 2, v6
  v_or_b32 v18, v18, v7
  v_ashrrev_i32 v7, 31, v19
  v_or_b32 v7, 0x80000000, v7
  v_xor_b32 v19, v19, v7
  v_and_b32 v19, 0xffff0000, v19
  v_subrev_u32 v7, 3, v6
  v_or_b32 v19, v19, v7
  v_ashrrev_i32 v7, 31, v20
  v_or_b32 v7, 0x80000000, v7
  v_xor_b32 v20, v20, v7
  v_and_b32 v20, 0xffff0000, v20
  v_subrev_u32 v7, 4, v6
  v_or_b32 v20, v20, v7
  v_ashrrev_i32 v7, 31, v21
  v_or_b32 v7, 0x80000000, v7
  v_xor_b32 v21, v21, v7
  v_and_b32 v21, 0xffff0000, v21
  v_subrev_u32 v7, 5, v6
  v_or_b32 v21, v21, v7
  v_ashrrev_i32 v7, 31, v22
  v_or_b32 v7, 0x80000000, v7
  v_xor_b32 v22, v22, v7
  v_and_b32 v22, 0xffff0000, v22
  v_subrev_u32 v7, 6, v6
  v_or_b32 v22, v22, v7
  v_ashrrev_i32 v7, 31, v23
  v_or_b32 v7, 0x80000000, v7
  v_xor_b32 v23, v23, v7
  v_and_b32 v23, 0xffff0000, v23
  v_subrev_u32 v7, 7, v6
  v_or_b32 v23, v23, v7
  v_max_u32 v7, v16, v17
  v_min_u32 v17, v16, v17
  v_mov_b32 v16, v7
  v_max_u32 v7, v18, v19
  v_min_u32 v19, v18, v19
  v_mov_b32 v18, v7
  v_max_u32 v7, v20, v21
  v_min_u32 v21, v20, v21
  v_mov_b32 v20, v7
  v_max_u32 v7, v22, v23
  v_min_u32 v23, v22, v23
  v_mov_b32 v22, v7
  v_max_u32 v7, v16, v18
  v_min_u32 v18, v16, v18
  v_mov_b32 v16, v7
  v_max_u32 v7, v17, v19
  v_min_u32 v19, v17, v19
  v_mov_b32 v17, v7
  v_max_u32 v7, v20, v22
  v_min_u32 v22, v20, v22
  v_mov_b32 v20, v7
  v_max_u32 v7, v21, v23
  v_min_u32 v23, v21, v23
  v_mov_b32 v21, v7
  v_max_u32 v7, v17, v18
  v_min_u32 v18, v17, v18
  v_mov_b32 v17, v7
  v_max_u32 v7, v21, v22
  v_min_u32 v22, v21, v22
  v_mov_b32 v21, v7
  v_max_u32 v7, v16, v20
  v_min_u32 v20, v16, v20
  v_mov_b32 v16, v7
  v_max_u32 v7, v19, v23
  v_min_u32 v23, v19, v23
  v_mov_b32 v19, v7
  v_max_u32 v7, v17, v21
  v_min_u32 v21, v17, v21
  v_mov_b32 v17, v7
  v_max_u32 v7, v18, v22
  v_min_u32 v22, v18, v22
  v_mov_b32 v18, v7
  v_max_u32 v7, v17, v20
  v_min_u32 v20, v17, v20
  v_mov_b32 v17, v7
  v_max_u32 v7, v19, v22
  v_min_u32 v22, v19, v22
  v_mov_b32 v19, v7
  v_max_u32 v7, v18, v20
  v_min_u32 v20, v18, v20
  v_mov_b32 v18, v7
  v_max_u32 v7, v19, v21
  v_min_u32 v21, v19, v21
  v_mov_b32 v19, v7
  v_max_u32 v7, v19, v20
  v_min_u32 v20, v19, v20
  v_mov_b32 v19, v7
  v_mov_b32 v9, 0
  v_mov_b32 v8, v16
  s_nop 1
  v_max_u32_dpp v8, v8, v8 quad_perm:[1,0,3,2] row_mask:0xf bank_mask:0xf
  s_nop 1
  v_max_u32_dpp v8, v8, v8 quad_perm:[2,3,0,1] row_mask:0xf bank_mask:0xf
  s_nop 1
  v_max_u32_dpp v8, v8, v8 row_half_mirror row_mask:0xf bank_mask:0xf
  s_nop 1
  v_max_u32_dpp v8, v8, v8 row_mirror row_mask:0xf bank_mask:0xf
  v_mov_b32 v7, v8
  s_nop 1
  v_permlane16_swap_b32 v8, v7
  s_nop 1
  v_max_u32 v8, v8, v7
  v_mov_b32 v7, v8
  s_nop 1
  v_permlane32_swap_b32 v8, v7
  s_nop 1
  v_max_u32 v8, v8, v7
  v_cmp_eq_u32 s[30:31], 0, v0
  v_cmp_eq_u32 vcc, v16, v8
  s_nop 1
  v_cndmask_b32 v16, v16, v17, vcc
  v_cndmask_b32 v17, v17, v18, vcc
  v_cndmask_b32 v18, v18, v19, vcc
  v_cndmask_b32 v19, v19, v20, vcc
  v_cndmask_b32 v20, v20, v21, vcc
  v_cndmask_b32 v21, v21, v22, vcc
  v_cndmask_b32 v22, v22, v23, vcc
  v_cndmask_b32 v9, v9, v8, s[30:31]
  v_mov_b32 v8, v16
  s_nop 1
  v_max_u32_dpp v8, v8, v8 quad_perm:[1,0,3,2] row_mask:0xf bank_mask:0xf
  s_nop 1
  v_max_u32_dpp v8, v8, v8 quad_perm:[2,3,0,1] row_mask:0xf bank_mask:0xf
  s_nop 1
  v_max_u32_dpp v8, v8, v8 row_half_mirror row_mask:0xf bank_mask:0xf
  s_nop 1
  v_max_u32_dpp v8, v8, v8 row_mirror row_mask:0xf bank_mask:0xf
  v_mov_b32 v7, v8
  s_nop 1
  v_permlane16_swap_b32 v8, v7
  s_nop 1
  v_max_u32 v8, v8, v7
  v_mov_b32 v7, v8
  s_nop 1
  v_permlane32_swap_b32 v8, v7
  s_nop 1
  v_max_u32 v8, v8, v7
  v_cmp_eq_u32 s[30:31], 1, v0
  v_cmp_eq_u32 vcc, v16, v8
  s_nop 1
  v_cndmask_b32 v16, v16, v17, vcc
  v_cndmask_b32 v17, v17, v18, vcc
  v_cndmask_b32 v18, v18, v19, vcc
  v_cndmask_b32 v19, v19, v20, vcc
  v_cndmask_b32 v20, v20, v21, vcc
  v_cndmask_b32 v21, v21, v22, vcc
  v_cndmask_b32 v9, v9, v8, s[30:31]
  v_mov_b32 v8, v16
  s_nop 1
  v_max_u32_dpp v8, v8, v8 quad_perm:[1,0,3,2] row_mask:0xf bank_mask:0xf
  s_nop 1
  v_max_u32_dpp v8, v8, v8 quad_perm:[2,3,0,1] row_mask:0xf bank_mask:0xf
  s_nop 1
  v_max_u32_dpp v8, v8, v8 row_half_mirror row_mask:0xf bank_mask:0xf
  s_nop 1
  v_max_u32_dpp v8, v8, v8 row_mirror row_mask:0xf bank_mask:0xf
  v_mov_b32 v7, v8
  s_nop 1
  v_permlane16_swap_b32 v8, v7
  s_nop 1
  v_max_u32 v8, v8, v7
  v_mov_b32 v7, v8
  s_nop 1
  v_permlane32_swap_b32 v8, v7
  s_nop 1
  v_max_u32 v8, v8, v7
  v_cmp_eq_u32 s[30:31], 2, v0
  v_cmp_eq_u32 vcc, v16, v8
  s_nop 1
  v_cndmask_b32 v16, v16, v17, vcc
  v_cndmask_b32 v17, v17, v18, vcc
  v_cndmask_b32 v18, v18, v19, vcc
  v_cndmask_b32 v19, v19, v20, vcc
  v_cndmask_b32 v20, v20, v21, vcc
  v_cndmask_b32 v9, v9, v8, s[30:31]
  v_mov_b32 v8, v16
  s_nop 1
  v_max_u32_dpp v8, v8, v8 quad_perm:[1,0,3,2] row_mask:0xf bank_mask:0xf
  s_nop 1
  v_max_u32_dpp v8, v8, v8 quad_perm:[2,3,0,1] row_mask:0xf bank_mask:0xf
  s_nop 1
  v_max_u32_dpp v8, v8, v8 row_half_mirror row_mask:0xf bank_mask:0xf
  s_nop 1
  v_max_u32_dpp v8, v8, v8 row_mirror row_mask:0xf bank_mask:0xf
  v_mov_b32 v7, v8
  s_nop 1
  v_permlane16_swap_b32 v8, v7
  s_nop 1
  v_max_u32 v8, v8, v7
  v_mov_b32 v7, v8
  s_nop 1
  v_permlane32_swap_b32 v8, v7
  s_nop 1
  v_max_u32 v8, v8, v7
  v_cmp_eq_u32 s[30:31], 3, v0
  v_cmp_eq_u32 vcc, v16, v8
  s_nop 1
  v_cndmask_b32 v16, v16, v17, vcc
  v_cndmask_b32 v17, v17, v18, vcc
  v_cndmask_b32 v18, v18, v19, vcc
  v_cndmask_b32 v19, v19, v20, vcc
  v_cndmask_b32 v9, v9, v8, s[30:31]
  v_mov_b32 v8, v16
  s_nop 1
  v_max_u32_dpp v8, v8, v8 quad_perm:[1,0,3,2] row_mask:0xf bank_mask:0xf
  s_nop 1
  v_max_u32_dpp v8, v8, v8 quad_perm:[2,3,0,1] row_mask:0xf bank_mask:0xf
  s_nop 1
  v_max_u32_dpp v8, v8, v8 row_half_mirror row_mask:0xf bank_mask:0xf
  s_nop 1
  v_max_u32_dpp v8, v8, v8 row_mirror row_mask:0xf bank_mask:0xf
  v_mov_b32 v7, v8
  s_nop 1
  v_permlane16_swap_b32 v8, v7
  s_nop 1
  v_max_u32 v8, v8, v7
  v_mov_b32 v7, v8
  s_nop 1
  v_permlane32_swap_b32 v8, v7
  s_nop 1
  v_max_u32 v8, v8, v7
  v_cmp_eq_u32 s[30:31], 4, v0
  v_cmp_eq_u32 vcc, v16, v8
  s_nop 1
  v_cndmask_b32 v16, v16, v17, vcc
  v_cndmask_b32 v17, v17, v18, vcc
  v_cndmask_b32 v18, v18, v19, vcc
  v_cndmask_b32 v9, v9, v8, s[30:31]
  v_mov_b32 v8, v16
  s_nop 1
  v_max_u32_dpp v8, v8, v8 quad_perm:[1,0,3,2] row_mask:0xf bank_mask:0xf
  s_nop 1
  v_max_u32_dpp v8, v8, v8 quad_perm:[2,3,0,1] row_mask:0xf bank_mask:0xf
  s_nop 1
  v_max_u32_dpp v8, v8, v8 row_half_mirror row_mask:0xf bank_mask:0xf
  s_nop 1
  v_max_u32_dpp v8, v8, v8 row_mirror row_mask:0xf bank_mask:0xf
  v_mov_b32 v7, v8
  s_nop 1
  v_permlane16_swap_b32 v8, v7
  s_nop 1
  v_max_u32 v8, v8, v7
  v_mov_b32 v7, v8
  s_nop 1
  v_permlane32_swap_b32 v8, v7
  s_nop 1
  v_max_u32 v8, v8, v7
  v_cmp_eq_u32 s[30:31], 5, v0
  v_cmp_eq_u32 vcc, v16, v8
  s_nop 1
  v_cndmask_b32 v16, v16, v17, vcc
  v_cndmask_b32 v17, v17, v18, vcc
  v_cndmask_b32 v9, v9, v8, s[30:31]
  v_mov_b32 v8, v16
  s_nop 1
  v_max_u32_dpp v8, v8, v8 quad_perm:[1,0,3,2] row_mask:0xf bank_mask:0xf
  s_nop 1
  v_max_u32_dpp v8, v8, v8 quad_perm:[2,3,0,1] row_mask:0xf bank_mask:0xf
  s_nop 1
  v_max_u32_dpp v8, v8, v8 row_half_mirror row_mask:0xf bank_mask:0xf
  s_nop 1
  v_max_u32_dpp v8, v8, v8 row_mirror row_mask:0xf bank_mask:0xf
  v_mov_b32 v7, v8
  s_nop 1
  v_permlane16_swap_b32 v8, v7
  s_nop 1
  v_max_u32 v8, v8, v7
  v_mov_b32 v7, v8
  s_nop 1
  v_permlane32_swap_b32 v8, v7
  s_nop 1
  v_max_u32 v8, v8, v7
  v_cmp_eq_u32 s[30:31], 6, v0
  v_cmp_eq_u32 vcc, v16, v8
  s_nop 1
  v_cndmask_b32 v16, v16, v17, vcc
  v_cndmask_b32 v9, v9, v8, s[30:31]
  v_mov_b32 v8, v16
  s_nop 1
  v_max_u32_dpp v8, v8, v8 quad_perm:[1,0,3,2] row_mask:0xf bank_mask:0xf
  s_nop 1
  v_max_u32_dpp v8, v8, v8 quad_perm:[2,3,0,1] row_mask:0xf bank_mask:0xf
  s_nop 1
  v_max_u32_dpp v8, v8, v8 row_half_mirror row_mask:0xf bank_mask:0xf
  s_nop 1
  v_max_u32_dpp v8, v8, v8 row_mirror row_mask:0xf bank_mask:0xf
  v_mov_b32 v7, v8
  s_nop 1
  v_permlane16_swap_b32 v8, v7
  s_nop 1
  v_max_u32 v8, v8, v7
  v_mov_b32 v7, v8
  s_nop 1
  v_permlane32_swap_b32 v8, v7
  s_nop 1
  v_max_u32 v8, v8, v7
  v_cmp_eq_u32 s[30:31], 7, v0
  s_nop 1
  v_cndmask_b32 v9, v9, v8, s[30:31]
  s_lshl_b32 s29, s22, 5
  v_lshl_add_u32 v7, v0, 2, s29
  v_add_u32 v7, 131072, v7
  v_cmp_gt_u32 vcc, 8, v0
  s_and_saveexec_b64 s[36:37], vcc
  ds_write_b32 v7, v9
  s_mov_b64 exec, s[36:37]
  s_waitcnt lgkmcnt(0)
  s_barrier
  v_lshrrev_b32 v12, 4, v0
  s_cmp_lg_u32 s22, 0
  s_cbranch_scc1 KT_OTH
  v_and_b32 v7, 31, v0
  v_lshlrev_b32 v7, 2, v7
  v_add_u32 v7, 131072, v7
  ds_read_b32 v9, v7
  v_mov_b32 v10, 131072
  ds_read_b128 v[16:19], v10 offset:0
  ds_read_b128 v[20:23], v10 offset:16
  ds_read_b128 v[24:27], v10 offset:32
  ds_read_b128 v[28:31], v10 offset:48
  ds_read_b128 v[32:35], v10 offset:64
  ds_read_b128 v[36:39], v10 offset:80
  ds_read_b128 v[40:43], v10 offset:96
  ds_read_b128 v[44:47], v10 offset:112
  s_waitcnt lgkmcnt(0)
  v_mov_b32 v11, 0
  v_cmp_gt_u32 s[32:33], v16, v9
  v_cmp_gt_u32 s[34:35], v17, v9
  s_nop 0
  v_addc_co_u32 v11, vcc, 0, v11, s[32:33]
  v_addc_co_u32 v11, vcc, 0, v11, s[34:35]
  v_cmp_gt_u32 s[32:33], v18, v9
  v_cmp_gt_u32 s[34:35], v19, v9
  s_nop 0
  v_addc_co_u32 v11, vcc, 0, v11, s[32:33]
  v_addc_co_u32 v11, vcc, 0, v11, s[34:35]
  v_cmp_gt_u32 s[32:33], v20, v9
  v_cmp_gt_u32 s[34:35], v21, v9
  s_nop 0
  v_addc_co_u32 v11, vcc, 0, v11, s[32:33]
  v_addc_co_u32 v11, vcc, 0, v11, s[34:35]
  v_cmp_gt_u32 s[32:33], v22, v9
  v_cmp_gt_u32 s[34:35], v23, v9
  s_nop 0
  v_addc_co_u32 v11, vcc, 0, v11, s[32:33]
  v_addc_co_u32 v11, vcc, 0, v11, s[34:35]
  v_cmp_gt_u32 s[32:33], v24, v9
  v_cmp_gt_u32 s[34:35], v25, v9
  s_nop 0
  v_addc_co_u32 v11, vcc, 0, v11, s[32:33]
  v_addc_co_u32 v11, vcc, 0, v11, s[34:35]
  v_cmp_gt_u32 s[32:33], v26, v9
  v_cmp_gt_u32 s[34:35], v27, v9
  s_nop 0
  v_addc_co_u32 v11, vcc, 0, v11, s[32:33]
  v_addc_co_u32 v11, vcc, 0, v11, s[34:35]
  v_cmp_gt_u32 s[32:33], v28, v9
  v_cmp_gt_u32 s[34:35], v29, v9
  s_nop 0
  v_addc_co_u32 v11, vcc, 0, v11, s[32:33]
  v_addc_co_u32 v11, vcc, 0, v11, s[34:35]
  v_cmp_gt_u32 s[32:33], v30, v9
  v_cmp_gt_u32 s[34:35], v31, v9
  s_nop 0
  v_addc_co_u32 v11, vcc, 0, v11, s[32:33]
  v_addc_co_u32 v11, vcc, 0, v11, s[34:35]
  v_cmp_gt_u32 s[32:33], v32, v9
  v_cmp_gt_u32 s[34:35], v33, v9
  s_nop 0
  v_addc_co_u32 v11, vcc, 0, v11, s[32:33]
  v_addc_co_u32 v11, vcc, 0, v11, s[34:35]
  v_cmp_gt_u32 s[32:33], v34, v9
  v_cmp_gt_u32 s[34:35], v35, v9
  s_nop 0
  v_addc_co_u32 v11, vcc, 0, v11, s[32:33]
  v_addc_co_u32 v11, vcc, 0, v11, s[34:35]
  v_cmp_gt_u32 s[32:33], v36, v9
  v_cmp_gt_u32 s[34:35], v37, v9
  s_nop 0
  v_addc_co_u32 v11, vcc, 0, v11, s[32:33]
  v_addc_co_u32 v11, vcc, 0, v11, s[34:35]
  v_cmp_gt_u32 s[32:33], v38, v9
  v_cmp_gt_u32 s[34:35], v39, v9
  s_nop 0
  v_addc_co_u32 v11, vcc, 0, v11, s[32:33]
  v_addc_co_u32 v11, vcc, 0, v11, s[34:35]
  v_cmp_gt_u32 s[32:33], v40, v9
  v_cmp_gt_u32 s[34:35], v41, v9
  s_nop 0
  v_addc_co_u32 v11, vcc, 0, v11, s[32:33]
  v_addc_co_u32 v11, vcc, 0, v11, s[34:35]
  v_cmp_gt_u32 s[32:33], v42, v9
  v_cmp_gt_u32 s[34:35], v43, v9
  s_nop 0
  v_addc_co_u32 v11, vcc, 0, v11, s[32:33]
  v_addc_co_u32 v11, vcc, 0, v11, s[34:35]
  v_cmp_gt_u32 s[32:33], v44, v9
  v_cmp_gt_u32 s[34:35], v45, v9
  s_nop 0
  v_addc_co_u32 v11, vcc, 0, v11, s[32:33]
  v_addc_co_u32 v11, vcc, 0, v11, s[34:35]
  v_cmp_gt_u32 s[32:33], v46, v9
  v_cmp_gt_u32 s[34:35], v47, v9
  s_nop 0
  v_addc_co_u32 v11, vcc, 0, v11, s[32:33]
  v_addc_co_u32 v11, vcc, 0, v11, s[34:35]
  v_cmp_gt_u32 s[32:33], 8, v11
  v_cmp_gt_u32 s[34:35], 32, v0
  s_and_b64 s[32:33], s[32:33], s[34:35]
  v_lshlrev_b32 v11, 2, v11
  v_add_u32 v11, 131200, v11
  s_and_saveexec_b64 s[36:37], s[32:33]
  ds_write_b32 v11, v9
  s_mov_b64 exec, s[36:37]
  s_waitcnt lgkmcnt(0)
  v_and_b32 v7, 7, v0
  v_lshlrev_b32 v7, 2, v7
  v_add_u32 v7, 131200, v7
  ds_read_b32 v9, v7
  s_waitcnt lgkmcnt(0)
  v_and_b32 v10, 0xffff, v9
  v_sub_u32 v10, 2047, v10
  v_mul_u32_u24 v11, 896, v10
  s_cmp_ge_u32 s2, 128
  s_cbranch_scc1 KT_DN0
  v_lshl_add_u32 v200, v12, 4, v11
  s_mov_b32 s24, 3145728
  buffer_load_dwordx4 v[16:19], v200, s[16:19], s24 offen offset:0 sc1
  buffer_load_dwordx4 v[20:23], v200, s[16:19], s24 offen offset:64 sc1
  buffer_load_dwordx4 v[24:27], v200, s[16:19], s24 offen offset:128 sc1
  buffer_load_dwordx4 v[28:31], v200, s[16:19], s24 offen offset:192 sc1
  buffer_load_dwordx4 v[32:35], v200, s[16:19], s24 offen offset:256 sc1
  buffer_load_dwordx4 v[36:39], v200, s[16:19], s24 offen offset:320 sc1
  buffer_load_dwordx4 v[40:43], v200, s[16:19], s24 offen offset:384 sc1
  buffer_load_dwordx4 v[44:47], v200, s[16:19], s24 offen offset:448 sc1
  buffer_load_dwordx4 v[48:51], v200, s[16:19], s24 offen offset:512 sc1
  buffer_load_dwordx4 v[52:55], v200, s[16:19], s24 offen offset:576 sc1
  buffer_load_dwordx4 v[56:59], v200, s[16:19], s24 offen offset:640 sc1
  buffer_load_dwordx4 v[60:63], v200, s[16:19], s24 offen offset:704 sc1
  buffer_load_dwordx4 v[64:67], v200, s[16:19], s24 offen offset:768 sc1
  buffer_load_dwordx4 v[68:71], v200, s[16:19], s24 offen offset:832 sc1
  s_barrier
  v_bfe_u32 v13, v0, 2, 2
  v_lshl_add_u32 v13, v12, 3, v13
  v_lshlrev_b32 v13, 5, v13
  v_and_b32 v14, 3, v0
  v_lshl_add_u32 v13, v14, 3, v13
  v_add_u32 v13, 65536, v13
  ds_read_b64_tr_b16 v[80:81], v13 offset:0
  ds_read_b64_tr_b16 v[82:83], v13 offset:128
  ds_read_b64_tr_b16 v[84:85], v13 offset:1024
  ds_read_b64_tr_b16 v[86:87], v13 offset:1152
  ds_read_b64_tr_b16 v[88:89], v13 offset:2048
  ds_read_b64_tr_b16 v[90:91], v13 offset:2176
  ds_read_b64_tr_b16 v[92:93], v13 offset:3072
  ds_read_b64_tr_b16 v[94:95], v13 offset:3200
  ds_read_b64_tr_b16 v[96:97], v13 offset:4096
  ds_read_b64_tr_b16 v[98:99], v13 offset:4224
  ds_read_b64_tr_b16 v[100:101], v13 offset:5120
  ds_read_b64_tr_b16 v[102:103], v13 offset:5248
  ds_read_b64_tr_b16 v[104:105], v13 offset:6144
  ds_read_b64_tr_b16 v[106:107], v13 offset:6272
  s_waitcnt lgkmcnt(0)
  ds_read_b64_tr_b16 v[108:109], v13 offset:7168
  ds_read_b64_tr_b16 v[110:111], v13 offset:7296
  ds_read_b64_tr_b16 v[112:113], v13 offset:8192
  ds_read_b64_tr_b16 v[114:115], v13 offset:8320
  ds_read_b64_tr_b16 v[116:117], v13 offset:9216
  ds_read_b64_tr_b16 v[118:119], v13 offset:9344
  ds_read_b64_tr_b16 v[120:121], v13 offset:10240
  ds_read_b64_tr_b16 v[122:123], v13 offset:10368
  ds_read_b64_tr_b16 v[124:125], v13 offset:11264
  ds_read_b64_tr_b16 v[126:127], v13 offset:11392
  ds_read_b64_tr_b16 v[128:129], v13 offset:12288
  ds_read_b64_tr_b16 v[130:131], v13 offset:12416
  ds_read_b64_tr_b16 v[132:133], v13 offset:13312
  ds_read_b64_tr_b16 v[134:135], v13 offset:13440
  s_waitcnt lgkmcnt(0)
  ds_read_b64_tr_b16 v[136:137], v13 offset:14336
  ds_read_b64_tr_b16 v[138:139], v13 offset:14464
  ds_read_b64_tr_b16 v[140:141], v13 offset:15360
  ds_read_b64_tr_b16 v[142:143], v13 offset:15488
  ds_read_b64_tr_b16 v[144:145], v13 offset:16384
  ds_read_b64_tr_b16 v[146:147], v13 offset:16512
  ds_read_b64_tr_b16 v[148:149], v13 offset:17408
  ds_read_b64_tr_b16 v[150:151], v13 offset:17536
  ds_read_b64_tr_b16 v[152:153], v13 offset:18432
  ds_read_b64_tr_b16 v[154:155], v13 offset:18560
  ds_read_b64_tr_b16 v[156:157], v13 offset:19456
  ds_read_b64_tr_b16 v[158:159], v13 offset:19584
  ds_read_b64_tr_b16 v[160:161], v13 offset:20480
  ds_read_b64_tr_b16 v[162:163], v13 offset:20608
  s_waitcnt lgkmcnt(0)
  ds_read_b64_tr_b16 v[164:165], v13 offset:21504
  ds_read_b64_tr_b16 v[166:167], v13 offset:21632
  ds_read_b64_tr_b16 v[168:169], v13 offset:22528
  ds_read_b64_tr_b16 v[170:171], v13 offset:22656
  ds_read_b64_tr_b16 v[172:173], v13 offset:23552
  ds_read_b64_tr_b16 v[174:175], v13 offset:23680
  ds_read_b64_tr_b16 v[176:177], v13 offset:24576
  ds_read_b64_tr_b16 v[178:179], v13 offset:24704
  ds_read_b64_tr_b16 v[180:181], v13 offset:25600
  ds_read_b64_tr_b16 v[182:183], v13 offset:25728
  ds_read_b64_tr_b16 v[184:185], v13 offset:26624
  ds_read_b64_tr_b16 v[186:187], v13 offset:26752
  ds_read_b64_tr_b16 v[188:189], v13 offset:27648
  ds_read_b64_tr_b16 v[190:191], v13 offset:27776
  s_waitcnt lgkmcnt(0)
  s_waitcnt vmcnt(0)
  v_mfma_f32_16x16x32_bf16 v[72:75], v[80:83], v[16:19], 0
  v_mfma_f32_16x16x32_bf16 v[76:79], v[136:139], v[16:19], 0
  v_mfma_f32_16x16x32_bf16 v[72:75], v[84:87], v[20:23], v[72:75]
  v_mfma_f32_16x16x32_bf16 v[76:79], v[140:143], v[20:23], v[76:79]
  v_mfma_f32_16x16x32_bf16 v[72:75], v[88:91], v[24:27], v[72:75]
  v_mfma_f32_16x16x32_bf16 v[76:79], v[144:147], v[24:27], v[76:79]
  v_mfma_f32_16x16x32_bf16 v[72:75], v[92:95], v[28:31], v[72:75]
  v_mfma_f32_16x16x32_bf16 v[76:79], v[148:151], v[28:31], v[76:79]
  v_mfma_f32_16x16x32_bf16 v[72:75], v[96:99], v[32:35], v[72:75]
  v_mfma_f32_16x16x32_bf16 v[76:79], v[152:155], v[32:35], v[76:79]
  v_mfma_f32_16x16x32_bf16 v[72:75], v[100:103], v[36:39], v[72:75]
  v_mfma_f32_16x16x32_bf16 v[76:79], v[156:159], v[36:39], v[76:79]
  v_mfma_f32_16x16x32_bf16 v[72:75], v[104:107], v[40:43], v[72:75]
  v_mfma_f32_16x16x32_bf16 v[76:79], v[160:163], v[40:43], v[76:79]
  v_mfma_f32_16x16x32_bf16 v[72:75], v[108:111], v[44:47], v[72:75]
  v_mfma_f32_16x16x32_bf16 v[76:79], v[164:167], v[44:47], v[76:79]
  v_mfma_f32_16x16x32_bf16 v[72:75], v[112:115], v[48:51], v[72:75]
  v_mfma_f32_16x16x32_bf16 v[76:79], v[168:171], v[48:51], v[76:79]
  v_mfma_f32_16x16x32_bf16 v[72:75], v[116:119], v[52:55], v[72:75]
  v_mfma_f32_16x16x32_bf16 v[76:79], v[172:175], v[52:55], v[76:79]
  v_mfma_f32_16x16x32_bf16 v[72:75], v[120:123], v[56:59], v[72:75]
  v_mfma_f32_16x16x32_bf16 v[76:79], v[176:179], v[56:59], v[76:79]
  v_mfma_f32_16x16x32_bf16 v[72:75], v[124:127], v[60:63], v[72:75]
  v_mfma_f32_16x16x32_bf16 v[76:79], v[180:183], v[60:63], v[76:79]
  v_mfma_f32_16x16x32_bf16 v[72:75], v[128:131], v[64:67], v[72:75]
  v_mfma_f32_16x16x32_bf16 v[76:79], v[184:187], v[64:67], v[76:79]
  v_mfma_f32_16x16x32_bf16 v[72:75], v[132:135], v[68:71], v[72:75]
  v_mfma_f32_16x16x32_bf16 v[76:79], v[188:191], v[68:71], v[76:79]
  s_nop 7
  v_cvt_pk_bf16_f32 v72, v72, v72
  v_lshlrev_b32 v72, 16, v72
  v_cvt_pk_bf16_f32 v76, v76, v76
  v_lshlrev_b32 v76, 16, v76
  v_mul_f32 v6, 0xbfb8aa3b, v72
  v_exp_f32 v6, v6
  s_nop 0
  v_add_f32 v6, 1.0, v6
  v_rcp_f32 v5, v6
  s_nop 0
  v_mul_f32 v72, v72, v5
  v_cvt_pk_bf16_f32 v72, v72, v72
  v_lshlrev_b32 v72, 16, v72
  v_mul_f32 v72, v72, v76
  v_cvt_pk_bf16_f32 v73, v73, v73
  v_lshlrev_b32 v73, 16, v73
  v_cvt_pk_bf16_f32 v77, v77, v77
  v_lshlrev_b32 v77, 16, v77
  v_mul_f32 v6, 0xbfb8aa3b, v73
  v_exp_f32 v6, v6
  s_nop 0
  v_add_f32 v6, 1.0, v6
  v_rcp_f32 v5, v6
  s_nop 0
  v_mul_f32 v73, v73, v5
  v_cvt_pk_bf16_f32 v73, v73, v73
  v_lshlrev_b32 v73, 16, v73
  v_mul_f32 v73, v73, v77
  v_cvt_pk_bf16_f32 v74, v74, v74
  v_lshlrev_b32 v74, 16, v74
  v_cvt_pk_bf16_f32 v78, v78, v78
  v_lshlrev_b32 v78, 16, v78
  v_mul_f32 v6, 0xbfb8aa3b, v74
  v_exp_f32 v6, v6
  s_nop 0
  v_add_f32 v6, 1.0, v6
  v_rcp_f32 v5, v6
  s_nop 0
  v_mul_f32 v74, v74, v5
  v_cvt_pk_bf16_f32 v74, v74, v74
  v_lshlrev_b32 v74, 16, v74
  v_mul_f32 v74, v74, v78
  v_cvt_pk_bf16_f32 v75, v75, v75
  v_lshlrev_b32 v75, 16, v75
  v_cvt_pk_bf16_f32 v79, v79, v79
  v_lshlrev_b32 v79, 16, v79
  v_mul_f32 v6, 0xbfb8aa3b, v75
  v_exp_f32 v6, v6
  s_nop 0
  v_add_f32 v6, 1.0, v6
  v_rcp_f32 v5, v6
  s_nop 0
  v_mul_f32 v75, v75, v5
  v_cvt_pk_bf16_f32 v75, v75, v75
  v_lshlrev_b32 v75, 16, v75
  v_mul_f32 v75, v75, v79
  v_cvt_pk_bf16_f32 v76, v72, v73
  v_cvt_pk_bf16_f32 v77, v74, v75
  v_and_b32 v5, 15, v0
  v_lshlrev_b32 v6, 4, v5
  v_lshrrev_b32 v7, 1, v12
  v_lshl_add_u32 v6, v7, 7, v6
  v_and_b32 v7, 1, v12
  v_lshl_add_u32 v6, v7, 3, v6
  s_lshr_b32 s24, s45, 1
  s_lshl_b32 s24, s24, 9
  s_and_b32 s26, s45, 1
  s_lshl_b32 s26, s26, 8
  s_add_u32 s24, s24, s26
  s_add_u32 s24, s24, 20480
  v_cmp_gt_u32 vcc, 8, v5
  s_and_saveexec_b64 s[36:37], vcc
  buffer_store_dwordx2 v[76:77], v6, s[16:19], s24 offen sc1
  s_mov_b64 exec, s[36:37]
  s_branch K1_TE
KT_OTH:
  s_waitcnt vmcnt(0)
  s_cmp_ge_u32 s2, 128
  s_cbranch_scc1 KT_PH2
  s_barrier
  s_branch K1_TE
KT_DN0:
  v_lshl_add_u32 v201, v12, 3, v11
  v_add_u32 v201, s25, v201
  s_mov_b32 s24, 1048576
  buffer_load_dwordx2 v[202:203], v201, s[16:19], s24 offen sc1
  s_mov_b32 s24, 3145728
  buffer_load_dwordx2 v[204:205], v201, s[16:19], s24 offen sc1
  v_lshlrev_b32 v13, 3, v12
  v_add_u32 v13, s25, v13
  s_mov_b32 s24, 7168
  buffer_load_dwordx2 v[206:207], v13, s[16:19], s24 offen
  v_lshrrev_b32 v13, 16, v9
  v_and_b32 v14, 0x8000, v13
  v_cmp_ne_u32 vcc, 0, v14
  v_xor_b32 v14, 0x8000, v13
  v_xor_b32 v15, 0xffff, v13
  v_cndmask_b32 v13, v15, v14, vcc
  v_lshlrev_b32 v208, 16, v13
KT_PH2:
  s_barrier
  s_mul_i32 s28, s22, 14336
  s_add_u32 s28, s28, 65536
  v_bfe_u32 v13, v0, 2, 2
  v_lshl_add_u32 v13, v12, 3, v13
  v_lshlrev_b32 v13, 5, v13
  v_and_b32 v14, 3, v0
  v_lshl_add_u32 v13, v14, 3, v13
  v_add_u32 v13, s28, v13
  ds_read_b64_tr_b16 v[80:81], v13 offset:0
  ds_read_b64_tr_b16 v[82:83], v13 offset:128
  ds_read_b64_tr_b16 v[84:85], v13 offset:1024
  ds_read_b64_tr_b16 v[86:87], v13 offset:1152
  ds_read_b64_tr_b16 v[88:89], v13 offset:2048
  ds_read_b64_tr_b16 v[90:91], v13 offset:2176
  ds_read_b64_tr_b16 v[92:93], v13 offset:3072
  ds_read_b64_tr_b16 v[94:95], v13 offset:3200
  ds_read_b64_tr_b16 v[96:97], v13 offset:4096
  ds_read_b64_tr_b16 v[98:99], v13 offset:4224
  ds_read_b64_tr_b16 v[100:101], v13 offset:5120
  ds_read_b64_tr_b16 v[102:103], v13 offset:5248
  ds_read_b64_tr_b16 v[104:105], v13 offset:6144
  ds_read_b64_tr_b16 v[106:107], v13 offset:6272
  s_waitcnt lgkmcnt(0)
  ds_read_b64_tr_b16 v[108:109], v13 offset:7168
  ds_read_b64_tr_b16 v[110:111], v13 offset:7296
  ds_read_b64_tr_b16 v[112:113], v13 offset:8192
  ds_read_b64_tr_b16 v[114:115], v13 offset:8320
  ds_read_b64_tr_b16 v[116:117], v13 offset:9216
  ds_read_b64_tr_b16 v[118:119], v13 offset:9344
  ds_read_b64_tr_b16 v[120:121], v13 offset:10240
  ds_read_b64_tr_b16 v[122:123], v13 offset:10368
  ds_read_b64_tr_b16 v[124:125], v13 offset:11264
  ds_read_b64_tr_b16 v[126:127], v13 offset:11392
  ds_read_b64_tr_b16 v[128:129], v13 offset:12288
  ds_read_b64_tr_b16 v[130:131], v13 offset:12416
  ds_read_b64_tr_b16 v[132:133], v13 offset:13312
  ds_read_b64_tr_b16 v[134:135], v13 offset:13440
  s_waitcnt lgkmcnt(0)
  v_and_b32 v5, 7, v0
  v_lshlrev_b32 v6, 4, v5
  v_lshl_add_u32 v6, v12, 7, v6
  s_mul_i32 s24, s22, 7168
  s_add_u32 s24, s24, 20480
  s_add_u32 s29, s24, 4096
  s_mov_b32 s26, 0x40000
KT_GPOLL:
  buffer_load_dwordx4 v[16:19], v6, s[16:19], s24 offen offset:0 sc1
  buffer_load_dwordx4 v[20:23], v6, s[16:19], s24 offen offset:512 sc1
  buffer_load_dwordx4 v[24:27], v6, s[16:19], s24 offen offset:1024 sc1
  buffer_load_dwordx4 v[28:31], v6, s[16:19], s24 offen offset:1536 sc1
  buffer_load_dwordx4 v[32:35], v6, s[16:19], s24 offen offset:2048 sc1
  buffer_load_dwordx4 v[36:39], v6, s[16:19], s24 offen offset:2560 sc1
  buffer_load_dwordx4 v[40:43], v6, s[16:19], s24 offen offset:3072 sc1
  buffer_load_dwordx4 v[44:47], v6, s[16:19], s24 offen offset:3584 sc1
  buffer_load_dwordx4 v[48:51], v6, s[16:19], s29 offen offset:0 sc1
  buffer_load_dwordx4 v[52:55], v6, s[16:19], s29 offen offset:512 sc1
  buffer_load_dwordx4 v[56:59], v6, s[16:19], s29 offen offset:1024 sc1
  buffer_load_dwordx4 v[60:63], v6, s[16:19], s29 offen offset:1536 sc1
  buffer_load_dwordx4 v[64:67], v6, s[16:19], s29 offen offset:2048 sc1
  buffer_load_dwordx4 v[68:71], v6, s[16:19], s29 offen offset:2560 sc1
  s_waitcnt vmcnt(0)
  v_max3_u32 v7, v16, v17, v18
  v_max3_u32 v7, v7, v19, v20
  v_max3_u32 v7, v7, v21, v22
  v_max3_u32 v7, v7, v23, v24
  v_max3_u32 v7, v7, v25, v26
  v_max3_u32 v7, v7, v27, v28
  v_max3_u32 v7, v7, v29, v30
  v_max3_u32 v7, v7, v31, v32
  v_max3_u32 v7, v7, v33, v34
  v_max3_u32 v7, v7, v35, v36
  v_max3_u32 v7, v7, v37, v38
  v_max3_u32 v7, v7, v39, v40
  v_max3_u32 v7, v7, v41, v42
  v_max3_u32 v7, v7, v43, v44
  v_max3_u32 v7, v7, v45, v46
  v_max3_u32 v7, v7, v47, v48
  v_max3_u32 v7, v7, v49, v50
  v_max3_u32 v7, v7, v51, v52
  v_max3_u32 v7, v7, v53, v54
  v_max3_u32 v7, v7, v55, v56
  v_max3_u32 v7, v7, v57, v58
  v_max3_u32 v7, v7, v59, v60
  v_max3_u32 v7, v7, v61, v62
  v_max3_u32 v7, v7, v63, v64
  v_max3_u32 v7, v7, v65, v66
  v_max3_u32 v7, v7, v67, v68
  v_max3_u32 v7, v7, v69, v70
  v_max_u32 v7, v7, v71
  v_cmp_eq_u32 vcc, -1, v7
  s_sub_u32 s26, s26, 1
  s_cbranch_scc1 KT_GGOT
  s_cbranch_vccnz KT_GPOLL
KT_GGOT:
  v_mfma_f32_16x16x32_bf16 v[72:75], v[80:83], v[16:19], 0
  v_mfma_f32_16x16x32_bf16 v[72:75], v[84:87], v[20:23], v[72:75]
  v_mfma_f32_16x16x32_bf16 v[72:75], v[88:91], v[24:27], v[72:75]
  v_mfma_f32_16x16x32_bf16 v[72:75], v[92:95], v[28:31], v[72:75]
  v_mfma_f32_16x16x32_bf16 v[72:75], v[96:99], v[32:35], v[72:75]
  v_mfma_f32_16x16x32_bf16 v[72:75], v[100:103], v[36:39], v[72:75]
  v_mfma_f32_16x16x32_bf16 v[72:75], v[104:107], v[40:43], v[72:75]
  v_mfma_f32_16x16x32_bf16 v[72:75], v[108:111], v[44:47], v[72:75]
  v_mfma_f32_16x16x32_bf16 v[72:75], v[112:115], v[48:51], v[72:75]
  v_mfma_f32_16x16x32_bf16 v[72:75], v[116:119], v[52:55], v[72:75]
  v_mfma_f32_16x16x32_bf16 v[72:75], v[120:123], v[56:59], v[72:75]
  v_mfma_f32_16x16x32_bf16 v[72:75], v[124:127], v[60:63], v[72:75]
  v_mfma_f32_16x16x32_bf16 v[72:75], v[128:131], v[64:67], v[72:75]
  v_mfma_f32_16x16x32_bf16 v[72:75], v[132:135], v[68:71], v[72:75]
  s_nop 7
  v_lshlrev_b32 v3, 4, v0
  s_lshl_b32 s24, s22, 10
  s_add_u32 s24, s24, 131328
  v_add_u32 v3, s24, v3
  ds_write_b128 v3, v[72:75]
  s_waitcnt lgkmcnt(0)
  s_barrier
  s_cmp_lg_u32 s22, 0
  s_cbranch_scc1 K1_TE
  ds_read_b128 v[20:23], v3 offset:1024
  ds_read_b128 v[24:27], v3 offset:2048
  ds_read_b128 v[28:31], v3 offset:3072
  v_mul_f32 v6, 0xbfb8aa3b, v208
  v_exp_f32 v6, v6
  s_nop 0
  v_add_f32 v6, 1.0, v6
  v_rcp_f32 v5, v6
  s_nop 0
  v_cvt_pk_bf16_f32 v5, v5, v5
  v_lshlrev_b32 v5, 16, v5
  s_waitcnt lgkmcnt(0)
  v_add_f32 v72, v72, v20
  v_add_f32 v72, v72, v24
  v_add_f32 v72, v72, v28
  v_cvt_pk_bf16_f32 v72, v72, v72
  v_lshlrev_b32 v72, 16, v72
  v_mul_f32 v72, v72, v5
  v_cvt_pk_bf16_f32 v72, v72, v72
  v_lshlrev_b32 v72, 16, v72
  v_add_f32 v73, v73, v21
  v_add_f32 v73, v73, v25
  v_add_f32 v73, v73, v29
  v_cvt_pk_bf16_f32 v73, v73, v73
  v_lshlrev_b32 v73, 16, v73
  v_mul_f32 v73, v73, v5
  v_cvt_pk_bf16_f32 v73, v73, v73
  v_lshlrev_b32 v73, 16, v73
  v_add_f32 v74, v74, v22
  v_add_f32 v74, v74, v26
  v_add_f32 v74, v74, v30
  v_cvt_pk_bf16_f32 v74, v74, v74
  v_lshlrev_b32 v74, 16, v74
  v_mul_f32 v74, v74, v5
  v_cvt_pk_bf16_f32 v74, v74, v74
  v_lshlrev_b32 v74, 16, v74
  v_add_f32 v75, v75, v23
  v_add_f32 v75, v75, v27
  v_add_f32 v75, v75, v31
  v_cvt_pk_bf16_f32 v75, v75, v75
  v_lshlrev_b32 v75, 16, v75
  v_mul_f32 v75, v75, v5
  v_cvt_pk_bf16_f32 v75, v75, v75
  v_lshlrev_b32 v75, 16, v75
  v_lshlrev_b32 v16, 16, v204
  v_and_b32 v17, 0xffff0000, v204
  v_lshlrev_b32 v20, 16, v202
  v_and_b32 v21, 0xffff0000, v202
  v_lshlrev_b32 v24, 16, v206
  v_and_b32 v25, 0xffff0000, v206
  v_lshlrev_b32 v18, 16, v205
  v_and_b32 v19, 0xffff0000, v205
  v_lshlrev_b32 v22, 16, v203
  v_and_b32 v23, 0xffff0000, v203
  v_lshlrev_b32 v26, 16, v207
  v_and_b32 v27, 0xffff0000, v207
  v_add_f32 v72, v72, v16
  v_cvt_pk_bf16_f32 v72, v72, v72
  v_lshlrev_b32 v72, 16, v72
  v_mul_f32 v72, v72, v24
  v_cvt_pk_bf16_f32 v72, v72, v72
  v_lshlrev_b32 v72, 16, v72
  v_add_f32 v72, v72, v20
  v_add_f32 v73, v73, v17
  v_cvt_pk_bf16_f32 v73, v73, v73
  v_lshlrev_b32 v73, 16, v73
  v_mul_f32 v73, v73, v25
  v_cvt_pk_bf16_f32 v73, v73, v73
  v_lshlrev_b32 v73, 16, v73
  v_add_f32 v73, v73, v21
  v_add_f32 v74, v74, v18
  v_cvt_pk_bf16_f32 v74, v74, v74
  v_lshlrev_b32 v74, 16, v74
  v_mul_f32 v74, v74, v26
  v_cvt_pk_bf16_f32 v74, v74, v74
  v_lshlrev_b32 v74, 16, v74
  v_add_f32 v74, v74, v22
  v_add_f32 v75, v75, v19
  v_cvt_pk_bf16_f32 v75, v75, v75
  v_lshlrev_b32 v75, 16, v75
  v_mul_f32 v75, v75, v27
  v_cvt_pk_bf16_f32 v75, v75, v75
  v_lshlrev_b32 v75, 16, v75
  v_add_f32 v75, v75, v23
  v_cvt_pk_bf16_f32 v76, v72, v73
  v_cvt_pk_bf16_f32 v77, v74, v75
  v_and_b32 v5, 15, v0
  v_cmp_gt_u32 vcc, 8, v5
  s_and_saveexec_b64 s[36:37], vcc
  buffer_store_dwordx2 v[76:77], v201, s[8:11], 0 offen sc1
  s_mov_b64 exec, s[36:37]
K1_TE:
  s_waitcnt vmcnt(0)
K1_DONE:
  s_endpgm
TR_1:
  s_call_b64 s[30:31], FB_1
  s_branch RET_2
TR_3:
  s_call_b64 s[30:31], FB_0
  s_branch RET_4
TR_5:
  s_call_b64 s[30:31], FB_1
  s_branch RET_6
TR_7:
  s_call_b64 s[30:31], FB_0
  s_branch RET_8
TR_9:
  s_call_b64 s[30:31], FB_1
  s_branch RET_10
FB_0:
  s_nop 15
  v_max3_f32 v4, v16, v17, v18
  v_max3_f32 v4, v4, v19, v32
  v_max3_f32 v4, v4, v33, v34
  v_max_f32 v4, v4, v35
  v_mov_b32 v5, v4
  s_nop 1
  v_permlane32_swap_b32 v4, v5
  s_nop 1
  v_max_f32 v4, v4, v5
  v_mov_b32 v5, v4
  s_nop 1
  v_permlane16_swap_b32 v4, v5
  s_nop 1
  v_max_f32 v4, v4, v5
  v_max_f32 v4, 0, v4
  v_exp_f32 v5, -v4
  s_nop 0
  v_accvgpr_read_b32 v1, a0
  v_mul_f32 v1, v5, v1
  v_accvgpr_write_b32 a0, v1
  v_accvgpr_read_b32 v1, a1
  v_mul_f32 v1, v5, v1
  v_accvgpr_write_b32 a1, v1
  v_accvgpr_read_b32 v1, a2
  v_mul_f32 v1, v5, v1
  v_accvgpr_write_b32 a2, v1
  v_accvgpr_read_b32 v1, a3
  v_mul_f32 v1, v5, v1
  v_accvgpr_write_b32 a3, v1
  v_accvgpr_read_b32 v1, a16
  v_mul_f32 v1, v5, v1
  v_accvgpr_write_b32 a16, v1
  v_accvgpr_read_b32 v1, a17
  v_mul_f32 v1, v5, v1
  v_accvgpr_write_b32 a17, v1
  v_accvgpr_read_b32 v1, a18
  v_mul_f32 v1, v5, v1
  v_accvgpr_write_b32 a18, v1
  v_accvgpr_read_b32 v1, a19
  v_mul_f32 v1, v5, v1
  v_accvgpr_write_b32 a19, v1
  v_accvgpr_read_b32 v1, a32
  v_mul_f32 v1, v5, v1
  v_accvgpr_write_b32 a32, v1
  v_accvgpr_read_b32 v1, a33
  v_mul_f32 v1, v5, v1
  v_accvgpr_write_b32 a33, v1
  v_accvgpr_read_b32 v1, a34
  v_mul_f32 v1, v5, v1
  v_accvgpr_write_b32 a34, v1
  v_accvgpr_read_b32 v1, a35
  v_mul_f32 v1, v5, v1
  v_accvgpr_write_b32 a35, v1
  v_accvgpr_read_b32 v1, a48
  v_mul_f32 v1, v5, v1
  v_accvgpr_write_b32 a48, v1
  v_accvgpr_read_b32 v1, a49
  v_mul_f32 v1, v5, v1
  v_accvgpr_write_b32 a49, v1
  v_accvgpr_read_b32 v1, a50
  v_mul_f32 v1, v5, v1
  v_accvgpr_write_b32 a50, v1
  v_accvgpr_read_b32 v1, a51
  v_mul_f32 v1, v5, v1
  v_accvgpr_write_b32 a51, v1
  v_accvgpr_read_b32 v1, a64
  v_mul_f32 v1, v5, v1
  v_accvgpr_write_b32 a64, v1
  v_accvgpr_read_b32 v1, a65
  v_mul_f32 v1, v5, v1
  v_accvgpr_write_b32 a65, v1
  v_accvgpr_read_b32 v1, a66
  v_mul_f32 v1, v5, v1
  v_accvgpr_write_b32 a66, v1
  v_accvgpr_read_b32 v1, a67
  v_mul_f32 v1, v5, v1
  v_accvgpr_write_b32 a67, v1
  v_accvgpr_read_b32 v1, a80
  v_mul_f32 v1, v5, v1
  v_accvgpr_write_b32 a80, v1
  v_accvgpr_read_b32 v1, a81
  v_mul_f32 v1, v5, v1
  v_accvgpr_write_b32 a81, v1
  v_accvgpr_read_b32 v1, a82
  v_mul_f32 v1, v5, v1
  v_accvgpr_write_b32 a82, v1
  v_accvgpr_read_b32 v1, a83
  v_mul_f32 v1, v5, v1
  v_accvgpr_write_b32 a83, v1
  v_accvgpr_read_b32 v1, a96
  v_mul_f32 v1, v5, v1
  v_accvgpr_write_b32 a96, v1
  v_accvgpr_read_b32 v1, a97
  v_mul_f32 v1, v5, v1
  v_accvgpr_write_b32 a97, v1
  v_accvgpr_read_b32 v1, a98
  v_mul_f32 v1, v5, v1
  v_accvgpr_write_b32 a98, v1
  v_accvgpr_read_b32 v1, a99
  v_mul_f32 v1, v5, v1
  v_accvgpr_write_b32 a99, v1
  v_accvgpr_read_b32 v1, a112
  v_mul_f32 v1, v5, v1
  v_accvgpr_write_b32 a112, v1
  v_accvgpr_read_b32 v1, a113
  v_mul_f32 v1, v5, v1
  v_accvgpr_write_b32 a113, v1
  v_accvgpr_read_b32 v1, a114
  v_mul_f32 v1, v5, v1
  v_accvgpr_write_b32 a114, v1
  v_accvgpr_read_b32 v1, a115
  v_mul_f32 v1, v5, v1
  v_accvgpr_write_b32 a115, v1
  v_accvgpr_read_b32 v1, a128
  v_mul_f32 v1, v5, v1
  v_accvgpr_write_b32 a128, v1
  v_accvgpr_read_b32 v1, a129
  v_mul_f32 v1, v5, v1
  v_accvgpr_write_b32 a129, v1
  v_accvgpr_read_b32 v1, a130
  v_mul_f32 v1, v5, v1
  v_accvgpr_write_b32 a130, v1
  v_accvgpr_read_b32 v1, a131
  v_mul_f32 v1, v5, v1
  v_accvgpr_write_b32 a131, v1
  v_accvgpr_read_b32 v1, a144
  v_mul_f32 v1, v5, v1
  v_accvgpr_write_b32 a144, v1
  v_accvgpr_read_b32 v1, a145
  v_mul_f32 v1, v5, v1
  v_accvgpr_write_b32 a145, v1
  v_accvgpr_read_b32 v1, a146
  v_mul_f32 v1, v5, v1
  v_accvgpr_write_b32 a146, v1
  v_accvgpr_read_b32 v1, a147
  v_mul_f32 v1, v5, v1
  v_accvgpr_write_b32 a147, v1
  v_accvgpr_read_b32 v1, a160
  v_mul_f32 v1, v5, v1
  v_accvgpr_write_b32 a160, v1
  v_accvgpr_read_b32 v1, a161
  v_mul_f32 v1, v5, v1
  v_accvgpr_write_b32 a161, v1
  v_accvgpr_read_b32 v1, a162
  v_mul_f32 v1, v5, v1
  v_accvgpr_write_b32 a162, v1
  v_accvgpr_read_b32 v1, a163
  v_mul_f32 v1, v5, v1
  v_accvgpr_write_b32 a163, v1
  v_accvgpr_read_b32 v1, a176
  v_mul_f32 v1, v5, v1
  v_accvgpr_write_b32 a176, v1
  v_accvgpr_read_b32 v1, a177
  v_mul_f32 v1, v5, v1
  v_accvgpr_write_b32 a177, v1
  v_accvgpr_read_b32 v1, a178
  v_mul_f32 v1, v5, v1
  v_accvgpr_write_b32 a178, v1
  v_accvgpr_read_b32 v1, a179
  v_mul_f32 v1, v5, v1
  v_accvgpr_write_b32 a179, v1
  v_accvgpr_read_b32 v1, a192
  v_mul_f32 v1, v5, v1
  v_accvgpr_write_b32 a192, v1
  v_accvgpr_read_b32 v1, a193
  v_mul_f32 v1, v5, v1
  v_accvgpr_write_b32 a193, v1
  v_accvgpr_read_b32 v1, a194
  v_mul_f32 v1, v5, v1
  v_accvgpr_write_b32 a194, v1
  v_accvgpr_read_b32 v1, a195
  v_mul_f32 v1, v5, v1
  v_accvgpr_write_b32 a195, v1
  v_accvgpr_read_b32 v1, a208
  v_mul_f32 v1, v5, v1
  v_accvgpr_write_b32 a208, v1
  v_accvgpr_read_b32 v1, a209
  v_mul_f32 v1, v5, v1
  v_accvgpr_write_b32 a209, v1
  v_accvgpr_read_b32 v1, a210
  v_mul_f32 v1, v5, v1
  v_accvgpr_write_b32 a210, v1
  v_accvgpr_read_b32 v1, a211
  v_mul_f32 v1, v5, v1
  v_accvgpr_write_b32 a211, v1
  v_accvgpr_read_b32 v1, a224
  v_mul_f32 v1, v5, v1
  v_accvgpr_write_b32 a224, v1
  v_accvgpr_read_b32 v1, a225
  v_mul_f32 v1, v5, v1
  v_accvgpr_write_b32 a225, v1
  v_accvgpr_read_b32 v1, a226
  v_mul_f32 v1, v5, v1
  v_accvgpr_write_b32 a226, v1
  v_accvgpr_read_b32 v1, a227
  v_mul_f32 v1, v5, v1
  v_accvgpr_write_b32 a227, v1
  v_accvgpr_read_b32 v1, a240
  v_mul_f32 v1, v5, v1
  v_accvgpr_write_b32 a240, v1
  v_accvgpr_read_b32 v1, a241
  v_mul_f32 v1, v5, v1
  v_accvgpr_write_b32 a241, v1
  v_accvgpr_read_b32 v1, a242
  v_mul_f32 v1, v5, v1
  v_accvgpr_write_b32 a242, v1
  v_accvgpr_read_b32 v1, a243
  v_mul_f32 v1, v5, v1
  v_accvgpr_write_b32 a243, v1
  v_mul_f32 v120, v5, v120
  v_sub_f32 v48, v48, v4
  v_sub_f32 v16, v16, v4
  v_sub_f32 v32, v32, v4
  v_sub_f32 v49, v49, v4
  v_sub_f32 v17, v17, v4
  v_sub_f32 v33, v33, v4
  v_sub_f32 v50, v50, v4
  v_sub_f32 v18, v18, v4
  v_sub_f32 v34, v34, v4
  v_sub_f32 v51, v51, v4
  v_sub_f32 v19, v19, v4
  v_sub_f32 v35, v35, v4
  v_max3_f32 v4, v20, v21, v22
  v_max3_f32 v4, v4, v23, v36
  v_max3_f32 v4, v4, v37, v38
  v_max_f32 v4, v4, v39
  v_mov_b32 v5, v4
  s_nop 1
  v_permlane32_swap_b32 v4, v5
  s_nop 1
  v_max_f32 v4, v4, v5
  v_mov_b32 v5, v4
  s_nop 1
  v_permlane16_swap_b32 v4, v5
  s_nop 1
  v_max_f32 v4, v4, v5
  v_max_f32 v4, 0, v4
  v_exp_f32 v5, -v4
  s_nop 0
  v_accvgpr_read_b32 v1, a4
  v_mul_f32 v1, v5, v1
  v_accvgpr_write_b32 a4, v1
  v_accvgpr_read_b32 v1, a5
  v_mul_f32 v1, v5, v1
  v_accvgpr_write_b32 a5, v1
  v_accvgpr_read_b32 v1, a6
  v_mul_f32 v1, v5, v1
  v_accvgpr_write_b32 a6, v1
  v_accvgpr_read_b32 v1, a7
  v_mul_f32 v1, v5, v1
  v_accvgpr_write_b32 a7, v1
  v_accvgpr_read_b32 v1, a20
  v_mul_f32 v1, v5, v1
  v_accvgpr_write_b32 a20, v1
  v_accvgpr_read_b32 v1, a21
  v_mul_f32 v1, v5, v1
  v_accvgpr_write_b32 a21, v1
  v_accvgpr_read_b32 v1, a22
  v_mul_f32 v1, v5, v1
  v_accvgpr_write_b32 a22, v1
  v_accvgpr_read_b32 v1, a23
  v_mul_f32 v1, v5, v1
  v_accvgpr_write_b32 a23, v1
  v_accvgpr_read_b32 v1, a36
  v_mul_f32 v1, v5, v1
  v_accvgpr_write_b32 a36, v1
  v_accvgpr_read_b32 v1, a37
  v_mul_f32 v1, v5, v1
  v_accvgpr_write_b32 a37, v1
  v_accvgpr_read_b32 v1, a38
  v_mul_f32 v1, v5, v1
  v_accvgpr_write_b32 a38, v1
  v_accvgpr_read_b32 v1, a39
  v_mul_f32 v1, v5, v1
  v_accvgpr_write_b32 a39, v1
  v_accvgpr_read_b32 v1, a52
  v_mul_f32 v1, v5, v1
  v_accvgpr_write_b32 a52, v1
  v_accvgpr_read_b32 v1, a53
  v_mul_f32 v1, v5, v1
  v_accvgpr_write_b32 a53, v1
  v_accvgpr_read_b32 v1, a54
  v_mul_f32 v1, v5, v1
  v_accvgpr_write_b32 a54, v1
  v_accvgpr_read_b32 v1, a55
  v_mul_f32 v1, v5, v1
  v_accvgpr_write_b32 a55, v1
  v_accvgpr_read_b32 v1, a68
  v_mul_f32 v1, v5, v1
  v_accvgpr_write_b32 a68, v1
  v_accvgpr_read_b32 v1, a69
  v_mul_f32 v1, v5, v1
  v_accvgpr_write_b32 a69, v1
  v_accvgpr_read_b32 v1, a70
  v_mul_f32 v1, v5, v1
  v_accvgpr_write_b32 a70, v1
  v_accvgpr_read_b32 v1, a71
  v_mul_f32 v1, v5, v1
  v_accvgpr_write_b32 a71, v1
  v_accvgpr_read_b32 v1, a84
  v_mul_f32 v1, v5, v1
  v_accvgpr_write_b32 a84, v1
  v_accvgpr_read_b32 v1, a85
  v_mul_f32 v1, v5, v1
  v_accvgpr_write_b32 a85, v1
  v_accvgpr_read_b32 v1, a86
  v_mul_f32 v1, v5, v1
  v_accvgpr_write_b32 a86, v1
  v_accvgpr_read_b32 v1, a87
  v_mul_f32 v1, v5, v1
  v_accvgpr_write_b32 a87, v1
  v_accvgpr_read_b32 v1, a100
  v_mul_f32 v1, v5, v1
  v_accvgpr_write_b32 a100, v1
  v_accvgpr_read_b32 v1, a101
  v_mul_f32 v1, v5, v1
  v_accvgpr_write_b32 a101, v1
  v_accvgpr_read_b32 v1, a102
  v_mul_f32 v1, v5, v1
  v_accvgpr_write_b32 a102, v1
  v_accvgpr_read_b32 v1, a103
  v_mul_f32 v1, v5, v1
  v_accvgpr_write_b32 a103, v1
  v_accvgpr_read_b32 v1, a116
  v_mul_f32 v1, v5, v1
  v_accvgpr_write_b32 a116, v1
  v_accvgpr_read_b32 v1, a117
  v_mul_f32 v1, v5, v1
  v_accvgpr_write_b32 a117, v1
  v_accvgpr_read_b32 v1, a118
  v_mul_f32 v1, v5, v1
  v_accvgpr_write_b32 a118, v1
  v_accvgpr_read_b32 v1, a119
  v_mul_f32 v1, v5, v1
  v_accvgpr_write_b32 a119, v1
  v_accvgpr_read_b32 v1, a132
  v_mul_f32 v1, v5, v1
  v_accvgpr_write_b32 a132, v1
  v_accvgpr_read_b32 v1, a133
  v_mul_f32 v1, v5, v1
  v_accvgpr_write_b32 a133, v1
  v_accvgpr_read_b32 v1, a134
  v_mul_f32 v1, v5, v1
  v_accvgpr_write_b32 a134, v1
  v_accvgpr_read_b32 v1, a135
  v_mul_f32 v1, v5, v1
  v_accvgpr_write_b32 a135, v1
  v_accvgpr_read_b32 v1, a148
  v_mul_f32 v1, v5, v1
  v_accvgpr_write_b32 a148, v1
  v_accvgpr_read_b32 v1, a149
  v_mul_f32 v1, v5, v1
  v_accvgpr_write_b32 a149, v1
  v_accvgpr_read_b32 v1, a150
  v_mul_f32 v1, v5, v1
  v_accvgpr_write_b32 a150, v1
  v_accvgpr_read_b32 v1, a151
  v_mul_f32 v1, v5, v1
  v_accvgpr_write_b32 a151, v1
  v_accvgpr_read_b32 v1, a164
  v_mul_f32 v1, v5, v1
  v_accvgpr_write_b32 a164, v1
  v_accvgpr_read_b32 v1, a165
  v_mul_f32 v1, v5, v1
  v_accvgpr_write_b32 a165, v1
  v_accvgpr_read_b32 v1, a166
  v_mul_f32 v1, v5, v1
  v_accvgpr_write_b32 a166, v1
  v_accvgpr_read_b32 v1, a167
  v_mul_f32 v1, v5, v1
  v_accvgpr_write_b32 a167, v1
  v_accvgpr_read_b32 v1, a180
  v_mul_f32 v1, v5, v1
  v_accvgpr_write_b32 a180, v1
  v_accvgpr_read_b32 v1, a181
  v_mul_f32 v1, v5, v1
  v_accvgpr_write_b32 a181, v1
  v_accvgpr_read_b32 v1, a182
  v_mul_f32 v1, v5, v1
  v_accvgpr_write_b32 a182, v1
  v_accvgpr_read_b32 v1, a183
  v_mul_f32 v1, v5, v1
  v_accvgpr_write_b32 a183, v1
  v_accvgpr_read_b32 v1, a196
  v_mul_f32 v1, v5, v1
  v_accvgpr_write_b32 a196, v1
  v_accvgpr_read_b32 v1, a197
  v_mul_f32 v1, v5, v1
  v_accvgpr_write_b32 a197, v1
  v_accvgpr_read_b32 v1, a198
  v_mul_f32 v1, v5, v1
  v_accvgpr_write_b32 a198, v1
  v_accvgpr_read_b32 v1, a199
  v_mul_f32 v1, v5, v1
  v_accvgpr_write_b32 a199, v1
  v_accvgpr_read_b32 v1, a212
  v_mul_f32 v1, v5, v1
  v_accvgpr_write_b32 a212, v1
  v_accvgpr_read_b32 v1, a213
  v_mul_f32 v1, v5, v1
  v_accvgpr_write_b32 a213, v1
  v_accvgpr_read_b32 v1, a214
  v_mul_f32 v1, v5, v1
  v_accvgpr_write_b32 a214, v1
  v_accvgpr_read_b32 v1, a215
  v_mul_f32 v1, v5, v1
  v_accvgpr_write_b32 a215, v1
  v_accvgpr_read_b32 v1, a228
  v_mul_f32 v1, v5, v1
  v_accvgpr_write_b32 a228, v1
  v_accvgpr_read_b32 v1, a229
  v_mul_f32 v1, v5, v1
  v_accvgpr_write_b32 a229, v1
  v_accvgpr_read_b32 v1, a230
  v_mul_f32 v1, v5, v1
  v_accvgpr_write_b32 a230, v1
  v_accvgpr_read_b32 v1, a231
  v_mul_f32 v1, v5, v1
  v_accvgpr_write_b32 a231, v1
  v_accvgpr_read_b32 v1, a244
  v_mul_f32 v1, v5, v1
  v_accvgpr_write_b32 a244, v1
  v_accvgpr_read_b32 v1, a245
  v_mul_f32 v1, v5, v1
  v_accvgpr_write_b32 a245, v1
  v_accvgpr_read_b32 v1, a246
  v_mul_f32 v1, v5, v1
  v_accvgpr_write_b32 a246, v1
  v_accvgpr_read_b32 v1, a247
  v_mul_f32 v1, v5, v1
  v_accvgpr_write_b32 a247, v1
  v_mul_f32 v121, v5, v121
  v_sub_f32 v52, v52, v4
  v_sub_f32 v20, v20, v4
  v_sub_f32 v36, v36, v4
  v_sub_f32 v53, v53, v4
  v_sub_f32 v21, v21, v4
  v_sub_f32 v37, v37, v4
  v_sub_f32 v54, v54, v4
  v_sub_f32 v22, v22, v4
  v_sub_f32 v38, v38, v4
  v_sub_f32 v55, v55, v4
  v_sub_f32 v23, v23, v4
  v_sub_f32 v39, v39, v4
  v_max3_f32 v4, v24, v25, v26
  v_max3_f32 v4, v4, v27, v40
  v_max3_f32 v4, v4, v41, v42
  v_max_f32 v4, v4, v43
  v_mov_b32 v5, v4
  s_nop 1
  v_permlane32_swap_b32 v4, v5
  s_nop 1
  v_max_f32 v4, v4, v5
  v_mov_b32 v5, v4
  s_nop 1
  v_permlane16_swap_b32 v4, v5
  s_nop 1
  v_max_f32 v4, v4, v5
  v_max_f32 v4, 0, v4
  v_exp_f32 v5, -v4
  s_nop 0
  v_accvgpr_read_b32 v1, a8
  v_mul_f32 v1, v5, v1
  v_accvgpr_write_b32 a8, v1
  v_accvgpr_read_b32 v1, a9
  v_mul_f32 v1, v5, v1
  v_accvgpr_write_b32 a9, v1
  v_accvgpr_read_b32 v1, a10
  v_mul_f32 v1, v5, v1
  v_accvgpr_write_b32 a10, v1
  v_accvgpr_read_b32 v1, a11
  v_mul_f32 v1, v5, v1
  v_accvgpr_write_b32 a11, v1
  v_accvgpr_read_b32 v1, a24
  v_mul_f32 v1, v5, v1
  v_accvgpr_write_b32 a24, v1
  v_accvgpr_read_b32 v1, a25
  v_mul_f32 v1, v5, v1
  v_accvgpr_write_b32 a25, v1
  v_accvgpr_read_b32 v1, a26
  v_mul_f32 v1, v5, v1
  v_accvgpr_write_b32 a26, v1
  v_accvgpr_read_b32 v1, a27
  v_mul_f32 v1, v5, v1
  v_accvgpr_write_b32 a27, v1
  v_accvgpr_read_b32 v1, a40
  v_mul_f32 v1, v5, v1
  v_accvgpr_write_b32 a40, v1
  v_accvgpr_read_b32 v1, a41
  v_mul_f32 v1, v5, v1
  v_accvgpr_write_b32 a41, v1
  v_accvgpr_read_b32 v1, a42
  v_mul_f32 v1, v5, v1
  v_accvgpr_write_b32 a42, v1
  v_accvgpr_read_b32 v1, a43
  v_mul_f32 v1, v5, v1
  v_accvgpr_write_b32 a43, v1
  v_accvgpr_read_b32 v1, a56
  v_mul_f32 v1, v5, v1
  v_accvgpr_write_b32 a56, v1
  v_accvgpr_read_b32 v1, a57
  v_mul_f32 v1, v5, v1
  v_accvgpr_write_b32 a57, v1
  v_accvgpr_read_b32 v1, a58
  v_mul_f32 v1, v5, v1
  v_accvgpr_write_b32 a58, v1
  v_accvgpr_read_b32 v1, a59
  v_mul_f32 v1, v5, v1
  v_accvgpr_write_b32 a59, v1
  v_accvgpr_read_b32 v1, a72
  v_mul_f32 v1, v5, v1
  v_accvgpr_write_b32 a72, v1
  v_accvgpr_read_b32 v1, a73
  v_mul_f32 v1, v5, v1
  v_accvgpr_write_b32 a73, v1
  v_accvgpr_read_b32 v1, a74
  v_mul_f32 v1, v5, v1
  v_accvgpr_write_b32 a74, v1
  v_accvgpr_read_b32 v1, a75
  v_mul_f32 v1, v5, v1
  v_accvgpr_write_b32 a75, v1
  v_accvgpr_read_b32 v1, a88
  v_mul_f32 v1, v5, v1
  v_accvgpr_write_b32 a88, v1
  v_accvgpr_read_b32 v1, a89
  v_mul_f32 v1, v5, v1
  v_accvgpr_write_b32 a89, v1
  v_accvgpr_read_b32 v1, a90
  v_mul_f32 v1, v5, v1
  v_accvgpr_write_b32 a90, v1
  v_accvgpr_read_b32 v1, a91
  v_mul_f32 v1, v5, v1
  v_accvgpr_write_b32 a91, v1
  v_accvgpr_read_b32 v1, a104
  v_mul_f32 v1, v5, v1
  v_accvgpr_write_b32 a104, v1
  v_accvgpr_read_b32 v1, a105
  v_mul_f32 v1, v5, v1
  v_accvgpr_write_b32 a105, v1
  v_accvgpr_read_b32 v1, a106
  v_mul_f32 v1, v5, v1
  v_accvgpr_write_b32 a106, v1
  v_accvgpr_read_b32 v1, a107
  v_mul_f32 v1, v5, v1
  v_accvgpr_write_b32 a107, v1
  v_accvgpr_read_b32 v1, a120
  v_mul_f32 v1, v5, v1
  v_accvgpr_write_b32 a120, v1
  v_accvgpr_read_b32 v1, a121
  v_mul_f32 v1, v5, v1
  v_accvgpr_write_b32 a121, v1
  v_accvgpr_read_b32 v1, a122
  v_mul_f32 v1, v5, v1
  v_accvgpr_write_b32 a122, v1
  v_accvgpr_read_b32 v1, a123
  v_mul_f32 v1, v5, v1
  v_accvgpr_write_b32 a123, v1
  v_accvgpr_read_b32 v1, a136
  v_mul_f32 v1, v5, v1
  v_accvgpr_write_b32 a136, v1
  v_accvgpr_read_b32 v1, a137
  v_mul_f32 v1, v5, v1
  v_accvgpr_write_b32 a137, v1
  v_accvgpr_read_b32 v1, a138
  v_mul_f32 v1, v5, v1
  v_accvgpr_write_b32 a138, v1
  v_accvgpr_read_b32 v1, a139
  v_mul_f32 v1, v5, v1
  v_accvgpr_write_b32 a139, v1
  v_accvgpr_read_b32 v1, a152
  v_mul_f32 v1, v5, v1
  v_accvgpr_write_b32 a152, v1
  v_accvgpr_read_b32 v1, a153
  v_mul_f32 v1, v5, v1
  v_accvgpr_write_b32 a153, v1
  v_accvgpr_read_b32 v1, a154
  v_mul_f32 v1, v5, v1
  v_accvgpr_write_b32 a154, v1
  v_accvgpr_read_b32 v1, a155
  v_mul_f32 v1, v5, v1
  v_accvgpr_write_b32 a155, v1
  v_accvgpr_read_b32 v1, a168
  v_mul_f32 v1, v5, v1
  v_accvgpr_write_b32 a168, v1
  v_accvgpr_read_b32 v1, a169
  v_mul_f32 v1, v5, v1
  v_accvgpr_write_b32 a169, v1
  v_accvgpr_read_b32 v1, a170
  v_mul_f32 v1, v5, v1
  v_accvgpr_write_b32 a170, v1
  v_accvgpr_read_b32 v1, a171
  v_mul_f32 v1, v5, v1
  v_accvgpr_write_b32 a171, v1
  v_accvgpr_read_b32 v1, a184
  v_mul_f32 v1, v5, v1
  v_accvgpr_write_b32 a184, v1
  v_accvgpr_read_b32 v1, a185
  v_mul_f32 v1, v5, v1
  v_accvgpr_write_b32 a185, v1
  v_accvgpr_read_b32 v1, a186
  v_mul_f32 v1, v5, v1
  v_accvgpr_write_b32 a186, v1
  v_accvgpr_read_b32 v1, a187
  v_mul_f32 v1, v5, v1
  v_accvgpr_write_b32 a187, v1
  v_accvgpr_read_b32 v1, a200
  v_mul_f32 v1, v5, v1
  v_accvgpr_write_b32 a200, v1
  v_accvgpr_read_b32 v1, a201
  v_mul_f32 v1, v5, v1
  v_accvgpr_write_b32 a201, v1
  v_accvgpr_read_b32 v1, a202
  v_mul_f32 v1, v5, v1
  v_accvgpr_write_b32 a202, v1
  v_accvgpr_read_b32 v1, a203
  v_mul_f32 v1, v5, v1
  v_accvgpr_write_b32 a203, v1
  v_accvgpr_read_b32 v1, a216
  v_mul_f32 v1, v5, v1
  v_accvgpr_write_b32 a216, v1
  v_accvgpr_read_b32 v1, a217
  v_mul_f32 v1, v5, v1
  v_accvgpr_write_b32 a217, v1
  v_accvgpr_read_b32 v1, a218
  v_mul_f32 v1, v5, v1
  v_accvgpr_write_b32 a218, v1
  v_accvgpr_read_b32 v1, a219
  v_mul_f32 v1, v5, v1
  v_accvgpr_write_b32 a219, v1
  v_accvgpr_read_b32 v1, a232
  v_mul_f32 v1, v5, v1
  v_accvgpr_write_b32 a232, v1
  v_accvgpr_read_b32 v1, a233
  v_mul_f32 v1, v5, v1
  v_accvgpr_write_b32 a233, v1
  v_accvgpr_read_b32 v1, a234
  v_mul_f32 v1, v5, v1
  v_accvgpr_write_b32 a234, v1
  v_accvgpr_read_b32 v1, a235
  v_mul_f32 v1, v5, v1
  v_accvgpr_write_b32 a235, v1
  v_accvgpr_read_b32 v1, a248
  v_mul_f32 v1, v5, v1
  v_accvgpr_write_b32 a248, v1
  v_accvgpr_read_b32 v1, a249
  v_mul_f32 v1, v5, v1
  v_accvgpr_write_b32 a249, v1
  v_accvgpr_read_b32 v1, a250
  v_mul_f32 v1, v5, v1
  v_accvgpr_write_b32 a250, v1
  v_accvgpr_read_b32 v1, a251
  v_mul_f32 v1, v5, v1
  v_accvgpr_write_b32 a251, v1
  v_mul_f32 v122, v5, v122
  v_sub_f32 v56, v56, v4
  v_sub_f32 v24, v24, v4
  v_sub_f32 v40, v40, v4
  v_sub_f32 v57, v57, v4
  v_sub_f32 v25, v25, v4
  v_sub_f32 v41, v41, v4
  v_sub_f32 v58, v58, v4
  v_sub_f32 v26, v26, v4
  v_sub_f32 v42, v42, v4
  v_sub_f32 v59, v59, v4
  v_sub_f32 v27, v27, v4
  v_sub_f32 v43, v43, v4
  v_max3_f32 v4, v28, v29, v30
  v_max3_f32 v4, v4, v31, v44
  v_max3_f32 v4, v4, v45, v46
  v_max_f32 v4, v4, v47
  v_mov_b32 v5, v4
  s_nop 1
  v_permlane32_swap_b32 v4, v5
  s_nop 1
  v_max_f32 v4, v4, v5
  v_mov_b32 v5, v4
  s_nop 1
  v_permlane16_swap_b32 v4, v5
  s_nop 1
  v_max_f32 v4, v4, v5
  v_max_f32 v4, 0, v4
  v_exp_f32 v5, -v4
  s_nop 0
  v_accvgpr_read_b32 v1, a12
  v_mul_f32 v1, v5, v1
  v_accvgpr_write_b32 a12, v1
  v_accvgpr_read_b32 v1, a13
  v_mul_f32 v1, v5, v1
  v_accvgpr_write_b32 a13, v1
  v_accvgpr_read_b32 v1, a14
  v_mul_f32 v1, v5, v1
  v_accvgpr_write_b32 a14, v1
  v_accvgpr_read_b32 v1, a15
  v_mul_f32 v1, v5, v1
  v_accvgpr_write_b32 a15, v1
  v_accvgpr_read_b32 v1, a28
  v_mul_f32 v1, v5, v1
  v_accvgpr_write_b32 a28, v1
  v_accvgpr_read_b32 v1, a29
  v_mul_f32 v1, v5, v1
  v_accvgpr_write_b32 a29, v1
  v_accvgpr_read_b32 v1, a30
  v_mul_f32 v1, v5, v1
  v_accvgpr_write_b32 a30, v1
  v_accvgpr_read_b32 v1, a31
  v_mul_f32 v1, v5, v1
  v_accvgpr_write_b32 a31, v1
  v_accvgpr_read_b32 v1, a44
  v_mul_f32 v1, v5, v1
  v_accvgpr_write_b32 a44, v1
  v_accvgpr_read_b32 v1, a45
  v_mul_f32 v1, v5, v1
  v_accvgpr_write_b32 a45, v1
  v_accvgpr_read_b32 v1, a46
  v_mul_f32 v1, v5, v1
  v_accvgpr_write_b32 a46, v1
  v_accvgpr_read_b32 v1, a47
  v_mul_f32 v1, v5, v1
  v_accvgpr_write_b32 a47, v1
  v_accvgpr_read_b32 v1, a60
  v_mul_f32 v1, v5, v1
  v_accvgpr_write_b32 a60, v1
  v_accvgpr_read_b32 v1, a61
  v_mul_f32 v1, v5, v1
  v_accvgpr_write_b32 a61, v1
  v_accvgpr_read_b32 v1, a62
  v_mul_f32 v1, v5, v1
  v_accvgpr_write_b32 a62, v1
  v_accvgpr_read_b32 v1, a63
  v_mul_f32 v1, v5, v1
  v_accvgpr_write_b32 a63, v1
  v_accvgpr_read_b32 v1, a76
  v_mul_f32 v1, v5, v1
  v_accvgpr_write_b32 a76, v1
  v_accvgpr_read_b32 v1, a77
  v_mul_f32 v1, v5, v1
  v_accvgpr_write_b32 a77, v1
  v_accvgpr_read_b32 v1, a78
  v_mul_f32 v1, v5, v1
  v_accvgpr_write_b32 a78, v1
  v_accvgpr_read_b32 v1, a79
  v_mul_f32 v1, v5, v1
  v_accvgpr_write_b32 a79, v1
  v_accvgpr_read_b32 v1, a92
  v_mul_f32 v1, v5, v1
  v_accvgpr_write_b32 a92, v1
  v_accvgpr_read_b32 v1, a93
  v_mul_f32 v1, v5, v1
  v_accvgpr_write_b32 a93, v1
  v_accvgpr_read_b32 v1, a94
  v_mul_f32 v1, v5, v1
  v_accvgpr_write_b32 a94, v1
  v_accvgpr_read_b32 v1, a95
  v_mul_f32 v1, v5, v1
  v_accvgpr_write_b32 a95, v1
  v_accvgpr_read_b32 v1, a108
  v_mul_f32 v1, v5, v1
  v_accvgpr_write_b32 a108, v1
  v_accvgpr_read_b32 v1, a109
  v_mul_f32 v1, v5, v1
  v_accvgpr_write_b32 a109, v1
  v_accvgpr_read_b32 v1, a110
  v_mul_f32 v1, v5, v1
  v_accvgpr_write_b32 a110, v1
  v_accvgpr_read_b32 v1, a111
  v_mul_f32 v1, v5, v1
  v_accvgpr_write_b32 a111, v1
  v_accvgpr_read_b32 v1, a124
  v_mul_f32 v1, v5, v1
  v_accvgpr_write_b32 a124, v1
  v_accvgpr_read_b32 v1, a125
  v_mul_f32 v1, v5, v1
  v_accvgpr_write_b32 a125, v1
  v_accvgpr_read_b32 v1, a126
  v_mul_f32 v1, v5, v1
  v_accvgpr_write_b32 a126, v1
  v_accvgpr_read_b32 v1, a127
  v_mul_f32 v1, v5, v1
  v_accvgpr_write_b32 a127, v1
  v_accvgpr_read_b32 v1, a140
  v_mul_f32 v1, v5, v1
  v_accvgpr_write_b32 a140, v1
  v_accvgpr_read_b32 v1, a141
  v_mul_f32 v1, v5, v1
  v_accvgpr_write_b32 a141, v1
  v_accvgpr_read_b32 v1, a142
  v_mul_f32 v1, v5, v1
  v_accvgpr_write_b32 a142, v1
  v_accvgpr_read_b32 v1, a143
  v_mul_f32 v1, v5, v1
  v_accvgpr_write_b32 a143, v1
  v_accvgpr_read_b32 v1, a156
  v_mul_f32 v1, v5, v1
  v_accvgpr_write_b32 a156, v1
  v_accvgpr_read_b32 v1, a157
  v_mul_f32 v1, v5, v1
  v_accvgpr_write_b32 a157, v1
  v_accvgpr_read_b32 v1, a158
  v_mul_f32 v1, v5, v1
  v_accvgpr_write_b32 a158, v1
  v_accvgpr_read_b32 v1, a159
  v_mul_f32 v1, v5, v1
  v_accvgpr_write_b32 a159, v1
  v_accvgpr_read_b32 v1, a172
  v_mul_f32 v1, v5, v1
  v_accvgpr_write_b32 a172, v1
  v_accvgpr_read_b32 v1, a173
  v_mul_f32 v1, v5, v1
  v_accvgpr_write_b32 a173, v1
  v_accvgpr_read_b32 v1, a174
  v_mul_f32 v1, v5, v1
  v_accvgpr_write_b32 a174, v1
  v_accvgpr_read_b32 v1, a175
  v_mul_f32 v1, v5, v1
  v_accvgpr_write_b32 a175, v1
  v_accvgpr_read_b32 v1, a188
  v_mul_f32 v1, v5, v1
  v_accvgpr_write_b32 a188, v1
  v_accvgpr_read_b32 v1, a189
  v_mul_f32 v1, v5, v1
  v_accvgpr_write_b32 a189, v1
  v_accvgpr_read_b32 v1, a190
  v_mul_f32 v1, v5, v1
  v_accvgpr_write_b32 a190, v1
  v_accvgpr_read_b32 v1, a191
  v_mul_f32 v1, v5, v1
  v_accvgpr_write_b32 a191, v1
  v_accvgpr_read_b32 v1, a204
  v_mul_f32 v1, v5, v1
  v_accvgpr_write_b32 a204, v1
  v_accvgpr_read_b32 v1, a205
  v_mul_f32 v1, v5, v1
  v_accvgpr_write_b32 a205, v1
  v_accvgpr_read_b32 v1, a206
  v_mul_f32 v1, v5, v1
  v_accvgpr_write_b32 a206, v1
  v_accvgpr_read_b32 v1, a207
  v_mul_f32 v1, v5, v1
  v_accvgpr_write_b32 a207, v1
  v_accvgpr_read_b32 v1, a220
  v_mul_f32 v1, v5, v1
  v_accvgpr_write_b32 a220, v1
  v_accvgpr_read_b32 v1, a221
  v_mul_f32 v1, v5, v1
  v_accvgpr_write_b32 a221, v1
  v_accvgpr_read_b32 v1, a222
  v_mul_f32 v1, v5, v1
  v_accvgpr_write_b32 a222, v1
  v_accvgpr_read_b32 v1, a223
  v_mul_f32 v1, v5, v1
  v_accvgpr_write_b32 a223, v1
  v_accvgpr_read_b32 v1, a236
  v_mul_f32 v1, v5, v1
  v_accvgpr_write_b32 a236, v1
  v_accvgpr_read_b32 v1, a237
  v_mul_f32 v1, v5, v1
  v_accvgpr_write_b32 a237, v1
  v_accvgpr_read_b32 v1, a238
  v_mul_f32 v1, v5, v1
  v_accvgpr_write_b32 a238, v1
  v_accvgpr_read_b32 v1, a239
  v_mul_f32 v1, v5, v1
  v_accvgpr_write_b32 a239, v1
  v_accvgpr_read_b32 v1, a252
  v_mul_f32 v1, v5, v1
  v_accvgpr_write_b32 a252, v1
  v_accvgpr_read_b32 v1, a253
  v_mul_f32 v1, v5, v1
  v_accvgpr_write_b32 a253, v1
  v_accvgpr_read_b32 v1, a254
  v_mul_f32 v1, v5, v1
  v_accvgpr_write_b32 a254, v1
  v_accvgpr_read_b32 v1, a255
  v_mul_f32 v1, v5, v1
  v_accvgpr_write_b32 a255, v1
  v_mul_f32 v123, v5, v123
  v_sub_f32 v60, v60, v4
  v_sub_f32 v28, v28, v4
  v_sub_f32 v44, v44, v4
  v_sub_f32 v61, v61, v4
  v_sub_f32 v29, v29, v4
  v_sub_f32 v45, v45, v4
  v_sub_f32 v62, v62, v4
  v_sub_f32 v30, v30, v4
  v_sub_f32 v46, v46, v4
  v_sub_f32 v63, v63, v4
  v_sub_f32 v31, v31, v4
  v_sub_f32 v47, v47, v4
  v_exp_f32 v112, v16
  s_nop 0
  v_exp_f32 v113, v17
  s_nop 0
  v_exp_f32 v114, v18
  s_nop 0
  v_exp_f32 v115, v19
  s_nop 0
  v_add_f32 v116, v112, v113
  v_cvt_pk_bf16_f32 v64, v112, v113
  v_exp_f32 v112, v20
  s_nop 0
  v_exp_f32 v113, v21
  s_nop 0
  v_add_f32 v116, v116, v114
  v_add_f32 v116, v116, v115
  v_cvt_pk_bf16_f32 v65, v114, v115
  v_exp_f32 v114, v22
  s_nop 0
  v_exp_f32 v115, v23
  s_nop 0
  v_add_f32 v117, v112, v113
  v_cvt_pk_bf16_f32 v68, v112, v113
  v_exp_f32 v112, v24
  s_nop 0
  v_exp_f32 v113, v25
  s_nop 0
  v_add_f32 v117, v117, v114
  v_add_f32 v117, v117, v115
  v_cvt_pk_bf16_f32 v69, v114, v115
  v_exp_f32 v114, v26
  s_nop 0
  v_exp_f32 v115, v27
  s_nop 0
  v_add_f32 v118, v112, v113
  v_cvt_pk_bf16_f32 v72, v112, v113
  v_exp_f32 v112, v28
  s_nop 0
  v_exp_f32 v113, v29
  s_nop 0
  v_add_f32 v118, v118, v114
  v_add_f32 v118, v118, v115
  v_cvt_pk_bf16_f32 v73, v114, v115
  v_exp_f32 v114, v30
  s_nop 0
  v_exp_f32 v115, v31
  s_nop 0
  v_add_f32 v119, v112, v113
  v_cvt_pk_bf16_f32 v76, v112, v113
  v_add_f32 v119, v119, v114
  v_add_f32 v119, v119, v115
  v_cvt_pk_bf16_f32 v77, v114, v115
  v_exp_f32 v112, v32
  s_nop 0
  v_exp_f32 v113, v33
  s_nop 0
  v_exp_f32 v114, v34
  s_nop 0
  v_exp_f32 v115, v35
  s_nop 0
  v_add_f32 v116, v116, v112
  v_add_f32 v116, v116, v113
  v_cvt_pk_bf16_f32 v66, v112, v113
  v_exp_f32 v112, v36
  s_nop 0
  v_exp_f32 v113, v37
  s_nop 0
  v_add_f32 v116, v116, v114
  v_add_f32 v116, v116, v115
  v_cvt_pk_bf16_f32 v67, v114, v115
  v_exp_f32 v114, v38
  s_nop 0
  v_exp_f32 v115, v39
  s_nop 0
  v_add_f32 v117, v117, v112
  v_add_f32 v117, v117, v113
  v_cvt_pk_bf16_f32 v70, v112, v113
  v_exp_f32 v112, v40
  s_nop 0
  v_exp_f32 v113, v41
  s_nop 0
  v_add_f32 v117, v117, v114
  v_add_f32 v117, v117, v115
  v_cvt_pk_bf16_f32 v71, v114, v115
  v_exp_f32 v114, v42
  s_nop 0
  v_exp_f32 v115, v43
  s_nop 0
  v_add_f32 v118, v118, v112
  v_add_f32 v118, v118, v113
  v_cvt_pk_bf16_f32 v74, v112, v113
  v_exp_f32 v112, v44
  s_nop 0
  v_exp_f32 v113, v45
  s_nop 0
  v_add_f32 v118, v118, v114
  v_add_f32 v118, v118, v115
  v_cvt_pk_bf16_f32 v75, v114, v115
  v_exp_f32 v114, v46
  s_nop 0
  v_exp_f32 v115, v47
  s_nop 0
  v_add_f32 v119, v119, v112
  v_add_f32 v119, v119, v113
  v_cvt_pk_bf16_f32 v78, v112, v113
  v_add_f32 v119, v119, v114
  v_add_f32 v119, v119, v115
  v_cvt_pk_bf16_f32 v79, v114, v115
  s_nop 3
  s_setpc_b64 s[30:31]
FB_1:
  s_nop 15
  v_max3_f32 v4, v16, v17, v18
  v_max3_f32 v4, v4, v19, v32
  v_max3_f32 v4, v4, v33, v34
  v_max_f32 v4, v4, v35
  v_mov_b32 v5, v4
  s_nop 1
  v_permlane32_swap_b32 v4, v5
  s_nop 1
  v_max_f32 v4, v4, v5
  v_mov_b32 v5, v4
  s_nop 1
  v_permlane16_swap_b32 v4, v5
  s_nop 1
  v_max_f32 v4, v4, v5
  v_max_f32 v4, 0, v4
  v_exp_f32 v5, -v4
  s_nop 0
  v_accvgpr_read_b32 v1, a0
  v_mul_f32 v1, v5, v1
  v_accvgpr_write_b32 a0, v1
  v_accvgpr_read_b32 v1, a1
  v_mul_f32 v1, v5, v1
  v_accvgpr_write_b32 a1, v1
  v_accvgpr_read_b32 v1, a2
  v_mul_f32 v1, v5, v1
  v_accvgpr_write_b32 a2, v1
  v_accvgpr_read_b32 v1, a3
  v_mul_f32 v1, v5, v1
  v_accvgpr_write_b32 a3, v1
  v_accvgpr_read_b32 v1, a16
  v_mul_f32 v1, v5, v1
  v_accvgpr_write_b32 a16, v1
  v_accvgpr_read_b32 v1, a17
  v_mul_f32 v1, v5, v1
  v_accvgpr_write_b32 a17, v1
  v_accvgpr_read_b32 v1, a18
  v_mul_f32 v1, v5, v1
  v_accvgpr_write_b32 a18, v1
  v_accvgpr_read_b32 v1, a19
  v_mul_f32 v1, v5, v1
  v_accvgpr_write_b32 a19, v1
  v_accvgpr_read_b32 v1, a32
  v_mul_f32 v1, v5, v1
  v_accvgpr_write_b32 a32, v1
  v_accvgpr_read_b32 v1, a33
  v_mul_f32 v1, v5, v1
  v_accvgpr_write_b32 a33, v1
  v_accvgpr_read_b32 v1, a34
  v_mul_f32 v1, v5, v1
  v_accvgpr_write_b32 a34, v1
  v_accvgpr_read_b32 v1, a35
  v_mul_f32 v1, v5, v1
  v_accvgpr_write_b32 a35, v1
  v_accvgpr_read_b32 v1, a48
  v_mul_f32 v1, v5, v1
  v_accvgpr_write_b32 a48, v1
  v_accvgpr_read_b32 v1, a49
  v_mul_f32 v1, v5, v1
  v_accvgpr_write_b32 a49, v1
  v_accvgpr_read_b32 v1, a50
  v_mul_f32 v1, v5, v1
  v_accvgpr_write_b32 a50, v1
  v_accvgpr_read_b32 v1, a51
  v_mul_f32 v1, v5, v1
  v_accvgpr_write_b32 a51, v1
  v_accvgpr_read_b32 v1, a64
  v_mul_f32 v1, v5, v1
  v_accvgpr_write_b32 a64, v1
  v_accvgpr_read_b32 v1, a65
  v_mul_f32 v1, v5, v1
  v_accvgpr_write_b32 a65, v1
  v_accvgpr_read_b32 v1, a66
  v_mul_f32 v1, v5, v1
  v_accvgpr_write_b32 a66, v1
  v_accvgpr_read_b32 v1, a67
  v_mul_f32 v1, v5, v1
  v_accvgpr_write_b32 a67, v1
  v_accvgpr_read_b32 v1, a80
  v_mul_f32 v1, v5, v1
  v_accvgpr_write_b32 a80, v1
  v_accvgpr_read_b32 v1, a81
  v_mul_f32 v1, v5, v1
  v_accvgpr_write_b32 a81, v1
  v_accvgpr_read_b32 v1, a82
  v_mul_f32 v1, v5, v1
  v_accvgpr_write_b32 a82, v1
  v_accvgpr_read_b32 v1, a83
  v_mul_f32 v1, v5, v1
  v_accvgpr_write_b32 a83, v1
  v_accvgpr_read_b32 v1, a96
  v_mul_f32 v1, v5, v1
  v_accvgpr_write_b32 a96, v1
  v_accvgpr_read_b32 v1, a97
  v_mul_f32 v1, v5, v1
  v_accvgpr_write_b32 a97, v1
  v_accvgpr_read_b32 v1, a98
  v_mul_f32 v1, v5, v1
  v_accvgpr_write_b32 a98, v1
  v_accvgpr_read_b32 v1, a99
  v_mul_f32 v1, v5, v1
  v_accvgpr_write_b32 a99, v1
  v_accvgpr_read_b32 v1, a112
  v_mul_f32 v1, v5, v1
  v_accvgpr_write_b32 a112, v1
  v_accvgpr_read_b32 v1, a113
  v_mul_f32 v1, v5, v1
  v_accvgpr_write_b32 a113, v1
  v_accvgpr_read_b32 v1, a114
  v_mul_f32 v1, v5, v1
  v_accvgpr_write_b32 a114, v1
  v_accvgpr_read_b32 v1, a115
  v_mul_f32 v1, v5, v1
  v_accvgpr_write_b32 a115, v1
  v_accvgpr_read_b32 v1, a128
  v_mul_f32 v1, v5, v1
  v_accvgpr_write_b32 a128, v1
  v_accvgpr_read_b32 v1, a129
  v_mul_f32 v1, v5, v1
  v_accvgpr_write_b32 a129, v1
  v_accvgpr_read_b32 v1, a130
  v_mul_f32 v1, v5, v1
  v_accvgpr_write_b32 a130, v1
  v_accvgpr_read_b32 v1, a131
  v_mul_f32 v1, v5, v1
  v_accvgpr_write_b32 a131, v1
  v_accvgpr_read_b32 v1, a144
  v_mul_f32 v1, v5, v1
  v_accvgpr_write_b32 a144, v1
  v_accvgpr_read_b32 v1, a145
  v_mul_f32 v1, v5, v1
  v_accvgpr_write_b32 a145, v1
  v_accvgpr_read_b32 v1, a146
  v_mul_f32 v1, v5, v1
  v_accvgpr_write_b32 a146, v1
  v_accvgpr_read_b32 v1, a147
  v_mul_f32 v1, v5, v1
  v_accvgpr_write_b32 a147, v1
  v_accvgpr_read_b32 v1, a160
  v_mul_f32 v1, v5, v1
  v_accvgpr_write_b32 a160, v1
  v_accvgpr_read_b32 v1, a161
  v_mul_f32 v1, v5, v1
  v_accvgpr_write_b32 a161, v1
  v_accvgpr_read_b32 v1, a162
  v_mul_f32 v1, v5, v1
  v_accvgpr_write_b32 a162, v1
  v_accvgpr_read_b32 v1, a163
  v_mul_f32 v1, v5, v1
  v_accvgpr_write_b32 a163, v1
  v_accvgpr_read_b32 v1, a176
  v_mul_f32 v1, v5, v1
  v_accvgpr_write_b32 a176, v1
  v_accvgpr_read_b32 v1, a177
  v_mul_f32 v1, v5, v1
  v_accvgpr_write_b32 a177, v1
  v_accvgpr_read_b32 v1, a178
  v_mul_f32 v1, v5, v1
  v_accvgpr_write_b32 a178, v1
  v_accvgpr_read_b32 v1, a179
  v_mul_f32 v1, v5, v1
  v_accvgpr_write_b32 a179, v1
  v_accvgpr_read_b32 v1, a192
  v_mul_f32 v1, v5, v1
  v_accvgpr_write_b32 a192, v1
  v_accvgpr_read_b32 v1, a193
  v_mul_f32 v1, v5, v1
  v_accvgpr_write_b32 a193, v1
  v_accvgpr_read_b32 v1, a194
  v_mul_f32 v1, v5, v1
  v_accvgpr_write_b32 a194, v1
  v_accvgpr_read_b32 v1, a195
  v_mul_f32 v1, v5, v1
  v_accvgpr_write_b32 a195, v1
  v_accvgpr_read_b32 v1, a208
  v_mul_f32 v1, v5, v1
  v_accvgpr_write_b32 a208, v1
  v_accvgpr_read_b32 v1, a209
  v_mul_f32 v1, v5, v1
  v_accvgpr_write_b32 a209, v1
  v_accvgpr_read_b32 v1, a210
  v_mul_f32 v1, v5, v1
  v_accvgpr_write_b32 a210, v1
  v_accvgpr_read_b32 v1, a211
  v_mul_f32 v1, v5, v1
  v_accvgpr_write_b32 a211, v1
  v_accvgpr_read_b32 v1, a224
  v_mul_f32 v1, v5, v1
  v_accvgpr_write_b32 a224, v1
  v_accvgpr_read_b32 v1, a225
  v_mul_f32 v1, v5, v1
  v_accvgpr_write_b32 a225, v1
  v_accvgpr_read_b32 v1, a226
  v_mul_f32 v1, v5, v1
  v_accvgpr_write_b32 a226, v1
  v_accvgpr_read_b32 v1, a227
  v_mul_f32 v1, v5, v1
  v_accvgpr_write_b32 a227, v1
  v_accvgpr_read_b32 v1, a240
  v_mul_f32 v1, v5, v1
  v_accvgpr_write_b32 a240, v1
  v_accvgpr_read_b32 v1, a241
  v_mul_f32 v1, v5, v1
  v_accvgpr_write_b32 a241, v1
  v_accvgpr_read_b32 v1, a242
  v_mul_f32 v1, v5, v1
  v_accvgpr_write_b32 a242, v1
  v_accvgpr_read_b32 v1, a243
  v_mul_f32 v1, v5, v1
  v_accvgpr_write_b32 a243, v1
  v_mul_f32 v120, v5, v120
  v_sub_f32 v48, v48, v4
  v_sub_f32 v16, v16, v4
  v_sub_f32 v32, v32, v4
  v_sub_f32 v49, v49, v4
  v_sub_f32 v17, v17, v4
  v_sub_f32 v33, v33, v4
  v_sub_f32 v50, v50, v4
  v_sub_f32 v18, v18, v4
  v_sub_f32 v34, v34, v4
  v_sub_f32 v51, v51, v4
  v_sub_f32 v19, v19, v4
  v_sub_f32 v35, v35, v4
  v_max3_f32 v4, v20, v21, v22
  v_max3_f32 v4, v4, v23, v36
  v_max3_f32 v4, v4, v37, v38
  v_max_f32 v4, v4, v39
  v_mov_b32 v5, v4
  s_nop 1
  v_permlane32_swap_b32 v4, v5
  s_nop 1
  v_max_f32 v4, v4, v5
  v_mov_b32 v5, v4
  s_nop 1
  v_permlane16_swap_b32 v4, v5
  s_nop 1
  v_max_f32 v4, v4, v5
  v_max_f32 v4, 0, v4
  v_exp_f32 v5, -v4
  s_nop 0
  v_accvgpr_read_b32 v1, a4
  v_mul_f32 v1, v5, v1
  v_accvgpr_write_b32 a4, v1
  v_accvgpr_read_b32 v1, a5
  v_mul_f32 v1, v5, v1
  v_accvgpr_write_b32 a5, v1
  v_accvgpr_read_b32 v1, a6
  v_mul_f32 v1, v5, v1
  v_accvgpr_write_b32 a6, v1
  v_accvgpr_read_b32 v1, a7
  v_mul_f32 v1, v5, v1
  v_accvgpr_write_b32 a7, v1
  v_accvgpr_read_b32 v1, a20
  v_mul_f32 v1, v5, v1
  v_accvgpr_write_b32 a20, v1
  v_accvgpr_read_b32 v1, a21
  v_mul_f32 v1, v5, v1
  v_accvgpr_write_b32 a21, v1
  v_accvgpr_read_b32 v1, a22
  v_mul_f32 v1, v5, v1
  v_accvgpr_write_b32 a22, v1
  v_accvgpr_read_b32 v1, a23
  v_mul_f32 v1, v5, v1
  v_accvgpr_write_b32 a23, v1
  v_accvgpr_read_b32 v1, a36
  v_mul_f32 v1, v5, v1
  v_accvgpr_write_b32 a36, v1
  v_accvgpr_read_b32 v1, a37
  v_mul_f32 v1, v5, v1
  v_accvgpr_write_b32 a37, v1
  v_accvgpr_read_b32 v1, a38
  v_mul_f32 v1, v5, v1
  v_accvgpr_write_b32 a38, v1
  v_accvgpr_read_b32 v1, a39
  v_mul_f32 v1, v5, v1
  v_accvgpr_write_b32 a39, v1
  v_accvgpr_read_b32 v1, a52
  v_mul_f32 v1, v5, v1
  v_accvgpr_write_b32 a52, v1
  v_accvgpr_read_b32 v1, a53
  v_mul_f32 v1, v5, v1
  v_accvgpr_write_b32 a53, v1
  v_accvgpr_read_b32 v1, a54
  v_mul_f32 v1, v5, v1
  v_accvgpr_write_b32 a54, v1
  v_accvgpr_read_b32 v1, a55
  v_mul_f32 v1, v5, v1
  v_accvgpr_write_b32 a55, v1
  v_accvgpr_read_b32 v1, a68
  v_mul_f32 v1, v5, v1
  v_accvgpr_write_b32 a68, v1
  v_accvgpr_read_b32 v1, a69
  v_mul_f32 v1, v5, v1
  v_accvgpr_write_b32 a69, v1
  v_accvgpr_read_b32 v1, a70
  v_mul_f32 v1, v5, v1
  v_accvgpr_write_b32 a70, v1
  v_accvgpr_read_b32 v1, a71
  v_mul_f32 v1, v5, v1
  v_accvgpr_write_b32 a71, v1
  v_accvgpr_read_b32 v1, a84
  v_mul_f32 v1, v5, v1
  v_accvgpr_write_b32 a84, v1
  v_accvgpr_read_b32 v1, a85
  v_mul_f32 v1, v5, v1
  v_accvgpr_write_b32 a85, v1
  v_accvgpr_read_b32 v1, a86
  v_mul_f32 v1, v5, v1
  v_accvgpr_write_b32 a86, v1
  v_accvgpr_read_b32 v1, a87
  v_mul_f32 v1, v5, v1
  v_accvgpr_write_b32 a87, v1
  v_accvgpr_read_b32 v1, a100
  v_mul_f32 v1, v5, v1
  v_accvgpr_write_b32 a100, v1
  v_accvgpr_read_b32 v1, a101
  v_mul_f32 v1, v5, v1
  v_accvgpr_write_b32 a101, v1
  v_accvgpr_read_b32 v1, a102
  v_mul_f32 v1, v5, v1
  v_accvgpr_write_b32 a102, v1
  v_accvgpr_read_b32 v1, a103
  v_mul_f32 v1, v5, v1
  v_accvgpr_write_b32 a103, v1
  v_accvgpr_read_b32 v1, a116
  v_mul_f32 v1, v5, v1
  v_accvgpr_write_b32 a116, v1
  v_accvgpr_read_b32 v1, a117
  v_mul_f32 v1, v5, v1
  v_accvgpr_write_b32 a117, v1
  v_accvgpr_read_b32 v1, a118
  v_mul_f32 v1, v5, v1
  v_accvgpr_write_b32 a118, v1
  v_accvgpr_read_b32 v1, a119
  v_mul_f32 v1, v5, v1
  v_accvgpr_write_b32 a119, v1
  v_accvgpr_read_b32 v1, a132
  v_mul_f32 v1, v5, v1
  v_accvgpr_write_b32 a132, v1
  v_accvgpr_read_b32 v1, a133
  v_mul_f32 v1, v5, v1
  v_accvgpr_write_b32 a133, v1
  v_accvgpr_read_b32 v1, a134
  v_mul_f32 v1, v5, v1
  v_accvgpr_write_b32 a134, v1
  v_accvgpr_read_b32 v1, a135
  v_mul_f32 v1, v5, v1
  v_accvgpr_write_b32 a135, v1
  v_accvgpr_read_b32 v1, a148
  v_mul_f32 v1, v5, v1
  v_accvgpr_write_b32 a148, v1
  v_accvgpr_read_b32 v1, a149
  v_mul_f32 v1, v5, v1
  v_accvgpr_write_b32 a149, v1
  v_accvgpr_read_b32 v1, a150
  v_mul_f32 v1, v5, v1
  v_accvgpr_write_b32 a150, v1
  v_accvgpr_read_b32 v1, a151
  v_mul_f32 v1, v5, v1
  v_accvgpr_write_b32 a151, v1
  v_accvgpr_read_b32 v1, a164
  v_mul_f32 v1, v5, v1
  v_accvgpr_write_b32 a164, v1
  v_accvgpr_read_b32 v1, a165
  v_mul_f32 v1, v5, v1
  v_accvgpr_write_b32 a165, v1
  v_accvgpr_read_b32 v1, a166
  v_mul_f32 v1, v5, v1
  v_accvgpr_write_b32 a166, v1
  v_accvgpr_read_b32 v1, a167
  v_mul_f32 v1, v5, v1
  v_accvgpr_write_b32 a167, v1
  v_accvgpr_read_b32 v1, a180
  v_mul_f32 v1, v5, v1
  v_accvgpr_write_b32 a180, v1
  v_accvgpr_read_b32 v1, a181
  v_mul_f32 v1, v5, v1
  v_accvgpr_write_b32 a181, v1
  v_accvgpr_read_b32 v1, a182
  v_mul_f32 v1, v5, v1
  v_accvgpr_write_b32 a182, v1
  v_accvgpr_read_b32 v1, a183
  v_mul_f32 v1, v5, v1
  v_accvgpr_write_b32 a183, v1
  v_accvgpr_read_b32 v1, a196
  v_mul_f32 v1, v5, v1
  v_accvgpr_write_b32 a196, v1
  v_accvgpr_read_b32 v1, a197
  v_mul_f32 v1, v5, v1
  v_accvgpr_write_b32 a197, v1
  v_accvgpr_read_b32 v1, a198
  v_mul_f32 v1, v5, v1
  v_accvgpr_write_b32 a198, v1
  v_accvgpr_read_b32 v1, a199
  v_mul_f32 v1, v5, v1
  v_accvgpr_write_b32 a199, v1
  v_accvgpr_read_b32 v1, a212
  v_mul_f32 v1, v5, v1
  v_accvgpr_write_b32 a212, v1
  v_accvgpr_read_b32 v1, a213
  v_mul_f32 v1, v5, v1
  v_accvgpr_write_b32 a213, v1
  v_accvgpr_read_b32 v1, a214
  v_mul_f32 v1, v5, v1
  v_accvgpr_write_b32 a214, v1
  v_accvgpr_read_b32 v1, a215
  v_mul_f32 v1, v5, v1
  v_accvgpr_write_b32 a215, v1
  v_accvgpr_read_b32 v1, a228
  v_mul_f32 v1, v5, v1
  v_accvgpr_write_b32 a228, v1
  v_accvgpr_read_b32 v1, a229
  v_mul_f32 v1, v5, v1
  v_accvgpr_write_b32 a229, v1
  v_accvgpr_read_b32 v1, a230
  v_mul_f32 v1, v5, v1
  v_accvgpr_write_b32 a230, v1
  v_accvgpr_read_b32 v1, a231
  v_mul_f32 v1, v5, v1
  v_accvgpr_write_b32 a231, v1
  v_accvgpr_read_b32 v1, a244
  v_mul_f32 v1, v5, v1
  v_accvgpr_write_b32 a244, v1
  v_accvgpr_read_b32 v1, a245
  v_mul_f32 v1, v5, v1
  v_accvgpr_write_b32 a245, v1
  v_accvgpr_read_b32 v1, a246
  v_mul_f32 v1, v5, v1
  v_accvgpr_write_b32 a246, v1
  v_accvgpr_read_b32 v1, a247
  v_mul_f32 v1, v5, v1
  v_accvgpr_write_b32 a247, v1
  v_mul_f32 v121, v5, v121
  v_sub_f32 v52, v52, v4
  v_sub_f32 v20, v20, v4
  v_sub_f32 v36, v36, v4
  v_sub_f32 v53, v53, v4
  v_sub_f32 v21, v21, v4
  v_sub_f32 v37, v37, v4
  v_sub_f32 v54, v54, v4
  v_sub_f32 v22, v22, v4
  v_sub_f32 v38, v38, v4
  v_sub_f32 v55, v55, v4
  v_sub_f32 v23, v23, v4
  v_sub_f32 v39, v39, v4
  v_max3_f32 v4, v24, v25, v26
  v_max3_f32 v4, v4, v27, v40
  v_max3_f32 v4, v4, v41, v42
  v_max_f32 v4, v4, v43
  v_mov_b32 v5, v4
  s_nop 1
  v_permlane32_swap_b32 v4, v5
  s_nop 1
  v_max_f32 v4, v4, v5
  v_mov_b32 v5, v4
  s_nop 1
  v_permlane16_swap_b32 v4, v5
  s_nop 1
  v_max_f32 v4, v4, v5
  v_max_f32 v4, 0, v4
  v_exp_f32 v5, -v4
  s_nop 0
  v_accvgpr_read_b32 v1, a8
  v_mul_f32 v1, v5, v1
  v_accvgpr_write_b32 a8, v1
  v_accvgpr_read_b32 v1, a9
  v_mul_f32 v1, v5, v1
  v_accvgpr_write_b32 a9, v1
  v_accvgpr_read_b32 v1, a10
  v_mul_f32 v1, v5, v1
  v_accvgpr_write_b32 a10, v1
  v_accvgpr_read_b32 v1, a11
  v_mul_f32 v1, v5, v1
  v_accvgpr_write_b32 a11, v1
  v_accvgpr_read_b32 v1, a24
  v_mul_f32 v1, v5, v1
  v_accvgpr_write_b32 a24, v1
  v_accvgpr_read_b32 v1, a25
  v_mul_f32 v1, v5, v1
  v_accvgpr_write_b32 a25, v1
  v_accvgpr_read_b32 v1, a26
  v_mul_f32 v1, v5, v1
  v_accvgpr_write_b32 a26, v1
  v_accvgpr_read_b32 v1, a27
  v_mul_f32 v1, v5, v1
  v_accvgpr_write_b32 a27, v1
  v_accvgpr_read_b32 v1, a40
  v_mul_f32 v1, v5, v1
  v_accvgpr_write_b32 a40, v1
  v_accvgpr_read_b32 v1, a41
  v_mul_f32 v1, v5, v1
  v_accvgpr_write_b32 a41, v1
  v_accvgpr_read_b32 v1, a42
  v_mul_f32 v1, v5, v1
  v_accvgpr_write_b32 a42, v1
  v_accvgpr_read_b32 v1, a43
  v_mul_f32 v1, v5, v1
  v_accvgpr_write_b32 a43, v1
  v_accvgpr_read_b32 v1, a56
  v_mul_f32 v1, v5, v1
  v_accvgpr_write_b32 a56, v1
  v_accvgpr_read_b32 v1, a57
  v_mul_f32 v1, v5, v1
  v_accvgpr_write_b32 a57, v1
  v_accvgpr_read_b32 v1, a58
  v_mul_f32 v1, v5, v1
  v_accvgpr_write_b32 a58, v1
  v_accvgpr_read_b32 v1, a59
  v_mul_f32 v1, v5, v1
  v_accvgpr_write_b32 a59, v1
  v_accvgpr_read_b32 v1, a72
  v_mul_f32 v1, v5, v1
  v_accvgpr_write_b32 a72, v1
  v_accvgpr_read_b32 v1, a73
  v_mul_f32 v1, v5, v1
  v_accvgpr_write_b32 a73, v1
  v_accvgpr_read_b32 v1, a74
  v_mul_f32 v1, v5, v1
  v_accvgpr_write_b32 a74, v1
  v_accvgpr_read_b32 v1, a75
  v_mul_f32 v1, v5, v1
  v_accvgpr_write_b32 a75, v1
  v_accvgpr_read_b32 v1, a88
  v_mul_f32 v1, v5, v1
  v_accvgpr_write_b32 a88, v1
  v_accvgpr_read_b32 v1, a89
  v_mul_f32 v1, v5, v1
  v_accvgpr_write_b32 a89, v1
  v_accvgpr_read_b32 v1, a90
  v_mul_f32 v1, v5, v1
  v_accvgpr_write_b32 a90, v1
  v_accvgpr_read_b32 v1, a91
  v_mul_f32 v1, v5, v1
  v_accvgpr_write_b32 a91, v1
  v_accvgpr_read_b32 v1, a104
  v_mul_f32 v1, v5, v1
  v_accvgpr_write_b32 a104, v1
  v_accvgpr_read_b32 v1, a105
  v_mul_f32 v1, v5, v1
  v_accvgpr_write_b32 a105, v1
  v_accvgpr_read_b32 v1, a106
  v_mul_f32 v1, v5, v1
  v_accvgpr_write_b32 a106, v1
  v_accvgpr_read_b32 v1, a107
  v_mul_f32 v1, v5, v1
  v_accvgpr_write_b32 a107, v1
  v_accvgpr_read_b32 v1, a120
  v_mul_f32 v1, v5, v1
  v_accvgpr_write_b32 a120, v1
  v_accvgpr_read_b32 v1, a121
  v_mul_f32 v1, v5, v1
  v_accvgpr_write_b32 a121, v1
  v_accvgpr_read_b32 v1, a122
  v_mul_f32 v1, v5, v1
  v_accvgpr_write_b32 a122, v1
  v_accvgpr_read_b32 v1, a123
  v_mul_f32 v1, v5, v1
  v_accvgpr_write_b32 a123, v1
  v_accvgpr_read_b32 v1, a136
  v_mul_f32 v1, v5, v1
  v_accvgpr_write_b32 a136, v1
  v_accvgpr_read_b32 v1, a137
  v_mul_f32 v1, v5, v1
  v_accvgpr_write_b32 a137, v1
  v_accvgpr_read_b32 v1, a138
  v_mul_f32 v1, v5, v1
  v_accvgpr_write_b32 a138, v1
  v_accvgpr_read_b32 v1, a139
  v_mul_f32 v1, v5, v1
  v_accvgpr_write_b32 a139, v1
  v_accvgpr_read_b32 v1, a152
  v_mul_f32 v1, v5, v1
  v_accvgpr_write_b32 a152, v1
  v_accvgpr_read_b32 v1, a153
  v_mul_f32 v1, v5, v1
  v_accvgpr_write_b32 a153, v1
  v_accvgpr_read_b32 v1, a154
  v_mul_f32 v1, v5, v1
  v_accvgpr_write_b32 a154, v1
  v_accvgpr_read_b32 v1, a155
  v_mul_f32 v1, v5, v1
  v_accvgpr_write_b32 a155, v1
  v_accvgpr_read_b32 v1, a168
  v_mul_f32 v1, v5, v1
  v_accvgpr_write_b32 a168, v1
  v_accvgpr_read_b32 v1, a169
  v_mul_f32 v1, v5, v1
  v_accvgpr_write_b32 a169, v1
  v_accvgpr_read_b32 v1, a170
  v_mul_f32 v1, v5, v1
  v_accvgpr_write_b32 a170, v1
  v_accvgpr_read_b32 v1, a171
  v_mul_f32 v1, v5, v1
  v_accvgpr_write_b32 a171, v1
  v_accvgpr_read_b32 v1, a184
  v_mul_f32 v1, v5, v1
  v_accvgpr_write_b32 a184, v1
  v_accvgpr_read_b32 v1, a185
  v_mul_f32 v1, v5, v1
  v_accvgpr_write_b32 a185, v1
  v_accvgpr_read_b32 v1, a186
  v_mul_f32 v1, v5, v1
  v_accvgpr_write_b32 a186, v1
  v_accvgpr_read_b32 v1, a187
  v_mul_f32 v1, v5, v1
  v_accvgpr_write_b32 a187, v1
  v_accvgpr_read_b32 v1, a200
  v_mul_f32 v1, v5, v1
  v_accvgpr_write_b32 a200, v1
  v_accvgpr_read_b32 v1, a201
  v_mul_f32 v1, v5, v1
  v_accvgpr_write_b32 a201, v1
  v_accvgpr_read_b32 v1, a202
  v_mul_f32 v1, v5, v1
  v_accvgpr_write_b32 a202, v1
  v_accvgpr_read_b32 v1, a203
  v_mul_f32 v1, v5, v1
  v_accvgpr_write_b32 a203, v1
  v_accvgpr_read_b32 v1, a216
  v_mul_f32 v1, v5, v1
  v_accvgpr_write_b32 a216, v1
  v_accvgpr_read_b32 v1, a217
  v_mul_f32 v1, v5, v1
  v_accvgpr_write_b32 a217, v1
  v_accvgpr_read_b32 v1, a218
  v_mul_f32 v1, v5, v1
  v_accvgpr_write_b32 a218, v1
  v_accvgpr_read_b32 v1, a219
  v_mul_f32 v1, v5, v1
  v_accvgpr_write_b32 a219, v1
  v_accvgpr_read_b32 v1, a232
  v_mul_f32 v1, v5, v1
  v_accvgpr_write_b32 a232, v1
  v_accvgpr_read_b32 v1, a233
  v_mul_f32 v1, v5, v1
  v_accvgpr_write_b32 a233, v1
  v_accvgpr_read_b32 v1, a234
  v_mul_f32 v1, v5, v1
  v_accvgpr_write_b32 a234, v1
  v_accvgpr_read_b32 v1, a235
  v_mul_f32 v1, v5, v1
  v_accvgpr_write_b32 a235, v1
  v_accvgpr_read_b32 v1, a248
  v_mul_f32 v1, v5, v1
  v_accvgpr_write_b32 a248, v1
  v_accvgpr_read_b32 v1, a249
  v_mul_f32 v1, v5, v1
  v_accvgpr_write_b32 a249, v1
  v_accvgpr_read_b32 v1, a250
  v_mul_f32 v1, v5, v1
  v_accvgpr_write_b32 a250, v1
  v_accvgpr_read_b32 v1, a251
  v_mul_f32 v1, v5, v1
  v_accvgpr_write_b32 a251, v1
  v_mul_f32 v122, v5, v122
  v_sub_f32 v56, v56, v4
  v_sub_f32 v24, v24, v4
  v_sub_f32 v40, v40, v4
  v_sub_f32 v57, v57, v4
  v_sub_f32 v25, v25, v4
  v_sub_f32 v41, v41, v4
  v_sub_f32 v58, v58, v4
  v_sub_f32 v26, v26, v4
  v_sub_f32 v42, v42, v4
  v_sub_f32 v59, v59, v4
  v_sub_f32 v27, v27, v4
  v_sub_f32 v43, v43, v4
  v_max3_f32 v4, v28, v29, v30
  v_max3_f32 v4, v4, v31, v44
  v_max3_f32 v4, v4, v45, v46
  v_max_f32 v4, v4, v47
  v_mov_b32 v5, v4
  s_nop 1
  v_permlane32_swap_b32 v4, v5
  s_nop 1
  v_max_f32 v4, v4, v5
  v_mov_b32 v5, v4
  s_nop 1
  v_permlane16_swap_b32 v4, v5
  s_nop 1
  v_max_f32 v4, v4, v5
  v_max_f32 v4, 0, v4
  v_exp_f32 v5, -v4
  s_nop 0
  v_accvgpr_read_b32 v1, a12
  v_mul_f32 v1, v5, v1
  v_accvgpr_write_b32 a12, v1
  v_accvgpr_read_b32 v1, a13
  v_mul_f32 v1, v5, v1
  v_accvgpr_write_b32 a13, v1
  v_accvgpr_read_b32 v1, a14
  v_mul_f32 v1, v5, v1
  v_accvgpr_write_b32 a14, v1
  v_accvgpr_read_b32 v1, a15
  v_mul_f32 v1, v5, v1
  v_accvgpr_write_b32 a15, v1
  v_accvgpr_read_b32 v1, a28
  v_mul_f32 v1, v5, v1
  v_accvgpr_write_b32 a28, v1
  v_accvgpr_read_b32 v1, a29
  v_mul_f32 v1, v5, v1
  v_accvgpr_write_b32 a29, v1
  v_accvgpr_read_b32 v1, a30
  v_mul_f32 v1, v5, v1
  v_accvgpr_write_b32 a30, v1
  v_accvgpr_read_b32 v1, a31
  v_mul_f32 v1, v5, v1
  v_accvgpr_write_b32 a31, v1
  v_accvgpr_read_b32 v1, a44
  v_mul_f32 v1, v5, v1
  v_accvgpr_write_b32 a44, v1
  v_accvgpr_read_b32 v1, a45
  v_mul_f32 v1, v5, v1
  v_accvgpr_write_b32 a45, v1
  v_accvgpr_read_b32 v1, a46
  v_mul_f32 v1, v5, v1
  v_accvgpr_write_b32 a46, v1
  v_accvgpr_read_b32 v1, a47
  v_mul_f32 v1, v5, v1
  v_accvgpr_write_b32 a47, v1
  v_accvgpr_read_b32 v1, a60
  v_mul_f32 v1, v5, v1
  v_accvgpr_write_b32 a60, v1
  v_accvgpr_read_b32 v1, a61
  v_mul_f32 v1, v5, v1
  v_accvgpr_write_b32 a61, v1
  v_accvgpr_read_b32 v1, a62
  v_mul_f32 v1, v5, v1
  v_accvgpr_write_b32 a62, v1
  v_accvgpr_read_b32 v1, a63
  v_mul_f32 v1, v5, v1
  v_accvgpr_write_b32 a63, v1
  v_accvgpr_read_b32 v1, a76
  v_mul_f32 v1, v5, v1
  v_accvgpr_write_b32 a76, v1
  v_accvgpr_read_b32 v1, a77
  v_mul_f32 v1, v5, v1
  v_accvgpr_write_b32 a77, v1
  v_accvgpr_read_b32 v1, a78
  v_mul_f32 v1, v5, v1
  v_accvgpr_write_b32 a78, v1
  v_accvgpr_read_b32 v1, a79
  v_mul_f32 v1, v5, v1
  v_accvgpr_write_b32 a79, v1
  v_accvgpr_read_b32 v1, a92
  v_mul_f32 v1, v5, v1
  v_accvgpr_write_b32 a92, v1
  v_accvgpr_read_b32 v1, a93
  v_mul_f32 v1, v5, v1
  v_accvgpr_write_b32 a93, v1
  v_accvgpr_read_b32 v1, a94
  v_mul_f32 v1, v5, v1
  v_accvgpr_write_b32 a94, v1
  v_accvgpr_read_b32 v1, a95
  v_mul_f32 v1, v5, v1
  v_accvgpr_write_b32 a95, v1
  v_accvgpr_read_b32 v1, a108
  v_mul_f32 v1, v5, v1
  v_accvgpr_write_b32 a108, v1
  v_accvgpr_read_b32 v1, a109
  v_mul_f32 v1, v5, v1
  v_accvgpr_write_b32 a109, v1
  v_accvgpr_read_b32 v1, a110
  v_mul_f32 v1, v5, v1
  v_accvgpr_write_b32 a110, v1
  v_accvgpr_read_b32 v1, a111
  v_mul_f32 v1, v5, v1
  v_accvgpr_write_b32 a111, v1
  v_accvgpr_read_b32 v1, a124
  v_mul_f32 v1, v5, v1
  v_accvgpr_write_b32 a124, v1
  v_accvgpr_read_b32 v1, a125
  v_mul_f32 v1, v5, v1
  v_accvgpr_write_b32 a125, v1
  v_accvgpr_read_b32 v1, a126
  v_mul_f32 v1, v5, v1
  v_accvgpr_write_b32 a126, v1
  v_accvgpr_read_b32 v1, a127
  v_mul_f32 v1, v5, v1
  v_accvgpr_write_b32 a127, v1
  v_accvgpr_read_b32 v1, a140
  v_mul_f32 v1, v5, v1
  v_accvgpr_write_b32 a140, v1
  v_accvgpr_read_b32 v1, a141
  v_mul_f32 v1, v5, v1
  v_accvgpr_write_b32 a141, v1
  v_accvgpr_read_b32 v1, a142
  v_mul_f32 v1, v5, v1
  v_accvgpr_write_b32 a142, v1
  v_accvgpr_read_b32 v1, a143
  v_mul_f32 v1, v5, v1
  v_accvgpr_write_b32 a143, v1
  v_accvgpr_read_b32 v1, a156
  v_mul_f32 v1, v5, v1
  v_accvgpr_write_b32 a156, v1
  v_accvgpr_read_b32 v1, a157
  v_mul_f32 v1, v5, v1
  v_accvgpr_write_b32 a157, v1
  v_accvgpr_read_b32 v1, a158
  v_mul_f32 v1, v5, v1
  v_accvgpr_write_b32 a158, v1
  v_accvgpr_read_b32 v1, a159
  v_mul_f32 v1, v5, v1
  v_accvgpr_write_b32 a159, v1
  v_accvgpr_read_b32 v1, a172
  v_mul_f32 v1, v5, v1
  v_accvgpr_write_b32 a172, v1
  v_accvgpr_read_b32 v1, a173
  v_mul_f32 v1, v5, v1
  v_accvgpr_write_b32 a173, v1
  v_accvgpr_read_b32 v1, a174
  v_mul_f32 v1, v5, v1
  v_accvgpr_write_b32 a174, v1
  v_accvgpr_read_b32 v1, a175
  v_mul_f32 v1, v5, v1
  v_accvgpr_write_b32 a175, v1
  v_accvgpr_read_b32 v1, a188
  v_mul_f32 v1, v5, v1
  v_accvgpr_write_b32 a188, v1
  v_accvgpr_read_b32 v1, a189
  v_mul_f32 v1, v5, v1
  v_accvgpr_write_b32 a189, v1
  v_accvgpr_read_b32 v1, a190
  v_mul_f32 v1, v5, v1
  v_accvgpr_write_b32 a190, v1
  v_accvgpr_read_b32 v1, a191
  v_mul_f32 v1, v5, v1
  v_accvgpr_write_b32 a191, v1
  v_accvgpr_read_b32 v1, a204
  v_mul_f32 v1, v5, v1
  v_accvgpr_write_b32 a204, v1
  v_accvgpr_read_b32 v1, a205
  v_mul_f32 v1, v5, v1
  v_accvgpr_write_b32 a205, v1
  v_accvgpr_read_b32 v1, a206
  v_mul_f32 v1, v5, v1
  v_accvgpr_write_b32 a206, v1
  v_accvgpr_read_b32 v1, a207
  v_mul_f32 v1, v5, v1
  v_accvgpr_write_b32 a207, v1
  v_accvgpr_read_b32 v1, a220
  v_mul_f32 v1, v5, v1
  v_accvgpr_write_b32 a220, v1
  v_accvgpr_read_b32 v1, a221
  v_mul_f32 v1, v5, v1
  v_accvgpr_write_b32 a221, v1
  v_accvgpr_read_b32 v1, a222
  v_mul_f32 v1, v5, v1
  v_accvgpr_write_b32 a222, v1
  v_accvgpr_read_b32 v1, a223
  v_mul_f32 v1, v5, v1
  v_accvgpr_write_b32 a223, v1
  v_accvgpr_read_b32 v1, a236
  v_mul_f32 v1, v5, v1
  v_accvgpr_write_b32 a236, v1
  v_accvgpr_read_b32 v1, a237
  v_mul_f32 v1, v5, v1
  v_accvgpr_write_b32 a237, v1
  v_accvgpr_read_b32 v1, a238
  v_mul_f32 v1, v5, v1
  v_accvgpr_write_b32 a238, v1
  v_accvgpr_read_b32 v1, a239
  v_mul_f32 v1, v5, v1
  v_accvgpr_write_b32 a239, v1
  v_accvgpr_read_b32 v1, a252
  v_mul_f32 v1, v5, v1
  v_accvgpr_write_b32 a252, v1
  v_accvgpr_read_b32 v1, a253
  v_mul_f32 v1, v5, v1
  v_accvgpr_write_b32 a253, v1
  v_accvgpr_read_b32 v1, a254
  v_mul_f32 v1, v5, v1
  v_accvgpr_write_b32 a254, v1
  v_accvgpr_read_b32 v1, a255
  v_mul_f32 v1, v5, v1
  v_accvgpr_write_b32 a255, v1
  v_mul_f32 v123, v5, v123
  v_sub_f32 v60, v60, v4
  v_sub_f32 v28, v28, v4
  v_sub_f32 v44, v44, v4
  v_sub_f32 v61, v61, v4
  v_sub_f32 v29, v29, v4
  v_sub_f32 v45, v45, v4
  v_sub_f32 v62, v62, v4
  v_sub_f32 v30, v30, v4
  v_sub_f32 v46, v46, v4
  v_sub_f32 v63, v63, v4
  v_sub_f32 v31, v31, v4
  v_sub_f32 v47, v47, v4
  v_exp_f32 v112, v16
  s_nop 0
  v_exp_f32 v113, v17
  s_nop 0
  v_exp_f32 v114, v18
  s_nop 0
  v_exp_f32 v115, v19
  s_nop 0
  v_add_f32 v116, v112, v113
  v_cvt_pk_bf16_f32 v80, v112, v113
  v_exp_f32 v112, v20
  s_nop 0
  v_exp_f32 v113, v21
  s_nop 0
  v_add_f32 v116, v116, v114
  v_add_f32 v116, v116, v115
  v_cvt_pk_bf16_f32 v81, v114, v115
  v_exp_f32 v114, v22
  s_nop 0
  v_exp_f32 v115, v23
  s_nop 0
  v_add_f32 v117, v112, v113
  v_cvt_pk_bf16_f32 v84, v112, v113
  v_exp_f32 v112, v24
  s_nop 0
  v_exp_f32 v113, v25
  s_nop 0
  v_add_f32 v117, v117, v114
  v_add_f32 v117, v117, v115
  v_cvt_pk_bf16_f32 v85, v114, v115
  v_exp_f32 v114, v26
  s_nop 0
  v_exp_f32 v115, v27
  s_nop 0
  v_add_f32 v118, v112, v113
  v_cvt_pk_bf16_f32 v88, v112, v113
  v_exp_f32 v112, v28
  s_nop 0
  v_exp_f32 v113, v29
  s_nop 0
  v_add_f32 v118, v118, v114
  v_add_f32 v118, v118, v115
  v_cvt_pk_bf16_f32 v89, v114, v115
  v_exp_f32 v114, v30
  s_nop 0
  v_exp_f32 v115, v31
  s_nop 0
  v_add_f32 v119, v112, v113
  v_cvt_pk_bf16_f32 v92, v112, v113
  v_add_f32 v119, v119, v114
  v_add_f32 v119, v119, v115
  v_cvt_pk_bf16_f32 v93, v114, v115
  v_exp_f32 v112, v32
  s_nop 0
  v_exp_f32 v113, v33
  s_nop 0
  v_exp_f32 v114, v34
  s_nop 0
  v_exp_f32 v115, v35
  s_nop 0
  v_add_f32 v116, v116, v112
  v_add_f32 v116, v116, v113
  v_cvt_pk_bf16_f32 v82, v112, v113
  v_exp_f32 v112, v36
  s_nop 0
  v_exp_f32 v113, v37
  s_nop 0
  v_add_f32 v116, v116, v114
  v_add_f32 v116, v116, v115
  v_cvt_pk_bf16_f32 v83, v114, v115
  v_exp_f32 v114, v38
  s_nop 0
  v_exp_f32 v115, v39
  s_nop 0
  v_add_f32 v117, v117, v112
  v_add_f32 v117, v117, v113
  v_cvt_pk_bf16_f32 v86, v112, v113
  v_exp_f32 v112, v40
  s_nop 0
  v_exp_f32 v113, v41
  s_nop 0
  v_add_f32 v117, v117, v114
  v_add_f32 v117, v117, v115
  v_cvt_pk_bf16_f32 v87, v114, v115
  v_exp_f32 v114, v42
  s_nop 0
  v_exp_f32 v115, v43
  s_nop 0
  v_add_f32 v118, v118, v112
  v_add_f32 v118, v118, v113
  v_cvt_pk_bf16_f32 v90, v112, v113
  v_exp_f32 v112, v44
  s_nop 0
  v_exp_f32 v113, v45
  s_nop 0
  v_add_f32 v118, v118, v114
  v_add_f32 v118, v118, v115
  v_cvt_pk_bf16_f32 v91, v114, v115
  v_exp_f32 v114, v46
  s_nop 0
  v_exp_f32 v115, v47
  s_nop 0
  v_add_f32 v119, v119, v112
  v_add_f32 v119, v119, v113
  v_cvt_pk_bf16_f32 v94, v112, v113
  v_add_f32 v119, v119, v114
  v_add_f32 v119, v119, v115
  v_cvt_pk_bf16_f32 v95, v114, v115
  s_nop 3
  s_setpc_b64 s[30:31]
K1_END:
ALL_END:
.section .rodata,"a"
.p2align 6
.amdhsa_kernel mod_kernel
  .amdhsa_next_free_vgpr 96
  .amdhsa_next_free_sgpr 40
  .amdhsa_accum_offset 96
  .amdhsa_group_segment_fixed_size 0
  .amdhsa_kernarg_size 120
  .amdhsa_user_sgpr_count 2
  .amdhsa_user_sgpr_kernarg_segment_ptr 1
  .amdhsa_system_sgpr_workgroup_id_x 1
  .amdhsa_float_denorm_mode_32 3
.end_amdhsa_kernel
.text
.section .rodata,"a"
.p2align 6
.amdhsa_kernel attn_kernel
  .amdhsa_next_free_vgpr 512
  .amdhsa_next_free_sgpr 102
  .amdhsa_accum_offset 256
  .amdhsa_group_segment_fixed_size 0
  .amdhsa_kernarg_size 120
  .amdhsa_user_sgpr_count 2
  .amdhsa_user_sgpr_kernarg_segment_ptr 1
  .amdhsa_system_sgpr_workgroup_id_x 1
  .amdhsa_float_denorm_mode_32 3
.end_amdhsa_kernel
.text
```
